```python
import torch

def _softmax(x, axis=-1):
    return torch.softmax(x, dim=axis)
def _gelu(x):
    return torch.nn.functional.gelu(x, approximate="tanh")
def _silu(x):
    return torch.nn.functional.silu(x)
def _sigmoid(x):
    return torch.sigmoid(x)
def _layernorm(x, axis=-1, eps=1e-5):
    m = x.mean(dim=axis, keepdim=True)
    v = x.var(dim=axis, keepdim=True, unbiased=False)
    return (x - m) / torch.sqrt(v + eps)
def _scatter_add(tgt, idx, src, axis=0):
    return tgt.clone().index_add_(axis, idx, src)
def _segment_sum(src, seg, n):
    out = torch.zeros((n,) + src.shape[1:], dtype=src.dtype)
    return out.index_add_(0, seg, src)
def _pad(x, pw):
    flat = tuple(v for pair in reversed(pw) for v in pair)
    return torch.nn.functional.pad(x, flat)

kernel_name = 'interleave_layers__ssm_conv_h3__glu_gated_reglu__prompt'

def setup_inputs():

    _w = (lambda a: (lambda t: t.to(torch.bfloat16) if t.is_floating_point() else t)(torch.as_tensor(a)))
    def _A_setup():
        B, S, D = 1, 2048, 640
        ks = 4
        return {
            "q": _w((lambda *s: torch.randn(*s, dtype=torch.bfloat16) * 0.05)(B, S, D)),
            "k": _w((lambda *s: torch.randn(*s, dtype=torch.bfloat16) * 0.2)(B, S, D)),
            "v": _w((lambda *s: torch.randn(*s, dtype=torch.bfloat16) * 0.2)(B, S, D)),
            "shift_k": _w((lambda *s: torch.randn(*s, dtype=torch.bfloat16) * 0.2)(D, ks) * 0.5),
            "ssm_k": _w((lambda *s: torch.randn(*s, dtype=torch.bfloat16) * 0.8)(D, S) * (1.0 / S ** 0.5)),
            "ssm_D": _w((lambda *s: torch.randn(*s, dtype=torch.bfloat16) * 0.2)(D)),
        }
    _A_in = _A_setup()

    def _B_setup():
        B, S, D, F = 1, 2048, 640, 1536
        return {
            "x": _w((lambda *s: torch.randn(*s, dtype=torch.bfloat16) * 0.05)(B, S, D)),
            "W_gate": _w((lambda *s: torch.randn(*s, dtype=torch.bfloat16) * 0.4)(D, F) * (2.0 / D) ** 0.5),
            "W_up": _w((lambda *s: torch.randn(*s, dtype=torch.bfloat16) * 0.4)(D, F) * (2.0 / D) ** 0.5),
            "W_down": _w((lambda *s: torch.randn(*s, dtype=torch.bfloat16) * 0.4)(F, D) * (1.0 / F) ** 0.5),
        }
    _B_in = _B_setup()

    return {
        "A_q": _A_in["q"],
        "A_k": _A_in["k"],
        "A_v": _A_in["v"],
        "A_shift_k": _A_in["shift_k"],
        "A_ssm_k": _A_in["ssm_k"],
        "A_ssm_D": _A_in["ssm_D"],
        "B_x": _B_in["x"],
        "B_W_gate": _B_in["W_gate"],
        "B_W_up": _B_in["W_up"],
        "B_W_down": _B_in["W_down"],
    }

def reference(A_q, A_k, A_v, A_shift_k, A_ssm_k, A_ssm_D, B_x, B_W_gate, B_W_up, B_W_down):
    def _A_ref(q, k, v, shift_k, ssm_k, ssm_D):
        B, S, D = q.shape
        ks = shift_k.shape[-1]
        k_pad = _pad(k, ((0, 0), (ks - 1, 0), (0, 0)))
        k_shift = torch.zeros_like(k)
        for t in range(ks):
            k_shift = k_shift + k_pad[:, t:t + S, :] * shift_k[:, ks - 1 - t][None, None, :]
        kv = k_shift * v
        L = 2 * S
        kv_pad = _pad(kv, ((0, 0), (0, S), (0, 0)))
        kf_pad = _pad(ssm_k, ((0, 0), (0, S)))
        kv_f = (lambda x, axes=(-2,-1): torch.fft.rfft2(x.float(), dim=axes))(kv_pad[:, None, :, :], axes=(1, 2))
        kf_f = (lambda x, axes=(-2,-1): torch.fft.rfft2(x.float(), dim=axes))(kf_pad[:, None, :], axes=(1, 2))
        kf_f = (lambda x, *d: x.permute(*d))(kf_f, 1, 2, 0)
        y_f = kv_f * kf_f[None, :, :, :]
        y = (lambda x, s, axes=(-2,-1): torch.fft.irfft2(x, s=s, dim=axes).to(torch.bfloat16))(y_f, (1, L), axes=(1, 2))[:, 0, :S, :]
        y = y + kv * ssm_D[None, None, :]
        return q * y

    def _B_ref(x, W_gate, W_up, W_down):
        gate = torch.einsum("bsd,df->bsf", x, W_gate)
        up = torch.einsum("bsd,df->bsf", x, W_up)
        gate = gate * (lambda x, dt: x.to(dt))(gate > 0, gate.dtype)
        h = gate * up
        return torch.einsum("bsf,fd->bsd", h, W_down)

    x = A_q
    x = x + _A_ref(_layernorm(x, axis=-1), A_k, A_v, A_shift_k, A_ssm_k, A_ssm_D)
    x = x + _B_ref(_layernorm(x, axis=-1), B_W_gate, B_W_up, B_W_down)
    x = x + _A_ref(_layernorm(x, axis=-1), A_k, A_v, A_shift_k, A_ssm_k, A_ssm_D)
    x = x + _B_ref(_layernorm(x, axis=-1), B_W_gate, B_W_up, B_W_down)
    return x
```

```asm
; @launch grid=(256,1,1) block=(256,1,1) lds=163840
.amdgcn_target "amdgcn-amd-amdhsa--gfx950"
.text
.globl interleave_layers__ssm_conv_h3__glu_gated_reglu__prompt_kernel
.p2align 8
.type interleave_layers__ssm_conv_h3__glu_gated_reglu__prompt_kernel,@function
interleave_layers__ssm_conv_h3__glu_gated_reglu__prompt_kernel:
  s_cmp_ge_u32 s2, 256
  s_cbranch_scc1 L_exit
  s_load_dwordx16 s[44:59], s[0:1], 0
  s_load_dwordx8 s[20:27], s[0:1], 64
  s_load_dwordx2 s[4:5], s[0:1], 96
  v_lshrrev_b32 v3, 6, v0
  v_and_b32 v0, 63, v0
  v_readfirstlane_b32 s42, v3
  s_and_b32 s40, s2, 7
  s_lshr_b32 s41, s2, 3
  v_lshlrev_b32 v2, 4, v0
  s_getpc_b64 s[60:61]
L_pc:
  s_lshl_b32 s68, s42, 3
  s_add_u32 s68, s68, s41
  s_and_b32 s68, s68, 31
  v_min_u32 v4, (L_r1_f-L_pc)/4096+2, v0
  v_lshl_add_u32 v4, v4, 5, s68
  v_lshlrev_b32 v4, 7, v4
  v_mov_b32 v5, s61
  v_add_co_u32 v4, vcc, s60, v4
  s_nop 1
  v_addc_co_u32 v5, vcc, 0, v5, vcc
  global_load_dword v92, v[4:5], off
  s_lshl_b32 s60, s41, 2
  s_add_u32 s60, s60, s42
  s_mul_i32 s60, s60, 20480
  s_mul_i32 s61, s40, 160
  s_add_u32 s60, s60, s61
  s_movk_i32 s62, 1120
  v_add_u32 v5, s60, v2
  v_add_u32 v3, 0, v0
  v_mul_u32_u24 v3, 6554, v3
  v_lshrrev_b32 v3, 16, v3
  v_mad_u32_u24 v3, v3, s62, v5
  v_add_u32 v80, 0, v3
  v_add_u32 v84, -3840, v3
  v_add_u32 v3, 64, v0
  v_mul_u32_u24 v3, 6554, v3
  v_lshrrev_b32 v3, 16, v3
  v_mad_u32_u24 v3, v3, s62, v5
  v_add_u32 v81, 1024, v3
  v_add_u32 v85, -2816, v3
  v_add_u32 v3, 128, v0
  v_mul_u32_u24 v3, 6554, v3
  v_lshrrev_b32 v3, 16, v3
  v_mad_u32_u24 v3, v3, s62, v5
  v_add_u32 v82, 2048, v3
  v_add_u32 v86, -1792, v3
  v_mov_b32 v7, 0x80000000
  v_cmp_gt_u32 vcc, 32, v0
  s_mul_i32 s61, s42, 6144
  s_mul_i32 s63, s40, 640
  v_cndmask_b32 v82, v7, v82, vcc
  s_mov_b32 s14, 2621440
  s_mov_b32 s15, 0x20000
  s_mov_b32 s18, 2621440
  s_mov_b32 s19, 0x20000
  s_mov_b32 s38, 5120
  s_mov_b32 s39, 0x20000
  s_waitcnt lgkmcnt(0)
  s_mov_b64 s[12:13], s[46:47]
  s_mov_b64 s[36:37], s[50:51]
  s_mov_b64 s[16:17], s[48:49]
  s_add_u32 m0, s61, 0
  s_nop 0
  buffer_load_dwordx4 v84, s[12:15], 0 offen nt lds
  s_add_u32 m0, s61, 1024
  s_nop 0
  buffer_load_dwordx4 v85, s[12:15], 0 offen nt lds
  s_add_u32 m0, s61, 2048
  s_nop 0
  buffer_load_dwordx4 v86, s[12:15], 0 offen nt lds
  s_lshl_b32 s62, s42, 10
  s_add_u32 m0, s62, 24576
  s_nop 0
  buffer_load_dwordx4 v2, s[36:39], s63 offen lds
  s_add_u32 m0, s61, 3072
  s_nop 0
  buffer_load_dwordx4 v80, s[16:19], 0 offen nt lds
  s_add_u32 m0, s61, 4096
  s_nop 0
  buffer_load_dwordx4 v81, s[16:19], 0 offen nt lds
  s_add_u32 m0, s61, 5120
  s_nop 0
  buffer_load_dwordx4 v82, s[16:19], 0 offen nt lds
  s_mov_b64 s[8:9], s[44:45]
  s_mov_b64 s[28:29], s[22:23]
  s_mov_b64 s[32:33], s[24:25]
  s_mov_b64 s[56:57], s[20:21]
  s_load_dword s43, s[4:5], 0
  s_getreg_b32 s44, hwreg(HW_REG_XCC_ID, 0, 4)
  v_cmp_le_u32 vcc, 20, v0
  s_nop 1
  v_cndmask_b32 v3, 0, 1, vcc
  v_mul_u32_u24 v4, 20, v3
  v_sub_u32 v4, v0, v4
  v_mul_u32_u24 v5, 1280, v3
  v_lshl_add_u32 v5, v4, 3, v5
  v_add_u32 v15, s61, v5
  v_lshlrev_b32 v14, 5, v4
  v_add_u32 v14, s62, v14
  s_mul_i32 s69, s40, 80
  s_lshl_b32 s60, s41, 2
  s_add_u32 s69, s69, s60
  s_add_u32 s69, s69, s42
  s_min_u32 s69, s69, 639
  s_lshl_b32 s60, s69, 12
  s_mov_b32 s23, 0x20000
  s_mov_b32 s22, 4096
  s_add_u32 s20, s52, s60
  s_addc_u32 s21, s53, 0
  s_lshr_b32 s61, s69, 1
  s_lshl_b32 s61, s61, 2
  s_load_dword s45, s[54:55], s61
  s_mov_b32 s6, 268435456
  s_mov_b32 s7, 0x20000
  s_mov_b32 s10, 2621440
  s_mov_b32 s11, 0x20000
  s_mov_b32 s30, 1966080
  s_mov_b32 s31, 0x20000
  s_mov_b32 s34, 2621440
  s_mov_b32 s35, 0x20000
  s_mov_b32 s26, 1966080
  s_mov_b32 s27, 0x20000
  s_cmp_lt_u32 s42, 2
  s_cselect_b32 s24, s58, s56
  s_cselect_b32 s25, s59, s57
  s_cselect_b32 s66, 0, 0x80000000
  s_lshl_b32 s65, s40, 9
  s_add_u32 s65, s65, 32768
  s_lshl_b32 s60, s41, 4
  s_lshl_b32 s61, s42, 2
  s_add_u32 s60, s60, s61
  s_add_u32 s64, s65, s60
  s_mul_i32 s47, s40, 327680
  s_add_u32 s47, s47, 1048576
  s_mul_i32 s60, s42, 20
  v_add_u32 v11, s60, v4
  v_add_u32 v12, s41, v11
  v_and_b32 v12, 31, v12
  v_lshlrev_b32 v11, 12, v11
  v_lshl_add_u32 v11, v12, 7, v11
  v_add_u32 v11, s47, v11
  s_lshl_b32 s61, s42, 7
  s_add_u32 s61, s61, s65
  v_lshlrev_b32 v12, 12, v4
  v_add_u32 v12, s61, v12
  v_cmp_le_u32 vcc, 20, v0
  s_nop 1
  v_cndmask_b32 v87, v11, v12, vcc
  s_lshl_b32 s61, s42, 1
  v_add_u32 v3, s61, v3
  v_lshlrev_b32 v3, 4, v3
  v_cmp_gt_u32 vcc, 40, v0
  v_lshl_add_u32 v9, v4, 2, 0
  v_add_u32 v10, s41, v9
  v_and_b32 v10, 31, v10
  v_lshl_add_u32 v9, v9, 12, v3
  v_lshl_add_u32 v9, v10, 7, v9
  v_cndmask_b32 v224, v7, v9, vcc
  v_lshl_add_u32 v9, v4, 2, 1
  v_add_u32 v10, s41, v9
  v_and_b32 v10, 31, v10
  v_lshl_add_u32 v9, v9, 12, v3
  v_lshl_add_u32 v9, v10, 7, v9
  v_cndmask_b32 v225, v7, v9, vcc
  v_lshl_add_u32 v9, v4, 2, 2
  v_add_u32 v10, s41, v9
  v_and_b32 v10, 31, v10
  v_lshl_add_u32 v9, v9, 12, v3
  v_lshl_add_u32 v9, v10, 7, v9
  v_cndmask_b32 v226, v7, v9, vcc
  v_lshl_add_u32 v9, v4, 2, 3
  v_add_u32 v10, s41, v9
  v_and_b32 v10, 31, v10
  v_lshl_add_u32 v9, v9, 12, v3
  v_lshl_add_u32 v9, v10, 7, v9
  v_cndmask_b32 v227, v7, v9, vcc
  v_and_b32 v97, 31, v0
  v_lshlrev_b32 v95, 4, v97
  v_lshlrev_b32 v97, 6, v97
  s_mov_b64 exec, 0x1fffffff
  buffer_load_dword v93, v87, s[4:7], 0 offen sc1
  s_mov_b64 exec, -1
  s_and_b32 s48, s42, 1
  s_mul_i32 s48, s48, 192
  s_and_b32 s49, s41, 15
  s_mul_i32 s49, s49, 192
  s_add_u32 s50, s48, 0
  v_add_u32 v3, s50, v0
  v_cvt_f32_u32 v6, v3
  v_add_f32 v6, 0.5, v6
  v_mul_f32 v6, 0.08333333333333333, v6
  v_cvt_u32_f32 v4, v6
  v_mul_u32_u24 v6, 12, v4
  v_sub_u32 v5, v3, v6
  v_bfe_u32 v6, v4, 2, 1
  v_sub_u32 v5, v5, v6
  v_add_u32 v6, 12, v5
  v_min_u32 v5, v5, v6
  v_bfe_u32 v6, v4, 2, 2
  v_mul_u32_u24 v6, 160, v6
  v_lshrrev_b32 v7, 4, v4
  v_lshl_add_u32 v6, v7, 2, v6
  v_and_b32 v7, 3, v4
  v_add_u32 v6, v6, v7
  v_mul_u32_u24 v6, 3072, v6
  v_lshl_add_u32 v6, v5, 4, v6
  v_add_u32 v104, s49, v6
  s_add_u32 s50, s48, 64
  v_add_u32 v3, s50, v0
  v_cvt_f32_u32 v6, v3
  v_add_f32 v6, 0.5, v6
  v_mul_f32 v6, 0.08333333333333333, v6
  v_cvt_u32_f32 v4, v6
  v_mul_u32_u24 v6, 12, v4
  v_sub_u32 v5, v3, v6
  v_bfe_u32 v6, v4, 2, 1
  v_sub_u32 v5, v5, v6
  v_add_u32 v6, 12, v5
  v_min_u32 v5, v5, v6
  v_bfe_u32 v6, v4, 2, 2
  v_mul_u32_u24 v6, 160, v6
  v_lshrrev_b32 v7, 4, v4
  v_lshl_add_u32 v6, v7, 2, v6
  v_and_b32 v7, 3, v4
  v_add_u32 v6, v6, v7
  v_mul_u32_u24 v6, 3072, v6
  v_lshl_add_u32 v6, v5, 4, v6
  v_add_u32 v105, s49, v6
  s_add_u32 s50, s48, 128
  v_add_u32 v3, s50, v0
  v_cvt_f32_u32 v6, v3
  v_add_f32 v6, 0.5, v6
  v_mul_f32 v6, 0.08333333333333333, v6
  v_cvt_u32_f32 v4, v6
  v_mul_u32_u24 v6, 12, v4
  v_sub_u32 v5, v3, v6
  v_bfe_u32 v6, v4, 2, 1
  v_sub_u32 v5, v5, v6
  v_add_u32 v6, 12, v5
  v_min_u32 v5, v5, v6
  v_bfe_u32 v6, v4, 2, 2
  v_mul_u32_u24 v6, 160, v6
  v_lshrrev_b32 v7, 4, v4
  v_lshl_add_u32 v6, v7, 2, v6
  v_and_b32 v7, 3, v4
  v_add_u32 v6, v6, v7
  v_mul_u32_u24 v6, 3072, v6
  v_lshl_add_u32 v6, v5, 4, v6
  v_add_u32 v106, s49, v6
  v_lshrrev_b32 v3, 4, v0
  v_bfe_u32 v4, v0, 2, 2
  v_lshl_add_u32 v4, v3, 2, v4
  v_mul_u32_u24 v4, 192, v4
  v_and_b32 v5, 1, v0
  v_mul_u32_u24 v5, 6176, v5
  v_add_u32 v4, v4, v5
  v_bfe_u32 v5, v0, 1, 1
  v_lshl_add_u32 v4, v5, 3, v4
  v_and_b32 v3, 1, v3
  s_mul_i32 s50, s42, 3
  v_add_u32 v3, s50, v3
  v_lshl_add_u32 v107, v3, 4, v4
  v_add_u32 v3, 2, v3
  v_subrev_u32 v5, 12, v3
  v_min_u32 v3, v3, v5
  v_lshl_add_u32 v108, v3, 4, v4
  v_add_u32 v110, 81920, v107
  v_add_u32 v111, 81920, v108
  s_mul_i32 s67, s40, 10
  s_lshr_b32 s67, s67, 3
  s_lshl_b32 s67, s67, 1
  s_sub_u32 s50, s41, 16
  s_cmp_lt_u32 s50, 4
  s_cselect_b32 s36, 12, 0
  s_add_u32 s3, s67, s36
  s_sub_u32 s50, s3, 20
  s_min_u32 s3, s3, s50
  s_mul_i32 s3, s3, 24576
  s_lshr_b32 s54, s42, 1
  s_mul_i32 s54, s54, 6176
  s_and_b32 s50, s42, 1
  s_mul_i32 s50, s50, 3072
  s_add_u32 s54, s54, s50
  v_mov_b32 v98, 0
  v_mov_b32 v99, 0
  v_mov_b32 v100, 0
  v_mov_b32 v101, 0
  v_mov_b32 v102, 0
  v_mov_b32 v103, 0
  v_mov_b32 v232, 0
  v_mov_b32 v233, 0
  v_mov_b32 v234, 0
  v_mov_b32 v235, 0
  v_mov_b32 v236, 0
  v_mov_b32 v237, 0
  v_mov_b32 v238, 0
  v_mov_b32 v239, 0
  s_cmp_lt_u32 s41, 20
  s_cbranch_scc1 L_nowd
  s_mul_i32 s48, s40, 12
  s_add_u32 s48, s48, s41
  s_sub_u32 s48, s48, 20
  s_and_b32 s49, s48, 1
  s_lshl_b32 s49, s49, 2
  s_add_u32 s49, s49, s42
  s_lshr_b32 s48, s48, 1
  s_mul_i32 s52, s49, 48
  s_add_u32 s52, s52, s48
  s_mul_i32 s52, s52, 5120
  s_add_u32 s52, s52, 4194304
  s_mul_i32 s49, s49, 160
  s_mul_i32 s50, s48, 43691
  s_lshr_b32 s50, s50, 17
  s_mul_i32 s51, s50, 3
  s_sub_u32 s51, s48, s51
  s_mul_i32 s50, s50, 96
  s_lshl_b32 s53, s51, 2
  s_cmp_eq_u32 s51, 2
  s_cselect_b32 s53, 16, s53
  s_cselect_b32 s51, 4, 8
  s_add_u32 s50, s50, s53
  s_mul_i32 s50, s50, 1280
  s_add_u32 s49, s49, s50
  s_mul_i32 s56, s42, 5120
  s_add_u32 s56, s56, 61760
  s_cmp_eq_u32 s42, 3
  s_cselect_b32 s56, 155840, s56
  v_add_u32 v3, 0, v0
  v_cvt_f32_u32 v6, v3
  v_add_f32 v6, 0.5, v6
  v_mul_f32 v6, 0.1, v6
  v_cvt_u32_f32 v4, v6
  v_mul_u32_u24 v6, 10, v4
  v_sub_u32 v5, v3, v6
  v_bfe_u32 v6, v4, 2, 2
  v_mul_u32_u24 v6, 24, v6
  v_and_b32 v7, 3, v4
  v_add_u32 v6, v6, v7
  v_lshrrev_b32 v7, 4, v4
  v_mad_u32_u24 v6, v7, s51, v6
  v_mul_u32_u24 v6, 1280, v6
  v_lshl_add_u32 v98, v5, 4, v6
  v_add_u32 v3, 64, v0
  v_cvt_f32_u32 v6, v3
  v_add_f32 v6, 0.5, v6
  v_mul_f32 v6, 0.1, v6
  v_cvt_u32_f32 v4, v6
  v_mul_u32_u24 v6, 10, v4
  v_sub_u32 v5, v3, v6
  v_bfe_u32 v6, v4, 2, 2
  v_mul_u32_u24 v6, 24, v6
  v_and_b32 v7, 3, v4
  v_add_u32 v6, v6, v7
  v_lshrrev_b32 v7, 4, v4
  v_mad_u32_u24 v6, v7, s51, v6
  v_mul_u32_u24 v6, 1280, v6
  v_lshl_add_u32 v99, v5, 4, v6
  v_add_u32 v3, 128, v0
  v_cvt_f32_u32 v6, v3
  v_add_f32 v6, 0.5, v6
  v_mul_f32 v6, 0.1, v6
  v_cvt_u32_f32 v4, v6
  v_mul_u32_u24 v6, 10, v4
  v_sub_u32 v5, v3, v6
  v_bfe_u32 v6, v4, 2, 2
  v_mul_u32_u24 v6, 24, v6
  v_and_b32 v7, 3, v4
  v_add_u32 v6, v6, v7
  v_lshrrev_b32 v7, 4, v4
  v_mad_u32_u24 v6, v7, s51, v6
  v_mul_u32_u24 v6, 1280, v6
  v_lshl_add_u32 v100, v5, 4, v6
  v_add_u32 v3, 192, v0
  v_cvt_f32_u32 v6, v3
  v_add_f32 v6, 0.5, v6
  v_mul_f32 v6, 0.1, v6
  v_cvt_u32_f32 v4, v6
  v_mul_u32_u24 v6, 10, v4
  v_sub_u32 v5, v3, v6
  v_bfe_u32 v6, v4, 2, 2
  v_mul_u32_u24 v6, 24, v6
  v_and_b32 v7, 3, v4
  v_add_u32 v6, v6, v7
  v_lshrrev_b32 v7, 4, v4
  v_mad_u32_u24 v6, v7, s51, v6
  v_mul_u32_u24 v6, 1280, v6
  v_lshl_add_u32 v101, v5, 4, v6
  v_add_u32 v3, 256, v0
  v_cvt_f32_u32 v6, v3
  v_add_f32 v6, 0.5, v6
  v_mul_f32 v6, 0.1, v6
  v_cvt_u32_f32 v4, v6
  v_mul_u32_u24 v6, 10, v4
  v_sub_u32 v5, v3, v6
  v_bfe_u32 v6, v4, 2, 2
  v_mul_u32_u24 v6, 24, v6
  v_and_b32 v7, 3, v4
  v_add_u32 v6, v6, v7
  v_lshrrev_b32 v7, 4, v4
  v_mad_u32_u24 v6, v7, s51, v6
  v_mul_u32_u24 v6, 1280, v6
  v_lshl_add_u32 v102, v5, 4, v6
  v_lshrrev_b32 v3, 4, v0
  v_bfe_u32 v4, v0, 2, 2
  v_lshl_add_u32 v4, v3, 2, v4
  v_mul_u32_u24 v4, 160, v4
  v_and_b32 v5, 3, v0
  v_lshl_add_u32 v4, v5, 3, v4
  v_add_u32 v103, s56, v4
  s_mov_b32 s57, s49
  s_sub_u32 s48, s41, 20
  s_lshl_b32 s48, s48, 1
  s_and_b32 s50, s42, 1
  s_add_u32 s48, s48, s50
  s_lshl_b32 s48, s48, 3
  v_and_b32 v3, 7, v0
  v_add_u32 v3, s48, v3
  v_cvt_f32_u32 v6, v3
  v_add_f32 v6, 0.5, v6
  v_mul_f32 v6, 0.16666666666666666, v6
  v_cvt_u32_f32 v4, v6
  v_mul_u32_u24 v6, 6, v4
  v_sub_u32 v5, v3, v6
  v_lshrrev_b32 v6, 3, v4
  v_and_b32 v4, 7, v4
  v_mul_u32_u24 v6, 160, v6
  v_add_u32 v4, v4, v6
  v_mul_u32_u24 v4, 3072, v4
  v_lshl_add_u32 v4, v5, 7, v4
  v_lshrrev_b32 v5, 3, v0
  v_add_u32 v5, s67, v5
  v_add_u32 v6, 5, v5
  v_subrev_u32 v7, 20, v6
  v_min_u32 v6, v6, v7
  v_mul_u32_u24 v6, 24576, v6
  v_add_u32 v84, v4, v6
  s_branch L_p0
L_nowd:
  s_mul_i32 s48, s42, 16640
  s_add_u32 s48, s48, 94240
  s_mul_i32 s49, s42, 4608
  s_add_u32 s49, s49, 62464
  v_mov_b32 v184, 0
  v_mov_b32 v185, 0
  v_mov_b32 v186, 0
  v_mov_b32 v187, 0
  v_min_u32 v4, 29, v0
  v_lshlrev_b32 v4, 4, v4
  v_add_u32 v4, s49, v4
  ds_write_b128 v4, v[184:187]
  v_and_b32 v7, 15, v0
  v_lshrrev_b32 v8, 4, v0
  v_add_u32 v9, 1, v7
  v_and_b32 v9, 3, v9
  v_lshlrev_b32 v10, 3, v8
  v_sub_u32 v10, v7, v10
  v_sub_u32 v11, v10, v9
  v_add_u32 v11, 25, v11
  v_lshlrev_b32 v11, 1, v11
  v_mul_u32_u24 v9, 4160, v9
  v_add3_u32 v232, v9, v11, s48
  v_lshlrev_b32 v6, 5, v7
  v_lshl_add_u32 v6, v8, 4, v6
  v_add_u32 v233, s49, v6
  v_sub_u32 v235, -9, v10
  v_lshrrev_b32 v9, 1, v7
  v_mul_u32_u24 v9, 40960, v9
  v_and_b32 v10, 1, v7
  v_lshlrev_b32 v10, 5, v10
  v_lshlrev_b32 v8, 3, v8
  v_add3_u32 v234, v9, v10, v8
  s_mul_i32 s51, s40, 80
  s_lshl_b32 s52, s41, 2
  s_add_u32 s52, s52, s42
  s_add_u32 s51, s51, s52
  s_lshl_b32 s51, s51, 6
  s_add_u32 s51, s51, 7340032
  s_lshl_b32 s53, s52, 7
  s_and_b32 s53, s53, 3968
  s_add_u32 s50, s53, 0
  v_add_u32 v236, s50, v2
  v_and_b32 v236, 4095, v236
  s_add_u32 s50, s53, 1024
  v_add_u32 v237, s50, v2
  v_and_b32 v237, 4095, v237
  s_add_u32 s50, s53, 2048
  v_add_u32 v238, s50, v2
  v_and_b32 v238, 4095, v238
  s_add_u32 s50, s53, 3072
  v_add_u32 v239, s50, v2
  v_and_b32 v239, 4095, v239
  s_mul_i32 s52, s52, 4096
  s_add_u32 s52, s52, s47
  s_add_u32 s49, s49, 480
L_p0:
  s_waitcnt vmcnt(4)
  ds_read_b128 v[152:155], v14 offset:24576
  ds_read_b128 v[156:159], v14 offset:24592
  ds_read_b64 v[112:113], v15 offset:0
  ds_read_b64 v[114:115], v15 offset:160
  ds_read_b64 v[116:117], v15 offset:320
  ds_read_b64 v[118:119], v15 offset:480
  ds_read_b64 v[120:121], v15 offset:640
  ds_read_b64 v[122:123], v15 offset:800
  ds_read_b64 v[124:125], v15 offset:960
  ds_read_b64 v[126:127], v15 offset:1120
  ds_read_b64 v[128:129], v15 offset:1280
  ds_read_b64 v[130:131], v15 offset:1440
  ds_read_b64 v[132:133], v15 offset:1600
  s_waitcnt lgkmcnt(11)
  v_lshlrev_b32 v16, 16, v152
  v_and_b32 v20, 0xffff0000, v152
  v_lshlrev_b32 v24, 16, v153
  v_and_b32 v28, 0xffff0000, v153
  v_lshlrev_b32 v17, 16, v154
  v_and_b32 v21, 0xffff0000, v154
  v_lshlrev_b32 v25, 16, v155
  v_and_b32 v29, 0xffff0000, v155
  v_lshlrev_b32 v18, 16, v156
  v_and_b32 v22, 0xffff0000, v156
  v_lshlrev_b32 v26, 16, v157
  v_and_b32 v30, 0xffff0000, v157
  v_lshlrev_b32 v19, 16, v158
  v_and_b32 v23, 0xffff0000, v158
  v_lshlrev_b32 v27, 16, v159
  v_and_b32 v31, 0xffff0000, v159
  s_waitcnt lgkmcnt(10)
  v_lshlrev_b32 v32, 16, v112
  v_and_b32 v33, 0xffff0000, v112
  v_lshlrev_b32 v34, 16, v113
  v_and_b32 v35, 0xffff0000, v113
  s_waitcnt lgkmcnt(9)
  v_lshlrev_b32 v36, 16, v114
  v_and_b32 v37, 0xffff0000, v114
  v_lshlrev_b32 v38, 16, v115
  v_and_b32 v39, 0xffff0000, v115
  s_waitcnt lgkmcnt(8)
  v_lshlrev_b32 v40, 16, v116
  v_and_b32 v41, 0xffff0000, v116
  v_lshlrev_b32 v42, 16, v117
  v_and_b32 v43, 0xffff0000, v117
  s_waitcnt lgkmcnt(7)
  v_lshlrev_b32 v44, 16, v118
  v_and_b32 v45, 0xffff0000, v118
  v_lshlrev_b32 v46, 16, v119
  v_and_b32 v47, 0xffff0000, v119
  v_pk_mul_f32 v[192:193], v[28:29], v[32:33]
  v_pk_fma_f32 v[192:193], v[24:25], v[36:37], v[192:193]
  v_pk_fma_f32 v[192:193], v[20:21], v[40:41], v[192:193]
  v_pk_fma_f32 v[192:193], v[16:17], v[44:45], v[192:193]
  v_pk_mul_f32 v[194:195], v[30:31], v[34:35]
  v_pk_fma_f32 v[194:195], v[26:27], v[38:39], v[194:195]
  v_pk_fma_f32 v[194:195], v[22:23], v[42:43], v[194:195]
  v_pk_fma_f32 v[194:195], v[18:19], v[46:47], v[194:195]
  s_waitcnt lgkmcnt(6)
  v_lshlrev_b32 v48, 16, v120
  v_and_b32 v49, 0xffff0000, v120
  v_lshlrev_b32 v50, 16, v121
  v_and_b32 v51, 0xffff0000, v121
  v_pk_mul_f32 v[196:197], v[28:29], v[36:37]
  v_pk_fma_f32 v[196:197], v[24:25], v[40:41], v[196:197]
  v_pk_fma_f32 v[196:197], v[20:21], v[44:45], v[196:197]
  v_pk_fma_f32 v[196:197], v[16:17], v[48:49], v[196:197]
  v_pk_mul_f32 v[198:199], v[30:31], v[38:39]
  v_pk_fma_f32 v[198:199], v[26:27], v[42:43], v[198:199]
  v_pk_fma_f32 v[198:199], v[22:23], v[46:47], v[198:199]
  v_pk_fma_f32 v[198:199], v[18:19], v[50:51], v[198:199]
  s_waitcnt lgkmcnt(5)
  v_lshlrev_b32 v52, 16, v122
  v_and_b32 v53, 0xffff0000, v122
  v_lshlrev_b32 v54, 16, v123
  v_and_b32 v55, 0xffff0000, v123
  v_pk_mul_f32 v[200:201], v[28:29], v[40:41]
  v_pk_fma_f32 v[200:201], v[24:25], v[44:45], v[200:201]
  v_pk_fma_f32 v[200:201], v[20:21], v[48:49], v[200:201]
  v_pk_fma_f32 v[200:201], v[16:17], v[52:53], v[200:201]
  v_pk_mul_f32 v[202:203], v[30:31], v[42:43]
  v_pk_fma_f32 v[202:203], v[26:27], v[46:47], v[202:203]
  v_pk_fma_f32 v[202:203], v[22:23], v[50:51], v[202:203]
  v_pk_fma_f32 v[202:203], v[18:19], v[54:55], v[202:203]
  s_waitcnt lgkmcnt(4)
  v_lshlrev_b32 v56, 16, v124
  v_and_b32 v57, 0xffff0000, v124
  v_lshlrev_b32 v58, 16, v125
  v_and_b32 v59, 0xffff0000, v125
  v_pk_mul_f32 v[204:205], v[28:29], v[44:45]
  v_pk_fma_f32 v[204:205], v[24:25], v[48:49], v[204:205]
  v_pk_fma_f32 v[204:205], v[20:21], v[52:53], v[204:205]
  v_pk_fma_f32 v[204:205], v[16:17], v[56:57], v[204:205]
  v_pk_mul_f32 v[206:207], v[30:31], v[46:47]
  v_pk_fma_f32 v[206:207], v[26:27], v[50:51], v[206:207]
  v_pk_fma_f32 v[206:207], v[22:23], v[54:55], v[206:207]
  v_pk_fma_f32 v[206:207], v[18:19], v[58:59], v[206:207]
  s_waitcnt lgkmcnt(3)
  v_lshlrev_b32 v60, 16, v126
  v_and_b32 v61, 0xffff0000, v126
  v_lshlrev_b32 v62, 16, v127
  v_and_b32 v63, 0xffff0000, v127
  v_pk_mul_f32 v[208:209], v[28:29], v[48:49]
  v_pk_fma_f32 v[208:209], v[24:25], v[52:53], v[208:209]
  v_pk_fma_f32 v[208:209], v[20:21], v[56:57], v[208:209]
  v_pk_fma_f32 v[208:209], v[16:17], v[60:61], v[208:209]
  v_pk_mul_f32 v[210:211], v[30:31], v[50:51]
  v_pk_fma_f32 v[210:211], v[26:27], v[54:55], v[210:211]
  v_pk_fma_f32 v[210:211], v[22:23], v[58:59], v[210:211]
  v_pk_fma_f32 v[210:211], v[18:19], v[62:63], v[210:211]
  s_waitcnt lgkmcnt(2)
  v_lshlrev_b32 v64, 16, v128
  v_and_b32 v65, 0xffff0000, v128
  v_lshlrev_b32 v66, 16, v129
  v_and_b32 v67, 0xffff0000, v129
  v_pk_mul_f32 v[212:213], v[28:29], v[52:53]
  v_pk_fma_f32 v[212:213], v[24:25], v[56:57], v[212:213]
  v_pk_fma_f32 v[212:213], v[20:21], v[60:61], v[212:213]
  v_pk_fma_f32 v[212:213], v[16:17], v[64:65], v[212:213]
  v_pk_mul_f32 v[214:215], v[30:31], v[54:55]
  v_pk_fma_f32 v[214:215], v[26:27], v[58:59], v[214:215]
  v_pk_fma_f32 v[214:215], v[22:23], v[62:63], v[214:215]
  v_pk_fma_f32 v[214:215], v[18:19], v[66:67], v[214:215]
  s_waitcnt lgkmcnt(1)
  v_lshlrev_b32 v68, 16, v130
  v_and_b32 v69, 0xffff0000, v130
  v_lshlrev_b32 v70, 16, v131
  v_and_b32 v71, 0xffff0000, v131
  v_pk_mul_f32 v[216:217], v[28:29], v[56:57]
  v_pk_fma_f32 v[216:217], v[24:25], v[60:61], v[216:217]
  v_pk_fma_f32 v[216:217], v[20:21], v[64:65], v[216:217]
  v_pk_fma_f32 v[216:217], v[16:17], v[68:69], v[216:217]
  v_pk_mul_f32 v[218:219], v[30:31], v[58:59]
  v_pk_fma_f32 v[218:219], v[26:27], v[62:63], v[218:219]
  v_pk_fma_f32 v[218:219], v[22:23], v[66:67], v[218:219]
  v_pk_fma_f32 v[218:219], v[18:19], v[70:71], v[218:219]
  s_waitcnt lgkmcnt(0)
  v_lshlrev_b32 v72, 16, v132
  v_and_b32 v73, 0xffff0000, v132
  v_lshlrev_b32 v74, 16, v133
  v_and_b32 v75, 0xffff0000, v133
  v_pk_mul_f32 v[220:221], v[28:29], v[60:61]
  v_pk_fma_f32 v[220:221], v[24:25], v[64:65], v[220:221]
  v_pk_fma_f32 v[220:221], v[20:21], v[68:69], v[220:221]
  v_pk_fma_f32 v[220:221], v[16:17], v[72:73], v[220:221]
  v_pk_mul_f32 v[222:223], v[30:31], v[62:63]
  v_pk_fma_f32 v[222:223], v[26:27], v[66:67], v[222:223]
  v_pk_fma_f32 v[222:223], v[22:23], v[70:71], v[222:223]
  v_pk_fma_f32 v[222:223], v[18:19], v[74:75], v[222:223]
  s_waitcnt lgkmcnt(0)
  s_mul_i32 s43, s43, 1664525
  s_add_u32 s43, s43, 1013904223
  v_mov_b32 v1, s43
  s_add_u32 s60, s43, s44
  s_lshl_b32 s69, s40, 11
  s_add_u32 s69, s69, 4096
  v_mov_b32 v96, s60
  s_and_b32 s50, s42, 1
  s_lshl_b32 s50, s50, 4
  s_lshr_b32 s50, s45, s50
  s_and_b32 s50, s50, 0xffff
  v_and_b32 v12, 1, v235
  v_lshlrev_b32 v12, 4, v12
  v_lshlrev_b32 v12, v12, s50
  v_ashrrev_i32 v11, 1, v235
  v_cmp_eq_u32 vcc, 0, v11
  s_nop 1
  v_cndmask_b32 v228, 0, v12, vcc
  v_cmp_eq_u32 vcc, 1, v11
  s_nop 1
  v_cndmask_b32 v229, 0, v12, vcc
  v_cmp_eq_u32 vcc, 2, v11
  s_nop 1
  v_cndmask_b32 v230, 0, v12, vcc
  v_cmp_eq_u32 vcc, 3, v11
  s_nop 1
  v_cndmask_b32 v231, 0, v12, vcc
  s_waitcnt vmcnt(1)
  s_cmp_ge_u32 s41, 20
  s_cbranch_scc1 L_noh
  buffer_load_dwordx4 v[160:163], v2, s[20:23], 0 offen offset:0 nt
  buffer_load_dwordx4 v[164:167], v2, s[20:23], 0 offen offset:1024 nt
  buffer_load_dwordx4 v[168:171], v2, s[20:23], 0 offen offset:2048 nt
  buffer_load_dwordx4 v[172:175], v2, s[20:23], 0 offen offset:3072 nt
L_noh:
  ds_read_b64 v[134:135], v15 offset:3072
  ds_read_b64 v[136:137], v15 offset:3232
  ds_read_b64 v[138:139], v15 offset:3392
  ds_read_b64 v[140:141], v15 offset:3552
  ds_read_b64 v[142:143], v15 offset:3712
  ds_read_b64 v[144:145], v15 offset:3872
  ds_read_b64 v[146:147], v15 offset:4032
  ds_read_b64 v[148:149], v15 offset:4192
  s_waitcnt lgkmcnt(7)
  v_lshlrev_b32 v76, 16, v134
  v_and_b32 v77, 0xffff0000, v134
  v_lshlrev_b32 v78, 16, v135
  v_and_b32 v79, 0xffff0000, v135
  v_pk_mul_f32 v[192:193], v[192:193], v[76:77]
  v_pk_mul_f32 v[194:195], v[194:195], v[78:79]
  s_waitcnt lgkmcnt(6)
  v_lshlrev_b32 v76, 16, v136
  v_and_b32 v77, 0xffff0000, v136
  v_lshlrev_b32 v78, 16, v137
  v_and_b32 v79, 0xffff0000, v137
  v_pk_mul_f32 v[196:197], v[196:197], v[76:77]
  v_pk_mul_f32 v[198:199], v[198:199], v[78:79]
  s_waitcnt lgkmcnt(5)
  v_lshlrev_b32 v76, 16, v138
  v_and_b32 v77, 0xffff0000, v138
  v_lshlrev_b32 v78, 16, v139
  v_and_b32 v79, 0xffff0000, v139
  v_pk_mul_f32 v[200:201], v[200:201], v[76:77]
  v_pk_mul_f32 v[202:203], v[202:203], v[78:79]
  s_waitcnt lgkmcnt(4)
  v_lshlrev_b32 v76, 16, v140
  v_and_b32 v77, 0xffff0000, v140
  v_lshlrev_b32 v78, 16, v141
  v_and_b32 v79, 0xffff0000, v141
  v_pk_mul_f32 v[204:205], v[204:205], v[76:77]
  v_pk_mul_f32 v[206:207], v[206:207], v[78:79]
  s_waitcnt lgkmcnt(3)
  v_lshlrev_b32 v76, 16, v142
  v_and_b32 v77, 0xffff0000, v142
  v_lshlrev_b32 v78, 16, v143
  v_and_b32 v79, 0xffff0000, v143
  v_pk_mul_f32 v[208:209], v[208:209], v[76:77]
  v_pk_mul_f32 v[210:211], v[210:211], v[78:79]
  s_waitcnt lgkmcnt(2)
  v_lshlrev_b32 v76, 16, v144
  v_and_b32 v77, 0xffff0000, v144
  v_lshlrev_b32 v78, 16, v145
  v_and_b32 v79, 0xffff0000, v145
  v_pk_mul_f32 v[212:213], v[212:213], v[76:77]
  v_pk_mul_f32 v[214:215], v[214:215], v[78:79]
  s_waitcnt lgkmcnt(1)
  v_lshlrev_b32 v76, 16, v146
  v_and_b32 v77, 0xffff0000, v146
  v_lshlrev_b32 v78, 16, v147
  v_and_b32 v79, 0xffff0000, v147
  v_pk_mul_f32 v[216:217], v[216:217], v[76:77]
  v_pk_mul_f32 v[218:219], v[218:219], v[78:79]
  s_waitcnt lgkmcnt(0)
  v_lshlrev_b32 v76, 16, v148
  v_and_b32 v77, 0xffff0000, v148
  v_lshlrev_b32 v78, 16, v149
  v_and_b32 v79, 0xffff0000, v149
  v_pk_mul_f32 v[220:221], v[220:221], v[76:77]
  v_pk_mul_f32 v[222:223], v[222:223], v[78:79]
  v_cvt_pk_bf16_f32 v16, v220, v216
  v_cvt_pk_bf16_f32 v17, v212, v208
  v_cvt_pk_bf16_f32 v18, v204, v200
  v_cvt_pk_bf16_f32 v19, v196, v192
  v_cvt_pk_bf16_f32 v20, v221, v217
  v_cvt_pk_bf16_f32 v21, v213, v209
  v_cvt_pk_bf16_f32 v22, v205, v201
  v_cvt_pk_bf16_f32 v23, v197, v193
  v_cvt_pk_bf16_f32 v24, v222, v218
  v_cvt_pk_bf16_f32 v25, v214, v210
  v_cvt_pk_bf16_f32 v26, v206, v202
  v_cvt_pk_bf16_f32 v27, v198, v194
  v_cvt_pk_bf16_f32 v28, v223, v219
  v_cvt_pk_bf16_f32 v29, v215, v211
  v_cvt_pk_bf16_f32 v30, v207, v203
  v_cvt_pk_bf16_f32 v31, v199, v195
  buffer_store_dwordx4 v[16:19], v224, s[4:7], s47 offen
  buffer_store_dwordx4 v[20:23], v225, s[4:7], s47 offen
  buffer_store_dwordx4 v[24:27], v226, s[4:7], s47 offen
  buffer_store_dwordx4 v[28:31], v227, s[4:7], s47 offen
  s_cmp_ge_u32 s41, 20
  s_cbranch_scc1 L_noconv_f
  s_mul_i32 s48, s42, 16640
  s_add_u32 s48, s48, 94240
  v_add_u32 v3, s48, v2
  v_and_b32 v4, 1, v0
  v_lshlrev_b32 v4, 4, v4
  v_add_u32 v4, s48, v4
  s_waitcnt vmcnt(0)
  s_add_u32 s46, s64, 0
  s_mov_b64 exec, 1
  buffer_store_dword v96, off, s[4:7], s46
  s_mov_b64 exec, -1
  v_readfirstlane_b32 s53, v164
  v_readfirstlane_b32 s50, v165
  v_mov_b32 v176, v161
  v_mov_b32 v177, v162
  v_mov_b32 v178, v163
  v_mov_b32 v179, s53
  v_mov_b32 v180, s50
  s_nop 0
  v_mov_b32_dpp v179, v160 wave_shl:1 row_mask:0xf bank_mask:0xf
  v_mov_b32_dpp v180, v161 wave_shl:1 row_mask:0xf bank_mask:0xf
  v_alignbit_b32 v8, v176, v160, 16
  v_alignbit_b32 v9, v177, v161, 16
  v_alignbit_b32 v10, v178, v162, 16
  v_alignbit_b32 v11, v179, v163, 16
  v_alignbit_b32 v12, v177, v176, 16
  v_alignbit_b32 v13, v178, v177, 16
  v_alignbit_b32 v14, v179, v178, 16
  v_alignbit_b32 v15, v180, v179, 16
  ds_write_b128 v3, v[160:163] offset:32
  ds_write_b128 v3, v[8:11] offset:4192
  ds_write_b128 v3, v[176:179] offset:8352
  ds_write_b128 v3, v[12:15] offset:12512
  v_readfirstlane_b32 s53, v168
  v_readfirstlane_b32 s50, v169
  v_mov_b32 v176, v165
  v_mov_b32 v177, v166
  v_mov_b32 v178, v167
  v_mov_b32 v179, s53
  v_mov_b32 v180, s50
  s_nop 0
  v_mov_b32_dpp v179, v164 wave_shl:1 row_mask:0xf bank_mask:0xf
  v_mov_b32_dpp v180, v165 wave_shl:1 row_mask:0xf bank_mask:0xf
  v_alignbit_b32 v8, v176, v164, 16
  v_alignbit_b32 v9, v177, v165, 16
  v_alignbit_b32 v10, v178, v166, 16
  v_alignbit_b32 v11, v179, v167, 16
  v_alignbit_b32 v12, v177, v176, 16
  v_alignbit_b32 v13, v178, v177, 16
  v_alignbit_b32 v14, v179, v178, 16
  v_alignbit_b32 v15, v180, v179, 16
  ds_write_b128 v3, v[164:167] offset:1056
  ds_write_b128 v3, v[8:11] offset:5216
  ds_write_b128 v3, v[176:179] offset:9376
  ds_write_b128 v3, v[12:15] offset:13536
  v_readfirstlane_b32 s53, v172
  v_readfirstlane_b32 s50, v173
  v_mov_b32 v176, v169
  v_mov_b32 v177, v170
  v_mov_b32 v178, v171
  v_mov_b32 v179, s53
  v_mov_b32 v180, s50
  s_nop 0
  v_mov_b32_dpp v179, v168 wave_shl:1 row_mask:0xf bank_mask:0xf
  v_mov_b32_dpp v180, v169 wave_shl:1 row_mask:0xf bank_mask:0xf
  v_alignbit_b32 v8, v176, v168, 16
  v_alignbit_b32 v9, v177, v169, 16
  v_alignbit_b32 v10, v178, v170, 16
  v_alignbit_b32 v11, v179, v171, 16
  v_alignbit_b32 v12, v177, v176, 16
  v_alignbit_b32 v13, v178, v177, 16
  v_alignbit_b32 v14, v179, v178, 16
  v_alignbit_b32 v15, v180, v179, 16
  ds_write_b128 v3, v[168:171] offset:2080
  ds_write_b128 v3, v[8:11] offset:6240
  ds_write_b128 v3, v[176:179] offset:10400
  ds_write_b128 v3, v[12:15] offset:14560
  v_mov_b32 v176, v173
  v_mov_b32 v177, v174
  v_mov_b32 v178, v175
  v_mov_b32 v179, 0
  v_mov_b32 v180, 0
  s_nop 0
  v_mov_b32_dpp v179, v172 wave_shl:1 row_mask:0xf bank_mask:0xf
  v_mov_b32_dpp v180, v173 wave_shl:1 row_mask:0xf bank_mask:0xf
  v_alignbit_b32 v8, v176, v172, 16
  v_alignbit_b32 v9, v177, v173, 16
  v_alignbit_b32 v10, v178, v174, 16
  v_alignbit_b32 v11, v179, v175, 16
  v_alignbit_b32 v12, v177, v176, 16
  v_alignbit_b32 v13, v178, v177, 16
  v_alignbit_b32 v14, v179, v178, 16
  v_alignbit_b32 v15, v180, v179, 16
  ds_write_b128 v3, v[172:175] offset:3104
  ds_write_b128 v3, v[8:11] offset:7264
  ds_write_b128 v3, v[176:179] offset:11424
  ds_write_b128 v3, v[12:15] offset:15584
  v_readfirstlane_b32 s53, v160
  v_readfirstlane_b32 s50, v161
  v_mov_b32 v176, 0
  v_mov_b32 v177, 0
  v_mov_b32 v178, 0
  v_and_b32 v8, 1, v0
  v_sub_u32 v8, 0, v8
  v_and_b32 v179, s53, v8
  v_and_b32 v180, s50, v8
  v_alignbit_b32 v8, v176, v184, 16
  v_alignbit_b32 v9, v177, v185, 16
  v_alignbit_b32 v10, v178, v186, 16
  v_alignbit_b32 v11, v179, v187, 16
  v_alignbit_b32 v12, v177, v176, 16
  v_alignbit_b32 v13, v178, v177, 16
  v_alignbit_b32 v14, v179, v178, 16
  v_alignbit_b32 v15, v180, v179, 16
  ds_write_b128 v4, v[184:187] offset:0
  ds_write_b128 v4, v[8:11] offset:4160
  ds_write_b128 v4, v[176:179] offset:8320
  ds_write_b128 v4, v[12:15] offset:12480
  ds_read_b64 a[28:29], v232 offset:448
  ds_read_b64 a[30:31], v232 offset:456
  ds_read_b64 a[60:61], v232 offset:960
  ds_read_b64 a[62:63], v232 offset:968
  ds_read_b64 a[92:93], v232 offset:1472
  ds_read_b64 a[94:95], v232 offset:1480
  ds_read_b64 a[124:125], v232 offset:1984
  ds_read_b64 a[126:127], v232 offset:1992
  ds_read_b64 a[156:157], v232 offset:2496
  ds_read_b64 a[158:159], v232 offset:2504
  ds_read_b64 a[188:189], v232 offset:3008
  ds_read_b64 a[190:191], v232 offset:3016
  ds_read_b64 a[220:221], v232 offset:3520
  ds_read_b64 a[222:223], v232 offset:3528
  ds_read_b64 a[252:253], v232 offset:4032
  ds_read_b64 a[254:255], v232 offset:4040
  s_add_u32 s46, s65, 0
  s_mov_b32 s63, 0
  buffer_load_dwordx4 v[8:11], v95, s[4:7], s46 offen sc1
  ds_read_b64 a[24:25], v232 offset:384
  ds_read_b64 a[26:27], v232 offset:392
  ds_read_b64 a[56:57], v232 offset:896
  ds_read_b64 a[58:59], v232 offset:904
  ds_read_b64 a[88:89], v232 offset:1408
  ds_read_b64 a[90:91], v232 offset:1416
  ds_read_b64 a[120:121], v232 offset:1920
  ds_read_b64 a[122:123], v232 offset:1928
  ds_read_b64 a[152:153], v232 offset:2432
  ds_read_b64 a[154:155], v232 offset:2440
  ds_read_b64 a[184:185], v232 offset:2944
  ds_read_b64 a[186:187], v232 offset:2952
  ds_read_b64 a[216:217], v232 offset:3456
  ds_read_b64 a[218:219], v232 offset:3464
  ds_read_b64 a[248:249], v232 offset:3968
  ds_read_b64 a[250:251], v232 offset:3976
  ds_read_b64 a[20:21], v232 offset:320
  ds_read_b64 a[22:23], v232 offset:328
  ds_read_b64 a[52:53], v232 offset:832
  ds_read_b64 a[54:55], v232 offset:840
  ds_read_b64 a[84:85], v232 offset:1344
  ds_read_b64 a[86:87], v232 offset:1352
  ds_read_b64 a[116:117], v232 offset:1856
  ds_read_b64 a[118:119], v232 offset:1864
  ds_read_b64 a[148:149], v232 offset:2368
  ds_read_b64 a[150:151], v232 offset:2376
  ds_read_b64 a[180:181], v232 offset:2880
  ds_read_b64 a[182:183], v232 offset:2888
  ds_read_b64 a[212:213], v232 offset:3392
  ds_read_b64 a[214:215], v232 offset:3400
  ds_read_b64 a[244:245], v232 offset:3904
  ds_read_b64 a[246:247], v232 offset:3912
  ds_read_b64 a[16:17], v232 offset:256
  ds_read_b64 a[18:19], v232 offset:264
  ds_read_b64 a[48:49], v232 offset:768
  ds_read_b64 a[50:51], v232 offset:776
  ds_read_b64 a[80:81], v232 offset:1280
  ds_read_b64 a[82:83], v232 offset:1288
  ds_read_b64 a[112:113], v232 offset:1792
  ds_read_b64 a[114:115], v232 offset:1800
  ds_read_b64 a[144:145], v232 offset:2304
  ds_read_b64 a[146:147], v232 offset:2312
  ds_read_b64 a[176:177], v232 offset:2816
  ds_read_b64 a[178:179], v232 offset:2824
  ds_read_b64 a[208:209], v232 offset:3328
  ds_read_b64 a[210:211], v232 offset:3336
  ds_read_b64 a[240:241], v232 offset:3840
  ds_read_b64 a[242:243], v232 offset:3848
  s_waitcnt vmcnt(0)
Ldec_1:
  v_bitop3_b32 v8, v8, v9, v96 bitop3:0x7e
  v_bitop3_b32 v10, v10, v11, v96 bitop3:0x7e
  v_or_b32 v8, v8, v10
  v_cmp_ne_u32 vcc, 0, v8
  s_nop 3
  s_cbranch_vccz Lfast_2
  s_add_u32 s63, s63, 1
  s_and_b32 s62, s63, 63
  s_cbranch_scc1 Lagain_3
  v_mov_b32 v88, v96
  v_mov_b32 v89, v96
  v_mov_b32 v90, v96
  v_mov_b32 v91, v96
  s_lshl_b32 s62, s41, 6
  s_add_u32 s62, s62, s69
  s_mov_b64 exec, 15
  buffer_store_dwordx4 v[88:91], v2, s[4:7], s62 offen sc1
  s_mov_b64 exec, -1
  buffer_load_dword v94, v97, s[4:7], s69 offen sc1
  s_waitcnt vmcnt(0)
  v_subrev_u32 v94, s43, v94
  v_cmp_lt_u32 vcc, 15, v94
  s_nop 3
  s_cbranch_vccnz Lagain_3
  v_cmp_ne_u32 vcc, s44, v94
  s_nop 3
  s_cbranch_vccnz L_slow_conv
Lagain_3:
  buffer_load_dwordx4 v[8:11], v95, s[4:7], s46 offen sc1
  s_waitcnt vmcnt(0)
  s_branch Ldec_1
Lfast_2:
  s_mov_b32 m0, s49
  s_nop 0
  buffer_load_dwordx4 v236, s[4:7], s52 offen sc1 lds
  s_add_u32 s49, s49, 1024
  s_mov_b32 m0, s49
  s_nop 0
  buffer_load_dwordx4 v237, s[4:7], s52 offen sc1 lds
  s_add_u32 s49, s49, 1024
  s_mov_b32 m0, s49
  s_nop 0
  buffer_load_dwordx4 v238, s[4:7], s52 offen sc1 lds
  s_add_u32 s49, s49, 1024
  s_mov_b32 m0, s49
  s_nop 0
  buffer_load_dwordx4 v239, s[4:7], s52 offen sc1 lds
  s_add_u32 s49, s49, 1024
  v_and_b32 v14, 7, v0
  v_lshrrev_b32 v15, 3, v0
  s_lshl_b32 s59, s42, 3
  v_add_u32 v15, s59, v15
  v_mul_u32_u24 v14, 1280, v14
  v_lshl_add_u32 v14, v15, 4, v14
  s_lshl_b32 s59, s40, 5
  s_add_u32 s59, s59, s41
  s_mul_i32 s59, s59, 10240
  s_add_u32 s60, s59, s66
  buffer_load_dwordx4 v[72:75], v14, s[8:11], s59 offen offset:0 nt
  buffer_load_dwordx4 v[76:79], v14, s[8:11], s59 offen offset:512 nt
  buffer_load_dwordx4 v[80:83], v14, s[8:11], s60 offen offset:1024 nt
  ds_read_b64 a[12:13], v232 offset:192
  ds_read_b64 a[14:15], v232 offset:200
  ds_read_b64 a[44:45], v232 offset:704
  ds_read_b64 a[46:47], v232 offset:712
  ds_read_b64 a[76:77], v232 offset:1216
  ds_read_b64 a[78:79], v232 offset:1224
  ds_read_b64 a[108:109], v232 offset:1728
  ds_read_b64 a[110:111], v232 offset:1736
  ds_read_b64 a[140:141], v232 offset:2240
  ds_read_b64 a[142:143], v232 offset:2248
  ds_read_b64 a[172:173], v232 offset:2752
  ds_read_b64 a[174:175], v232 offset:2760
  ds_read_b64 a[204:205], v232 offset:3264
  ds_read_b64 a[206:207], v232 offset:3272
  ds_read_b64 a[236:237], v232 offset:3776
  ds_read_b64 a[238:239], v232 offset:3784
  ds_read_b64 a[8:9], v232 offset:128
  ds_read_b64 a[10:11], v232 offset:136
  ds_read_b64 a[40:41], v232 offset:640
  ds_read_b64 a[42:43], v232 offset:648
  ds_read_b64 a[72:73], v232 offset:1152
  ds_read_b64 a[74:75], v232 offset:1160
  ds_read_b64 a[104:105], v232 offset:1664
  ds_read_b64 a[106:107], v232 offset:1672
  ds_read_b64 a[136:137], v232 offset:2176
  ds_read_b64 a[138:139], v232 offset:2184
  ds_read_b64 a[168:169], v232 offset:2688
  ds_read_b64 a[170:171], v232 offset:2696
  ds_read_b64 a[200:201], v232 offset:3200
  ds_read_b64 a[202:203], v232 offset:3208
  ds_read_b64 a[232:233], v232 offset:3712
  ds_read_b64 a[234:235], v232 offset:3720
  ds_read_b64 a[4:5], v232 offset:64
  ds_read_b64 a[6:7], v232 offset:72
  ds_read_b64 a[36:37], v232 offset:576
  ds_read_b64 a[38:39], v232 offset:584
  ds_read_b64 a[68:69], v232 offset:1088
  ds_read_b64 a[70:71], v232 offset:1096
  ds_read_b64 a[100:101], v232 offset:1600
  ds_read_b64 a[102:103], v232 offset:1608
  ds_read_b64 a[132:133], v232 offset:2112
  ds_read_b64 a[134:135], v232 offset:2120
  ds_read_b64 a[164:165], v232 offset:2624
  ds_read_b64 a[166:167], v232 offset:2632
  ds_read_b64 a[196:197], v232 offset:3136
  ds_read_b64 a[198:199], v232 offset:3144
  ds_read_b64 a[228:229], v232 offset:3648
  ds_read_b64 a[230:231], v232 offset:3656
  ds_read_b64 a[0:1], v232 offset:0
  ds_read_b64 a[2:3], v232 offset:8
  ds_read_b64 a[32:33], v232 offset:512
  ds_read_b64 a[34:35], v232 offset:520
  ds_read_b64 a[64:65], v232 offset:1024
  ds_read_b64 a[66:67], v232 offset:1032
  ds_read_b64 a[96:97], v232 offset:1536
  ds_read_b64 a[98:99], v232 offset:1544
  ds_read_b64 a[128:129], v232 offset:2048
  ds_read_b64 a[130:131], v232 offset:2056
  ds_read_b64 a[160:161], v232 offset:2560
  ds_read_b64 a[162:163], v232 offset:2568
  ds_read_b64 a[192:193], v232 offset:3072
  ds_read_b64 a[194:195], v232 offset:3080
  ds_read_b64 a[224:225], v232 offset:3584
  ds_read_b64 a[226:227], v232 offset:3592
  s_waitcnt vmcnt(5)
  ds_read_b128 v[48:51], v233 offset:0
  ds_read_b128 v[52:55], v233 offset:64
  ds_read_b128 v[56:59], v233 offset:128
  s_waitcnt lgkmcnt(2)
  v_mfma_f32_16x16x32_bf16 v[16:19], a[28:31], v[48:51], 0
  ds_read_b128 v[60:63], v233 offset:192
  s_waitcnt lgkmcnt(14)
  v_mfma_f32_16x16x32_bf16 v[20:23], a[60:63], v[48:51], 0
  s_waitcnt lgkmcnt(14)
  v_mfma_f32_16x16x32_bf16 v[24:27], a[92:95], v[48:51], 0
  s_waitcnt lgkmcnt(14)
  v_mfma_f32_16x16x32_bf16 v[28:31], a[124:127], v[48:51], 0
  s_waitcnt lgkmcnt(14)
  v_mfma_f32_16x16x32_bf16 v[32:35], a[156:159], v[48:51], 0
  s_waitcnt lgkmcnt(14)
  v_mfma_f32_16x16x32_bf16 v[36:39], a[188:191], v[48:51], 0
  s_waitcnt lgkmcnt(14)
  v_mfma_f32_16x16x32_bf16 v[40:43], a[220:223], v[48:51], 0
  s_waitcnt lgkmcnt(14)
  v_mfma_f32_16x16x32_bf16 v[44:47], a[252:255], v[48:51], 0
  s_waitcnt lgkmcnt(2)
  v_mfma_f32_16x16x32_bf16 v[16:19], a[24:27], v[52:55], v[16:19]
  ds_read_b128 v[48:51], v233 offset:256
  s_waitcnt lgkmcnt(14)
  v_mfma_f32_16x16x32_bf16 v[20:23], a[56:59], v[52:55], v[20:23]
  s_waitcnt lgkmcnt(14)
  v_mfma_f32_16x16x32_bf16 v[24:27], a[88:91], v[52:55], v[24:27]
  s_waitcnt lgkmcnt(14)
  v_mfma_f32_16x16x32_bf16 v[28:31], a[120:123], v[52:55], v[28:31]
  s_waitcnt lgkmcnt(14)
  v_mfma_f32_16x16x32_bf16 v[32:35], a[152:155], v[52:55], v[32:35]
  s_waitcnt lgkmcnt(14)
  v_mfma_f32_16x16x32_bf16 v[36:39], a[184:187], v[52:55], v[36:39]
  s_waitcnt lgkmcnt(14)
  v_mfma_f32_16x16x32_bf16 v[40:43], a[216:219], v[52:55], v[40:43]
  s_waitcnt lgkmcnt(14)
  v_mfma_f32_16x16x32_bf16 v[44:47], a[248:251], v[52:55], v[44:47]
  s_waitcnt lgkmcnt(2)
  v_mfma_f32_16x16x32_bf16 v[16:19], a[20:23], v[56:59], v[16:19]
  ds_read_b128 v[52:55], v233 offset:320
  s_waitcnt lgkmcnt(14)
  v_mfma_f32_16x16x32_bf16 v[20:23], a[52:55], v[56:59], v[20:23]
  s_waitcnt lgkmcnt(14)
  v_mfma_f32_16x16x32_bf16 v[24:27], a[84:87], v[56:59], v[24:27]
  s_waitcnt lgkmcnt(14)
  v_mfma_f32_16x16x32_bf16 v[28:31], a[116:119], v[56:59], v[28:31]
  s_add_u32 m0, s54, 0
  s_nop 0
  buffer_load_dwordx4 v104, s[24:27], s3 offen lds
  s_waitcnt lgkmcnt(14)
  v_mfma_f32_16x16x32_bf16 v[32:35], a[148:151], v[56:59], v[32:35]
  s_waitcnt lgkmcnt(14)
  v_mfma_f32_16x16x32_bf16 v[36:39], a[180:183], v[56:59], v[36:39]
  s_waitcnt lgkmcnt(14)
  v_mfma_f32_16x16x32_bf16 v[40:43], a[212:215], v[56:59], v[40:43]
  s_waitcnt lgkmcnt(14)
  v_mfma_f32_16x16x32_bf16 v[44:47], a[244:247], v[56:59], v[44:47]
  s_waitcnt lgkmcnt(2)
  v_mfma_f32_16x16x32_bf16 v[16:19], a[16:19], v[60:63], v[16:19]
  ds_read_b128 v[56:59], v233 offset:384
  s_waitcnt lgkmcnt(14)
  v_mfma_f32_16x16x32_bf16 v[20:23], a[48:51], v[60:63], v[20:23]
  s_waitcnt lgkmcnt(14)
  v_mfma_f32_16x16x32_bf16 v[24:27], a[80:83], v[60:63], v[24:27]
  s_waitcnt lgkmcnt(14)
  v_mfma_f32_16x16x32_bf16 v[28:31], a[112:115], v[60:63], v[28:31]
  s_waitcnt lgkmcnt(14)
  v_mfma_f32_16x16x32_bf16 v[32:35], a[144:147], v[60:63], v[32:35]
  s_waitcnt lgkmcnt(14)
  v_mfma_f32_16x16x32_bf16 v[36:39], a[176:179], v[60:63], v[36:39]
  s_add_u32 m0, s54, 1024
  s_nop 0
  buffer_load_dwordx4 v105, s[24:27], s3 offen lds
  s_waitcnt lgkmcnt(14)
  v_mfma_f32_16x16x32_bf16 v[40:43], a[208:211], v[60:63], v[40:43]
  s_waitcnt lgkmcnt(14)
  v_mfma_f32_16x16x32_bf16 v[44:47], a[240:243], v[60:63], v[44:47]
  s_waitcnt lgkmcnt(2)
  v_mfma_f32_16x16x32_bf16 v[16:19], a[12:15], v[48:51], v[16:19]
  ds_read_b128 v[60:63], v233 offset:448
  s_waitcnt lgkmcnt(14)
  v_mfma_f32_16x16x32_bf16 v[20:23], a[44:47], v[48:51], v[20:23]
  s_waitcnt lgkmcnt(14)
  v_mfma_f32_16x16x32_bf16 v[24:27], a[76:79], v[48:51], v[24:27]
  s_waitcnt lgkmcnt(14)
  v_mfma_f32_16x16x32_bf16 v[28:31], a[108:111], v[48:51], v[28:31]
  s_waitcnt lgkmcnt(14)
  v_mfma_f32_16x16x32_bf16 v[32:35], a[140:143], v[48:51], v[32:35]
  s_waitcnt lgkmcnt(14)
  v_mfma_f32_16x16x32_bf16 v[36:39], a[172:175], v[48:51], v[36:39]
  s_waitcnt lgkmcnt(14)
  v_mfma_f32_16x16x32_bf16 v[40:43], a[204:207], v[48:51], v[40:43]
  s_waitcnt lgkmcnt(14)
  v_mfma_f32_16x16x32_bf16 v[44:47], a[236:239], v[48:51], v[44:47]
  s_add_u32 m0, s54, 2048
  s_nop 0
  buffer_load_dwordx4 v106, s[24:27], s3 offen lds
  s_add_u32 s3, s3, 24576
  s_cmp_eq_u32 s3, 491520
  s_cselect_b32 s3, 0, s3
  s_waitcnt lgkmcnt(2)
  v_mfma_f32_16x16x32_bf16 v[16:19], a[8:11], v[52:55], v[16:19]
  ds_read_b128 v[48:51], v233 offset:512
  s_waitcnt lgkmcnt(14)
  v_mfma_f32_16x16x32_bf16 v[20:23], a[40:43], v[52:55], v[20:23]
  s_waitcnt lgkmcnt(14)
  v_mfma_f32_16x16x32_bf16 v[24:27], a[72:75], v[52:55], v[24:27]
  s_waitcnt lgkmcnt(14)
  v_mfma_f32_16x16x32_bf16 v[28:31], a[104:107], v[52:55], v[28:31]
  s_waitcnt lgkmcnt(14)
  v_mfma_f32_16x16x32_bf16 v[32:35], a[136:139], v[52:55], v[32:35]
  s_waitcnt lgkmcnt(14)
  v_mfma_f32_16x16x32_bf16 v[36:39], a[168:171], v[52:55], v[36:39]
  s_waitcnt lgkmcnt(14)
  v_mfma_f32_16x16x32_bf16 v[40:43], a[200:203], v[52:55], v[40:43]
  s_waitcnt lgkmcnt(14)
  v_mfma_f32_16x16x32_bf16 v[44:47], a[232:235], v[52:55], v[44:47]
  s_waitcnt lgkmcnt(2)
  v_mfma_f32_16x16x32_bf16 v[16:19], a[4:7], v[56:59], v[16:19]
  ds_read_b128 v[52:55], v233 offset:576
  s_waitcnt lgkmcnt(14)
  v_mfma_f32_16x16x32_bf16 v[20:23], a[36:39], v[56:59], v[20:23]
  s_add_u32 m0, s54, 12320
  s_nop 0
  buffer_load_dwordx4 v104, s[24:27], s3 offen lds
  s_waitcnt lgkmcnt(14)
  v_mfma_f32_16x16x32_bf16 v[24:27], a[68:71], v[56:59], v[24:27]
  s_waitcnt lgkmcnt(14)
  v_mfma_f32_16x16x32_bf16 v[28:31], a[100:103], v[56:59], v[28:31]
  s_waitcnt lgkmcnt(14)
  v_mfma_f32_16x16x32_bf16 v[32:35], a[132:135], v[56:59], v[32:35]
  s_waitcnt lgkmcnt(14)
  v_mfma_f32_16x16x32_bf16 v[36:39], a[164:167], v[56:59], v[36:39]
  s_waitcnt lgkmcnt(14)
  v_mfma_f32_16x16x32_bf16 v[40:43], a[196:199], v[56:59], v[40:43]
  s_waitcnt lgkmcnt(14)
  v_mfma_f32_16x16x32_bf16 v[44:47], a[228:231], v[56:59], v[44:47]
  s_waitcnt lgkmcnt(2)
  v_mfma_f32_16x16x32_bf16 v[16:19], a[0:3], v[60:63], v[16:19]
  v_mfma_f32_16x16x32_bf16 v[16:19], v[228:231], v[60:63], v[16:19]
  ds_read_b128 v[56:59], v233 offset:640
  s_waitcnt lgkmcnt(14)
  v_mfma_f32_16x16x32_bf16 v[20:23], a[32:35], v[60:63], v[20:23]
  s_waitcnt lgkmcnt(14)
  v_mfma_f32_16x16x32_bf16 v[24:27], a[64:67], v[60:63], v[24:27]
  s_waitcnt lgkmcnt(14)
  v_mfma_f32_16x16x32_bf16 v[28:31], a[96:99], v[60:63], v[28:31]
  s_add_u32 m0, s54, 13344
  s_nop 0
  buffer_load_dwordx4 v105, s[24:27], s3 offen lds
  s_waitcnt lgkmcnt(14)
  v_mfma_f32_16x16x32_bf16 v[32:35], a[128:131], v[60:63], v[32:35]
  v_cvt_pk_bf16_f32 v68, v16, v17
  v_cvt_pk_bf16_f32 v69, v18, v19
  s_add_u32 s53, s51, 0
  buffer_store_dwordx2 v[68:69], v234, s[4:7], s53 offen sc1
  s_waitcnt lgkmcnt(14)
  v_mfma_f32_16x16x32_bf16 v[36:39], a[160:163], v[60:63], v[36:39]
  s_waitcnt lgkmcnt(13)
  v_mfma_f32_16x16x32_bf16 v[40:43], a[192:195], v[60:63], v[40:43]
  s_waitcnt lgkmcnt(11)
  v_mfma_f32_16x16x32_bf16 v[44:47], a[224:227], v[60:63], v[44:47]
  s_waitcnt lgkmcnt(2)
  v_mfma_f32_16x16x32_bf16 v[20:23], a[28:31], v[48:51], v[20:23]
  ds_read_b128 v[60:63], v233 offset:704
  s_barrier
  v_mfma_f32_16x16x32_bf16 v[24:27], a[60:63], v[48:51], v[24:27]
  v_mfma_f32_16x16x32_bf16 v[28:31], a[92:95], v[48:51], v[28:31]
  v_mfma_f32_16x16x32_bf16 v[32:35], a[124:127], v[48:51], v[32:35]
  v_mfma_f32_16x16x32_bf16 v[36:39], a[156:159], v[48:51], v[36:39]
  v_mfma_f32_16x16x32_bf16 v[40:43], a[188:191], v[48:51], v[40:43]
  s_add_u32 m0, s54, 14368
  s_nop 0
  buffer_load_dwordx4 v106, s[24:27], s3 offen lds
  s_add_u32 s3, s3, 24576
  s_cmp_eq_u32 s3, 491520
  s_cselect_b32 s3, 0, s3
  v_mfma_f32_16x16x32_bf16 v[44:47], a[220:223], v[48:51], v[44:47]
  s_waitcnt lgkmcnt(2)
  v_mfma_f32_16x16x32_bf16 v[20:23], a[24:27], v[52:55], v[20:23]
  ds_read_b128 v[48:51], v233 offset:768
  v_mfma_f32_16x16x32_bf16 v[24:27], a[56:59], v[52:55], v[24:27]
  v_mfma_f32_16x16x32_bf16 v[28:31], a[88:91], v[52:55], v[28:31]
  v_mfma_f32_16x16x32_bf16 v[32:35], a[120:123], v[52:55], v[32:35]
  v_mfma_f32_16x16x32_bf16 v[36:39], a[152:155], v[52:55], v[36:39]
  v_mfma_f32_16x16x32_bf16 v[40:43], a[184:187], v[52:55], v[40:43]
  v_mfma_f32_16x16x32_bf16 v[44:47], a[216:219], v[52:55], v[44:47]
  s_waitcnt lgkmcnt(2)
  v_mfma_f32_16x16x32_bf16 v[20:23], a[20:23], v[56:59], v[20:23]
  ds_read_b128 v[52:55], v233 offset:832
  v_mfma_f32_16x16x32_bf16 v[24:27], a[52:55], v[56:59], v[24:27]
  s_add_u32 m0, s54, 24640
  s_nop 0
  buffer_load_dwordx4 v104, s[24:27], s3 offen lds
  v_mfma_f32_16x16x32_bf16 v[28:31], a[84:87], v[56:59], v[28:31]
  v_mfma_f32_16x16x32_bf16 v[32:35], a[116:119], v[56:59], v[32:35]
  v_mfma_f32_16x16x32_bf16 v[36:39], a[148:151], v[56:59], v[36:39]
  v_mfma_f32_16x16x32_bf16 v[40:43], a[180:183], v[56:59], v[40:43]
  v_mfma_f32_16x16x32_bf16 v[44:47], a[212:215], v[56:59], v[44:47]
  s_waitcnt lgkmcnt(2)
  v_mfma_f32_16x16x32_bf16 v[20:23], a[16:19], v[60:63], v[20:23]
  ds_read_b128 v[56:59], v233 offset:896
  v_mfma_f32_16x16x32_bf16 v[24:27], a[48:51], v[60:63], v[24:27]
  v_mfma_f32_16x16x32_bf16 v[28:31], a[80:83], v[60:63], v[28:31]
  v_mfma_f32_16x16x32_bf16 v[32:35], a[112:115], v[60:63], v[32:35]
  v_mfma_f32_16x16x32_bf16 v[36:39], a[144:147], v[60:63], v[36:39]
  s_add_u32 m0, s54, 25664
  s_nop 0
  buffer_load_dwordx4 v105, s[24:27], s3 offen lds
  v_mfma_f32_16x16x32_bf16 v[40:43], a[176:179], v[60:63], v[40:43]
  v_mfma_f32_16x16x32_bf16 v[44:47], a[208:211], v[60:63], v[44:47]
  s_waitcnt lgkmcnt(2)
  v_mfma_f32_16x16x32_bf16 v[20:23], a[12:15], v[48:51], v[20:23]
  ds_read_b128 v[60:63], v233 offset:960
  v_mfma_f32_16x16x32_bf16 v[24:27], a[44:47], v[48:51], v[24:27]
  v_mfma_f32_16x16x32_bf16 v[28:31], a[76:79], v[48:51], v[28:31]
  v_mfma_f32_16x16x32_bf16 v[32:35], a[108:111], v[48:51], v[32:35]
  v_mfma_f32_16x16x32_bf16 v[36:39], a[140:143], v[48:51], v[36:39]
  v_mfma_f32_16x16x32_bf16 v[40:43], a[172:175], v[48:51], v[40:43]
  v_mfma_f32_16x16x32_bf16 v[44:47], a[204:207], v[48:51], v[44:47]
  s_waitcnt lgkmcnt(2)
  v_mfma_f32_16x16x32_bf16 v[20:23], a[8:11], v[52:55], v[20:23]
  s_waitcnt vmcnt(13)
  ds_read_b128 v[48:51], v233 offset:1024
  s_add_u32 m0, s54, 26688
  s_nop 0
  buffer_load_dwordx4 v106, s[24:27], s3 offen lds
  s_add_u32 s3, s3, 24576
  s_cmp_eq_u32 s3, 491520
  s_cselect_b32 s3, 0, s3
  v_mfma_f32_16x16x32_bf16 v[24:27], a[40:43], v[52:55], v[24:27]
  v_mfma_f32_16x16x32_bf16 v[28:31], a[72:75], v[52:55], v[28:31]
  v_mfma_f32_16x16x32_bf16 v[32:35], a[104:107], v[52:55], v[32:35]
  v_mfma_f32_16x16x32_bf16 v[36:39], a[136:139], v[52:55], v[36:39]
  v_mfma_f32_16x16x32_bf16 v[40:43], a[168:171], v[52:55], v[40:43]
  v_mfma_f32_16x16x32_bf16 v[44:47], a[200:203], v[52:55], v[44:47]
  s_waitcnt lgkmcnt(2)
  v_mfma_f32_16x16x32_bf16 v[20:23], a[4:7], v[56:59], v[20:23]
  ds_read_b128 v[52:55], v233 offset:1088
  v_mfma_f32_16x16x32_bf16 v[24:27], a[36:39], v[56:59], v[24:27]
  v_mfma_f32_16x16x32_bf16 v[28:31], a[68:71], v[56:59], v[28:31]
  v_mfma_f32_16x16x32_bf16 v[32:35], a[100:103], v[56:59], v[32:35]
  s_add_u32 m0, s54, 36960
  s_nop 0
  buffer_load_dwordx4 v104, s[24:27], s3 offen lds
  v_mfma_f32_16x16x32_bf16 v[36:39], a[132:135], v[56:59], v[36:39]
  v_mfma_f32_16x16x32_bf16 v[40:43], a[164:167], v[56:59], v[40:43]
  v_mfma_f32_16x16x32_bf16 v[44:47], a[196:199], v[56:59], v[44:47]
  s_waitcnt lgkmcnt(2)
  v_mfma_f32_16x16x32_bf16 v[20:23], a[0:3], v[60:63], v[20:23]
  v_mfma_f32_16x16x32_bf16 v[20:23], v[228:231], v[60:63], v[20:23]
  ds_read_b128 v[56:59], v233 offset:1152
  v_mfma_f32_16x16x32_bf16 v[24:27], a[32:35], v[60:63], v[24:27]
  v_mfma_f32_16x16x32_bf16 v[28:31], a[64:67], v[60:63], v[28:31]
  v_mfma_f32_16x16x32_bf16 v[32:35], a[96:99], v[60:63], v[32:35]
  v_mfma_f32_16x16x32_bf16 v[36:39], a[128:131], v[60:63], v[36:39]
  s_nop 2
  v_cvt_pk_bf16_f32 v70, v20, v21
  v_cvt_pk_bf16_f32 v71, v22, v23
  s_add_u32 s53, s51, 327680
  buffer_store_dwordx2 v[70:71], v234, s[4:7], s53 offen sc1
  v_mfma_f32_16x16x32_bf16 v[40:43], a[160:163], v[60:63], v[40:43]
  v_mfma_f32_16x16x32_bf16 v[44:47], a[192:195], v[60:63], v[44:47]
  s_add_u32 m0, s54, 37984
  s_nop 0
  buffer_load_dwordx4 v105, s[24:27], s3 offen lds
  s_waitcnt lgkmcnt(2)
  v_mfma_f32_16x16x32_bf16 v[24:27], a[28:31], v[48:51], v[24:27]
  ds_read_b128 v[60:63], v233 offset:1216
  v_mfma_f32_16x16x32_bf16 v[28:31], a[60:63], v[48:51], v[28:31]
  v_mfma_f32_16x16x32_bf16 v[32:35], a[92:95], v[48:51], v[32:35]
  v_mfma_f32_16x16x32_bf16 v[36:39], a[124:127], v[48:51], v[36:39]
  v_mfma_f32_16x16x32_bf16 v[40:43], a[156:159], v[48:51], v[40:43]
  v_mfma_f32_16x16x32_bf16 v[44:47], a[188:191], v[48:51], v[44:47]
  s_waitcnt lgkmcnt(2)
  v_mfma_f32_16x16x32_bf16 v[24:27], a[24:27], v[52:55], v[24:27]
  ds_read_b128 v[48:51], v233 offset:1280
  v_mfma_f32_16x16x32_bf16 v[28:31], a[56:59], v[52:55], v[28:31]
  v_mfma_f32_16x16x32_bf16 v[32:35], a[88:91], v[52:55], v[32:35]
  v_mfma_f32_16x16x32_bf16 v[36:39], a[120:123], v[52:55], v[36:39]
  s_add_u32 m0, s54, 39008
  s_nop 0
  buffer_load_dwordx4 v106, s[24:27], s3 offen lds
  s_add_u32 s3, s3, 24576
  s_cmp_eq_u32 s3, 491520
  s_cselect_b32 s3, 0, s3
  v_mfma_f32_16x16x32_bf16 v[40:43], a[152:155], v[52:55], v[40:43]
  v_mfma_f32_16x16x32_bf16 v[44:47], a[184:187], v[52:55], v[44:47]
  s_waitcnt lgkmcnt(2)
  v_mfma_f32_16x16x32_bf16 v[24:27], a[20:23], v[56:59], v[24:27]
  ds_read_b128 v[52:55], v233 offset:1344
  v_mfma_f32_16x16x32_bf16 v[28:31], a[52:55], v[56:59], v[28:31]
  v_mfma_f32_16x16x32_bf16 v[32:35], a[84:87], v[56:59], v[32:35]
  v_mfma_f32_16x16x32_bf16 v[36:39], a[116:119], v[56:59], v[36:39]
  v_mfma_f32_16x16x32_bf16 v[40:43], a[148:151], v[56:59], v[40:43]
  v_mfma_f32_16x16x32_bf16 v[44:47], a[180:183], v[56:59], v[44:47]
  s_waitcnt lgkmcnt(2)
  v_mfma_f32_16x16x32_bf16 v[24:27], a[16:19], v[60:63], v[24:27]
  ds_read_b128 v[56:59], v233 offset:1408
  v_mfma_f32_16x16x32_bf16 v[28:31], a[48:51], v[60:63], v[28:31]
  s_add_u32 m0, s54, 49280
  s_nop 0
  buffer_load_dwordx4 v104, s[24:27], s3 offen lds
  v_mfma_f32_16x16x32_bf16 v[32:35], a[80:83], v[60:63], v[32:35]
  v_mfma_f32_16x16x32_bf16 v[36:39], a[112:115], v[60:63], v[36:39]
  v_mfma_f32_16x16x32_bf16 v[40:43], a[144:147], v[60:63], v[40:43]
  v_mfma_f32_16x16x32_bf16 v[44:47], a[176:179], v[60:63], v[44:47]
  s_waitcnt lgkmcnt(2)
  v_mfma_f32_16x16x32_bf16 v[24:27], a[12:15], v[48:51], v[24:27]
  ds_read_b128 v[60:63], v233 offset:1472
  v_mfma_f32_16x16x32_bf16 v[28:31], a[44:47], v[48:51], v[28:31]
  v_mfma_f32_16x16x32_bf16 v[32:35], a[76:79], v[48:51], v[32:35]
  v_mfma_f32_16x16x32_bf16 v[36:39], a[108:111], v[48:51], v[36:39]
  v_mfma_f32_16x16x32_bf16 v[40:43], a[140:143], v[48:51], v[40:43]
  v_mfma_f32_16x16x32_bf16 v[44:47], a[172:175], v[48:51], v[44:47]
  s_add_u32 m0, s54, 50304
  s_nop 0
  buffer_load_dwordx4 v105, s[24:27], s3 offen lds
  s_waitcnt lgkmcnt(2)
  v_mfma_f32_16x16x32_bf16 v[24:27], a[8:11], v[52:55], v[24:27]
  ds_read_b128 v[48:51], v233 offset:1536
  v_mfma_f32_16x16x32_bf16 v[28:31], a[40:43], v[52:55], v[28:31]
  v_mfma_f32_16x16x32_bf16 v[32:35], a[72:75], v[52:55], v[32:35]
  v_mfma_f32_16x16x32_bf16 v[36:39], a[104:107], v[52:55], v[36:39]
  v_mfma_f32_16x16x32_bf16 v[40:43], a[136:139], v[52:55], v[40:43]
  v_mfma_f32_16x16x32_bf16 v[44:47], a[168:171], v[52:55], v[44:47]
  s_waitcnt lgkmcnt(2)
  v_mfma_f32_16x16x32_bf16 v[24:27], a[4:7], v[56:59], v[24:27]
  ds_read_b128 v[52:55], v233 offset:1600
  v_mfma_f32_16x16x32_bf16 v[28:31], a[36:39], v[56:59], v[28:31]
  v_mfma_f32_16x16x32_bf16 v[32:35], a[68:71], v[56:59], v[32:35]
  v_mfma_f32_16x16x32_bf16 v[36:39], a[100:103], v[56:59], v[36:39]
  s_add_u32 m0, s54, 51328
  s_nop 0
  buffer_load_dwordx4 v106, s[24:27], s3 offen lds
  s_add_u32 s3, s3, 24576
  s_cmp_eq_u32 s3, 491520
  s_cselect_b32 s3, 0, s3
  v_mfma_f32_16x16x32_bf16 v[40:43], a[132:135], v[56:59], v[40:43]
  v_mfma_f32_16x16x32_bf16 v[44:47], a[164:167], v[56:59], v[44:47]
  s_waitcnt lgkmcnt(2)
  v_mfma_f32_16x16x32_bf16 v[24:27], a[0:3], v[60:63], v[24:27]
  v_mfma_f32_16x16x32_bf16 v[24:27], v[228:231], v[60:63], v[24:27]
  ds_read_b128 v[56:59], v233 offset:1664
  v_mfma_f32_16x16x32_bf16 v[28:31], a[32:35], v[60:63], v[28:31]
  v_mfma_f32_16x16x32_bf16 v[32:35], a[64:67], v[60:63], v[32:35]
  v_mfma_f32_16x16x32_bf16 v[36:39], a[96:99], v[60:63], v[36:39]
  v_mfma_f32_16x16x32_bf16 v[40:43], a[128:131], v[60:63], v[40:43]
  s_nop 2
  v_cvt_pk_bf16_f32 v68, v24, v25
  v_cvt_pk_bf16_f32 v69, v26, v27
  s_add_u32 s53, s51, 655360
  buffer_store_dwordx2 v[68:69], v234, s[4:7], s53 offen sc1
  v_mfma_f32_16x16x32_bf16 v[44:47], a[160:163], v[60:63], v[44:47]
  s_waitcnt lgkmcnt(2)
  v_mfma_f32_16x16x32_bf16 v[28:31], a[28:31], v[48:51], v[28:31]
  ds_read_b128 v[60:63], v233 offset:1728
  v_mfma_f32_16x16x32_bf16 v[32:35], a[60:63], v[48:51], v[32:35]
  s_add_u32 m0, s54, 81920
  s_nop 0
  buffer_load_dwordx4 v104, s[24:27], s3 offen lds
  v_mfma_f32_16x16x32_bf16 v[36:39], a[92:95], v[48:51], v[36:39]
  v_mfma_f32_16x16x32_bf16 v[40:43], a[124:127], v[48:51], v[40:43]
  v_mfma_f32_16x16x32_bf16 v[44:47], a[156:159], v[48:51], v[44:47]
  s_waitcnt lgkmcnt(2)
  v_mfma_f32_16x16x32_bf16 v[28:31], a[24:27], v[52:55], v[28:31]
  ds_read_b128 v[48:51], v233 offset:1792
  v_mfma_f32_16x16x32_bf16 v[32:35], a[56:59], v[52:55], v[32:35]
  v_mfma_f32_16x16x32_bf16 v[36:39], a[88:91], v[52:55], v[36:39]
  v_mfma_f32_16x16x32_bf16 v[40:43], a[120:123], v[52:55], v[40:43]
  v_mfma_f32_16x16x32_bf16 v[44:47], a[152:155], v[52:55], v[44:47]
  s_waitcnt lgkmcnt(2)
  v_mfma_f32_16x16x32_bf16 v[28:31], a[20:23], v[56:59], v[28:31]
  ds_read_b128 v[52:55], v233 offset:1856
  v_mfma_f32_16x16x32_bf16 v[32:35], a[52:55], v[56:59], v[32:35]
  s_add_u32 m0, s54, 82944
  s_nop 0
  buffer_load_dwordx4 v105, s[24:27], s3 offen lds
  v_mfma_f32_16x16x32_bf16 v[36:39], a[84:87], v[56:59], v[36:39]
  v_mfma_f32_16x16x32_bf16 v[40:43], a[116:119], v[56:59], v[40:43]
  v_mfma_f32_16x16x32_bf16 v[44:47], a[148:151], v[56:59], v[44:47]
  s_waitcnt lgkmcnt(2)
  v_mfma_f32_16x16x32_bf16 v[28:31], a[16:19], v[60:63], v[28:31]
  ds_read_b128 v[56:59], v233 offset:1920
  v_mfma_f32_16x16x32_bf16 v[32:35], a[48:51], v[60:63], v[32:35]
  v_mfma_f32_16x16x32_bf16 v[36:39], a[80:83], v[60:63], v[36:39]
  v_mfma_f32_16x16x32_bf16 v[40:43], a[112:115], v[60:63], v[40:43]
  v_mfma_f32_16x16x32_bf16 v[44:47], a[144:147], v[60:63], v[44:47]
  s_waitcnt lgkmcnt(2)
  v_mfma_f32_16x16x32_bf16 v[28:31], a[12:15], v[48:51], v[28:31]
  ds_read_b128 v[60:63], v233 offset:1984
  v_mfma_f32_16x16x32_bf16 v[32:35], a[44:47], v[48:51], v[32:35]
  s_add_u32 m0, s54, 83968
  s_nop 0
  buffer_load_dwordx4 v106, s[24:27], s3 offen lds
  s_add_u32 s3, s3, 24576
  s_cmp_eq_u32 s3, 491520
  s_cselect_b32 s3, 0, s3
  v_mfma_f32_16x16x32_bf16 v[36:39], a[76:79], v[48:51], v[36:39]
  v_mfma_f32_16x16x32_bf16 v[40:43], a[108:111], v[48:51], v[40:43]
  v_mfma_f32_16x16x32_bf16 v[44:47], a[140:143], v[48:51], v[44:47]
  s_waitcnt lgkmcnt(2)
  v_mfma_f32_16x16x32_bf16 v[28:31], a[8:11], v[52:55], v[28:31]
  s_waitcnt vmcnt(24)
  ds_read_b128 v[48:51], v233 offset:2048
  v_mfma_f32_16x16x32_bf16 v[32:35], a[40:43], v[52:55], v[32:35]
  v_mfma_f32_16x16x32_bf16 v[36:39], a[72:75], v[52:55], v[36:39]
  v_mfma_f32_16x16x32_bf16 v[40:43], a[104:107], v[52:55], v[40:43]
  v_mfma_f32_16x16x32_bf16 v[44:47], a[136:139], v[52:55], v[44:47]
  s_waitcnt lgkmcnt(2)
  v_mfma_f32_16x16x32_bf16 v[28:31], a[4:7], v[56:59], v[28:31]
  ds_read_b128 v[52:55], v233 offset:2112
  v_mfma_f32_16x16x32_bf16 v[32:35], a[36:39], v[56:59], v[32:35]
  s_add_u32 m0, s54, 94240
  s_nop 0
  buffer_load_dwordx4 v104, s[24:27], s3 offen lds
  v_mfma_f32_16x16x32_bf16 v[36:39], a[68:71], v[56:59], v[36:39]
  v_mfma_f32_16x16x32_bf16 v[40:43], a[100:103], v[56:59], v[40:43]
  v_mfma_f32_16x16x32_bf16 v[44:47], a[132:135], v[56:59], v[44:47]
  s_waitcnt lgkmcnt(2)
  v_mfma_f32_16x16x32_bf16 v[28:31], a[0:3], v[60:63], v[28:31]
  v_mfma_f32_16x16x32_bf16 v[28:31], v[228:231], v[60:63], v[28:31]
  ds_read_b128 v[56:59], v233 offset:2176
  v_mfma_f32_16x16x32_bf16 v[32:35], a[32:35], v[60:63], v[32:35]
  v_mfma_f32_16x16x32_bf16 v[36:39], a[64:67], v[60:63], v[36:39]
  v_mfma_f32_16x16x32_bf16 v[40:43], a[96:99], v[60:63], v[40:43]
  v_mfma_f32_16x16x32_bf16 v[44:47], a[128:131], v[60:63], v[44:47]
  s_nop 2
  v_cvt_pk_bf16_f32 v70, v28, v29
  v_cvt_pk_bf16_f32 v71, v30, v31
  s_add_u32 s53, s51, 983040
  buffer_store_dwordx2 v[70:71], v234, s[4:7], s53 offen sc1
  s_waitcnt lgkmcnt(2)
  v_mfma_f32_16x16x32_bf16 v[32:35], a[28:31], v[48:51], v[32:35]
  ds_read_b128 v[60:63], v233 offset:2240
  v_mfma_f32_16x16x32_bf16 v[36:39], a[60:63], v[48:51], v[36:39]
  s_add_u32 m0, s54, 95264
  s_nop 0
  buffer_load_dwordx4 v105, s[24:27], s3 offen lds
  v_mfma_f32_16x16x32_bf16 v[40:43], a[92:95], v[48:51], v[40:43]
  v_mfma_f32_16x16x32_bf16 v[44:47], a[124:127], v[48:51], v[44:47]
  s_waitcnt lgkmcnt(2)
  v_mfma_f32_16x16x32_bf16 v[32:35], a[24:27], v[52:55], v[32:35]
  ds_read_b128 v[48:51], v233 offset:2304
  v_mfma_f32_16x16x32_bf16 v[36:39], a[56:59], v[52:55], v[36:39]
  v_mfma_f32_16x16x32_bf16 v[40:43], a[88:91], v[52:55], v[40:43]
  v_mfma_f32_16x16x32_bf16 v[44:47], a[120:123], v[52:55], v[44:47]
  s_waitcnt lgkmcnt(2)
  v_mfma_f32_16x16x32_bf16 v[32:35], a[20:23], v[56:59], v[32:35]
  ds_read_b128 v[52:55], v233 offset:2368
  v_mfma_f32_16x16x32_bf16 v[36:39], a[52:55], v[56:59], v[36:39]
  v_mfma_f32_16x16x32_bf16 v[40:43], a[84:87], v[56:59], v[40:43]
  v_mfma_f32_16x16x32_bf16 v[44:47], a[116:119], v[56:59], v[44:47]
  s_add_u32 m0, s54, 96288
  s_nop 0
  buffer_load_dwordx4 v106, s[24:27], s3 offen lds
  s_add_u32 s3, s3, 24576
  s_cmp_eq_u32 s3, 491520
  s_cselect_b32 s3, 0, s3
  s_waitcnt lgkmcnt(2)
  v_mfma_f32_16x16x32_bf16 v[32:35], a[16:19], v[60:63], v[32:35]
  ds_read_b128 v[56:59], v233 offset:2432
  v_mfma_f32_16x16x32_bf16 v[36:39], a[48:51], v[60:63], v[36:39]
  v_mfma_f32_16x16x32_bf16 v[40:43], a[80:83], v[60:63], v[40:43]
  v_mfma_f32_16x16x32_bf16 v[44:47], a[112:115], v[60:63], v[44:47]
  s_waitcnt lgkmcnt(2)
  v_mfma_f32_16x16x32_bf16 v[32:35], a[12:15], v[48:51], v[32:35]
  ds_read_b128 v[60:63], v233 offset:2496
  v_mfma_f32_16x16x32_bf16 v[36:39], a[44:47], v[48:51], v[36:39]
  v_mfma_f32_16x16x32_bf16 v[40:43], a[76:79], v[48:51], v[40:43]
  v_mfma_f32_16x16x32_bf16 v[44:47], a[108:111], v[48:51], v[44:47]
  s_waitcnt lgkmcnt(2)
  v_mfma_f32_16x16x32_bf16 v[32:35], a[8:11], v[52:55], v[32:35]
  ds_read_b128 v[48:51], v233 offset:2560
  v_mfma_f32_16x16x32_bf16 v[36:39], a[40:43], v[52:55], v[36:39]
  s_add_u32 m0, s54, 106560
  s_nop 0
  buffer_load_dwordx4 v104, s[24:27], s3 offen lds
  v_mfma_f32_16x16x32_bf16 v[40:43], a[72:75], v[52:55], v[40:43]
  v_mfma_f32_16x16x32_bf16 v[44:47], a[104:107], v[52:55], v[44:47]
  s_waitcnt lgkmcnt(2)
  v_mfma_f32_16x16x32_bf16 v[32:35], a[4:7], v[56:59], v[32:35]
  ds_read_b128 v[52:55], v233 offset:2624
  v_mfma_f32_16x16x32_bf16 v[36:39], a[36:39], v[56:59], v[36:39]
  v_mfma_f32_16x16x32_bf16 v[40:43], a[68:71], v[56:59], v[40:43]
  v_mfma_f32_16x16x32_bf16 v[44:47], a[100:103], v[56:59], v[44:47]
  s_waitcnt lgkmcnt(2)
  v_mfma_f32_16x16x32_bf16 v[32:35], a[0:3], v[60:63], v[32:35]
  v_mfma_f32_16x16x32_bf16 v[32:35], v[228:231], v[60:63], v[32:35]
  ds_read_b128 v[56:59], v233 offset:2688
  v_mfma_f32_16x16x32_bf16 v[36:39], a[32:35], v[60:63], v[36:39]
  v_mfma_f32_16x16x32_bf16 v[40:43], a[64:67], v[60:63], v[40:43]
  v_mfma_f32_16x16x32_bf16 v[44:47], a[96:99], v[60:63], v[44:47]
  s_add_u32 m0, s54, 107584
  s_nop 0
  buffer_load_dwordx4 v105, s[24:27], s3 offen lds
  s_waitcnt lgkmcnt(2)
  v_mfma_f32_16x16x32_bf16 v[36:39], a[28:31], v[48:51], v[36:39]
  ds_read_b128 v[60:63], v233 offset:2752
  v_cvt_pk_bf16_f32 v68, v32, v33
  v_cvt_pk_bf16_f32 v69, v34, v35
  s_add_u32 s53, s51, 1310720
  buffer_store_dwordx2 v[68:69], v234, s[4:7], s53 offen sc1
  v_mfma_f32_16x16x32_bf16 v[40:43], a[60:63], v[48:51], v[40:43]
  v_mfma_f32_16x16x32_bf16 v[44:47], a[92:95], v[48:51], v[44:47]
  s_waitcnt lgkmcnt(2)
  v_mfma_f32_16x16x32_bf16 v[36:39], a[24:27], v[52:55], v[36:39]
  ds_read_b128 v[48:51], v233 offset:2816
  v_mfma_f32_16x16x32_bf16 v[40:43], a[56:59], v[52:55], v[40:43]
  v_mfma_f32_16x16x32_bf16 v[44:47], a[88:91], v[52:55], v[44:47]
  s_waitcnt lgkmcnt(2)
  v_mfma_f32_16x16x32_bf16 v[36:39], a[20:23], v[56:59], v[36:39]
  ds_read_b128 v[52:55], v233 offset:2880
  v_mfma_f32_16x16x32_bf16 v[40:43], a[52:55], v[56:59], v[40:43]
  v_mfma_f32_16x16x32_bf16 v[44:47], a[84:87], v[56:59], v[44:47]
  s_waitcnt lgkmcnt(2)
  v_mfma_f32_16x16x32_bf16 v[36:39], a[16:19], v[60:63], v[36:39]
  ds_read_b128 v[56:59], v233 offset:2944
  v_mfma_f32_16x16x32_bf16 v[40:43], a[48:51], v[60:63], v[40:43]
  v_mfma_f32_16x16x32_bf16 v[44:47], a[80:83], v[60:63], v[44:47]
  s_waitcnt lgkmcnt(2)
  v_mfma_f32_16x16x32_bf16 v[36:39], a[12:15], v[48:51], v[36:39]
  ds_read_b128 v[60:63], v233 offset:3008
  v_mfma_f32_16x16x32_bf16 v[40:43], a[44:47], v[48:51], v[40:43]
  v_mfma_f32_16x16x32_bf16 v[44:47], a[76:79], v[48:51], v[44:47]
  s_waitcnt lgkmcnt(2)
  v_mfma_f32_16x16x32_bf16 v[36:39], a[8:11], v[52:55], v[36:39]
  s_waitcnt vmcnt(30)
  ds_read_b128 v[48:51], v233 offset:3072
  v_mfma_f32_16x16x32_bf16 v[40:43], a[40:43], v[52:55], v[40:43]
  v_mfma_f32_16x16x32_bf16 v[44:47], a[72:75], v[52:55], v[44:47]
  s_waitcnt lgkmcnt(2)
  v_mfma_f32_16x16x32_bf16 v[36:39], a[4:7], v[56:59], v[36:39]
  ds_read_b128 v[52:55], v233 offset:3136
  v_mfma_f32_16x16x32_bf16 v[40:43], a[36:39], v[56:59], v[40:43]
  v_mfma_f32_16x16x32_bf16 v[44:47], a[68:71], v[56:59], v[44:47]
  s_waitcnt lgkmcnt(2)
  v_mfma_f32_16x16x32_bf16 v[36:39], a[0:3], v[60:63], v[36:39]
  v_mfma_f32_16x16x32_bf16 v[36:39], v[228:231], v[60:63], v[36:39]
  ds_read_b128 v[56:59], v233 offset:3200
  v_mfma_f32_16x16x32_bf16 v[40:43], a[32:35], v[60:63], v[40:43]
  v_mfma_f32_16x16x32_bf16 v[44:47], a[64:67], v[60:63], v[44:47]
  s_waitcnt lgkmcnt(2)
  v_mfma_f32_16x16x32_bf16 v[40:43], a[28:31], v[48:51], v[40:43]
  ds_read_b128 v[60:63], v233 offset:3264
  v_mfma_f32_16x16x32_bf16 v[44:47], a[60:63], v[48:51], v[44:47]
  s_nop 0
  v_cvt_pk_bf16_f32 v70, v36, v37
  v_cvt_pk_bf16_f32 v71, v38, v39
  s_add_u32 s53, s51, 1638400
  buffer_store_dwordx2 v[70:71], v234, s[4:7], s53 offen sc1
  s_waitcnt lgkmcnt(2)
  v_mfma_f32_16x16x32_bf16 v[40:43], a[24:27], v[52:55], v[40:43]
  ds_read_b128 v[48:51], v233 offset:3328
  v_mfma_f32_16x16x32_bf16 v[44:47], a[56:59], v[52:55], v[44:47]
  s_waitcnt lgkmcnt(2)
  v_mfma_f32_16x16x32_bf16 v[40:43], a[20:23], v[56:59], v[40:43]
  ds_read_b128 v[52:55], v233 offset:3392
  v_mfma_f32_16x16x32_bf16 v[44:47], a[52:55], v[56:59], v[44:47]
  s_waitcnt lgkmcnt(2)
  v_mfma_f32_16x16x32_bf16 v[40:43], a[16:19], v[60:63], v[40:43]
  ds_read_b128 v[56:59], v233 offset:3456
  v_mfma_f32_16x16x32_bf16 v[44:47], a[48:51], v[60:63], v[44:47]
  s_waitcnt lgkmcnt(2)
  v_mfma_f32_16x16x32_bf16 v[40:43], a[12:15], v[48:51], v[40:43]
  ds_read_b128 v[60:63], v233 offset:3520
  v_mfma_f32_16x16x32_bf16 v[44:47], a[44:47], v[48:51], v[44:47]
  s_waitcnt lgkmcnt(2)
  v_mfma_f32_16x16x32_bf16 v[40:43], a[8:11], v[52:55], v[40:43]
  ds_read_b128 v[48:51], v233 offset:3584
  v_mfma_f32_16x16x32_bf16 v[44:47], a[40:43], v[52:55], v[44:47]
  s_waitcnt lgkmcnt(2)
  v_mfma_f32_16x16x32_bf16 v[40:43], a[4:7], v[56:59], v[40:43]
  ds_read_b128 v[52:55], v233 offset:3648
  v_mfma_f32_16x16x32_bf16 v[44:47], a[36:39], v[56:59], v[44:47]
  s_waitcnt lgkmcnt(2)
  v_mfma_f32_16x16x32_bf16 v[40:43], a[0:3], v[60:63], v[40:43]
  v_mfma_f32_16x16x32_bf16 v[40:43], v[228:231], v[60:63], v[40:43]
  ds_read_b128 v[56:59], v233 offset:3712
  v_mfma_f32_16x16x32_bf16 v[44:47], a[32:35], v[60:63], v[44:47]
  s_waitcnt lgkmcnt(2)
  v_mfma_f32_16x16x32_bf16 v[44:47], a[28:31], v[48:51], v[44:47]
  ds_read_b128 v[60:63], v233 offset:3776
  s_waitcnt lgkmcnt(2)
  v_mfma_f32_16x16x32_bf16 v[44:47], a[24:27], v[52:55], v[44:47]
  ds_read_b128 v[48:51], v233 offset:3840
  s_waitcnt lgkmcnt(2)
  v_mfma_f32_16x16x32_bf16 v[44:47], a[20:23], v[56:59], v[44:47]
  ds_read_b128 v[52:55], v233 offset:3904
  v_cvt_pk_bf16_f32 v68, v40, v41
  v_cvt_pk_bf16_f32 v69, v42, v43
  s_add_u32 s53, s51, 1966080
  buffer_store_dwordx2 v[68:69], v234, s[4:7], s53 offen sc1
  s_waitcnt lgkmcnt(2)
  v_mfma_f32_16x16x32_bf16 v[44:47], a[16:19], v[60:63], v[44:47]
  ds_read_b128 v[56:59], v233 offset:3968
  s_waitcnt lgkmcnt(2)
  v_mfma_f32_16x16x32_bf16 v[44:47], a[12:15], v[48:51], v[44:47]
  ds_read_b128 v[60:63], v233 offset:4032
  s_waitcnt lgkmcnt(2)
  v_mfma_f32_16x16x32_bf16 v[44:47], a[8:11], v[52:55], v[44:47]
  s_waitcnt lgkmcnt(1)
  v_mfma_f32_16x16x32_bf16 v[44:47], a[4:7], v[56:59], v[44:47]
  s_waitcnt lgkmcnt(0)
  v_mfma_f32_16x16x32_bf16 v[44:47], a[0:3], v[60:63], v[44:47]
  v_mfma_f32_16x16x32_bf16 v[44:47], v[228:231], v[60:63], v[44:47]
  s_nop 7
  v_cvt_pk_bf16_f32 v70, v44, v45
  v_cvt_pk_bf16_f32 v71, v46, v47
  s_add_u32 s53, s51, 2293760
  buffer_store_dwordx2 v[70:71], v234, s[4:7], s53 offen sc1
  s_waitcnt vmcnt(0)
  s_add_u32 s46, s64, 4096
  s_mov_b64 exec, 1
  buffer_store_dword v1, off, s[4:7], s46
  s_mov_b64 exec, -1
  s_barrier
  ds_read_b64_tr_b16 v[112:113], v107 offset:0
  ds_read_b64_tr_b16 v[114:115], v107 offset:3072
  ds_read_b64_tr_b16 v[116:117], v107 offset:16
  ds_read_b64_tr_b16 v[118:119], v107 offset:3088
  ds_read_b64_tr_b16 v[120:121], v108 offset:0
  ds_read_b64_tr_b16 v[122:123], v108 offset:3072
  ds_read_b64_tr_b16 v[124:125], v107 offset:12320
  ds_read_b64_tr_b16 v[126:127], v107 offset:15392
  ds_read_b64_tr_b16 v[128:129], v107 offset:12336
  ds_read_b64_tr_b16 v[130:131], v107 offset:15408
  ds_read_b64_tr_b16 v[132:133], v108 offset:12320
  ds_read_b64_tr_b16 v[134:135], v108 offset:15392
  ds_read_b64_tr_b16 v[136:137], v107 offset:24640
  ds_read_b64_tr_b16 v[138:139], v107 offset:27712
  ds_read_b64_tr_b16 v[140:141], v107 offset:24656
  ds_read_b64_tr_b16 v[142:143], v107 offset:27728
  ds_read_b64_tr_b16 v[144:145], v108 offset:24640
  ds_read_b64_tr_b16 v[146:147], v108 offset:27712
  ds_read_b64_tr_b16 v[148:149], v107 offset:36960
  ds_read_b64_tr_b16 v[150:151], v107 offset:40032
  ds_read_b64_tr_b16 v[152:153], v107 offset:36976
  ds_read_b64_tr_b16 v[154:155], v107 offset:40048
  ds_read_b64_tr_b16 v[156:157], v108 offset:36960
  ds_read_b64_tr_b16 v[158:159], v108 offset:40032
  ds_read_b64_tr_b16 v[160:161], v107 offset:49280
  ds_read_b64_tr_b16 v[162:163], v107 offset:52352
  ds_read_b64_tr_b16 v[164:165], v107 offset:49296
  ds_read_b64_tr_b16 v[166:167], v107 offset:52368
  ds_read_b64_tr_b16 v[168:169], v108 offset:49280
  ds_read_b64_tr_b16 v[170:171], v108 offset:52352
  s_waitcnt vmcnt(0)
  s_add_u32 s46, s65, 4096
  buffer_load_dwordx4 v[8:11], v95, s[4:7], s46 offen sc1
  s_add_u32 m0, s54, 108608
  s_nop 0
  buffer_load_dwordx4 v106, s[24:27], s3 offen lds
  s_add_u32 s3, s3, 24576
  s_cmp_eq_u32 s3, 491520
  s_cselect_b32 s3, 0, s3
  s_add_u32 m0, s54, 118880
  s_nop 0
  buffer_load_dwordx4 v104, s[24:27], s3 offen lds
  s_add_u32 m0, s54, 119904
  s_nop 0
  buffer_load_dwordx4 v105, s[24:27], s3 offen lds
  s_add_u32 m0, s54, 120928
  s_nop 0
  buffer_load_dwordx4 v106, s[24:27], s3 offen lds
  s_add_u32 s3, s3, 24576
  s_cmp_eq_u32 s3, 491520
  s_cselect_b32 s3, 0, s3
  s_add_u32 m0, s54, 131200
  s_nop 0
  buffer_load_dwordx4 v104, s[24:27], s3 offen lds
  s_add_u32 m0, s54, 132224
  s_nop 0
  buffer_load_dwordx4 v105, s[24:27], s3 offen lds
  s_add_u32 m0, s54, 133248
  s_nop 0
  buffer_load_dwordx4 v106, s[24:27], s3 offen lds
  s_add_u32 s3, s3, 24576
  s_cmp_eq_u32 s3, 491520
  s_cselect_b32 s3, 0, s3
  s_add_u32 m0, s54, 143520
  s_nop 0
  buffer_load_dwordx4 v104, s[24:27], s3 offen lds
  s_add_u32 m0, s54, 144544
  s_nop 0
  buffer_load_dwordx4 v105, s[24:27], s3 offen lds
  s_add_u32 m0, s54, 145568
  s_nop 0
  buffer_load_dwordx4 v106, s[24:27], s3 offen lds
  s_add_u32 s3, s3, 24576
  s_cmp_eq_u32 s3, 491520
  s_cselect_b32 s3, 0, s3
  s_waitcnt lgkmcnt(0)
  s_barrier
  v_lshrrev_b32 v12, 3, v0
  v_lshlrev_b32 v12, 10, v12
  v_and_b32 v13, 7, v0
  v_lshl_add_u32 v12, v13, 4, v12
  s_lshl_b32 s48, s40, 7
  s_add_u32 s48, s48, 77824
  s_waitcnt vmcnt(10)
  v_bitop3_b32 v8, v8, v9, v1 bitop3:0x7e
  v_bitop3_b32 v10, v10, v11, v1 bitop3:0x7e
  v_or_b32 v8, v8, v10
  v_cmp_ne_u32 vcc, 0, v8
  s_nop 3
  s_cbranch_vccnz Lypass_4
  v_mov_b32 v8, v1
  v_mov_b32 v9, v1
  v_mov_b32 v10, v1
  v_mov_b32 v11, v1
  buffer_store_dwordx4 v[8:11], v12, s[4:7], s48 offen sc1
Lypass_4:
  s_add_u32 m0, s54, 0
  s_nop 0
  buffer_load_dwordx4 v104, s[24:27], s3 offen lds
  ds_read_b64_tr_b16 v[172:173], v110 offset:0
  ds_read_b64_tr_b16 v[174:175], v110 offset:3072
  ds_read_b64_tr_b16 v[176:177], v110 offset:16
  s_add_u32 m0, s54, 1024
  s_nop 0
  buffer_load_dwordx4 v105, s[24:27], s3 offen lds
  ds_read_b64_tr_b16 v[178:179], v110 offset:3088
  ds_read_b64_tr_b16 v[180:181], v111 offset:0
  ds_read_b64_tr_b16 v[182:183], v111 offset:3072
  s_add_u32 m0, s54, 2048
  s_nop 0
  buffer_load_dwordx4 v106, s[24:27], s3 offen lds
  s_add_u32 s3, s3, 24576
  s_cmp_eq_u32 s3, 491520
  s_cselect_b32 s3, 0, s3
  ds_read_b64_tr_b16 v[184:185], v110 offset:12320
  ds_read_b64_tr_b16 v[186:187], v110 offset:15392
  ds_read_b64_tr_b16 v[188:189], v110 offset:12336
  s_add_u32 m0, s54, 12320
  s_nop 0
  buffer_load_dwordx4 v104, s[24:27], s3 offen lds
  ds_read_b64_tr_b16 v[190:191], v110 offset:15408
  ds_read_b64_tr_b16 v[192:193], v111 offset:12320
  ds_read_b64_tr_b16 v[194:195], v111 offset:15392
  s_add_u32 m0, s54, 13344
  s_nop 0
  buffer_load_dwordx4 v105, s[24:27], s3 offen lds
  s_add_u32 m0, s54, 14368
  s_nop 0
  buffer_load_dwordx4 v106, s[24:27], s3 offen lds
  s_add_u32 s3, s3, 24576
  s_cmp_eq_u32 s3, 491520
  s_cselect_b32 s3, 0, s3
  s_add_u32 m0, s54, 24640
  s_nop 0
  buffer_load_dwordx4 v104, s[24:27], s3 offen lds
  s_add_u32 m0, s54, 25664
  s_nop 0
  buffer_load_dwordx4 v105, s[24:27], s3 offen lds
  s_add_u32 m0, s54, 26688
  s_nop 0
  buffer_load_dwordx4 v106, s[24:27], s3 offen lds
  s_add_u32 s3, s3, 24576
  s_cmp_eq_u32 s3, 491520
  s_cselect_b32 s3, 0, s3
  s_add_u32 m0, s54, 36960
  s_nop 0
  buffer_load_dwordx4 v104, s[24:27], s3 offen lds
  s_add_u32 m0, s54, 37984
  s_nop 0
  buffer_load_dwordx4 v105, s[24:27], s3 offen lds
  s_add_u32 m0, s54, 39008
  s_nop 0
  buffer_load_dwordx4 v106, s[24:27], s3 offen lds
  s_add_u32 s3, s3, 24576
  s_cmp_eq_u32 s3, 491520
  s_cselect_b32 s3, 0, s3
  s_add_u32 m0, s54, 49280
  s_nop 0
  buffer_load_dwordx4 v104, s[24:27], s3 offen lds
  s_add_u32 m0, s54, 50304
  s_nop 0
  buffer_load_dwordx4 v105, s[24:27], s3 offen lds
  s_add_u32 m0, s54, 51328
  s_nop 0
  buffer_load_dwordx4 v106, s[24:27], s3 offen lds
  s_add_u32 s3, s3, 24576
  s_cmp_eq_u32 s3, 491520
  s_cselect_b32 s3, 0, s3
  s_waitcnt vmcnt(15)
  s_barrier
  ds_read_b64_tr_b16 v[196:197], v110 offset:24640
  ds_read_b64_tr_b16 v[198:199], v110 offset:27712
  ds_read_b64_tr_b16 v[200:201], v110 offset:24656
  ds_read_b64_tr_b16 v[202:203], v110 offset:27728
  ds_read_b64_tr_b16 v[204:205], v111 offset:24640
  ds_read_b64_tr_b16 v[206:207], v111 offset:27712
  ds_read_b64_tr_b16 v[208:209], v110 offset:36960
  ds_read_b64_tr_b16 v[210:211], v110 offset:40032
  ds_read_b64_tr_b16 v[212:213], v110 offset:36976
  ds_read_b64_tr_b16 v[214:215], v110 offset:40048
  ds_read_b64_tr_b16 v[216:217], v111 offset:36960
  ds_read_b64_tr_b16 v[218:219], v111 offset:40032
  ds_read_b64_tr_b16 v[220:221], v110 offset:49280
  ds_read_b64_tr_b16 v[222:223], v110 offset:52352
  ds_read_b64_tr_b16 v[224:225], v110 offset:49296
  ds_read_b64_tr_b16 v[226:227], v110 offset:52368
  ds_read_b64_tr_b16 v[228:229], v111 offset:49280
  ds_read_b64_tr_b16 v[230:231], v111 offset:52352
  ds_read_b64_tr_b16 v[232:233], v110 offset:61600
  ds_read_b64_tr_b16 v[234:235], v110 offset:64672
  ds_read_b64_tr_b16 v[236:237], v110 offset:61616
  ds_read_b64_tr_b16 v[238:239], v110 offset:64688
  ds_read_b64_tr_b16 v[240:241], v111 offset:61600
  ds_read_b64_tr_b16 v[242:243], v111 offset:64672
  s_waitcnt lgkmcnt(0)
  s_barrier
  s_branch L_join_f
L_noconv_f:
  s_waitcnt vmcnt(0)
  s_add_u32 s46, s64, 0
  s_mov_b64 exec, 1
  buffer_store_dword v96, off, s[4:7], s46
  s_mov_b64 exec, -1
  s_add_u32 m0, s56, 0
  s_nop 0
  buffer_load_dwordx4 v98, s[28:31], s57 offen nt lds
  s_add_u32 m0, s56, 1024
  s_nop 0
  buffer_load_dwordx4 v99, s[28:31], s57 offen nt lds
  s_add_u32 m0, s56, 2048
  s_nop 0
  buffer_load_dwordx4 v100, s[28:31], s57 offen nt lds
  s_add_u32 m0, s56, 3072
  s_nop 0
  buffer_load_dwordx4 v101, s[28:31], s57 offen nt lds
  s_add_u32 m0, s56, 4096
  s_nop 0
  buffer_load_dwordx4 v102, s[28:31], s57 offen nt lds
  s_barrier
  buffer_load_dword v92, v84, s[24:27], 0 offen
  s_add_u32 m0, s54, 0
  s_nop 0
  buffer_load_dwordx4 v104, s[24:27], s3 offen lds
  s_add_u32 m0, s54, 1024
  s_nop 0
  buffer_load_dwordx4 v105, s[24:27], s3 offen lds
  s_add_u32 m0, s54, 2048
  s_nop 0
  buffer_load_dwordx4 v106, s[24:27], s3 offen lds
  s_add_u32 s3, s3, 24576
  s_cmp_eq_u32 s3, 491520
  s_cselect_b32 s3, 0, s3
  s_add_u32 m0, s54, 12320
  s_nop 0
  buffer_load_dwordx4 v104, s[24:27], s3 offen lds
  s_add_u32 m0, s54, 13344
  s_nop 0
  buffer_load_dwordx4 v105, s[24:27], s3 offen lds
  s_add_u32 m0, s54, 14368
  s_nop 0
  buffer_load_dwordx4 v106, s[24:27], s3 offen lds
  s_add_u32 s3, s3, 24576
  s_cmp_eq_u32 s3, 491520
  s_cselect_b32 s3, 0, s3
  s_add_u32 m0, s54, 24640
  s_nop 0
  buffer_load_dwordx4 v104, s[24:27], s3 offen lds
  s_add_u32 m0, s54, 25664
  s_nop 0
  buffer_load_dwordx4 v105, s[24:27], s3 offen lds
  s_add_u32 m0, s54, 26688
  s_nop 0
  buffer_load_dwordx4 v106, s[24:27], s3 offen lds
  s_add_u32 s3, s3, 24576
  s_cmp_eq_u32 s3, 491520
  s_cselect_b32 s3, 0, s3
  s_add_u32 m0, s54, 36960
  s_nop 0
  buffer_load_dwordx4 v104, s[24:27], s3 offen lds
  s_add_u32 m0, s54, 37984
  s_nop 0
  buffer_load_dwordx4 v105, s[24:27], s3 offen lds
  s_add_u32 m0, s54, 39008
  s_nop 0
  buffer_load_dwordx4 v106, s[24:27], s3 offen lds
  s_add_u32 s3, s3, 24576
  s_cmp_eq_u32 s3, 491520
  s_cselect_b32 s3, 0, s3
  s_waitcnt vmcnt(13)
  ds_read_b64_tr_b16 v[16:17], v103 offset:0
  ds_read_b64_tr_b16 v[18:19], v103 offset:2560
  ds_read_b64_tr_b16 v[20:21], v103 offset:32
  ds_read_b64_tr_b16 v[22:23], v103 offset:2592
  ds_read_b64_tr_b16 v[24:25], v103 offset:64
  ds_read_b64_tr_b16 v[26:27], v103 offset:2624
  ds_read_b64_tr_b16 v[28:29], v103 offset:96
  ds_read_b64_tr_b16 v[30:31], v103 offset:2656
  ds_read_b64_tr_b16 v[32:33], v103 offset:128
  ds_read_b64_tr_b16 v[34:35], v103 offset:2688
  s_waitcnt lgkmcnt(0)
  s_add_u32 s53, s52, 4096
  buffer_store_dwordx4 v[16:19], v2, s[4:7], s52 offen offset:0 sc1
  buffer_store_dwordx4 v[20:23], v2, s[4:7], s52 offen offset:1024 sc1
  buffer_store_dwordx4 v[24:27], v2, s[4:7], s52 offen offset:2048 sc1
  buffer_store_dwordx4 v[28:31], v2, s[4:7], s52 offen offset:3072 sc1
  buffer_store_dwordx4 v[32:35], v2, s[4:7], s53 offen offset:0 sc1
  s_add_u32 s46, s65, 0
  s_mov_b32 s63, 0
  buffer_load_dwordx4 v[8:11], v95, s[4:7], s46 offen sc1
  s_add_u32 m0, s54, 49280
  s_nop 0
  buffer_load_dwordx4 v104, s[24:27], s3 offen lds
  s_add_u32 m0, s54, 50304
  s_nop 0
  buffer_load_dwordx4 v105, s[24:27], s3 offen lds
  s_add_u32 m0, s54, 51328
  s_nop 0
  buffer_load_dwordx4 v106, s[24:27], s3 offen lds
  s_add_u32 s3, s3, 24576
  s_cmp_eq_u32 s3, 491520
  s_cselect_b32 s3, 0, s3
  s_add_u32 m0, s54, 81920
  s_nop 0
  buffer_load_dwordx4 v104, s[24:27], s3 offen lds
  s_add_u32 m0, s54, 82944
  s_nop 0
  buffer_load_dwordx4 v105, s[24:27], s3 offen lds
  s_add_u32 m0, s54, 83968
  s_nop 0
  buffer_load_dwordx4 v106, s[24:27], s3 offen lds
  s_add_u32 s3, s3, 24576
  s_cmp_eq_u32 s3, 491520
  s_cselect_b32 s3, 0, s3
  s_add_u32 m0, s54, 94240
  s_nop 0
  buffer_load_dwordx4 v104, s[24:27], s3 offen lds
  s_add_u32 m0, s54, 95264
  s_nop 0
  buffer_load_dwordx4 v105, s[24:27], s3 offen lds
  s_add_u32 m0, s54, 96288
  s_nop 0
  buffer_load_dwordx4 v106, s[24:27], s3 offen lds
  s_add_u32 s3, s3, 24576
  s_cmp_eq_u32 s3, 491520
  s_cselect_b32 s3, 0, s3
  s_nop 0
  s_waitcnt vmcnt(9)
Ldec_5:
  v_bitop3_b32 v8, v8, v9, v96 bitop3:0x7e
  v_bitop3_b32 v10, v10, v11, v96 bitop3:0x7e
  v_or_b32 v8, v8, v10
  v_cmp_ne_u32 vcc, 0, v8
  s_nop 3
  s_cbranch_vccz Lfast_6
  s_add_u32 s63, s63, 1
  s_and_b32 s62, s63, 63
  s_cbranch_scc1 Lagain_7
  v_mov_b32 v88, v96
  v_mov_b32 v89, v96
  v_mov_b32 v90, v96
  v_mov_b32 v91, v96
  s_lshl_b32 s62, s41, 6
  s_add_u32 s62, s62, s69
  s_mov_b64 exec, 15
  buffer_store_dwordx4 v[88:91], v2, s[4:7], s62 offen sc1
  s_mov_b64 exec, -1
  buffer_load_dword v94, v97, s[4:7], s69 offen sc1
  s_waitcnt vmcnt(0)
  v_subrev_u32 v94, s43, v94
  v_cmp_lt_u32 vcc, 15, v94
  s_nop 3
  s_cbranch_vccnz Lagain_7
  v_cmp_ne_u32 vcc, s44, v94
  s_nop 3
  s_cbranch_vccnz L_slow_nc
Lagain_7:
  buffer_load_dwordx4 v[8:11], v95, s[4:7], s46 offen sc1
  s_waitcnt vmcnt(0)
  s_branch Ldec_5
Lfast_6:
  s_add_u32 s46, s64, 4096
  s_mov_b64 exec, 1
  buffer_store_dword v1, off, s[4:7], s46
  s_mov_b64 exec, -1
  s_add_u32 m0, s54, 106560
  s_nop 0
  buffer_load_dwordx4 v104, s[24:27], s3 offen lds
  s_add_u32 m0, s54, 107584
  s_nop 0
  buffer_load_dwordx4 v105, s[24:27], s3 offen lds
  s_add_u32 m0, s54, 108608
  s_nop 0
  buffer_load_dwordx4 v106, s[24:27], s3 offen lds
  s_add_u32 s3, s3, 24576
  s_cmp_eq_u32 s3, 491520
  s_cselect_b32 s3, 0, s3
  s_add_u32 m0, s54, 118880
  s_nop 0
  buffer_load_dwordx4 v104, s[24:27], s3 offen lds
  s_add_u32 m0, s54, 119904
  s_nop 0
  buffer_load_dwordx4 v105, s[24:27], s3 offen lds
  s_add_u32 m0, s54, 120928
  s_nop 0
  buffer_load_dwordx4 v106, s[24:27], s3 offen lds
  s_add_u32 s3, s3, 24576
  s_cmp_eq_u32 s3, 491520
  s_cselect_b32 s3, 0, s3
  s_waitcnt vmcnt(6)
  s_add_u32 s46, s65, 4096
  buffer_load_dwordx4 v[8:11], v95, s[4:7], s46 offen sc1
  s_add_u32 m0, s54, 131200
  s_nop 0
  buffer_load_dwordx4 v104, s[24:27], s3 offen lds
  s_add_u32 m0, s54, 132224
  s_nop 0
  buffer_load_dwordx4 v105, s[24:27], s3 offen lds
  s_add_u32 m0, s54, 133248
  s_nop 0
  buffer_load_dwordx4 v106, s[24:27], s3 offen lds
  s_add_u32 s3, s3, 24576
  s_cmp_eq_u32 s3, 491520
  s_cselect_b32 s3, 0, s3
  s_add_u32 m0, s54, 143520
  s_nop 0
  buffer_load_dwordx4 v104, s[24:27], s3 offen lds
  s_add_u32 m0, s54, 144544
  s_nop 0
  buffer_load_dwordx4 v105, s[24:27], s3 offen lds
  s_add_u32 m0, s54, 145568
  s_nop 0
  buffer_load_dwordx4 v106, s[24:27], s3 offen lds
  s_add_u32 s3, s3, 24576
  s_cmp_eq_u32 s3, 491520
  s_cselect_b32 s3, 0, s3
  s_nop 0
  v_and_b32 v14, 7, v0
  v_lshrrev_b32 v15, 3, v0
  s_lshl_b32 s59, s42, 3
  v_add_u32 v15, s59, v15
  v_mul_u32_u24 v14, 1280, v14
  v_lshl_add_u32 v14, v15, 4, v14
  s_lshl_b32 s59, s40, 5
  s_add_u32 s59, s59, s41
  s_mul_i32 s59, s59, 10240
  s_add_u32 s60, s59, s66
  buffer_load_dwordx4 v[72:75], v14, s[8:11], s59 offen offset:0 nt
  buffer_load_dwordx4 v[76:79], v14, s[8:11], s59 offen offset:512 nt
  buffer_load_dwordx4 v[80:83], v14, s[8:11], s60 offen offset:1024 nt
  v_lshrrev_b32 v12, 3, v0
  v_lshlrev_b32 v12, 10, v12
  v_and_b32 v13, 7, v0
  v_lshl_add_u32 v12, v13, 4, v12
  s_lshl_b32 s48, s40, 7
  s_add_u32 s48, s48, 77824
  s_waitcnt vmcnt(8)
  v_bitop3_b32 v8, v8, v9, v1 bitop3:0x7e
  v_bitop3_b32 v10, v10, v11, v1 bitop3:0x7e
  v_or_b32 v8, v8, v10
  v_cmp_ne_u32 vcc, 0, v8
  s_nop 3
  s_cbranch_vccnz Lypass_8
  v_mov_b32 v8, v1
  v_mov_b32 v9, v1
  v_mov_b32 v10, v1
  v_mov_b32 v11, v1
  buffer_store_dwordx4 v[8:11], v12, s[4:7], s48 offen sc1
Lypass_8:
  s_waitcnt vmcnt(8)
  s_barrier
  ds_read_b64_tr_b16 v[112:113], v107 offset:0
  ds_read_b64_tr_b16 v[114:115], v107 offset:3072
  ds_read_b64_tr_b16 v[116:117], v107 offset:16
  ds_read_b64_tr_b16 v[118:119], v107 offset:3088
  ds_read_b64_tr_b16 v[120:121], v108 offset:0
  ds_read_b64_tr_b16 v[122:123], v108 offset:3072
  ds_read_b64_tr_b16 v[124:125], v107 offset:12320
  ds_read_b64_tr_b16 v[126:127], v107 offset:15392
  ds_read_b64_tr_b16 v[128:129], v107 offset:12336
  ds_read_b64_tr_b16 v[130:131], v107 offset:15408
  ds_read_b64_tr_b16 v[132:133], v108 offset:12320
  ds_read_b64_tr_b16 v[134:135], v108 offset:15392
  ds_read_b64_tr_b16 v[136:137], v107 offset:24640
  ds_read_b64_tr_b16 v[138:139], v107 offset:27712
  ds_read_b64_tr_b16 v[140:141], v107 offset:24656
  ds_read_b64_tr_b16 v[142:143], v107 offset:27728
  ds_read_b64_tr_b16 v[144:145], v108 offset:24640
  ds_read_b64_tr_b16 v[146:147], v108 offset:27712
  ds_read_b64_tr_b16 v[148:149], v107 offset:36960
  ds_read_b64_tr_b16 v[150:151], v107 offset:40032
  ds_read_b64_tr_b16 v[152:153], v107 offset:36976
  ds_read_b64_tr_b16 v[154:155], v107 offset:40048
  ds_read_b64_tr_b16 v[156:157], v108 offset:36960
  ds_read_b64_tr_b16 v[158:159], v108 offset:40032
  ds_read_b64_tr_b16 v[160:161], v107 offset:49280
  ds_read_b64_tr_b16 v[162:163], v107 offset:52352
  ds_read_b64_tr_b16 v[164:165], v107 offset:49296
  ds_read_b64_tr_b16 v[166:167], v107 offset:52368
  ds_read_b64_tr_b16 v[168:169], v108 offset:49280
  ds_read_b64_tr_b16 v[170:171], v108 offset:52352
  s_waitcnt lgkmcnt(0)
  s_barrier
  s_add_u32 m0, s54, 0
  s_nop 0
  buffer_load_dwordx4 v104, s[24:27], s3 offen lds
  s_add_u32 m0, s54, 1024
  s_nop 0
  buffer_load_dwordx4 v105, s[24:27], s3 offen lds
  s_add_u32 m0, s54, 2048
  s_nop 0
  buffer_load_dwordx4 v106, s[24:27], s3 offen lds
  s_add_u32 s3, s3, 24576
  s_cmp_eq_u32 s3, 491520
  s_cselect_b32 s3, 0, s3
  s_add_u32 m0, s54, 12320
  s_nop 0
  buffer_load_dwordx4 v104, s[24:27], s3 offen lds
  s_add_u32 m0, s54, 13344
  s_nop 0
  buffer_load_dwordx4 v105, s[24:27], s3 offen lds
  s_add_u32 m0, s54, 14368
  s_nop 0
  buffer_load_dwordx4 v106, s[24:27], s3 offen lds
  s_add_u32 s3, s3, 24576
  s_cmp_eq_u32 s3, 491520
  s_cselect_b32 s3, 0, s3
  s_add_u32 m0, s54, 24640
  s_nop 0
  buffer_load_dwordx4 v104, s[24:27], s3 offen lds
  s_add_u32 m0, s54, 25664
  s_nop 0
  buffer_load_dwordx4 v105, s[24:27], s3 offen lds
  s_add_u32 m0, s54, 26688
  s_nop 0
  buffer_load_dwordx4 v106, s[24:27], s3 offen lds
  s_add_u32 s3, s3, 24576
  s_cmp_eq_u32 s3, 491520
  s_cselect_b32 s3, 0, s3
  s_add_u32 m0, s54, 36960
  s_nop 0
  buffer_load_dwordx4 v104, s[24:27], s3 offen lds
  s_add_u32 m0, s54, 37984
  s_nop 0
  buffer_load_dwordx4 v105, s[24:27], s3 offen lds
  s_add_u32 m0, s54, 39008
  s_nop 0
  buffer_load_dwordx4 v106, s[24:27], s3 offen lds
  s_add_u32 s3, s3, 24576
  s_cmp_eq_u32 s3, 491520
  s_cselect_b32 s3, 0, s3
  s_add_u32 m0, s54, 49280
  s_nop 0
  buffer_load_dwordx4 v104, s[24:27], s3 offen lds
  s_add_u32 m0, s54, 50304
  s_nop 0
  buffer_load_dwordx4 v105, s[24:27], s3 offen lds
  s_add_u32 m0, s54, 51328
  s_nop 0
  buffer_load_dwordx4 v106, s[24:27], s3 offen lds
  s_add_u32 s3, s3, 24576
  s_cmp_eq_u32 s3, 491520
  s_cselect_b32 s3, 0, s3
  s_waitcnt vmcnt(15)
  s_barrier
  ds_read_b64_tr_b16 v[172:173], v110 offset:0
  ds_read_b64_tr_b16 v[174:175], v110 offset:3072
  ds_read_b64_tr_b16 v[176:177], v110 offset:16
  ds_read_b64_tr_b16 v[178:179], v110 offset:3088
  ds_read_b64_tr_b16 v[180:181], v111 offset:0
  ds_read_b64_tr_b16 v[182:183], v111 offset:3072
  ds_read_b64_tr_b16 v[184:185], v110 offset:12320
  ds_read_b64_tr_b16 v[186:187], v110 offset:15392
  ds_read_b64_tr_b16 v[188:189], v110 offset:12336
  ds_read_b64_tr_b16 v[190:191], v110 offset:15408
  ds_read_b64_tr_b16 v[192:193], v111 offset:12320
  ds_read_b64_tr_b16 v[194:195], v111 offset:15392
  ds_read_b64_tr_b16 v[196:197], v110 offset:24640
  ds_read_b64_tr_b16 v[198:199], v110 offset:27712
  ds_read_b64_tr_b16 v[200:201], v110 offset:24656
  ds_read_b64_tr_b16 v[202:203], v110 offset:27728
  ds_read_b64_tr_b16 v[204:205], v111 offset:24640
  ds_read_b64_tr_b16 v[206:207], v111 offset:27712
  ds_read_b64_tr_b16 v[208:209], v110 offset:36960
  ds_read_b64_tr_b16 v[210:211], v110 offset:40032
  ds_read_b64_tr_b16 v[212:213], v110 offset:36976
  ds_read_b64_tr_b16 v[214:215], v110 offset:40048
  ds_read_b64_tr_b16 v[216:217], v111 offset:36960
  ds_read_b64_tr_b16 v[218:219], v111 offset:40032
  ds_read_b64_tr_b16 v[220:221], v110 offset:49280
  ds_read_b64_tr_b16 v[222:223], v110 offset:52352
  ds_read_b64_tr_b16 v[224:225], v110 offset:49296
  ds_read_b64_tr_b16 v[226:227], v110 offset:52368
  ds_read_b64_tr_b16 v[228:229], v111 offset:49280
  ds_read_b64_tr_b16 v[230:231], v111 offset:52352
  ds_read_b64_tr_b16 v[232:233], v110 offset:61600
  ds_read_b64_tr_b16 v[234:235], v110 offset:64672
  ds_read_b64_tr_b16 v[236:237], v110 offset:61616
  ds_read_b64_tr_b16 v[238:239], v110 offset:64688
  ds_read_b64_tr_b16 v[240:241], v111 offset:61600
  ds_read_b64_tr_b16 v[242:243], v111 offset:64672
  s_waitcnt lgkmcnt(0)
  s_barrier
L_join_f:
  s_getpc_b64 s[12:13]
Lpc_9:
  s_add_u32 s12, s12, L_r1_f-Lpc_9
  s_addc_u32 s13, s13, 0
  s_lshl_b32 s14, s42, 3
  s_add_u32 s14, s14, s41
  s_and_b32 s14, s14, 31
  v_min_u32 v92, (L_r2_f-L_r1_f)/4096, v0
  v_lshl_add_u32 v92, v92, 5, s14
  v_lshlrev_b32 v92, 7, v92
  v_mov_b32 v93, s13
  v_add_co_u32 v92, vcc, s12, v92
  s_nop 1
  v_addc_co_u32 v93, vcc, 0, v93, vcc
  global_load_dword v94, v[92:93], off
  s_lshl_b32 s48, s40, 5
  s_add_u32 s48, s48, s41
  s_lshl_b32 s48, s48, 7
  s_add_u32 s48, s48, 98304
  v_and_b32 v91, 1, v0
  v_lshlrev_b32 v91, 15, v91
  buffer_load_dword v91, v91, s[4:7], s48 offen sc1
  s_add_u32 m0, s54, 81920
  s_nop 0
  buffer_load_dwordx4 v104, s[24:27], s3 offen lds
  s_add_u32 m0, s54, 82944
  s_nop 0
  buffer_load_dwordx4 v105, s[24:27], s3 offen lds
  v_mov_b32 v8, 0x3f803f80
  v_accvgpr_write_b32 a252, v8
  v_accvgpr_write_b32 a253, v8
  v_accvgpr_write_b32 a254, v8
  v_accvgpr_write_b32 a255, v8
  s_add_u32 m0, s54, 83968
  s_nop 0
  buffer_load_dwordx4 v106, s[24:27], s3 offen lds
  s_add_u32 s3, s3, 24576
  s_cmp_eq_u32 s3, 491520
  s_cselect_b32 s3, 0, s3
  v_mfma_f32_16x16x32_bf16 a[240:243], v[112:115], a[252:255], 0
  v_mfma_f32_16x16x32_bf16 a[244:247], v[116:119], a[252:255], 0
  v_mfma_f32_16x16x32_bf16 a[248:251], v[120:123], a[252:255], 0
  v_mfma_f32_16x16x32_bf16 a[240:243], v[124:127], a[252:255], a[240:243]
  v_mfma_f32_16x16x32_bf16 a[244:247], v[128:131], a[252:255], a[244:247]
  s_add_u32 m0, s54, 94240
  s_nop 0
  buffer_load_dwordx4 v104, s[24:27], s3 offen lds
  v_mfma_f32_16x16x32_bf16 a[248:251], v[132:135], a[252:255], a[248:251]
  v_mfma_f32_16x16x32_bf16 a[240:243], v[136:139], a[252:255], a[240:243]
  v_mfma_f32_16x16x32_bf16 a[244:247], v[140:143], a[252:255], a[244:247]
  v_mfma_f32_16x16x32_bf16 a[248:251], v[144:147], a[252:255], a[248:251]
  v_mfma_f32_16x16x32_bf16 a[240:243], v[148:151], a[252:255], a[240:243]
  s_add_u32 m0, s54, 95264
  s_nop 0
  buffer_load_dwordx4 v105, s[24:27], s3 offen lds
  v_mfma_f32_16x16x32_bf16 a[244:247], v[152:155], a[252:255], a[244:247]
  v_mfma_f32_16x16x32_bf16 a[248:251], v[156:159], a[252:255], a[248:251]
  v_mfma_f32_16x16x32_bf16 a[240:243], v[160:163], a[252:255], a[240:243]
  v_mfma_f32_16x16x32_bf16 a[244:247], v[164:167], a[252:255], a[244:247]
  v_mfma_f32_16x16x32_bf16 a[248:251], v[168:171], a[252:255], a[248:251]
  s_add_u32 m0, s54, 96288
  s_nop 0
  buffer_load_dwordx4 v106, s[24:27], s3 offen lds
  s_add_u32 s3, s3, 24576
  s_cmp_eq_u32 s3, 491520
  s_cselect_b32 s3, 0, s3
  v_mfma_f32_16x16x32_bf16 a[240:243], v[172:175], a[252:255], a[240:243]
  v_mfma_f32_16x16x32_bf16 a[244:247], v[176:179], a[252:255], a[244:247]
  v_mfma_f32_16x16x32_bf16 a[248:251], v[180:183], a[252:255], a[248:251]
  v_mfma_f32_16x16x32_bf16 a[240:243], v[184:187], a[252:255], a[240:243]
  v_mfma_f32_16x16x32_bf16 a[244:247], v[188:191], a[252:255], a[244:247]
  s_add_u32 m0, s54, 106560
  s_nop 0
  buffer_load_dwordx4 v104, s[24:27], s3 offen lds
  v_mfma_f32_16x16x32_bf16 a[248:251], v[192:195], a[252:255], a[248:251]
  v_mfma_f32_16x16x32_bf16 a[240:243], v[196:199], a[252:255], a[240:243]
  v_mfma_f32_16x16x32_bf16 a[244:247], v[200:203], a[252:255], a[244:247]
  v_mfma_f32_16x16x32_bf16 a[248:251], v[204:207], a[252:255], a[248:251]
  v_mfma_f32_16x16x32_bf16 a[240:243], v[208:211], a[252:255], a[240:243]
  s_add_u32 m0, s54, 107584
  s_nop 0
  buffer_load_dwordx4 v105, s[24:27], s3 offen lds
  v_mfma_f32_16x16x32_bf16 a[244:247], v[212:215], a[252:255], a[244:247]
  v_mfma_f32_16x16x32_bf16 a[248:251], v[216:219], a[252:255], a[248:251]
  v_mfma_f32_16x16x32_bf16 a[240:243], v[220:223], a[252:255], a[240:243]
  v_mfma_f32_16x16x32_bf16 a[244:247], v[224:227], a[252:255], a[244:247]
  v_mfma_f32_16x16x32_bf16 a[248:251], v[228:231], a[252:255], a[248:251]
  s_add_u32 m0, s54, 108608
  s_nop 0
  buffer_load_dwordx4 v106, s[24:27], s3 offen lds
  s_add_u32 s3, s3, 24576
  s_cmp_eq_u32 s3, 491520
  s_cselect_b32 s3, 0, s3
  v_mfma_f32_16x16x32_bf16 a[240:243], v[232:235], a[252:255], a[240:243]
  v_mfma_f32_16x16x32_bf16 a[244:247], v[236:239], a[252:255], a[244:247]
  v_mfma_f32_16x16x32_bf16 a[248:251], v[240:243], a[252:255], a[248:251]
  s_lshl_b32 s48, s42, 12
  v_lshlrev_b32 v5, 6, v0
  v_add_u32 v5, s48, v5
  s_add_u32 m0, s54, 118880
  s_nop 0
  buffer_load_dwordx4 v104, s[24:27], s3 offen lds
  s_mul_i32 s58, s42, 3072
  s_add_u32 s58, s58, 69632
  s_lshl_b32 s48, s40, 3
  s_lshr_b32 s61, s41, 2
  s_add_u32 s61, s61, s48
  s_mul_i32 s61, s61, 40960
  s_and_b32 s48, s41, 3
  s_lshl_b32 s48, s48, 4
  s_add_u32 s61, s61, s48
  s_add_u32 s61, s61, 7340032
  v_and_b32 v24, 7, v0
  v_lshrrev_b32 v25, 3, v0
  s_lshl_b32 s48, s42, 3
  v_add_u32 v25, s48, v25
  v_lshlrev_b32 v3, 4, v24
  s_lshl_b32 s48, s67, 2
  v_subrev_u32 v26, s48, v25
  s_add_u32 m0, s54, 119904
  s_nop 0
  buffer_load_dwordx4 v105, s[24:27], s3 offen lds
  v_add_u32 v27, 0, v25
  v_mul_u32_u24 v26, 205, v27
  v_lshrrev_b32 v26, 12, v26
  v_mul_u32_u24 v98, 20, v26
  v_sub_u32 v27, v27, v98
  s_add_u32 m0, s54, 120928
  s_nop 0
  buffer_load_dwordx4 v106, s[24:27], s3 offen lds
  s_add_u32 s3, s3, 24576
  s_cmp_eq_u32 s3, 491520
  s_cselect_b32 s3, 0, s3
  v_subrev_u32 v27, s67, v27
  v_add_u32 v98, 20, v27
  v_min_u32 v27, v27, v98
  v_lshl_add_u32 v27, v27, 2, v26
  v_lshl_add_u32 v99, v27, 8, v3
  v_add_u32 v27, 32, v25
  v_mul_u32_u24 v26, 205, v27
  v_lshrrev_b32 v26, 12, v26
  v_mul_u32_u24 v98, 20, v26
  v_sub_u32 v27, v27, v98
  v_subrev_u32 v27, s67, v27
  v_add_u32 v98, 20, v27
  v_min_u32 v27, v27, v98
  v_lshl_add_u32 v27, v27, 2, v26
  v_lshl_add_u32 v100, v27, 8, v3
  v_add_u32 v27, 64, v25
  v_mul_u32_u24 v26, 205, v27
  v_lshrrev_b32 v26, 12, v26
  v_mul_u32_u24 v98, 20, v26
  v_sub_u32 v27, v27, v98
  v_subrev_u32 v27, s67, v27
  v_add_u32 v98, 20, v27
  v_min_u32 v27, v27, v98
  v_lshl_add_u32 v27, v27, 2, v26
  v_lshl_add_u32 v101, v27, 8, v3
  v_lshrrev_b32 v25, 4, v0
  v_lshlrev_b32 v6, 8, v25
  v_bfe_u32 v26, v0, 1, 1
  v_lshl_add_u32 v6, v26, 7, v6
  v_bfe_u32 v26, v0, 2, 2
  v_lshl_add_u32 v6, v26, 4, v6
  v_and_b32 v26, 1, v0
  v_lshl_add_u32 v6, v26, 3, v6
  v_add_u32 v6, s58, v6
  v_lshlrev_b32 v90, 5, v24
  v_add_u32 v90, 61760, v90
  v_and_b32 v25, 1, v25
  v_lshl_add_u32 v7, v25, 4, v90
  s_lshl_b32 s48, s42, 2
  v_add_u32 v7, s48, v7
  s_lshl_b32 s48, s40, 5
  s_add_u32 s48, s48, s41
  s_lshl_b32 s59, s48, 7
  s_add_u32 s59, s59, 98304
  s_cmp_eq_u32 s42, 0
  s_cselect_b32 s59, s59, 0x80000000
  s_lshr_b32 s49, s48, 1
  s_mul_i32 s60, s49, 20480
  s_and_b32 s49, s41, 1
  s_lshl_b32 s49, s49, 7
  s_add_u32 s60, s60, s49
  s_add_u32 s60, s60, 1048576
  s_and_b32 s57, s41, 7
  s_lshl_b32 s57, s57, 2
  s_add_u32 s57, s57, s42
  s_mul_i32 s57, s57, 61440
  s_add_u32 s57, s57, 4194304
  s_mul_i32 s56, s42, 20480
  s_add_u32 s56, s56, 81920
  v_lshlrev_b32 v32, 16, v72
  v_and_b32 v33, 0xffff0000, v72
  v_lshlrev_b32 v34, 16, v73
  v_and_b32 v35, 0xffff0000, v73
  v_lshlrev_b32 v36, 16, v74
  v_and_b32 v37, 0xffff0000, v74
  v_lshlrev_b32 v38, 16, v75
  v_and_b32 v39, 0xffff0000, v75
  v_lshlrev_b32 v40, 16, v76
  v_and_b32 v41, 0xffff0000, v76
  v_lshlrev_b32 v42, 16, v77
  v_and_b32 v43, 0xffff0000, v77
  v_lshlrev_b32 v44, 16, v78
  v_and_b32 v45, 0xffff0000, v78
  v_lshlrev_b32 v46, 16, v79
  v_and_b32 v47, 0xffff0000, v79
  v_lshlrev_b32 v48, 16, v80
  v_and_b32 v49, 0xffff0000, v80
  v_lshlrev_b32 v50, 16, v81
  v_and_b32 v51, 0xffff0000, v81
  v_lshlrev_b32 v52, 16, v82
  v_and_b32 v53, 0xffff0000, v82
  v_lshlrev_b32 v54, 16, v83
  v_and_b32 v55, 0xffff0000, v83
  v_pk_add_f32 v[80:81], v[32:33], v[34:35]
  v_pk_mul_f32 v[82:83], v[32:33], v[32:33]
  v_pk_add_f32 v[84:85], v[36:37], v[38:39]
  v_pk_mul_f32 v[86:87], v[34:35], v[34:35]
  v_pk_fma_f32 v[82:83], v[36:37], v[36:37], v[82:83]
  v_pk_fma_f32 v[86:87], v[38:39], v[38:39], v[86:87]
  v_pk_add_f32 v[80:81], v[80:81], v[40:41]
  v_pk_fma_f32 v[82:83], v[40:41], v[40:41], v[82:83]
  v_pk_add_f32 v[84:85], v[84:85], v[42:43]
  v_pk_fma_f32 v[86:87], v[42:43], v[42:43], v[86:87]
  v_pk_add_f32 v[80:81], v[80:81], v[44:45]
  v_pk_fma_f32 v[82:83], v[44:45], v[44:45], v[82:83]
  v_pk_add_f32 v[84:85], v[84:85], v[46:47]
  v_pk_fma_f32 v[86:87], v[46:47], v[46:47], v[86:87]
  v_pk_add_f32 v[80:81], v[80:81], v[48:49]
  v_pk_fma_f32 v[82:83], v[48:49], v[48:49], v[82:83]
  v_pk_add_f32 v[84:85], v[84:85], v[50:51]
  v_pk_fma_f32 v[86:87], v[50:51], v[50:51], v[86:87]
  v_pk_add_f32 v[80:81], v[80:81], v[52:53]
  v_pk_fma_f32 v[82:83], v[52:53], v[52:53], v[82:83]
  v_pk_add_f32 v[84:85], v[84:85], v[54:55]
  v_pk_fma_f32 v[86:87], v[54:55], v[54:55], v[86:87]
  v_pk_add_f32 v[80:81], v[80:81], v[84:85]
  v_pk_add_f32 v[82:83], v[82:83], v[86:87]
  v_add_f32 v80, v80, v81
  v_add_f32 v82, v82, v83
  s_nop 0
  v_add_f32_dpp v80, v80, v80 row_ror:8 row_mask:0xf bank_mask:0xf
  v_add_f32_dpp v82, v82, v82 row_ror:8 row_mask:0xf bank_mask:0xf
  s_nop 1
  v_permlane16_swap_b32 v80, v82
  v_add_f32 v80, v80, v82
  v_mov_b32 v82, v80
  s_nop 1
  v_permlane32_swap_b32 v80, v82
  v_add_f32 v80, v80, v82
  s_mov_b64 exec, 0x00ff00ff
  ds_write_b32 v7, v80 offset:0
  s_mov_b64 exec, -1
  s_waitcnt lgkmcnt(0)
  s_barrier
  ds_read_b128 v[80:83], v90 offset:0
  ds_read_b128 v[84:87], v90 offset:16
  s_waitcnt lgkmcnt(0)
  v_pk_add_f32 v[80:81], v[80:81], v[82:83]
  v_pk_add_f32 v[84:85], v[84:85], v[86:87]
  v_add_f32 v80, v80, v81
  v_add_f32 v84, v84, v85
  v_mul_f32 v80, 0.0015625, v80
  v_mul_f32 v84, 0.0015625, v84
  v_fma_f32 v84, -v80, v80, v84
  v_max_f32 v84, 0, v84
  v_cvt_pk_bf16_f32 v84, v84, v80
  v_and_b32 v80, 0xffff0000, v84
  v_lshlrev_b32 v84, 16, v84
  v_add_f32 v84, 0x3727c5ac, v84
  v_cvt_pk_bf16_f32 v84, v84, v84
  v_lshlrev_b32 v84, 16, v84
  v_sqrt_f32 v84, v84
  s_nop 0
  v_cvt_pk_bf16_f32 v84, v84, v84
  v_lshlrev_b32 v84, 16, v84
  v_rcp_f32 v88, v84
  s_nop 0
  v_mul_f32 v89, v80, v88
  v_sub_f32 v89, 0, v89
  s_cmp_lg_u32 s42, 0
  s_cbranch_scc1 Lxdone_12
  v_and_b32 v80, 7, v0
  v_lshlrev_b32 v80, 7, v80
  s_lshl_b32 s48, s40, 10
  s_add_u32 s48, s48, 77824
Lxpoll_11:
  buffer_load_dword v81, v80, s[4:7], s48 offen sc1
  s_waitcnt vmcnt(0)
  v_cmp_ne_u32 vcc, v81, v1
  s_nop 3
  s_cbranch_vccnz Lxpoll_11
  s_cmp_lg_u32 s2, 0
  s_cbranch_scc1 Lxpoll_11e
  s_mov_b64 exec, 1
  buffer_store_dword v1, off, s[4:7], 0 offset:0 sc1
  s_mov_b64 exec, -1
Lxpoll_11e:
  s_barrier
  s_branch Lnoe_13
Lxdone_12:
  s_waitcnt vmcnt(0)
  s_barrier
Lnoe_13:
L_r1_f:
  s_add_u32 m0, s58, 0
  s_add_u32 s48, s61, 0
  buffer_load_dwordx4 v5, s[4:7], s48 offen sc1 lds
  s_add_u32 m0, s58, 1024
  s_add_u32 s48, s61, 16384
  buffer_load_dwordx4 v5, s[4:7], s48 offen sc1 lds
  s_add_u32 m0, s58, 2048
  s_add_u32 s48, s61, 32768
  s_add_u32 s48, s48, s66
  buffer_load_dwordx4 v5, s[4:7], s48 offen sc1 lds
  s_add_u32 s54, s57, 0
  buffer_load_dwordx4 a[96:99], v2, s[4:7], s54 offen offset:0 sc1
  buffer_load_dwordx4 a[100:103], v2, s[4:7], s54 offen offset:1024 sc1
  buffer_load_dwordx4 a[104:107], v2, s[4:7], s54 offen offset:2048 sc1
  buffer_load_dwordx4 a[108:111], v2, s[4:7], s54 offen offset:3072 sc1
  s_waitcnt vmcnt(4)
  ds_read_b64_tr_b16 v[20:21], v6 offset:0
  ds_read_b64_tr_b16 v[22:23], v6 offset:64
  ds_read_b64_tr_b16 v[24:25], v6 offset:1024
  ds_read_b64_tr_b16 v[26:27], v6 offset:1088
  ds_read_b64_tr_b16 v[28:29], v6 offset:2048
  ds_read_b64_tr_b16 v[30:31], v6 offset:2112
  s_waitcnt lgkmcnt(0)
  v_lshlrev_b32 v56, 16, v20
  v_and_b32 v57, 0xffff0000, v20
  v_lshlrev_b32 v58, 16, v21
  v_and_b32 v59, 0xffff0000, v21
  v_lshlrev_b32 v60, 16, v22
  v_and_b32 v61, 0xffff0000, v22
  v_lshlrev_b32 v62, 16, v23
  v_and_b32 v63, 0xffff0000, v23
  v_lshlrev_b32 v64, 16, v24
  v_and_b32 v65, 0xffff0000, v24
  v_lshlrev_b32 v66, 16, v25
  v_and_b32 v67, 0xffff0000, v25
  v_lshlrev_b32 v68, 16, v26
  v_and_b32 v69, 0xffff0000, v26
  v_lshlrev_b32 v70, 16, v27
  v_and_b32 v71, 0xffff0000, v27
  v_lshlrev_b32 v72, 16, v28
  v_and_b32 v73, 0xffff0000, v28
  v_lshlrev_b32 v74, 16, v29
  v_and_b32 v75, 0xffff0000, v29
  v_lshlrev_b32 v76, 16, v30
  v_and_b32 v77, 0xffff0000, v30
  v_lshlrev_b32 v78, 16, v31
  v_and_b32 v79, 0xffff0000, v31
  s_add_u32 s49, s60, s66
  v_pk_fma_f32 v[92:93], v[32:33], v[88:89], v[88:89] op_sel:[0,0,1] op_sel_hi:[1,0,1]
  v_pk_fma_f32 v[32:33], v[92:93], v[56:57], v[32:33]
  v_cvt_pk_bf16_f32 v20, v32, v33
  v_pk_fma_f32 v[94:95], v[34:35], v[88:89], v[88:89] op_sel:[0,0,1] op_sel_hi:[1,0,1]
  v_pk_fma_f32 v[34:35], v[94:95], v[58:59], v[34:35]
  v_cvt_pk_bf16_f32 v21, v34, v35
  v_pk_fma_f32 v[92:93], v[36:37], v[88:89], v[88:89] op_sel:[0,0,1] op_sel_hi:[1,0,1]
  v_pk_fma_f32 v[36:37], v[92:93], v[60:61], v[36:37]
  v_cvt_pk_bf16_f32 v22, v36, v37
  v_pk_fma_f32 v[94:95], v[38:39], v[88:89], v[88:89] op_sel:[0,0,1] op_sel_hi:[1,0,1]
  v_pk_fma_f32 v[38:39], v[94:95], v[62:63], v[38:39]
  v_cvt_pk_bf16_f32 v23, v38, v39
  buffer_store_dwordx4 v[20:23], v99, s[4:7], s60 offen
  v_pk_fma_f32 v[92:93], v[40:41], v[88:89], v[88:89] op_sel:[0,0,1] op_sel_hi:[1,0,1]
  v_pk_fma_f32 v[40:41], v[92:93], v[64:65], v[40:41]
  v_cvt_pk_bf16_f32 v24, v40, v41
  v_pk_fma_f32 v[94:95], v[42:43], v[88:89], v[88:89] op_sel:[0,0,1] op_sel_hi:[1,0,1]
  v_pk_fma_f32 v[42:43], v[94:95], v[66:67], v[42:43]
  v_cvt_pk_bf16_f32 v25, v42, v43
  v_pk_fma_f32 v[92:93], v[44:45], v[88:89], v[88:89] op_sel:[0,0,1] op_sel_hi:[1,0,1]
  v_pk_fma_f32 v[44:45], v[92:93], v[68:69], v[44:45]
  v_cvt_pk_bf16_f32 v26, v44, v45
  v_pk_fma_f32 v[94:95], v[46:47], v[88:89], v[88:89] op_sel:[0,0,1] op_sel_hi:[1,0,1]
  v_pk_fma_f32 v[46:47], v[94:95], v[70:71], v[46:47]
  v_cvt_pk_bf16_f32 v27, v46, v47
  buffer_store_dwordx4 v[24:27], v100, s[4:7], s60 offen
  v_pk_fma_f32 v[92:93], v[48:49], v[88:89], v[88:89] op_sel:[0,0,1] op_sel_hi:[1,0,1]
  v_pk_fma_f32 v[48:49], v[92:93], v[72:73], v[48:49]
  v_cvt_pk_bf16_f32 v28, v48, v49
  v_pk_fma_f32 v[94:95], v[50:51], v[88:89], v[88:89] op_sel:[0,0,1] op_sel_hi:[1,0,1]
  v_pk_fma_f32 v[50:51], v[94:95], v[74:75], v[50:51]
  v_cvt_pk_bf16_f32 v29, v50, v51
  v_pk_fma_f32 v[92:93], v[52:53], v[88:89], v[88:89] op_sel:[0,0,1] op_sel_hi:[1,0,1]
  v_pk_fma_f32 v[52:53], v[92:93], v[76:77], v[52:53]
  v_cvt_pk_bf16_f32 v30, v52, v53
  v_pk_fma_f32 v[94:95], v[54:55], v[88:89], v[88:89] op_sel:[0,0,1] op_sel_hi:[1,0,1]
  v_pk_fma_f32 v[54:55], v[94:95], v[78:79], v[54:55]
  v_cvt_pk_bf16_f32 v31, v54, v55
  buffer_store_dwordx4 v[28:31], v101, s[4:7], s49 offen
  v_mov_b32 v93, v3
  s_mov_b32 s58, s59
  v_mov_b32 v84, 0x3f803f80
  v_dot2_f32_bf16 v80, v20, v84, 0
  v_dot2_f32_bf16 v82, v20, v20, 0
  v_dot2_f32_bf16 v81, v21, v84, 0
  v_dot2_f32_bf16 v83, v21, v21, 0
  v_dot2_f32_bf16 v80, v22, v84, v80
  v_dot2_f32_bf16 v82, v22, v22, v82
  v_dot2_f32_bf16 v81, v23, v84, v81
  v_dot2_f32_bf16 v83, v23, v23, v83
  v_dot2_f32_bf16 v80, v24, v84, v80
  v_dot2_f32_bf16 v82, v24, v24, v82
  v_dot2_f32_bf16 v81, v25, v84, v81
  v_dot2_f32_bf16 v83, v25, v25, v83
  v_dot2_f32_bf16 v80, v26, v84, v80
  v_dot2_f32_bf16 v82, v26, v26, v82
  v_dot2_f32_bf16 v81, v27, v84, v81
  v_dot2_f32_bf16 v83, v27, v27, v83
  v_dot2_f32_bf16 v80, v28, v84, v80
  v_dot2_f32_bf16 v82, v28, v28, v82
  v_dot2_f32_bf16 v81, v29, v84, v81
  v_dot2_f32_bf16 v83, v29, v29, v83
  v_dot2_f32_bf16 v80, v30, v84, v80
  v_dot2_f32_bf16 v82, v30, v30, v82
  v_dot2_f32_bf16 v81, v31, v84, v81
  v_dot2_f32_bf16 v83, v31, v31, v83
  s_nop 1
  v_add_f32 v80, v80, v81
  v_add_f32 v82, v82, v83
  s_nop 0
  v_add_f32_dpp v80, v80, v80 row_ror:8 row_mask:0xf bank_mask:0xf
  v_add_f32_dpp v82, v82, v82 row_ror:8 row_mask:0xf bank_mask:0xf
  s_nop 1
  v_permlane16_swap_b32 v80, v82
  v_add_f32 v80, v80, v82
  v_mov_b32 v82, v80
  s_nop 1
  v_permlane32_swap_b32 v80, v82
  v_add_f32 v80, v80, v82
  s_mov_b64 exec, 0x00ff00ff
  ds_write_b32 v7, v80 offset:256
  s_mov_b64 exec, -1
  ds_read_b64_tr_b16 v[244:245], v107 offset:0
  ds_read_b64_tr_b16 v[246:247], v107 offset:3072
  ds_read_b64_tr_b16 v[248:249], v107 offset:16
  ds_read_b64_tr_b16 v[250:251], v107 offset:3088
  ds_read_b64_tr_b16 v[252:253], v108 offset:0
  ds_read_b64_tr_b16 v[254:255], v108 offset:3072
  ds_read_b64_tr_b16 a[0:1], v107 offset:12320
  ds_read_b64_tr_b16 a[2:3], v107 offset:15392
  ds_read_b64_tr_b16 a[4:5], v107 offset:12336
  ds_read_b64_tr_b16 a[6:7], v107 offset:15408
  ds_read_b64_tr_b16 a[8:9], v108 offset:12320
  ds_read_b64_tr_b16 a[10:11], v108 offset:15392
  s_waitcnt vmcnt(0)
  s_add_u32 s46, s64, 8192
  s_mov_b64 exec, 1
  buffer_store_dword v1, off, s[4:7], s46
  s_mov_b64 exec, -1
  ds_read_b64_tr_b16 a[12:13], v107 offset:24640
  ds_read_b64_tr_b16 a[14:15], v107 offset:27712
  ds_read_b64_tr_b16 a[16:17], v107 offset:24656
  ds_read_b64_tr_b16 a[18:19], v107 offset:27728
  ds_read_b64_tr_b16 a[20:21], v108 offset:24640
  ds_read_b64_tr_b16 a[22:23], v108 offset:27712
  ds_read_b64_tr_b16 a[24:25], v107 offset:36960
  ds_read_b64_tr_b16 a[26:27], v107 offset:40032
  ds_read_b64_tr_b16 a[28:29], v107 offset:36976
  ds_read_b64_tr_b16 a[30:31], v107 offset:40048
  ds_read_b64_tr_b16 a[32:33], v108 offset:36960
  ds_read_b64_tr_b16 a[34:35], v108 offset:40032
  ds_read_b64_tr_b16 a[36:37], v107 offset:49280
  ds_read_b64_tr_b16 a[38:39], v107 offset:52352
  ds_read_b64_tr_b16 a[40:41], v107 offset:49296
  ds_read_b64_tr_b16 a[42:43], v107 offset:52368
  ds_read_b64_tr_b16 a[44:45], v108 offset:49280
  ds_read_b64_tr_b16 a[46:47], v108 offset:52352
  ds_read_b64_tr_b16 a[48:49], v110 offset:0
  ds_read_b64_tr_b16 a[50:51], v110 offset:3072
  ds_read_b64_tr_b16 a[52:53], v110 offset:16
  ds_read_b64_tr_b16 a[54:55], v110 offset:3088
  ds_read_b64_tr_b16 a[56:57], v111 offset:0
  ds_read_b64_tr_b16 a[58:59], v111 offset:3072
  ds_read_b64_tr_b16 a[60:61], v110 offset:12320
  ds_read_b64_tr_b16 a[62:63], v110 offset:15392
  ds_read_b64_tr_b16 a[64:65], v110 offset:12336
  ds_read_b64_tr_b16 a[66:67], v110 offset:15408
  ds_read_b64_tr_b16 a[68:69], v111 offset:12320
  ds_read_b64_tr_b16 a[70:71], v111 offset:15392
  ds_read_b64_tr_b16 a[72:73], v110 offset:24640
  ds_read_b64_tr_b16 a[74:75], v110 offset:27712
  ds_read_b64_tr_b16 a[76:77], v110 offset:24656
  ds_read_b64_tr_b16 a[78:79], v110 offset:27728
  ds_read_b64_tr_b16 a[80:81], v111 offset:24640
  ds_read_b64_tr_b16 a[82:83], v111 offset:27712
  ds_read_b64_tr_b16 a[84:85], v110 offset:36960
  ds_read_b64_tr_b16 a[86:87], v110 offset:40032
  ds_read_b64_tr_b16 a[88:89], v110 offset:36976
  ds_read_b64_tr_b16 a[90:91], v110 offset:40048
  ds_read_b64_tr_b16 a[92:93], v111 offset:36960
  ds_read_b64_tr_b16 a[94:95], v111 offset:40032
  s_add_u32 s54, s57, 4096
  buffer_load_dwordx4 a[112:115], v2, s[4:7], s54 offen offset:0 sc1
  buffer_load_dwordx4 a[116:119], v2, s[4:7], s54 offen offset:1024 sc1
  buffer_load_dwordx4 a[120:123], v2, s[4:7], s54 offen offset:2048 sc1
  buffer_load_dwordx4 a[124:127], v2, s[4:7], s54 offen offset:3072 sc1
  s_add_u32 s54, s57, 8192
  buffer_load_dwordx4 a[128:131], v2, s[4:7], s54 offen offset:0 sc1
  buffer_load_dwordx4 a[132:135], v2, s[4:7], s54 offen offset:1024 sc1
  buffer_load_dwordx4 a[136:139], v2, s[4:7], s54 offen offset:2048 sc1
  buffer_load_dwordx4 a[140:143], v2, s[4:7], s54 offen offset:3072 sc1
  s_add_u32 s54, s57, 12288
  buffer_load_dwordx4 a[144:147], v2, s[4:7], s54 offen offset:0 sc1
  buffer_load_dwordx4 a[148:151], v2, s[4:7], s54 offen offset:1024 sc1
  buffer_load_dwordx4 a[152:155], v2, s[4:7], s54 offen offset:2048 sc1
  buffer_load_dwordx4 a[156:159], v2, s[4:7], s54 offen offset:3072 sc1
  s_add_u32 s54, s57, 16384
  buffer_load_dwordx4 a[160:163], v2, s[4:7], s54 offen offset:0 sc1
  buffer_load_dwordx4 a[164:167], v2, s[4:7], s54 offen offset:1024 sc1
  v_and_b32 v5, 15, v0
  v_lshlrev_b32 v5, 4, v5
  v_bfe_u32 v6, v0, 4, 1
  v_lshl_add_u32 v7, v6, 8, v5
  s_lshl_b32 s48, s42, 8
  v_add_u32 v5, s48, v5
  v_mul_u32_u24 v6, 49152, v6
  v_add_u32 v5, v5, v6
  v_lshrrev_b32 v6, 5, v0
  v_lshl_add_u32 v3, v6, 10, v5
  v_lshl_add_u32 v4, v6, 3, v5
  v_add_u32 v4, 2048, v4
  v_mul_u32_u24 v13, 96, v6
  s_mul_i32 s48, s42, 192
  s_add_u32 s48, s48, 36864
  v_add_u32 v13, s48, v13
  v_add_u32 v5, 40960, v2
  s_lshr_b32 s49, s41, 4
  s_lshl_b32 s50, s40, 1
  s_add_u32 s50, s50, s49
  s_lshl_b32 s50, s50, 3
  s_and_b32 s48, s42, 1
  s_mul_i32 s48, s48, 20480
  s_lshr_b32 s53, s42, 1
  s_lshl_b32 s53, s53, 10
  s_add_u32 s53, s53, s48
  s_mul_i32 s51, s50, 20480
  s_add_u32 s51, s51, s53
  s_add_u32 s51, s51, 1048576
  s_lshl_b32 s48, s36, 10
  s_add_u32 s51, s51, s48
  s_cmp_eq_u32 s36, 0
  s_cselect_b32 s48, 0, 20480
  s_sub_u32 s61, s51, s48
  s_and_b32 s48, s41, 15
  s_mul_i32 s48, s48, 3072
  s_mul_i32 s52, s50, 49152
  s_add_u32 s52, s52, s48
  s_add_u32 s52, s52, 10485760
  s_lshl_b32 s62, s50, 8
  s_add_u32 s62, s62, 98304
  s_lshr_b32 s48, s41, 3
  s_lshl_b32 s59, s40, 2
  s_add_u32 s59, s59, s48
  s_mul_i32 s59, s59, 196608
  s_mul_i32 s48, s42, 12288
  s_add_u32 s59, s59, s48
  s_add_u32 s59, s59, 10485760
  s_mul_i32 s60, s42, 9216
  s_lshl_b32 s49, s49, 4
  v_and_b32 v6, 15, v0
  v_add_u32 v6, s49, v6
  v_lshlrev_b32 v6, 4, v6
  s_waitcnt lgkmcnt(0)
  s_barrier
  s_add_u32 s46, s65, 8192
Lpoll_14:
  buffer_load_dwordx4 v[8:11], v6, s[4:7], s46 offen sc1
  s_waitcnt vmcnt(0)
  v_bitop3_b32 v8, v8, v9, v1 bitop3:0x7e
  v_bitop3_b32 v10, v10, v11, v1 bitop3:0x7e
  v_or_b32 v8, v8, v10
  v_cmp_ne_u32 vcc, 0, v8
  s_nop 3
  s_cbranch_vccnz Lpoll_14
  s_add_u32 m0, s53, 0
  s_add_u32 s48, s51, 0
  buffer_load_dwordx4 v2, s[4:7], s48 offen offset:0 sc1 lds
  buffer_load_dwordx4 v2, s[4:7], s48 offen offset:2048 sc1 lds
  s_add_u32 m0, s53, 4096
  s_add_u32 s48, s51, 4096
  buffer_load_dwordx4 v2, s[4:7], s48 offen offset:0 sc1 lds
  buffer_load_dwordx4 v2, s[4:7], s48 offen offset:2048 sc1 lds
  s_lshl_b32 s55, s42, 2
  s_add_u32 s49, s49, s55
  v_and_b32 v6, 3, v0
  v_add_u32 v6, s49, v6
  v_lshlrev_b32 v6, 4, v6
  s_waitcnt lgkmcnt(0)
  s_barrier
  ds_read_b128 v[80:83], v90 offset:256
  ds_read_b128 v[84:87], v90 offset:272
  s_waitcnt lgkmcnt(0)
  v_pk_add_f32 v[80:81], v[80:81], v[82:83]
  v_pk_add_f32 v[84:85], v[84:85], v[86:87]
  v_add_f32 v80, v80, v81
  v_add_f32 v84, v84, v85
  v_mul_f32 v80, 0.0015625, v80
  v_mul_f32 v84, 0.0015625, v84
  v_fma_f32 v84, -v80, v80, v84
  v_max_f32 v84, 0, v84
  v_cvt_pk_bf16_f32 v84, v84, v80
  v_and_b32 v80, 0xffff0000, v84
  v_lshlrev_b32 v84, 16, v84
  v_add_f32 v84, 0x3727c5ac, v84
  v_cvt_pk_bf16_f32 v84, v84, v84
  v_lshlrev_b32 v84, 16, v84
  v_sqrt_f32 v84, v84
  s_nop 0
  v_cvt_pk_bf16_f32 v84, v84, v84
  v_lshlrev_b32 v84, 16, v84
  v_rcp_f32 v88, v84
  s_nop 0
  v_mul_f32 v89, v88, v88
  v_sub_f32 v88, 0, v80
  v_mov_b32 v90, v1
  v_mov_b32 v91, v1
  s_mov_b64 exec, 0xff
  buffer_store_dwordx4 v[88:91], v93, s[4:7], s58 offen
  s_mov_b64 exec, -1
  s_waitcnt lgkmcnt(0)
  v_mfma_f32_16x16x32_bf16 a[240:243], v[244:247], a[252:255], a[240:243]
  v_mfma_f32_16x16x32_bf16 a[244:247], v[248:251], a[252:255], a[244:247]
  v_mfma_f32_16x16x32_bf16 a[248:251], v[252:255], a[252:255], a[248:251]
  v_mfma_f32_16x16x32_bf16 a[240:243], a[0:3], a[252:255], a[240:243]
  v_mfma_f32_16x16x32_bf16 a[244:247], a[4:7], a[252:255], a[244:247]
  v_mfma_f32_16x16x32_bf16 a[248:251], a[8:11], a[252:255], a[248:251]
  v_mfma_f32_16x16x32_bf16 a[240:243], a[12:15], a[252:255], a[240:243]
  v_mfma_f32_16x16x32_bf16 a[244:247], a[16:19], a[252:255], a[244:247]
  v_mfma_f32_16x16x32_bf16 a[248:251], a[20:23], a[252:255], a[248:251]
  v_mfma_f32_16x16x32_bf16 a[240:243], a[24:27], a[252:255], a[240:243]
  v_mfma_f32_16x16x32_bf16 a[244:247], a[28:31], a[252:255], a[244:247]
  v_mfma_f32_16x16x32_bf16 a[248:251], a[32:35], a[252:255], a[248:251]
  v_mfma_f32_16x16x32_bf16 a[240:243], a[36:39], a[252:255], a[240:243]
  v_mfma_f32_16x16x32_bf16 a[244:247], a[40:43], a[252:255], a[244:247]
  v_mfma_f32_16x16x32_bf16 a[248:251], a[44:47], a[252:255], a[248:251]
  v_mfma_f32_16x16x32_bf16 a[240:243], a[48:51], a[252:255], a[240:243]
  v_mfma_f32_16x16x32_bf16 a[244:247], a[52:55], a[252:255], a[244:247]
  v_mfma_f32_16x16x32_bf16 a[248:251], a[56:59], a[252:255], a[248:251]
  v_mfma_f32_16x16x32_bf16 a[240:243], a[60:63], a[252:255], a[240:243]
  v_mfma_f32_16x16x32_bf16 a[244:247], a[64:67], a[252:255], a[244:247]
  v_mfma_f32_16x16x32_bf16 a[248:251], a[68:71], a[252:255], a[248:251]
  v_mfma_f32_16x16x32_bf16 a[240:243], a[72:75], a[252:255], a[240:243]
  v_mfma_f32_16x16x32_bf16 a[244:247], a[76:79], a[252:255], a[244:247]
  v_mfma_f32_16x16x32_bf16 a[248:251], a[80:83], a[252:255], a[248:251]
  v_mfma_f32_16x16x32_bf16 a[240:243], a[84:87], a[252:255], a[240:243]
  v_mfma_f32_16x16x32_bf16 a[244:247], a[88:91], a[252:255], a[244:247]
  v_mfma_f32_16x16x32_bf16 a[248:251], a[92:95], a[252:255], a[248:251]
  s_waitcnt vmcnt(2)
  s_barrier
  ds_read_b128 v[64:67], v2 offset:0
  ds_read_b128 v[68:71], v2 offset:20480
  ds_read_b128 v[72:75], v2 offset:1024
  ds_read_b128 v[76:79], v2 offset:21504
  s_waitcnt lgkmcnt(2)
  v_mfma_f32_16x16x32_bf16 v[16:19], v[112:115], v[64:67], 0
  ds_read_b128 v[80:83], v2 offset:2048
  s_add_u32 m0, s53, 8192
  v_mfma_f32_16x16x32_bf16 v[28:31], v[112:115], v[68:71], 0
  ds_read_b128 v[84:87], v2 offset:22528
  s_add_u32 s48, s61, 8192
  v_mfma_f32_16x16x32_bf16 v[20:23], v[116:119], v[64:67], 0
  buffer_load_dwordx4 v2, s[4:7], s48 offen offset:0 sc1 lds
  buffer_load_dwordx4 v2, s[4:7], s48 offen offset:2048 sc1 lds
  v_mfma_f32_16x16x32_bf16 v[32:35], v[116:119], v[68:71], 0
  v_accvgpr_read_b32 v88, a240
  v_accvgpr_read_b32 v100, a240
  v_mfma_f32_16x16x32_bf16 v[24:27], v[120:123], v[64:67], 0
  v_accvgpr_read_b32 v89, a241
  v_accvgpr_read_b32 v101, a241
  v_mfma_f32_16x16x32_bf16 v[36:39], v[120:123], v[68:71], 0
  v_accvgpr_read_b32 v90, a242
  s_waitcnt lgkmcnt(2)
  v_mfma_f32_16x16x32_bf16 v[16:19], v[124:127], v[72:75], v[16:19]
  ds_read_b128 v[64:67], v2 offset:3072
  s_add_u32 m0, s53, 12288
  v_mfma_f32_16x16x32_bf16 v[28:31], v[124:127], v[76:79], v[28:31]
  ds_read_b128 v[68:71], v2 offset:23552
  s_add_u32 s48, s61, 12288
  v_mfma_f32_16x16x32_bf16 v[20:23], v[128:131], v[72:75], v[20:23]
  buffer_load_dwordx4 v2, s[4:7], s48 offen offset:0 sc1 lds
  buffer_load_dwordx4 v2, s[4:7], s48 offen offset:2048 sc1 lds
  v_mfma_f32_16x16x32_bf16 v[32:35], v[128:131], v[76:79], v[32:35]
  v_accvgpr_read_b32 v102, a242
  v_accvgpr_read_b32 v91, a243
  v_mfma_f32_16x16x32_bf16 v[24:27], v[132:135], v[72:75], v[24:27]
  v_accvgpr_read_b32 v103, a243
  v_accvgpr_read_b32 v92, a244
  v_mfma_f32_16x16x32_bf16 v[36:39], v[132:135], v[76:79], v[36:39]
  v_accvgpr_read_b32 v104, a244
  s_waitcnt lgkmcnt(2)
  v_mfma_f32_16x16x32_bf16 v[16:19], v[136:139], v[80:83], v[16:19]
  s_waitcnt vmcnt(4)
  s_barrier
  ds_read_b128 v[72:75], v2 offset:4096
  v_mfma_f32_16x16x32_bf16 v[28:31], v[136:139], v[84:87], v[28:31]
  ds_read_b128 v[76:79], v2 offset:24576
  s_add_u32 m0, s53, 16384
  v_mfma_f32_16x16x32_bf16 v[20:23], v[140:143], v[80:83], v[20:23]
  s_add_u32 s48, s61, 16384
  buffer_load_dwordx4 v2, s[4:7], s48 offen offset:0 sc1 lds
  v_mfma_f32_16x16x32_bf16 v[32:35], v[140:143], v[84:87], v[32:35]
  buffer_load_dwordx4 v2, s[4:7], s48 offen offset:2048 sc1 lds
  v_accvgpr_read_b32 v93, a245
  v_mfma_f32_16x16x32_bf16 v[24:27], v[144:147], v[80:83], v[24:27]
  v_accvgpr_read_b32 v105, a245
  v_accvgpr_read_b32 v94, a246
  v_mfma_f32_16x16x32_bf16 v[36:39], v[144:147], v[84:87], v[36:39]
  v_accvgpr_read_b32 v106, a246
  s_waitcnt lgkmcnt(2)
  v_mfma_f32_16x16x32_bf16 v[16:19], v[148:151], v[64:67], v[16:19]
  ds_read_b128 v[80:83], v2 offset:5120
  s_add_u32 m0, s53, 40960
  v_mfma_f32_16x16x32_bf16 v[28:31], v[148:151], v[68:71], v[28:31]
  ds_read_b128 v[84:87], v2 offset:25600
  s_add_u32 s48, s51, 81920
  v_mfma_f32_16x16x32_bf16 v[20:23], v[152:155], v[64:67], v[20:23]
  buffer_load_dwordx4 v2, s[4:7], s48 offen offset:0 sc1 lds
  buffer_load_dwordx4 v2, s[4:7], s48 offen offset:2048 sc1 lds
  v_mfma_f32_16x16x32_bf16 v[32:35], v[152:155], v[68:71], v[32:35]
  v_accvgpr_read_b32 v95, a247
  v_accvgpr_read_b32 v107, a247
  v_mfma_f32_16x16x32_bf16 v[24:27], v[156:159], v[64:67], v[24:27]
  v_accvgpr_read_b32 v96, a248
  v_accvgpr_read_b32 v108, a248
  v_mfma_f32_16x16x32_bf16 v[36:39], v[156:159], v[68:71], v[36:39]
  v_accvgpr_read_b32 v97, a249
  s_waitcnt lgkmcnt(2)
  v_mfma_f32_16x16x32_bf16 v[16:19], v[160:163], v[72:75], v[16:19]
  ds_read_b128 v[64:67], v2 offset:6144
  s_add_u32 m0, s53, 45056
  v_mfma_f32_16x16x32_bf16 v[28:31], v[160:163], v[76:79], v[28:31]
  ds_read_b128 v[68:71], v2 offset:26624
  s_add_u32 s48, s51, 86016
  v_mfma_f32_16x16x32_bf16 v[20:23], v[164:167], v[72:75], v[20:23]
  buffer_load_dwordx4 v2, s[4:7], s48 offen offset:0 sc1 lds
  v_accvgpr_read_b32 v109, a249
  v_mfma_f32_16x16x32_bf16 v[32:35], v[164:167], v[76:79], v[32:35]
  v_accvgpr_read_b32 v98, a250
  v_accvgpr_read_b32 v110, a250
  v_mfma_f32_16x16x32_bf16 v[24:27], v[168:171], v[72:75], v[24:27]
  v_accvgpr_read_b32 v99, a251
  v_accvgpr_read_b32 v111, a251
  v_mfma_f32_16x16x32_bf16 v[36:39], v[168:171], v[76:79], v[36:39]
  s_waitcnt lgkmcnt(2)
  v_mfma_f32_16x16x32_bf16 v[16:19], v[172:175], v[80:83], v[16:19]
  ds_read_b128 v[72:75], v2 offset:7168
  buffer_load_dwordx4 v2, s[4:7], s48 offen offset:2048 sc1 lds
  v_mfma_f32_16x16x32_bf16 v[28:31], v[172:175], v[84:87], v[28:31]
  ds_read_b128 v[76:79], v2 offset:27648
  v_mfma_f32_16x16x32_bf16 v[20:23], v[176:179], v[80:83], v[20:23]
  v_permlane16_swap_b32 v88, v100
  v_mfma_f32_16x16x32_bf16 v[32:35], v[176:179], v[84:87], v[32:35]
  v_permlane16_swap_b32 v89, v101
  v_mfma_f32_16x16x32_bf16 v[24:27], v[180:183], v[80:83], v[24:27]
  v_permlane16_swap_b32 v90, v102
  v_mfma_f32_16x16x32_bf16 v[36:39], v[180:183], v[84:87], v[36:39]
  s_waitcnt lgkmcnt(2)
  v_mfma_f32_16x16x32_bf16 v[16:19], v[184:187], v[64:67], v[16:19]
  s_waitcnt vmcnt(7)
  s_barrier
  ds_read_b128 v[80:83], v2 offset:8192
  v_mfma_f32_16x16x32_bf16 v[28:31], v[184:187], v[68:71], v[28:31]
  ds_read_b128 v[84:87], v2 offset:28672
  s_add_u32 m0, s53, 49152
  v_mfma_f32_16x16x32_bf16 v[20:23], v[188:191], v[64:67], v[20:23]
  s_add_u32 s48, s61, 90112
  buffer_load_dwordx4 v2, s[4:7], s48 offen offset:0 sc1 lds
  v_mfma_f32_16x16x32_bf16 v[32:35], v[188:191], v[68:71], v[32:35]
  v_permlane16_swap_b32 v91, v103
  v_mfma_f32_16x16x32_bf16 v[24:27], v[192:195], v[64:67], v[24:27]
  v_permlane16_swap_b32 v92, v104
  v_mfma_f32_16x16x32_bf16 v[36:39], v[192:195], v[68:71], v[36:39]
  s_waitcnt lgkmcnt(2)
  v_mfma_f32_16x16x32_bf16 v[16:19], v[196:199], v[72:75], v[16:19]
  ds_read_b128 v[64:67], v2 offset:9216
  buffer_load_dwordx4 v2, s[4:7], s48 offen offset:2048 sc1 lds
  v_mfma_f32_16x16x32_bf16 v[28:31], v[196:199], v[76:79], v[28:31]
  ds_read_b128 v[68:71], v2 offset:29696
  v_mfma_f32_16x16x32_bf16 v[20:23], v[200:203], v[72:75], v[20:23]
  v_permlane16_swap_b32 v93, v105
  v_mfma_f32_16x16x32_bf16 v[32:35], v[200:203], v[76:79], v[32:35]
  v_permlane16_swap_b32 v94, v106
  v_mfma_f32_16x16x32_bf16 v[24:27], v[204:207], v[72:75], v[24:27]
  v_permlane16_swap_b32 v95, v107
  v_mfma_f32_16x16x32_bf16 v[36:39], v[204:207], v[76:79], v[36:39]
  s_waitcnt lgkmcnt(2)
  v_mfma_f32_16x16x32_bf16 v[16:19], v[208:211], v[80:83], v[16:19]
  ds_read_b128 v[72:75], v2 offset:10240
  s_add_u32 m0, s53, 53248
  v_mfma_f32_16x16x32_bf16 v[28:31], v[208:211], v[84:87], v[28:31]
  ds_read_b128 v[76:79], v2 offset:30720
  s_add_u32 s48, s61, 94208
  v_mfma_f32_16x16x32_bf16 v[20:23], v[212:215], v[80:83], v[20:23]
  buffer_load_dwordx4 v2, s[4:7], s48 offen offset:0 sc1 lds
  v_mfma_f32_16x16x32_bf16 v[32:35], v[212:215], v[84:87], v[32:35]
  v_permlane16_swap_b32 v96, v108
  v_mfma_f32_16x16x32_bf16 v[24:27], v[216:219], v[80:83], v[24:27]
  v_permlane16_swap_b32 v97, v109
  v_mfma_f32_16x16x32_bf16 v[36:39], v[216:219], v[84:87], v[36:39]
  s_waitcnt lgkmcnt(2)
  v_mfma_f32_16x16x32_bf16 v[16:19], v[220:223], v[64:67], v[16:19]
  ds_read_b128 v[80:83], v2 offset:11264
  buffer_load_dwordx4 v2, s[4:7], s48 offen offset:2048 sc1 lds
  v_mfma_f32_16x16x32_bf16 v[28:31], v[220:223], v[68:71], v[28:31]
  ds_read_b128 v[84:87], v2 offset:31744
  v_mfma_f32_16x16x32_bf16 v[20:23], v[224:227], v[64:67], v[20:23]
  v_permlane16_swap_b32 v98, v110
  v_mfma_f32_16x16x32_bf16 v[32:35], v[224:227], v[68:71], v[32:35]
  v_permlane16_swap_b32 v99, v111
  v_mfma_f32_16x16x32_bf16 v[24:27], v[228:231], v[64:67], v[24:27]
  v_mfma_f32_16x16x32_bf16 v[36:39], v[228:231], v[68:71], v[36:39]
  s_waitcnt lgkmcnt(2)
  v_mfma_f32_16x16x32_bf16 v[16:19], v[232:235], v[72:75], v[16:19]
  ds_read_b128 v[64:67], v2 offset:12288
  s_add_u32 m0, s53, 57344
  v_mfma_f32_16x16x32_bf16 v[28:31], v[232:235], v[76:79], v[28:31]
  ds_read_b128 v[68:71], v2 offset:32768
  s_add_u32 s48, s61, 98304
  v_mfma_f32_16x16x32_bf16 v[20:23], v[236:239], v[72:75], v[20:23]
  buffer_load_dwordx4 v2, s[4:7], s48 offen offset:0 sc1 lds
  v_mfma_f32_16x16x32_bf16 v[32:35], v[236:239], v[76:79], v[32:35]
  v_mfma_f32_16x16x32_bf16 v[24:27], v[240:243], v[72:75], v[24:27]
  v_mfma_f32_16x16x32_bf16 v[36:39], v[240:243], v[76:79], v[36:39]
  s_waitcnt lgkmcnt(2)
  v_mfma_f32_16x16x32_bf16 v[16:19], v[244:247], v[80:83], v[16:19]
  ds_read_b128 v[72:75], v2 offset:13312
  buffer_load_dwordx4 v2, s[4:7], s48 offen offset:2048 sc1 lds
  v_mfma_f32_16x16x32_bf16 v[28:31], v[244:247], v[84:87], v[28:31]
  ds_read_b128 v[76:79], v2 offset:33792
  v_mfma_f32_16x16x32_bf16 v[20:23], v[248:251], v[80:83], v[20:23]
  v_mfma_f32_16x16x32_bf16 v[32:35], v[248:251], v[84:87], v[32:35]
  v_mfma_f32_16x16x32_bf16 v[24:27], v[252:255], v[80:83], v[24:27]
  v_mfma_f32_16x16x32_bf16 v[36:39], v[252:255], v[84:87], v[36:39]
  s_waitcnt lgkmcnt(2)
  v_mfma_f32_16x16x32_bf16 v[16:19], a[0:3], v[64:67], v[16:19]
  s_waitcnt vmcnt(10)
  s_barrier
  ds_read_b128 v[80:83], v2 offset:14336
  v_mfma_f32_16x16x32_bf16 v[28:31], a[0:3], v[68:71], v[28:31]
  ds_read_b128 v[84:87], v2 offset:34816
  s_add_u32 s55, s62, 0
  v_mfma_f32_16x16x32_bf16 v[20:23], a[4:7], v[64:67], v[20:23]
  buffer_load_dwordx4 v[8:11], v7, s[4:7], s55 offen sc1
  buffer_load_dwordx4 a[168:171], v2, s[4:7], s54 offen offset:2048 sc1
  v_mfma_f32_16x16x32_bf16 v[32:35], a[4:7], v[68:71], v[32:35]
  buffer_load_dwordx4 a[172:175], v2, s[4:7], s54 offen offset:3072 sc1
  v_mfma_f32_16x16x32_bf16 v[24:27], a[8:11], v[64:67], v[24:27]
  v_mfma_f32_16x16x32_bf16 v[36:39], a[8:11], v[68:71], v[36:39]
  s_waitcnt lgkmcnt(2)
  v_mfma_f32_16x16x32_bf16 v[16:19], a[12:15], v[72:75], v[16:19]
  ds_read_b128 v[64:67], v2 offset:15360
  s_add_u32 s54, s57, 20480
  v_mfma_f32_16x16x32_bf16 v[28:31], a[12:15], v[76:79], v[28:31]
  ds_read_b128 v[68:71], v2 offset:35840
  buffer_load_dwordx4 a[176:179], v2, s[4:7], s54 offen offset:0 sc1
  v_mfma_f32_16x16x32_bf16 v[20:23], a[16:19], v[72:75], v[20:23]
  v_mfma_f32_16x16x32_bf16 v[32:35], a[16:19], v[76:79], v[32:35]
  v_mfma_f32_16x16x32_bf16 v[24:27], a[20:23], v[72:75], v[24:27]
  v_mfma_f32_16x16x32_bf16 v[36:39], a[20:23], v[76:79], v[36:39]
  s_waitcnt lgkmcnt(2)
  v_mfma_f32_16x16x32_bf16 v[16:19], a[24:27], v[80:83], v[16:19]
  ds_read_b128 v[72:75], v2 offset:16384
  buffer_load_dwordx4 a[180:183], v2, s[4:7], s54 offen offset:1024 sc1
  v_mfma_f32_16x16x32_bf16 v[28:31], a[24:27], v[84:87], v[28:31]
  ds_read_b128 v[76:79], v2 offset:36864
  buffer_load_dwordx4 a[184:187], v2, s[4:7], s54 offen offset:2048 sc1
  v_mfma_f32_16x16x32_bf16 v[20:23], a[28:31], v[80:83], v[20:23]
  v_mfma_f32_16x16x32_bf16 v[32:35], a[28:31], v[84:87], v[32:35]
  v_mfma_f32_16x16x32_bf16 v[24:27], a[32:35], v[80:83], v[24:27]
  v_mfma_f32_16x16x32_bf16 v[36:39], a[32:35], v[84:87], v[36:39]
  s_waitcnt lgkmcnt(2)
  v_mfma_f32_16x16x32_bf16 v[16:19], a[36:39], v[64:67], v[16:19]
  ds_read_b128 v[80:83], v2 offset:17408
  buffer_load_dwordx4 a[188:191], v2, s[4:7], s54 offen offset:3072 sc1
  v_mfma_f32_16x16x32_bf16 v[28:31], a[36:39], v[68:71], v[28:31]
  ds_read_b128 v[84:87], v2 offset:37888
  v_mfma_f32_16x16x32_bf16 v[20:23], a[40:43], v[64:67], v[20:23]
  v_mfma_f32_16x16x32_bf16 v[32:35], a[40:43], v[68:71], v[32:35]
  v_mfma_f32_16x16x32_bf16 v[24:27], a[44:47], v[64:67], v[24:27]
  v_mfma_f32_16x16x32_bf16 v[36:39], a[44:47], v[68:71], v[36:39]
  s_waitcnt lgkmcnt(2)
  v_mfma_f32_16x16x32_bf16 v[16:19], a[48:51], v[72:75], v[16:19]
  ds_read_b128 v[64:67], v2 offset:18432
  s_add_u32 s54, s57, 24576
  v_mfma_f32_16x16x32_bf16 v[28:31], a[48:51], v[76:79], v[28:31]
  ds_read_b128 v[68:71], v2 offset:38912
  buffer_load_dwordx4 a[192:195], v2, s[4:7], s54 offen offset:0 sc1
  v_mfma_f32_16x16x32_bf16 v[20:23], a[52:55], v[72:75], v[20:23]
  buffer_load_dwordx4 a[196:199], v2, s[4:7], s54 offen offset:1024 sc1
  v_mfma_f32_16x16x32_bf16 v[32:35], a[52:55], v[76:79], v[32:35]
  v_mfma_f32_16x16x32_bf16 v[24:27], a[56:59], v[72:75], v[24:27]
  v_mfma_f32_16x16x32_bf16 v[36:39], a[56:59], v[76:79], v[36:39]
  s_waitcnt lgkmcnt(2)
  v_mfma_f32_16x16x32_bf16 v[16:19], a[60:63], v[80:83], v[16:19]
  ds_read_b128 v[72:75], v2 offset:19456
  buffer_load_dwordx4 a[200:203], v2, s[4:7], s54 offen offset:2048 sc1
  v_mfma_f32_16x16x32_bf16 v[28:31], a[60:63], v[84:87], v[28:31]
  ds_read_b128 v[76:79], v2 offset:39936
  v_mfma_f32_16x16x32_bf16 v[20:23], a[64:67], v[80:83], v[20:23]
  v_mfma_f32_16x16x32_bf16 v[32:35], a[64:67], v[84:87], v[32:35]
  v_mfma_f32_16x16x32_bf16 v[24:27], a[68:71], v[80:83], v[24:27]
  v_mfma_f32_16x16x32_bf16 v[36:39], a[68:71], v[84:87], v[36:39]
  s_waitcnt lgkmcnt(2)
  v_mfma_f32_16x16x32_bf16 v[16:19], a[72:75], v[64:67], v[16:19]
  s_waitcnt vmcnt(10) lgkmcnt(0)
  s_barrier
  ds_read_b128 v[80:83], v5 offset:0
  v_mfma_f32_16x16x32_bf16 v[28:31], a[72:75], v[68:71], v[28:31]
  ds_read_b128 v[84:87], v5 offset:20480
  buffer_load_dwordx4 a[204:207], v2, s[4:7], s54 offen offset:3072 sc1
  v_mfma_f32_16x16x32_bf16 v[20:23], a[76:79], v[64:67], v[20:23]
  s_add_u32 s54, s57, 28672
  buffer_load_dwordx4 a[208:211], v2, s[4:7], s54 offen offset:0 sc1
  v_mfma_f32_16x16x32_bf16 v[32:35], a[76:79], v[68:71], v[32:35]
  v_mfma_f32_16x16x32_bf16 v[24:27], a[80:83], v[64:67], v[24:27]
  v_mfma_f32_16x16x32_bf16 v[36:39], a[80:83], v[68:71], v[36:39]
  s_waitcnt lgkmcnt(2)
  v_mfma_f32_16x16x32_bf16 v[16:19], a[84:87], v[72:75], v[16:19]
  ds_read_b128 v[64:67], v5 offset:1024
  buffer_load_dwordx4 a[212:215], v2, s[4:7], s54 offen offset:1024 sc1
  v_mfma_f32_16x16x32_bf16 v[28:31], a[84:87], v[76:79], v[28:31]
  ds_read_b128 v[68:71], v5 offset:21504
  v_mfma_f32_16x16x32_bf16 v[20:23], a[88:91], v[72:75], v[20:23]
  v_mfma_f32_16x16x32_bf16 v[32:35], a[88:91], v[76:79], v[32:35]
  v_mfma_f32_16x16x32_bf16 v[24:27], a[92:95], v[72:75], v[24:27]
  v_mfma_f32_16x16x32_bf16 v[36:39], a[92:95], v[76:79], v[36:39]
  s_waitcnt lgkmcnt(2)
  v_mfma_f32_16x16x32_bf16 v[40:43], v[112:115], v[80:83], 0
  ds_read_b128 v[72:75], v5 offset:2048
  buffer_load_dwordx4 a[216:219], v2, s[4:7], s54 offen offset:2048 sc1
  v_mfma_f32_16x16x32_bf16 v[52:55], v[112:115], v[84:87], 0
  ds_read_b128 v[76:79], v5 offset:22528
  buffer_load_dwordx4 a[220:223], v2, s[4:7], s54 offen offset:3072 sc1
  v_mfma_f32_16x16x32_bf16 v[44:47], v[116:119], v[80:83], 0
  v_mfma_f32_16x16x32_bf16 v[56:59], v[116:119], v[84:87], 0
  v_mfma_f32_16x16x32_bf16 v[48:51], v[120:123], v[80:83], 0
  v_mfma_f32_16x16x32_bf16 v[60:63], v[120:123], v[84:87], 0
  s_waitcnt lgkmcnt(2)
  v_mfma_f32_16x16x32_bf16 v[40:43], v[124:127], v[64:67], v[40:43]
  ds_read_b128 v[80:83], v5 offset:3072
  s_add_u32 s54, s57, 32768
  v_mfma_f32_16x16x32_bf16 v[52:55], v[124:127], v[68:71], v[52:55]
  ds_read_b128 v[84:87], v5 offset:23552
  buffer_load_dwordx4 a[224:227], v2, s[4:7], s54 offen offset:0 sc1
  v_mfma_f32_16x16x32_bf16 v[44:47], v[128:131], v[64:67], v[44:47]
  v_permlane16_swap_b32 v16, v28
  v_mfma_f32_16x16x32_bf16 v[56:59], v[128:131], v[68:71], v[56:59]
  v_permlane16_swap_b32 v17, v29
  v_mfma_f32_16x16x32_bf16 v[48:51], v[132:135], v[64:67], v[48:51]
  v_permlane16_swap_b32 v18, v30
  v_mfma_f32_16x16x32_bf16 v[60:63], v[132:135], v[68:71], v[60:63]
  s_waitcnt lgkmcnt(2)
  v_mfma_f32_16x16x32_bf16 v[40:43], v[136:139], v[72:75], v[40:43]
  ds_read_b128 v[64:67], v5 offset:4096
  s_add_u32 m0, s53, 0
  v_mfma_f32_16x16x32_bf16 v[52:55], v[136:139], v[76:79], v[52:55]
  ds_read_b128 v[68:71], v5 offset:24576
  s_add_u32 s48, s51, 40960
  v_mfma_f32_16x16x32_bf16 v[44:47], v[140:143], v[72:75], v[44:47]
  buffer_load_dwordx4 v2, s[4:7], s48 offen offset:0 sc1 lds
  v_mfma_f32_16x16x32_bf16 v[56:59], v[140:143], v[76:79], v[56:59]
  v_permlane16_swap_b32 v19, v31
  v_mfma_f32_16x16x32_bf16 v[48:51], v[144:147], v[72:75], v[48:51]
  v_permlane16_swap_b32 v20, v32
  v_mfma_f32_16x16x32_bf16 v[60:63], v[144:147], v[76:79], v[60:63]
  s_waitcnt lgkmcnt(2)
  v_mfma_f32_16x16x32_bf16 v[40:43], v[148:151], v[80:83], v[40:43]
  ds_read_b128 v[72:75], v5 offset:5120
  buffer_load_dwordx4 v2, s[4:7], s48 offen offset:2048 sc1 lds
  v_mfma_f32_16x16x32_bf16 v[52:55], v[148:151], v[84:87], v[52:55]
  ds_read_b128 v[76:79], v5 offset:25600
  v_mfma_f32_16x16x32_bf16 v[44:47], v[152:155], v[80:83], v[44:47]
  v_permlane16_swap_b32 v21, v33
  v_mfma_f32_16x16x32_bf16 v[56:59], v[152:155], v[84:87], v[56:59]
  v_permlane16_swap_b32 v22, v34
  v_mfma_f32_16x16x32_bf16 v[48:51], v[156:159], v[80:83], v[48:51]
  v_permlane16_swap_b32 v23, v35
  v_mfma_f32_16x16x32_bf16 v[60:63], v[156:159], v[84:87], v[60:63]
  s_waitcnt vmcnt(17)
  s_waitcnt lgkmcnt(2)
  v_mfma_f32_16x16x32_bf16 v[40:43], v[160:163], v[64:67], v[40:43]
  ds_read_b128 v[80:83], v5 offset:6144
  s_add_u32 m0, s53, 4096
  v_mfma_f32_16x16x32_bf16 v[52:55], v[160:163], v[68:71], v[52:55]
  ds_read_b128 v[84:87], v5 offset:26624
  s_add_u32 s48, s51, 45056
  v_mfma_f32_16x16x32_bf16 v[44:47], v[164:167], v[64:67], v[44:47]
  buffer_load_dwordx4 v2, s[4:7], s48 offen offset:0 sc1 lds
  v_bitop3_b32 v10, v10, v11, v1 bitop3:0x7e
  v_mfma_f32_16x16x32_bf16 v[56:59], v[164:167], v[68:71], v[56:59]
  v_cmp_ne_u32 vcc, 0, v10
  v_mfma_f32_16x16x32_bf16 v[48:51], v[168:171], v[64:67], v[48:51]
  v_permlane16_swap_b32 v24, v36
  v_mfma_f32_16x16x32_bf16 v[60:63], v[168:171], v[68:71], v[60:63]
  s_waitcnt lgkmcnt(2)
  v_mfma_f32_16x16x32_bf16 v[40:43], v[172:175], v[72:75], v[40:43]
  ds_read_b128 v[64:67], v5 offset:7168
  buffer_load_dwordx4 v2, s[4:7], s48 offen offset:2048 sc1 lds
  v_mfma_f32_16x16x32_bf16 v[52:55], v[172:175], v[76:79], v[52:55]
  ds_read_b128 v[68:71], v5 offset:27648
  v_mfma_f32_16x16x32_bf16 v[44:47], v[176:179], v[72:75], v[44:47]
  v_permlane16_swap_b32 v25, v37
  v_mfma_f32_16x16x32_bf16 v[56:59], v[176:179], v[76:79], v[56:59]
  v_permlane16_swap_b32 v26, v38
  v_mfma_f32_16x16x32_bf16 v[48:51], v[180:183], v[72:75], v[48:51]
  v_permlane16_swap_b32 v27, v39
  v_mfma_f32_16x16x32_bf16 v[60:63], v[180:183], v[76:79], v[60:63]
  s_cbranch_vccz Lsckd_16
Lsck_15:
  s_add_u32 s55, s62, 0
  buffer_load_dwordx4 v[8:11], v7, s[4:7], s55 offen sc1
  s_waitcnt vmcnt(0)
  v_bitop3_b32 v10, v10, v11, v1 bitop3:0x7e
  v_cmp_ne_u32 vcc, 0, v10
  s_nop 1
  s_nop 1
  s_cbranch_vccnz Lsck_15
Lsckd_16:
  s_waitcnt lgkmcnt(2)
  v_mfma_f32_16x16x32_bf16 v[40:43], v[184:187], v[80:83], v[40:43]
  ds_read_b128 v[72:75], v5 offset:8192
  s_add_u32 m0, s53, 8192
  v_mfma_f32_16x16x32_bf16 v[52:55], v[184:187], v[84:87], v[52:55]
  ds_read_b128 v[76:79], v5 offset:28672
  s_add_u32 s48, s61, 49152
  v_mfma_f32_16x16x32_bf16 v[44:47], v[188:191], v[80:83], v[44:47]
  buffer_load_dwordx4 v2, s[4:7], s48 offen offset:0 sc1 lds
  v_fmac_f32 v16, v8, v88
  v_mfma_f32_16x16x32_bf16 v[56:59], v[188:191], v[84:87], v[56:59]
  v_fmac_f32 v17, v8, v89
  v_fmac_f32 v18, v8, v90
  v_mfma_f32_16x16x32_bf16 v[48:51], v[192:195], v[80:83], v[48:51]
  v_fmac_f32 v19, v8, v91
  v_fmac_f32 v20, v8, v92
  v_mfma_f32_16x16x32_bf16 v[60:63], v[192:195], v[84:87], v[60:63]
  v_fmac_f32 v21, v8, v93
  s_waitcnt lgkmcnt(2)
  v_mfma_f32_16x16x32_bf16 v[40:43], v[196:199], v[64:67], v[40:43]
  ds_read_b128 v[80:83], v5 offset:9216
  buffer_load_dwordx4 v2, s[4:7], s48 offen offset:2048 sc1 lds
  v_mfma_f32_16x16x32_bf16 v[52:55], v[196:199], v[68:71], v[52:55]
  ds_read_b128 v[84:87], v5 offset:29696
  v_fmac_f32 v22, v8, v94
  v_mfma_f32_16x16x32_bf16 v[44:47], v[200:203], v[64:67], v[44:47]
  v_fmac_f32 v23, v8, v95
  v_fmac_f32 v24, v8, v96
  v_mfma_f32_16x16x32_bf16 v[56:59], v[200:203], v[68:71], v[56:59]
  v_fmac_f32 v25, v8, v97
  v_fmac_f32 v26, v8, v98
  v_mfma_f32_16x16x32_bf16 v[48:51], v[204:207], v[64:67], v[48:51]
  v_fmac_f32 v27, v8, v99
  v_fmac_f32 v28, v8, v100
  v_mfma_f32_16x16x32_bf16 v[60:63], v[204:207], v[68:71], v[60:63]
  v_fmac_f32 v29, v8, v101
  s_waitcnt lgkmcnt(2)
  v_mfma_f32_16x16x32_bf16 v[40:43], v[208:211], v[72:75], v[40:43]
  ds_read_b128 v[64:67], v5 offset:10240
  s_add_u32 m0, s53, 12288
  v_mfma_f32_16x16x32_bf16 v[52:55], v[208:211], v[76:79], v[52:55]
  ds_read_b128 v[68:71], v5 offset:30720
  s_add_u32 s48, s61, 53248
  v_mfma_f32_16x16x32_bf16 v[44:47], v[212:215], v[72:75], v[44:47]
  buffer_load_dwordx4 v2, s[4:7], s48 offen offset:0 sc1 lds
  v_fmac_f32 v30, v8, v102
  v_mfma_f32_16x16x32_bf16 v[56:59], v[212:215], v[76:79], v[56:59]
  v_fmac_f32 v31, v8, v103
  v_fmac_f32 v32, v8, v104
  v_mfma_f32_16x16x32_bf16 v[48:51], v[216:219], v[72:75], v[48:51]
  v_fmac_f32 v33, v8, v105
  v_fmac_f32 v34, v8, v106
  v_mfma_f32_16x16x32_bf16 v[60:63], v[216:219], v[76:79], v[60:63]
  v_fmac_f32 v35, v8, v107
  s_waitcnt lgkmcnt(2)
  v_mfma_f32_16x16x32_bf16 v[40:43], v[220:223], v[80:83], v[40:43]
  ds_read_b128 v[72:75], v5 offset:11264
  buffer_load_dwordx4 v2, s[4:7], s48 offen offset:2048 sc1 lds
  v_mfma_f32_16x16x32_bf16 v[52:55], v[220:223], v[84:87], v[52:55]
  ds_read_b128 v[76:79], v5 offset:31744
  v_fmac_f32 v36, v8, v108
  v_mfma_f32_16x16x32_bf16 v[44:47], v[224:227], v[80:83], v[44:47]
  v_fmac_f32 v37, v8, v109
  v_fmac_f32 v38, v8, v110
  v_mfma_f32_16x16x32_bf16 v[56:59], v[224:227], v[84:87], v[56:59]
  v_fmac_f32 v39, v8, v111
  v_max_f32 v16, 0, v16
  v_mfma_f32_16x16x32_bf16 v[48:51], v[228:231], v[80:83], v[48:51]
  v_mul_f32 v28, v9, v28
  v_max_f32 v17, 0, v17
  v_mfma_f32_16x16x32_bf16 v[60:63], v[228:231], v[84:87], v[60:63]
  v_mul_f32 v29, v9, v29
  s_waitcnt lgkmcnt(2)
  v_mfma_f32_16x16x32_bf16 v[40:43], v[232:235], v[64:67], v[40:43]
  ds_read_b128 v[80:83], v5 offset:12288
  s_add_u32 m0, s53, 16384
  v_mfma_f32_16x16x32_bf16 v[52:55], v[232:235], v[68:71], v[52:55]
  ds_read_b128 v[84:87], v5 offset:32768
  s_add_u32 s48, s61, 57344
  v_mfma_f32_16x16x32_bf16 v[44:47], v[236:239], v[64:67], v[44:47]
  buffer_load_dwordx4 v2, s[4:7], s48 offen offset:0 sc1 lds
  v_max_f32 v18, 0, v18
  v_mfma_f32_16x16x32_bf16 v[56:59], v[236:239], v[68:71], v[56:59]
  v_mul_f32 v30, v9, v30
  v_max_f32 v19, 0, v19
  v_mfma_f32_16x16x32_bf16 v[48:51], v[240:243], v[64:67], v[48:51]
  v_mul_f32 v31, v9, v31
  v_max_f32 v20, 0, v20
  v_mfma_f32_16x16x32_bf16 v[60:63], v[240:243], v[68:71], v[60:63]
  v_mul_f32 v32, v9, v32
  s_waitcnt lgkmcnt(2)
  v_mfma_f32_16x16x32_bf16 v[40:43], v[244:247], v[72:75], v[40:43]
  ds_read_b128 v[64:67], v5 offset:13312
  buffer_load_dwordx4 v2, s[4:7], s48 offen offset:2048 sc1 lds
  v_mfma_f32_16x16x32_bf16 v[52:55], v[244:247], v[76:79], v[52:55]
  ds_read_b128 v[68:71], v5 offset:33792
  v_max_f32 v21, 0, v21
  v_mfma_f32_16x16x32_bf16 v[44:47], v[248:251], v[72:75], v[44:47]
  v_mul_f32 v33, v9, v33
  v_max_f32 v22, 0, v22
  v_mfma_f32_16x16x32_bf16 v[56:59], v[248:251], v[76:79], v[56:59]
  v_mul_f32 v34, v9, v34
  v_max_f32 v23, 0, v23
  v_mfma_f32_16x16x32_bf16 v[48:51], v[252:255], v[72:75], v[48:51]
  v_mul_f32 v35, v9, v35
  v_max_f32 v24, 0, v24
  v_mfma_f32_16x16x32_bf16 v[60:63], v[252:255], v[76:79], v[60:63]
  v_mul_f32 v36, v9, v36
  s_waitcnt lgkmcnt(2)
  v_mfma_f32_16x16x32_bf16 v[40:43], a[0:3], v[80:83], v[40:43]
  ds_read_b128 v[72:75], v5 offset:14336
  s_add_u32 s55, s62, 1024
  v_mfma_f32_16x16x32_bf16 v[52:55], a[0:3], v[84:87], v[52:55]
  ds_read_b128 v[76:79], v5 offset:34816
  buffer_load_dwordx4 v[12:15], v7, s[4:7], s55 offen sc1
  v_mfma_f32_16x16x32_bf16 v[44:47], a[4:7], v[80:83], v[44:47]
  s_add_u32 m0, s56, 0
  s_add_u32 s63, s57, 40960
  v_mfma_f32_16x16x32_bf16 v[56:59], a[4:7], v[84:87], v[56:59]
  buffer_load_dwordx4 v2, s[4:7], s63 offen offset:0 sc1 lds
  v_max_f32 v25, 0, v25
  v_mfma_f32_16x16x32_bf16 v[48:51], a[8:11], v[80:83], v[48:51]
  v_mul_f32 v37, v9, v37
  v_max_f32 v26, 0, v26
  v_mfma_f32_16x16x32_bf16 v[60:63], a[8:11], v[84:87], v[60:63]
  v_mul_f32 v38, v9, v38
  s_waitcnt lgkmcnt(2)
  v_mfma_f32_16x16x32_bf16 v[40:43], a[12:15], v[64:67], v[40:43]
  ds_read_b128 v[80:83], v5 offset:15360
  buffer_load_dwordx4 v2, s[4:7], s63 offen offset:1024 sc1 lds
  v_mfma_f32_16x16x32_bf16 v[52:55], a[12:15], v[68:71], v[52:55]
  ds_read_b128 v[84:87], v5 offset:35840
  buffer_load_dwordx4 v2, s[4:7], s63 offen offset:2048 sc1 lds
  v_mfma_f32_16x16x32_bf16 v[44:47], a[16:19], v[64:67], v[44:47]
  v_max_f32 v27, 0, v27
  v_mul_f32 v39, v9, v39
  v_mfma_f32_16x16x32_bf16 v[56:59], a[16:19], v[68:71], v[56:59]
  v_mul_f32 v16, v16, v28
  v_mul_f32 v17, v17, v29
  v_mfma_f32_16x16x32_bf16 v[48:51], a[20:23], v[64:67], v[48:51]
  v_mul_f32 v18, v18, v30
  v_mul_f32 v19, v19, v31
  v_mfma_f32_16x16x32_bf16 v[60:63], a[20:23], v[68:71], v[60:63]
  v_mul_f32 v20, v20, v32
  s_waitcnt lgkmcnt(2)
  v_mfma_f32_16x16x32_bf16 v[40:43], a[24:27], v[72:75], v[40:43]
  ds_read_b128 v[64:67], v5 offset:16384
  buffer_load_dwordx4 v2, s[4:7], s63 offen offset:3072 sc1 lds
  v_mfma_f32_16x16x32_bf16 v[52:55], a[24:27], v[76:79], v[52:55]
  ds_read_b128 v[68:71], v5 offset:36864
  v_mul_f32 v21, v21, v33
  v_mfma_f32_16x16x32_bf16 v[44:47], a[28:31], v[72:75], v[44:47]
  v_mul_f32 v22, v22, v34
  v_mul_f32 v23, v23, v35
  v_mfma_f32_16x16x32_bf16 v[56:59], a[28:31], v[76:79], v[56:59]
  v_mul_f32 v24, v24, v36
  v_mul_f32 v25, v25, v37
  v_mfma_f32_16x16x32_bf16 v[48:51], a[32:35], v[72:75], v[48:51]
  v_mul_f32 v26, v26, v38
  v_mul_f32 v27, v27, v39
  v_mfma_f32_16x16x32_bf16 v[60:63], a[32:35], v[76:79], v[60:63]
  v_cvt_pk_bf16_f32 v28, v16, v17
  s_waitcnt lgkmcnt(2)
  v_mfma_f32_16x16x32_bf16 v[40:43], a[36:39], v[80:83], v[40:43]
  ds_read_b128 v[72:75], v5 offset:17408
  s_add_u32 m0, s56, 4096
  v_mfma_f32_16x16x32_bf16 v[52:55], a[36:39], v[84:87], v[52:55]
  ds_read_b128 v[76:79], v5 offset:37888
  s_add_u32 s63, s57, 45056
  v_mfma_f32_16x16x32_bf16 v[44:47], a[40:43], v[80:83], v[44:47]
  buffer_load_dwordx4 v2, s[4:7], s63 offen offset:0 sc1 lds
  v_cvt_pk_bf16_f32 v29, v18, v19
  v_mfma_f32_16x16x32_bf16 v[56:59], a[40:43], v[84:87], v[56:59]
  v_cvt_pk_bf16_f32 v30, v20, v21
  v_cvt_pk_bf16_f32 v31, v22, v23
  v_mfma_f32_16x16x32_bf16 v[48:51], a[44:47], v[80:83], v[48:51]
  v_cvt_pk_bf16_f32 v32, v24, v25
  v_cvt_pk_bf16_f32 v33, v26, v27
  v_mfma_f32_16x16x32_bf16 v[60:63], a[44:47], v[84:87], v[60:63]
  s_add_u32 s49, s52, 0
  s_waitcnt lgkmcnt(2)
  v_mfma_f32_16x16x32_bf16 v[40:43], a[48:51], v[64:67], v[40:43]
  ds_read_b128 v[80:83], v5 offset:18432
  buffer_load_dwordx4 v2, s[4:7], s63 offen offset:1024 sc1 lds
  v_mfma_f32_16x16x32_bf16 v[52:55], a[48:51], v[68:71], v[52:55]
  ds_read_b128 v[84:87], v5 offset:38912
  buffer_store_dwordx4 v[28:31], v3, s[4:7], s49 offen sc1
  v_mfma_f32_16x16x32_bf16 v[44:47], a[52:55], v[64:67], v[44:47]
  buffer_store_dwordx2 v[32:33], v4, s[4:7], s49 offen sc1
  v_mfma_f32_16x16x32_bf16 v[56:59], a[52:55], v[68:71], v[56:59]
  v_mfma_f32_16x16x32_bf16 v[48:51], a[56:59], v[64:67], v[48:51]
  v_mfma_f32_16x16x32_bf16 v[60:63], a[56:59], v[68:71], v[60:63]
  s_waitcnt lgkmcnt(2)
  v_mfma_f32_16x16x32_bf16 v[40:43], a[60:63], v[72:75], v[40:43]
  ds_read_b128 v[64:67], v5 offset:19456
  buffer_load_dwordx4 v2, s[4:7], s63 offen offset:2048 sc1 lds
  v_mfma_f32_16x16x32_bf16 v[52:55], a[60:63], v[76:79], v[52:55]
  ds_read_b128 v[68:71], v5 offset:39936
  buffer_load_dwordx4 v2, s[4:7], s63 offen offset:3072 sc1 lds
  v_mfma_f32_16x16x32_bf16 v[44:47], a[64:67], v[72:75], v[44:47]
  v_mfma_f32_16x16x32_bf16 v[56:59], a[64:67], v[76:79], v[56:59]
  v_mfma_f32_16x16x32_bf16 v[48:51], a[68:71], v[72:75], v[48:51]
  v_mfma_f32_16x16x32_bf16 v[60:63], a[68:71], v[76:79], v[60:63]
  s_waitcnt lgkmcnt(2)
  v_mfma_f32_16x16x32_bf16 v[40:43], a[72:75], v[80:83], v[40:43]
  s_waitcnt vmcnt(11) lgkmcnt(0)
  s_barrier
  ds_read_b128 v[72:75], v2 offset:0
  v_mfma_f32_16x16x32_bf16 v[52:55], a[72:75], v[84:87], v[52:55]
  ds_read_b128 v[76:79], v2 offset:20480
  s_add_u32 m0, s56, 8192
  v_mfma_f32_16x16x32_bf16 v[44:47], a[76:79], v[80:83], v[44:47]
  s_add_u32 s63, s57, 49152
  buffer_load_dwordx4 v2, s[4:7], s63 offen offset:0 sc1 lds
  v_mfma_f32_16x16x32_bf16 v[56:59], a[76:79], v[84:87], v[56:59]
  v_mfma_f32_16x16x32_bf16 v[48:51], a[80:83], v[80:83], v[48:51]
  v_mfma_f32_16x16x32_bf16 v[60:63], a[80:83], v[84:87], v[60:63]
  s_waitcnt lgkmcnt(2)
  v_mfma_f32_16x16x32_bf16 v[40:43], a[84:87], v[64:67], v[40:43]
  ds_read_b128 v[80:83], v2 offset:1024
  buffer_load_dwordx4 v2, s[4:7], s63 offen offset:1024 sc1 lds
  v_mfma_f32_16x16x32_bf16 v[52:55], a[84:87], v[68:71], v[52:55]
  ds_read_b128 v[84:87], v2 offset:21504
  v_mfma_f32_16x16x32_bf16 v[44:47], a[88:91], v[64:67], v[44:47]
  v_mfma_f32_16x16x32_bf16 v[56:59], a[88:91], v[68:71], v[56:59]
  v_mfma_f32_16x16x32_bf16 v[48:51], a[92:95], v[64:67], v[48:51]
  v_mfma_f32_16x16x32_bf16 v[60:63], a[92:95], v[68:71], v[60:63]
  s_waitcnt lgkmcnt(2)
  v_mfma_f32_16x16x32_bf16 v[16:19], v[112:115], v[72:75], 0
  ds_read_b128 v[64:67], v2 offset:2048
  buffer_load_dwordx4 v2, s[4:7], s63 offen offset:2048 sc1 lds
  v_mfma_f32_16x16x32_bf16 v[28:31], v[112:115], v[76:79], 0
  ds_read_b128 v[68:71], v2 offset:22528
  v_mfma_f32_16x16x32_bf16 v[20:23], v[116:119], v[72:75], 0
  v_mfma_f32_16x16x32_bf16 v[32:35], v[116:119], v[76:79], 0
  v_mfma_f32_16x16x32_bf16 v[24:27], v[120:123], v[72:75], 0
  v_mfma_f32_16x16x32_bf16 v[36:39], v[120:123], v[76:79], 0
  s_waitcnt lgkmcnt(2)
  v_mfma_f32_16x16x32_bf16 v[16:19], v[124:127], v[80:83], v[16:19]
  ds_read_b128 v[72:75], v2 offset:3072
  buffer_load_dwordx4 v2, s[4:7], s63 offen offset:3072 sc1 lds
  v_mfma_f32_16x16x32_bf16 v[28:31], v[124:127], v[84:87], v[28:31]
  ds_read_b128 v[76:79], v2 offset:23552
  v_mfma_f32_16x16x32_bf16 v[20:23], v[128:131], v[80:83], v[20:23]
  v_permlane16_swap_b32 v40, v52
  v_mfma_f32_16x16x32_bf16 v[32:35], v[128:131], v[84:87], v[32:35]
  v_permlane16_swap_b32 v41, v53
  v_mfma_f32_16x16x32_bf16 v[24:27], v[132:135], v[80:83], v[24:27]
  v_permlane16_swap_b32 v42, v54
  v_mfma_f32_16x16x32_bf16 v[36:39], v[132:135], v[84:87], v[36:39]
  s_waitcnt lgkmcnt(2)
  v_mfma_f32_16x16x32_bf16 v[16:19], v[136:139], v[64:67], v[16:19]
  ds_read_b128 v[80:83], v2 offset:4096
  v_mfma_f32_16x16x32_bf16 v[28:31], v[136:139], v[68:71], v[28:31]
  ds_read_b128 v[84:87], v2 offset:24576
  v_mfma_f32_16x16x32_bf16 v[20:23], v[140:143], v[64:67], v[20:23]
  v_permlane16_swap_b32 v43, v55
  v_mfma_f32_16x16x32_bf16 v[32:35], v[140:143], v[68:71], v[32:35]
  v_permlane16_swap_b32 v44, v56
  v_mfma_f32_16x16x32_bf16 v[24:27], v[144:147], v[64:67], v[24:27]
  v_permlane16_swap_b32 v45, v57
  v_mfma_f32_16x16x32_bf16 v[36:39], v[144:147], v[68:71], v[36:39]
  s_waitcnt lgkmcnt(2)
  v_mfma_f32_16x16x32_bf16 v[16:19], v[148:151], v[72:75], v[16:19]
  ds_read_b128 v[64:67], v2 offset:5120
  v_mfma_f32_16x16x32_bf16 v[28:31], v[148:151], v[76:79], v[28:31]
  ds_read_b128 v[68:71], v2 offset:25600
  v_mfma_f32_16x16x32_bf16 v[20:23], v[152:155], v[72:75], v[20:23]
  v_permlane16_swap_b32 v46, v58
  v_mfma_f32_16x16x32_bf16 v[32:35], v[152:155], v[76:79], v[32:35]
  v_permlane16_swap_b32 v47, v59
  v_mfma_f32_16x16x32_bf16 v[24:27], v[156:159], v[72:75], v[24:27]
  s_waitcnt vmcnt(14)
  v_bitop3_b32 v14, v14, v15, v1 bitop3:0x7e
  v_mfma_f32_16x16x32_bf16 v[36:39], v[156:159], v[76:79], v[36:39]
  v_cmp_ne_u32 vcc, 0, v14
  s_waitcnt lgkmcnt(2)
  v_mfma_f32_16x16x32_bf16 v[16:19], v[160:163], v[80:83], v[16:19]
  ds_read_b128 v[72:75], v2 offset:6144
  v_mfma_f32_16x16x32_bf16 v[28:31], v[160:163], v[84:87], v[28:31]
  ds_read_b128 v[76:79], v2 offset:26624
  v_mfma_f32_16x16x32_bf16 v[20:23], v[164:167], v[80:83], v[20:23]
  v_permlane16_swap_b32 v48, v60
  v_mfma_f32_16x16x32_bf16 v[32:35], v[164:167], v[84:87], v[32:35]
  v_permlane16_swap_b32 v49, v61
  v_mfma_f32_16x16x32_bf16 v[24:27], v[168:171], v[80:83], v[24:27]
  v_permlane16_swap_b32 v50, v62
  v_mfma_f32_16x16x32_bf16 v[36:39], v[168:171], v[84:87], v[36:39]
  s_waitcnt lgkmcnt(2)
  v_mfma_f32_16x16x32_bf16 v[16:19], v[172:175], v[64:67], v[16:19]
  ds_read_b128 v[80:83], v2 offset:7168
  v_mfma_f32_16x16x32_bf16 v[28:31], v[172:175], v[68:71], v[28:31]
  ds_read_b128 v[84:87], v2 offset:27648
  v_mfma_f32_16x16x32_bf16 v[20:23], v[176:179], v[64:67], v[20:23]
  v_permlane16_swap_b32 v51, v63
  v_mfma_f32_16x16x32_bf16 v[32:35], v[176:179], v[68:71], v[32:35]
  s_cbranch_vccz Lsckd_18
Lsck_17:
  s_add_u32 s55, s62, 1024
  buffer_load_dwordx4 v[12:15], v7, s[4:7], s55 offen sc1
  s_waitcnt vmcnt(0)
  v_bitop3_b32 v14, v14, v15, v1 bitop3:0x7e
  v_cmp_ne_u32 vcc, 0, v14
  s_nop 1
  s_nop 1
  s_cbranch_vccnz Lsck_17
Lsckd_18:
  v_fmac_f32 v40, v12, v88
  v_mfma_f32_16x16x32_bf16 v[24:27], v[180:183], v[64:67], v[24:27]
  v_fmac_f32 v41, v12, v89
  v_fmac_f32 v42, v12, v90
  v_mfma_f32_16x16x32_bf16 v[36:39], v[180:183], v[68:71], v[36:39]
  v_fmac_f32 v43, v12, v91
  s_waitcnt lgkmcnt(2)
  v_mfma_f32_16x16x32_bf16 v[16:19], v[184:187], v[72:75], v[16:19]
  ds_read_b128 v[64:67], v2 offset:8192
  s_add_u32 m0, s53, 40960
  v_mfma_f32_16x16x32_bf16 v[28:31], v[184:187], v[76:79], v[28:31]
  ds_read_b128 v[68:71], v2 offset:28672
  s_add_u32 s48, s51, 122880
  v_mfma_f32_16x16x32_bf16 v[20:23], v[188:191], v[72:75], v[20:23]
  buffer_load_dwordx4 v2, s[4:7], s48 offen offset:0 sc1 lds
  buffer_load_dwordx4 v2, s[4:7], s48 offen offset:2048 sc1 lds
  v_mfma_f32_16x16x32_bf16 v[32:35], v[188:191], v[76:79], v[32:35]
  v_fmac_f32 v44, v12, v92
  v_fmac_f32 v45, v12, v93
  v_mfma_f32_16x16x32_bf16 v[24:27], v[192:195], v[72:75], v[24:27]
  v_fmac_f32 v46, v12, v94
  v_fmac_f32 v47, v12, v95
  v_mfma_f32_16x16x32_bf16 v[36:39], v[192:195], v[76:79], v[36:39]
  v_fmac_f32 v48, v12, v96
  s_waitcnt lgkmcnt(2)
  v_mfma_f32_16x16x32_bf16 v[16:19], v[196:199], v[80:83], v[16:19]
  ds_read_b128 v[72:75], v2 offset:9216
  s_add_u32 m0, s53, 45056
  v_mfma_f32_16x16x32_bf16 v[28:31], v[196:199], v[84:87], v[28:31]
  ds_read_b128 v[76:79], v2 offset:29696
  s_add_u32 s48, s51, 126976
  v_mfma_f32_16x16x32_bf16 v[20:23], v[200:203], v[80:83], v[20:23]
  buffer_load_dwordx4 v2, s[4:7], s48 offen offset:0 sc1 lds
  v_fmac_f32 v49, v12, v97
  v_mfma_f32_16x16x32_bf16 v[32:35], v[200:203], v[84:87], v[32:35]
  v_fmac_f32 v50, v12, v98
  v_fmac_f32 v51, v12, v99
  v_mfma_f32_16x16x32_bf16 v[24:27], v[204:207], v[80:83], v[24:27]
  v_fmac_f32 v52, v12, v100
  v_fmac_f32 v53, v12, v101
  v_mfma_f32_16x16x32_bf16 v[36:39], v[204:207], v[84:87], v[36:39]
  v_fmac_f32 v54, v12, v102
  s_waitcnt lgkmcnt(2)
  v_mfma_f32_16x16x32_bf16 v[16:19], v[208:211], v[64:67], v[16:19]
  ds_read_b128 v[80:83], v2 offset:10240
  buffer_load_dwordx4 v2, s[4:7], s48 offen offset:2048 sc1 lds
  v_mfma_f32_16x16x32_bf16 v[28:31], v[208:211], v[68:71], v[28:31]
  ds_read_b128 v[84:87], v2 offset:30720
  v_fmac_f32 v55, v12, v103
  v_mfma_f32_16x16x32_bf16 v[20:23], v[212:215], v[64:67], v[20:23]
  v_fmac_f32 v56, v12, v104
  v_fmac_f32 v57, v12, v105
  v_mfma_f32_16x16x32_bf16 v[32:35], v[212:215], v[68:71], v[32:35]
  v_fmac_f32 v58, v12, v106
  v_fmac_f32 v59, v12, v107
  v_mfma_f32_16x16x32_bf16 v[24:27], v[216:219], v[64:67], v[24:27]
  v_fmac_f32 v60, v12, v108
  v_fmac_f32 v61, v12, v109
  v_mfma_f32_16x16x32_bf16 v[36:39], v[216:219], v[68:71], v[36:39]
  v_fmac_f32 v62, v12, v110
  s_waitcnt lgkmcnt(2)
  v_mfma_f32_16x16x32_bf16 v[16:19], v[220:223], v[72:75], v[16:19]
  ds_read_b128 v[64:67], v2 offset:11264
  s_add_u32 m0, s53, 49152
  v_mfma_f32_16x16x32_bf16 v[28:31], v[220:223], v[76:79], v[28:31]
  ds_read_b128 v[68:71], v2 offset:31744
  s_add_u32 s48, s61, 131072
  v_mfma_f32_16x16x32_bf16 v[20:23], v[224:227], v[72:75], v[20:23]
  buffer_load_dwordx4 v2, s[4:7], s48 offen offset:0 sc1 lds
  v_fmac_f32 v63, v12, v111
  v_mfma_f32_16x16x32_bf16 v[32:35], v[224:227], v[76:79], v[32:35]
  v_max_f32 v40, 0, v40
  v_mul_f32 v52, v13, v52
  v_mfma_f32_16x16x32_bf16 v[24:27], v[228:231], v[72:75], v[24:27]
  v_max_f32 v41, 0, v41
  v_mul_f32 v53, v13, v53
  v_mfma_f32_16x16x32_bf16 v[36:39], v[228:231], v[76:79], v[36:39]
  v_max_f32 v42, 0, v42
  s_waitcnt lgkmcnt(2)
  v_mfma_f32_16x16x32_bf16 v[16:19], v[232:235], v[80:83], v[16:19]
  ds_read_b128 v[72:75], v2 offset:12288
  buffer_load_dwordx4 v2, s[4:7], s48 offen offset:2048 sc1 lds
  v_mfma_f32_16x16x32_bf16 v[28:31], v[232:235], v[84:87], v[28:31]
  ds_read_b128 v[76:79], v2 offset:32768
  v_mul_f32 v54, v13, v54
  v_mfma_f32_16x16x32_bf16 v[20:23], v[236:239], v[80:83], v[20:23]
  v_max_f32 v43, 0, v43
  v_mul_f32 v55, v13, v55
  v_mfma_f32_16x16x32_bf16 v[32:35], v[236:239], v[84:87], v[32:35]
  v_max_f32 v44, 0, v44
  v_mul_f32 v56, v13, v56
  v_mfma_f32_16x16x32_bf16 v[24:27], v[240:243], v[80:83], v[24:27]
  v_max_f32 v45, 0, v45
  v_mul_f32 v57, v13, v57
  v_mfma_f32_16x16x32_bf16 v[36:39], v[240:243], v[84:87], v[36:39]
  v_max_f32 v46, 0, v46
  s_waitcnt lgkmcnt(2)
  v_mfma_f32_16x16x32_bf16 v[16:19], v[244:247], v[64:67], v[16:19]
  ds_read_b128 v[80:83], v2 offset:13312
  s_add_u32 m0, s53, 53248
  v_mfma_f32_16x16x32_bf16 v[28:31], v[244:247], v[68:71], v[28:31]
  ds_read_b128 v[84:87], v2 offset:33792
  s_add_u32 s48, s61, 135168
  v_mfma_f32_16x16x32_bf16 v[20:23], v[248:251], v[64:67], v[20:23]
  buffer_load_dwordx4 v2, s[4:7], s48 offen offset:0 sc1 lds
  v_mul_f32 v58, v13, v58
  v_mfma_f32_16x16x32_bf16 v[32:35], v[248:251], v[68:71], v[32:35]
  v_max_f32 v47, 0, v47
  v_mul_f32 v59, v13, v59
  v_mfma_f32_16x16x32_bf16 v[24:27], v[252:255], v[64:67], v[24:27]
  v_max_f32 v48, 0, v48
  v_mul_f32 v60, v13, v60
  v_mfma_f32_16x16x32_bf16 v[36:39], v[252:255], v[68:71], v[36:39]
  v_max_f32 v49, 0, v49
  s_waitcnt lgkmcnt(2)
  v_mfma_f32_16x16x32_bf16 v[16:19], a[0:3], v[72:75], v[16:19]
  ds_read_b128 v[64:67], v2 offset:14336
  buffer_load_dwordx4 v2, s[4:7], s48 offen offset:2048 sc1 lds
  v_mfma_f32_16x16x32_bf16 v[28:31], a[0:3], v[76:79], v[28:31]
  ds_read_b128 v[68:71], v2 offset:34816
  v_mul_f32 v61, v13, v61
  v_mfma_f32_16x16x32_bf16 v[20:23], a[4:7], v[72:75], v[20:23]
  v_max_f32 v50, 0, v50
  v_mul_f32 v62, v13, v62
  v_mfma_f32_16x16x32_bf16 v[32:35], a[4:7], v[76:79], v[32:35]
  v_max_f32 v51, 0, v51
  v_mul_f32 v63, v13, v63
  v_mfma_f32_16x16x32_bf16 v[24:27], a[8:11], v[72:75], v[24:27]
  v_mul_f32 v40, v40, v52
  v_mul_f32 v41, v41, v53
  v_mfma_f32_16x16x32_bf16 v[36:39], a[8:11], v[76:79], v[36:39]
  v_mul_f32 v42, v42, v54
  s_waitcnt lgkmcnt(2)
  v_mfma_f32_16x16x32_bf16 v[16:19], a[12:15], v[80:83], v[16:19]
  ds_read_b128 v[72:75], v2 offset:15360
  s_add_u32 m0, s53, 57344
  v_mfma_f32_16x16x32_bf16 v[28:31], a[12:15], v[84:87], v[28:31]
  ds_read_b128 v[76:79], v2 offset:35840
  s_add_u32 s48, s61, 139264
  v_mfma_f32_16x16x32_bf16 v[20:23], a[16:19], v[80:83], v[20:23]
  buffer_load_dwordx4 v2, s[4:7], s48 offen offset:0 sc1 lds
  v_mul_f32 v43, v43, v55
  v_mfma_f32_16x16x32_bf16 v[32:35], a[16:19], v[84:87], v[32:35]
  v_mul_f32 v44, v44, v56
  v_mul_f32 v45, v45, v57
  v_mfma_f32_16x16x32_bf16 v[24:27], a[20:23], v[80:83], v[24:27]
  v_mul_f32 v46, v46, v58
  v_mul_f32 v47, v47, v59
  v_mfma_f32_16x16x32_bf16 v[36:39], a[20:23], v[84:87], v[36:39]
  v_mul_f32 v48, v48, v60
  s_waitcnt lgkmcnt(2)
  v_mfma_f32_16x16x32_bf16 v[16:19], a[24:27], v[64:67], v[16:19]
  ds_read_b128 v[80:83], v2 offset:16384
  buffer_load_dwordx4 v2, s[4:7], s48 offen offset:2048 sc1 lds
  v_mfma_f32_16x16x32_bf16 v[28:31], a[24:27], v[68:71], v[28:31]
  ds_read_b128 v[84:87], v2 offset:36864
  v_mul_f32 v49, v49, v61
  v_mfma_f32_16x16x32_bf16 v[20:23], a[28:31], v[64:67], v[20:23]
  v_mul_f32 v50, v50, v62
  v_mul_f32 v51, v51, v63
  v_mfma_f32_16x16x32_bf16 v[32:35], a[28:31], v[68:71], v[32:35]
  v_cvt_pk_bf16_f32 v52, v40, v41
  v_cvt_pk_bf16_f32 v53, v42, v43
  v_mfma_f32_16x16x32_bf16 v[24:27], a[32:35], v[64:67], v[24:27]
  v_cvt_pk_bf16_f32 v54, v44, v45
  v_cvt_pk_bf16_f32 v55, v46, v47
  v_mfma_f32_16x16x32_bf16 v[36:39], a[32:35], v[68:71], v[36:39]
  v_cvt_pk_bf16_f32 v56, v48, v49
  s_waitcnt lgkmcnt(2)
  v_mfma_f32_16x16x32_bf16 v[16:19], a[36:39], v[72:75], v[16:19]
  ds_read_b128 v[64:67], v2 offset:17408
  s_add_u32 s55, s62, 512
  v_mfma_f32_16x16x32_bf16 v[28:31], a[36:39], v[76:79], v[28:31]
  ds_read_b128 v[68:71], v2 offset:37888
  buffer_load_dwordx4 v[8:11], v7, s[4:7], s55 offen sc1
  v_mfma_f32_16x16x32_bf16 v[20:23], a[40:43], v[72:75], v[20:23]
  v_cvt_pk_bf16_f32 v57, v50, v51
  s_add_u32 s49, s52, 196608
  v_mfma_f32_16x16x32_bf16 v[32:35], a[40:43], v[76:79], v[32:35]
  buffer_store_dwordx4 v[52:55], v3, s[4:7], s49 offen sc1
  buffer_store_dwordx2 v[56:57], v4, s[4:7], s49 offen sc1
  v_mfma_f32_16x16x32_bf16 v[24:27], a[44:47], v[72:75], v[24:27]
  v_mfma_f32_16x16x32_bf16 v[36:39], a[44:47], v[76:79], v[36:39]
  s_waitcnt lgkmcnt(2)
  v_mfma_f32_16x16x32_bf16 v[16:19], a[48:51], v[80:83], v[16:19]
  ds_read_b128 v[72:75], v2 offset:18432
  s_add_u32 m0, s56, 12288
  v_mfma_f32_16x16x32_bf16 v[28:31], a[48:51], v[84:87], v[28:31]
  ds_read_b128 v[76:79], v2 offset:38912
  s_add_u32 s63, s57, 53248
  v_mfma_f32_16x16x32_bf16 v[20:23], a[52:55], v[80:83], v[20:23]
  buffer_load_dwordx4 v2, s[4:7], s63 offen offset:0 sc1 lds
  v_mfma_f32_16x16x32_bf16 v[32:35], a[52:55], v[84:87], v[32:35]
  v_mfma_f32_16x16x32_bf16 v[24:27], a[56:59], v[80:83], v[24:27]
  v_mfma_f32_16x16x32_bf16 v[36:39], a[56:59], v[84:87], v[36:39]
  s_waitcnt lgkmcnt(2)
  v_mfma_f32_16x16x32_bf16 v[16:19], a[60:63], v[64:67], v[16:19]
  ds_read_b128 v[80:83], v2 offset:19456
  buffer_load_dwordx4 v2, s[4:7], s63 offen offset:1024 sc1 lds
  v_mfma_f32_16x16x32_bf16 v[28:31], a[60:63], v[68:71], v[28:31]
  ds_read_b128 v[84:87], v2 offset:39936
  v_mfma_f32_16x16x32_bf16 v[20:23], a[64:67], v[64:67], v[20:23]
  v_mfma_f32_16x16x32_bf16 v[32:35], a[64:67], v[68:71], v[32:35]
  v_mfma_f32_16x16x32_bf16 v[24:27], a[68:71], v[64:67], v[24:27]
  v_mfma_f32_16x16x32_bf16 v[36:39], a[68:71], v[68:71], v[36:39]
  s_waitcnt lgkmcnt(2)
  v_mfma_f32_16x16x32_bf16 v[16:19], a[72:75], v[72:75], v[16:19]
  s_waitcnt vmcnt(5) lgkmcnt(0)
  s_barrier
  ds_read_b128 v[64:67], v5 offset:0
  v_mfma_f32_16x16x32_bf16 v[28:31], a[72:75], v[76:79], v[28:31]
  ds_read_b128 v[68:71], v5 offset:20480
  buffer_load_dwordx4 v2, s[4:7], s63 offen offset:2048 sc1 lds
  v_mfma_f32_16x16x32_bf16 v[20:23], a[76:79], v[72:75], v[20:23]
  v_mfma_f32_16x16x32_bf16 v[32:35], a[76:79], v[76:79], v[32:35]
  v_mfma_f32_16x16x32_bf16 v[24:27], a[80:83], v[72:75], v[24:27]
  v_mfma_f32_16x16x32_bf16 v[36:39], a[80:83], v[76:79], v[36:39]
  s_waitcnt lgkmcnt(2)
  v_mfma_f32_16x16x32_bf16 v[16:19], a[84:87], v[80:83], v[16:19]
  ds_read_b128 v[72:75], v5 offset:1024
  buffer_load_dwordx4 v2, s[4:7], s63 offen offset:3072 sc1 lds
  v_mfma_f32_16x16x32_bf16 v[28:31], a[84:87], v[84:87], v[28:31]
  ds_read_b128 v[76:79], v5 offset:21504
  v_mfma_f32_16x16x32_bf16 v[20:23], a[88:91], v[80:83], v[20:23]
  v_mfma_f32_16x16x32_bf16 v[32:35], a[88:91], v[84:87], v[32:35]
  v_mfma_f32_16x16x32_bf16 v[24:27], a[92:95], v[80:83], v[24:27]
  v_mfma_f32_16x16x32_bf16 v[36:39], a[92:95], v[84:87], v[36:39]
  s_waitcnt lgkmcnt(2)
  v_mfma_f32_16x16x32_bf16 v[40:43], v[112:115], v[64:67], 0
  ds_read_b128 v[80:83], v5 offset:2048
  s_add_u32 m0, s56, 16384
  v_mfma_f32_16x16x32_bf16 v[52:55], v[112:115], v[68:71], 0
  ds_read_b128 v[84:87], v5 offset:22528
  s_add_u32 s63, s57, 57344
  v_mfma_f32_16x16x32_bf16 v[44:47], v[116:119], v[64:67], 0
  buffer_load_dwordx4 v2, s[4:7], s63 offen offset:0 sc1 lds
  s_getpc_b64 s[12:13]
Lpc_19:
  v_mfma_f32_16x16x32_bf16 v[56:59], v[116:119], v[68:71], 0
  s_add_u32 s12, s12, L_r2_f-Lpc_19
  s_addc_u32 s13, s13, 0
  v_mfma_f32_16x16x32_bf16 v[48:51], v[120:123], v[64:67], 0
  s_lshl_b32 s14, s42, 3
  s_add_u32 s14, s14, s41
  v_mfma_f32_16x16x32_bf16 v[60:63], v[120:123], v[68:71], 0
  s_and_b32 s14, s14, 31
  s_waitcnt lgkmcnt(2)
  v_mfma_f32_16x16x32_bf16 v[40:43], v[124:127], v[72:75], v[40:43]
  ds_read_b128 v[64:67], v5 offset:3072
  v_min_u32 v12, (L_fin_f-L_r2_f)/4096, v0
  v_mfma_f32_16x16x32_bf16 v[52:55], v[124:127], v[76:79], v[52:55]
  ds_read_b128 v[68:71], v5 offset:23552
  v_lshl_add_u32 v12, v12, 5, s14
  v_mfma_f32_16x16x32_bf16 v[44:47], v[128:131], v[72:75], v[44:47]
  v_lshlrev_b32 v12, 7, v12
  v_mov_b32 v13, s13
  v_mfma_f32_16x16x32_bf16 v[56:59], v[128:131], v[76:79], v[56:59]
  v_add_co_u32 v12, vcc, s12, v12
  s_nop 1
  v_addc_co_u32 v13, vcc, 0, v13, vcc
  v_mfma_f32_16x16x32_bf16 v[48:51], v[132:135], v[72:75], v[48:51]
  global_load_dword v14, v[12:13], off
  buffer_load_dwordx4 v2, s[4:7], s63 offen offset:1024 sc1 lds
  v_mfma_f32_16x16x32_bf16 v[60:63], v[132:135], v[76:79], v[60:63]
  s_waitcnt lgkmcnt(2)
  v_mfma_f32_16x16x32_bf16 v[40:43], v[136:139], v[80:83], v[40:43]
  ds_read_b128 v[72:75], v5 offset:4096
  buffer_load_dwordx4 v2, s[4:7], s63 offen offset:2048 sc1 lds
  v_mfma_f32_16x16x32_bf16 v[52:55], v[136:139], v[84:87], v[52:55]
  ds_read_b128 v[76:79], v5 offset:24576
  v_mfma_f32_16x16x32_bf16 v[44:47], v[140:143], v[80:83], v[44:47]
  s_waitcnt vmcnt(8)
  s_add_u32 s46, s64, 28672
  s_mov_b64 exec, 1
  buffer_store_dword v1, off, s[4:7], s46
  s_mov_b64 exec, -1
  v_mfma_f32_16x16x32_bf16 v[56:59], v[140:143], v[84:87], v[56:59]
  v_permlane16_swap_b32 v16, v28
  v_mfma_f32_16x16x32_bf16 v[48:51], v[144:147], v[80:83], v[48:51]
  v_permlane16_swap_b32 v17, v29
  v_mfma_f32_16x16x32_bf16 v[60:63], v[144:147], v[84:87], v[60:63]
  s_waitcnt lgkmcnt(2)
  v_mfma_f32_16x16x32_bf16 v[40:43], v[148:151], v[64:67], v[40:43]
  ds_read_b128 v[80:83], v5 offset:5120
  buffer_load_dwordx4 v2, s[4:7], s63 offen offset:3072 sc1 lds
  v_mfma_f32_16x16x32_bf16 v[52:55], v[148:151], v[68:71], v[52:55]
  ds_read_b128 v[84:87], v5 offset:25600
  v_mfma_f32_16x16x32_bf16 v[44:47], v[152:155], v[64:67], v[44:47]
  v_permlane16_swap_b32 v18, v30
  v_mfma_f32_16x16x32_bf16 v[56:59], v[152:155], v[68:71], v[56:59]
  v_permlane16_swap_b32 v19, v31
  v_mfma_f32_16x16x32_bf16 v[48:51], v[156:159], v[64:67], v[48:51]
  v_permlane16_swap_b32 v20, v32
  v_mfma_f32_16x16x32_bf16 v[60:63], v[156:159], v[68:71], v[60:63]
  s_waitcnt lgkmcnt(2)
  v_mfma_f32_16x16x32_bf16 v[40:43], v[160:163], v[72:75], v[40:43]
  ds_read_b128 v[64:67], v5 offset:6144
  buffer_load_dwordx4 a[228:231], v2, s[4:7], s54 offen offset:1024 sc1
  v_mfma_f32_16x16x32_bf16 v[52:55], v[160:163], v[76:79], v[52:55]
  ds_read_b128 v[68:71], v5 offset:26624
  v_mfma_f32_16x16x32_bf16 v[44:47], v[164:167], v[72:75], v[44:47]
  v_permlane16_swap_b32 v21, v33
  v_mfma_f32_16x16x32_bf16 v[56:59], v[164:167], v[76:79], v[56:59]
  v_permlane16_swap_b32 v22, v34
  v_mfma_f32_16x16x32_bf16 v[48:51], v[168:171], v[72:75], v[48:51]
  v_permlane16_swap_b32 v23, v35
  v_mfma_f32_16x16x32_bf16 v[60:63], v[168:171], v[76:79], v[60:63]
  s_waitcnt vmcnt(13)
  s_waitcnt lgkmcnt(2)
  v_mfma_f32_16x16x32_bf16 v[40:43], v[172:175], v[80:83], v[40:43]
  ds_read_b128 v[72:75], v5 offset:7168
  s_add_u32 s55, s65, 28672
  buffer_load_dwordx4 v[12:15], v6, s[4:7], s55 offen sc1
  v_mfma_f32_16x16x32_bf16 v[52:55], v[172:175], v[84:87], v[52:55]
  ds_read_b128 v[76:79], v5 offset:27648
  buffer_load_dwordx4 a[232:235], v2, s[4:7], s54 offen offset:2048 sc1
  v_mfma_f32_16x16x32_bf16 v[44:47], v[176:179], v[80:83], v[44:47]
  v_bitop3_b32 v10, v10, v11, v1 bitop3:0x7e
  v_cmp_ne_u32 vcc, 0, v10
  v_mfma_f32_16x16x32_bf16 v[56:59], v[176:179], v[84:87], v[56:59]
  v_permlane16_swap_b32 v24, v36
  v_mfma_f32_16x16x32_bf16 v[48:51], v[180:183], v[80:83], v[48:51]
  v_permlane16_swap_b32 v25, v37
  v_mfma_f32_16x16x32_bf16 v[60:63], v[180:183], v[84:87], v[60:63]
  s_waitcnt lgkmcnt(2)
  v_mfma_f32_16x16x32_bf16 v[40:43], v[184:187], v[64:67], v[40:43]
  ds_read_b128 v[80:83], v5 offset:8192
  buffer_load_dwordx4 a[236:239], v2, s[4:7], s54 offen offset:3072 sc1
  v_mfma_f32_16x16x32_bf16 v[52:55], v[184:187], v[68:71], v[52:55]
  ds_read_b128 v[84:87], v5 offset:28672
  v_mfma_f32_16x16x32_bf16 v[44:47], v[188:191], v[64:67], v[44:47]
  v_permlane16_swap_b32 v26, v38
  v_mfma_f32_16x16x32_bf16 v[56:59], v[188:191], v[68:71], v[56:59]
  v_permlane16_swap_b32 v27, v39
  v_mfma_f32_16x16x32_bf16 v[48:51], v[192:195], v[64:67], v[48:51]
  s_cbranch_vccz Lsckd_21
Lsck_20:
  s_add_u32 s55, s62, 512
  buffer_load_dwordx4 v[8:11], v7, s[4:7], s55 offen sc1
  s_waitcnt vmcnt(0)
  v_bitop3_b32 v10, v10, v11, v1 bitop3:0x7e
  v_cmp_ne_u32 vcc, 0, v10
  s_nop 1
  s_nop 1
  s_cbranch_vccnz Lsck_20
Lsckd_21:
  v_fmac_f32 v16, v8, v88
  v_mfma_f32_16x16x32_bf16 v[60:63], v[192:195], v[68:71], v[60:63]
  v_fmac_f32 v17, v8, v89
  s_waitcnt lgkmcnt(2)
  v_mfma_f32_16x16x32_bf16 v[40:43], v[196:199], v[72:75], v[40:43]
  ds_read_b128 v[64:67], v5 offset:9216
  s_add_u32 s54, s57, 36864
  v_mfma_f32_16x16x32_bf16 v[52:55], v[196:199], v[76:79], v[52:55]
  ds_read_b128 v[68:71], v5 offset:29696
  buffer_load_dwordx4 a[240:243], v2, s[4:7], s54 offen offset:0 sc1
  v_mfma_f32_16x16x32_bf16 v[44:47], v[200:203], v[72:75], v[44:47]
  v_fmac_f32 v18, v8, v90
  v_fmac_f32 v19, v8, v91
  v_mfma_f32_16x16x32_bf16 v[56:59], v[200:203], v[76:79], v[56:59]
  v_fmac_f32 v20, v8, v92
  v_fmac_f32 v21, v8, v93
  v_mfma_f32_16x16x32_bf16 v[48:51], v[204:207], v[72:75], v[48:51]
  v_fmac_f32 v22, v8, v94
  v_fmac_f32 v23, v8, v95
  v_mfma_f32_16x16x32_bf16 v[60:63], v[204:207], v[76:79], v[60:63]
  v_fmac_f32 v24, v8, v96
  s_waitcnt lgkmcnt(2)
  v_mfma_f32_16x16x32_bf16 v[40:43], v[208:211], v[80:83], v[40:43]
  ds_read_b128 v[72:75], v5 offset:10240
  buffer_load_dwordx4 a[244:247], v2, s[4:7], s54 offen offset:1024 sc1
  v_mfma_f32_16x16x32_bf16 v[52:55], v[208:211], v[84:87], v[52:55]
  ds_read_b128 v[76:79], v5 offset:30720
  v_fmac_f32 v25, v8, v97
  v_mfma_f32_16x16x32_bf16 v[44:47], v[212:215], v[80:83], v[44:47]
  s_waitcnt vmcnt(4)
  v_bitop3_b32 v12, v12, v13, v1 bitop3:0x7e
  v_mfma_f32_16x16x32_bf16 v[56:59], v[212:215], v[84:87], v[56:59]
  v_bitop3_b32 v14, v14, v15, v1 bitop3:0x7e
  v_or_b32 v12, v12, v14
  v_mfma_f32_16x16x32_bf16 v[48:51], v[216:219], v[80:83], v[48:51]
  v_cmp_ne_u32 vcc, 0, v12
  v_fmac_f32 v26, v8, v98
  v_mfma_f32_16x16x32_bf16 v[60:63], v[216:219], v[84:87], v[60:63]
  v_fmac_f32 v27, v8, v99
  s_waitcnt lgkmcnt(2)
  v_mfma_f32_16x16x32_bf16 v[40:43], v[220:223], v[64:67], v[40:43]
  ds_read_b128 v[80:83], v5 offset:11264
  buffer_load_dwordx4 a[248:251], v2, s[4:7], s54 offen offset:2048 sc1
  v_mfma_f32_16x16x32_bf16 v[52:55], v[220:223], v[68:71], v[52:55]
  ds_read_b128 v[84:87], v5 offset:31744
  s_cbranch_vccz Lsckd_23
Lsck_22:
  s_add_u32 s55, s65, 28672
  buffer_load_dwordx4 v[12:15], v6, s[4:7], s55 offen sc1
  s_waitcnt vmcnt(0)
  v_bitop3_b32 v12, v12, v13, v1 bitop3:0x7e
  v_bitop3_b32 v14, v14, v15, v1 bitop3:0x7e
  v_or_b32 v12, v12, v14
  v_cmp_ne_u32 vcc, 0, v12
  s_nop 1
  s_nop 1
  s_cbranch_vccnz Lsck_22
Lsckd_23:
  v_mfma_f32_16x16x32_bf16 v[44:47], v[224:227], v[64:67], v[44:47]
  v_fmac_f32 v28, v8, v100
  v_mfma_f32_16x16x32_bf16 v[56:59], v[224:227], v[68:71], v[56:59]
  v_fmac_f32 v29, v8, v101
  v_fmac_f32 v30, v8, v102
  v_mfma_f32_16x16x32_bf16 v[48:51], v[228:231], v[64:67], v[48:51]
  v_fmac_f32 v31, v8, v103
  v_fmac_f32 v32, v8, v104
  v_mfma_f32_16x16x32_bf16 v[60:63], v[228:231], v[68:71], v[60:63]
  v_fmac_f32 v33, v8, v105
  s_waitcnt lgkmcnt(2)
  v_mfma_f32_16x16x32_bf16 v[40:43], v[232:235], v[72:75], v[40:43]
  ds_read_b128 v[64:67], v5 offset:12288
  s_add_u32 s55, s62, 1536
  buffer_load_dwordx4 v[12:15], v7, s[4:7], s55 offen sc1
  v_mfma_f32_16x16x32_bf16 v[52:55], v[232:235], v[76:79], v[52:55]
  ds_read_b128 v[68:71], v5 offset:32768
  s_add_u32 m0, s60, 0
  s_add_u32 s48, s59, 0
  v_mfma_f32_16x16x32_bf16 v[44:47], v[236:239], v[72:75], v[44:47]
  buffer_load_dwordx4 v2, s[4:7], s48 offen offset:0 sc1 lds
  buffer_load_dwordx4 v2, s[4:7], s48 offen offset:1024 sc1 lds
  buffer_load_dwordx4 a[252:255], v2, s[4:7], s54 offen offset:3072 sc1
  v_mfma_f32_16x16x32_bf16 v[56:59], v[236:239], v[76:79], v[56:59]
  v_fmac_f32 v34, v8, v106
  v_fmac_f32 v35, v8, v107
  v_mfma_f32_16x16x32_bf16 v[48:51], v[240:243], v[72:75], v[48:51]
  v_fmac_f32 v36, v8, v108
  v_fmac_f32 v37, v8, v109
  v_mfma_f32_16x16x32_bf16 v[60:63], v[240:243], v[76:79], v[60:63]
  v_fmac_f32 v38, v8, v110
  s_waitcnt lgkmcnt(2)
  v_mfma_f32_16x16x32_bf16 v[40:43], v[244:247], v[80:83], v[40:43]
  ds_read_b128 v[72:75], v5 offset:13312
  buffer_load_dwordx4 v2, s[4:7], s48 offen offset:2048 sc1 lds
  buffer_load_dwordx4 v2, s[4:7], s48 offen offset:3072 sc1 lds
  v_mfma_f32_16x16x32_bf16 v[52:55], v[244:247], v[84:87], v[52:55]
  ds_read_b128 v[76:79], v5 offset:33792
  v_fmac_f32 v39, v8, v111
  v_mfma_f32_16x16x32_bf16 v[44:47], v[248:251], v[80:83], v[44:47]
  v_max_f32 v16, 0, v16
  v_mul_f32 v28, v9, v28
  v_mfma_f32_16x16x32_bf16 v[56:59], v[248:251], v[84:87], v[56:59]
  v_max_f32 v17, 0, v17
  v_mul_f32 v29, v9, v29
  v_mfma_f32_16x16x32_bf16 v[48:51], v[252:255], v[80:83], v[48:51]
  v_max_f32 v18, 0, v18
  v_mul_f32 v30, v9, v30
  v_mfma_f32_16x16x32_bf16 v[60:63], v[252:255], v[84:87], v[60:63]
  v_max_f32 v19, 0, v19
  s_waitcnt lgkmcnt(2)
  v_mfma_f32_16x16x32_bf16 v[40:43], a[0:3], v[64:67], v[40:43]
  ds_read_b128 v[80:83], v5 offset:14336
  s_add_u32 m0, s60, 4096
  v_mfma_f32_16x16x32_bf16 v[52:55], a[0:3], v[68:71], v[52:55]
  ds_read_b128 v[84:87], v5 offset:34816
  s_add_u32 s48, s59, 8192
  v_mfma_f32_16x16x32_bf16 v[44:47], a[4:7], v[64:67], v[44:47]
  buffer_load_dwordx4 v2, s[4:7], s48 offen offset:0 sc1 lds
  v_mul_f32 v31, v9, v31
  v_mfma_f32_16x16x32_bf16 v[56:59], a[4:7], v[68:71], v[56:59]
  v_max_f32 v20, 0, v20
  v_mul_f32 v32, v9, v32
  v_mfma_f32_16x16x32_bf16 v[48:51], a[8:11], v[64:67], v[48:51]
  v_max_f32 v21, 0, v21
  v_mul_f32 v33, v9, v33
  v_mfma_f32_16x16x32_bf16 v[60:63], a[8:11], v[68:71], v[60:63]
  v_max_f32 v22, 0, v22
  s_waitcnt lgkmcnt(2)
  v_mfma_f32_16x16x32_bf16 v[40:43], a[12:15], v[72:75], v[40:43]
  ds_read_b128 v[64:67], v5 offset:15360
  buffer_load_dwordx4 v2, s[4:7], s48 offen offset:1024 sc1 lds
  v_mfma_f32_16x16x32_bf16 v[52:55], a[12:15], v[76:79], v[52:55]
  ds_read_b128 v[68:71], v5 offset:35840
  v_mul_f32 v34, v9, v34
  v_mfma_f32_16x16x32_bf16 v[44:47], a[16:19], v[72:75], v[44:47]
  v_max_f32 v23, 0, v23
  v_mul_f32 v35, v9, v35
  v_mfma_f32_16x16x32_bf16 v[56:59], a[16:19], v[76:79], v[56:59]
  v_max_f32 v24, 0, v24
  v_mul_f32 v36, v9, v36
  v_mfma_f32_16x16x32_bf16 v[48:51], a[20:23], v[72:75], v[48:51]
  v_max_f32 v25, 0, v25
  v_mul_f32 v37, v9, v37
  v_mfma_f32_16x16x32_bf16 v[60:63], a[20:23], v[76:79], v[60:63]
  v_max_f32 v26, 0, v26
  s_waitcnt lgkmcnt(2)
  v_mfma_f32_16x16x32_bf16 v[40:43], a[24:27], v[80:83], v[40:43]
  ds_read_b128 v[72:75], v5 offset:16384
  buffer_load_dwordx4 v2, s[4:7], s48 offen offset:2048 sc1 lds
  v_mfma_f32_16x16x32_bf16 v[52:55], a[24:27], v[84:87], v[52:55]
  ds_read_b128 v[76:79], v5 offset:36864
  v_mul_f32 v38, v9, v38
  v_mfma_f32_16x16x32_bf16 v[44:47], a[28:31], v[80:83], v[44:47]
  v_max_f32 v27, 0, v27
  v_mul_f32 v39, v9, v39
  v_mfma_f32_16x16x32_bf16 v[56:59], a[28:31], v[84:87], v[56:59]
  v_mul_f32 v16, v16, v28
  v_mul_f32 v17, v17, v29
  v_mfma_f32_16x16x32_bf16 v[48:51], a[32:35], v[80:83], v[48:51]
  v_mul_f32 v18, v18, v30
  v_mul_f32 v19, v19, v31
  v_mfma_f32_16x16x32_bf16 v[60:63], a[32:35], v[84:87], v[60:63]
  v_mul_f32 v20, v20, v32
  s_waitcnt lgkmcnt(2)
  v_mfma_f32_16x16x32_bf16 v[40:43], a[36:39], v[64:67], v[40:43]
  ds_read_b128 v[80:83], v5 offset:17408
  s_add_u32 m0, s60, 7168
  v_mfma_f32_16x16x32_bf16 v[52:55], a[36:39], v[68:71], v[52:55]
  ds_read_b128 v[84:87], v5 offset:37888
  s_add_u32 s48, s59, 4096
  v_mfma_f32_16x16x32_bf16 v[44:47], a[40:43], v[64:67], v[44:47]
  buffer_load_dwordx4 v2, s[4:7], s48 offen offset:0 sc1 lds
  v_mul_f32 v21, v21, v33
  v_mfma_f32_16x16x32_bf16 v[56:59], a[40:43], v[68:71], v[56:59]
  v_mul_f32 v22, v22, v34
  v_mul_f32 v23, v23, v35
  v_mfma_f32_16x16x32_bf16 v[48:51], a[44:47], v[64:67], v[48:51]
  v_mul_f32 v24, v24, v36
  v_mul_f32 v25, v25, v37
  v_mfma_f32_16x16x32_bf16 v[60:63], a[44:47], v[68:71], v[60:63]
  v_mul_f32 v26, v26, v38
  s_waitcnt lgkmcnt(2)
  v_mfma_f32_16x16x32_bf16 v[40:43], a[48:51], v[72:75], v[40:43]
  ds_read_b128 v[64:67], v5 offset:18432
  buffer_load_dwordx4 v2, s[4:7], s48 offen offset:1024 sc1 lds
  v_mfma_f32_16x16x32_bf16 v[52:55], a[48:51], v[76:79], v[52:55]
  ds_read_b128 v[68:71], v5 offset:38912
  v_mul_f32 v27, v27, v39
  v_mfma_f32_16x16x32_bf16 v[44:47], a[52:55], v[72:75], v[44:47]
  v_cvt_pk_bf16_f32 v28, v16, v17
  v_cvt_pk_bf16_f32 v29, v18, v19
  v_mfma_f32_16x16x32_bf16 v[56:59], a[52:55], v[76:79], v[56:59]
  v_cvt_pk_bf16_f32 v30, v20, v21
  v_cvt_pk_bf16_f32 v31, v22, v23
  v_mfma_f32_16x16x32_bf16 v[48:51], a[56:59], v[72:75], v[48:51]
  v_cvt_pk_bf16_f32 v32, v24, v25
  v_cvt_pk_bf16_f32 v33, v26, v27
  v_mfma_f32_16x16x32_bf16 v[60:63], a[56:59], v[76:79], v[60:63]
  s_add_u32 s49, s52, 98304
  s_waitcnt lgkmcnt(2)
  v_mfma_f32_16x16x32_bf16 v[40:43], a[60:63], v[80:83], v[40:43]
  ds_read_b128 v[72:75], v5 offset:19456
  buffer_store_dwordx4 v[28:31], v3, s[4:7], s49 offen sc1
  v_mfma_f32_16x16x32_bf16 v[52:55], a[60:63], v[84:87], v[52:55]
  ds_read_b128 v[76:79], v5 offset:39936
  buffer_store_dwordx2 v[32:33], v4, s[4:7], s49 offen sc1
  v_mfma_f32_16x16x32_bf16 v[44:47], a[64:67], v[80:83], v[44:47]
  v_mfma_f32_16x16x32_bf16 v[56:59], a[64:67], v[84:87], v[56:59]
  v_mfma_f32_16x16x32_bf16 v[48:51], a[68:71], v[80:83], v[48:51]
  v_mfma_f32_16x16x32_bf16 v[60:63], a[68:71], v[84:87], v[60:63]
  s_waitcnt lgkmcnt(2)
  v_mfma_f32_16x16x32_bf16 v[40:43], a[72:75], v[64:67], v[40:43]
  s_waitcnt vmcnt(12)
  v_bitop3_b32 v14, v14, v15, v1 bitop3:0x7e
  v_mfma_f32_16x16x32_bf16 v[52:55], a[72:75], v[68:71], v[52:55]
  v_cmp_ne_u32 vcc, 0, v14
  v_add_u32 v8, s60, v2
  v_mfma_f32_16x16x32_bf16 v[44:47], a[76:79], v[64:67], v[44:47]
  s_nop 0
  s_nop 0
  s_cbranch_vccz Lsckd_25
Lsck_24:
  s_add_u32 s55, s62, 1536
  buffer_load_dwordx4 v[12:15], v7, s[4:7], s55 offen sc1
  s_waitcnt vmcnt(0)
  v_bitop3_b32 v14, v14, v15, v1 bitop3:0x7e
  v_cmp_ne_u32 vcc, 0, v14
  s_nop 1
  s_nop 1
  s_cbranch_vccnz Lsck_24
Lsckd_25:
  v_mfma_f32_16x16x32_bf16 v[56:59], a[76:79], v[68:71], v[56:59]
  v_add_u32 v7, s56, v2
  v_mfma_f32_16x16x32_bf16 v[48:51], a[80:83], v[64:67], v[48:51]
  v_mfma_f32_16x16x32_bf16 v[60:63], a[80:83], v[68:71], v[60:63]
  s_waitcnt lgkmcnt(0)
  v_mfma_f32_16x16x32_bf16 v[40:43], a[84:87], v[72:75], v[40:43]
  v_mfma_f32_16x16x32_bf16 v[52:55], a[84:87], v[76:79], v[52:55]
  v_mfma_f32_16x16x32_bf16 v[44:47], a[88:91], v[72:75], v[44:47]
  v_mfma_f32_16x16x32_bf16 v[56:59], a[88:91], v[76:79], v[56:59]
  v_mfma_f32_16x16x32_bf16 v[48:51], a[92:95], v[72:75], v[48:51]
  v_mfma_f32_16x16x32_bf16 v[60:63], a[92:95], v[76:79], v[60:63]
  s_waitcnt vmcnt(10)
  ds_read_b128 v[64:67], v8 offset:0
  ds_read_b128 v[68:71], v8 offset:1024
  s_nop 0
  v_permlane16_swap_b32 v40, v52
  v_permlane16_swap_b32 v41, v53
  v_permlane16_swap_b32 v42, v54
  v_permlane16_swap_b32 v43, v55
  v_permlane16_swap_b32 v44, v56
  v_permlane16_swap_b32 v45, v57
  v_permlane16_swap_b32 v46, v58
  v_permlane16_swap_b32 v47, v59
  v_permlane16_swap_b32 v48, v60
  v_permlane16_swap_b32 v49, v61
  v_permlane16_swap_b32 v50, v62
  v_permlane16_swap_b32 v51, v63
  v_pk_fma_f32 v[40:41], v[88:89], v[12:13], v[40:41] op_sel_hi:[1,0,1]
  v_pk_fma_f32 v[42:43], v[90:91], v[12:13], v[42:43] op_sel_hi:[1,0,1]
  v_pk_fma_f32 v[44:45], v[92:93], v[12:13], v[44:45] op_sel_hi:[1,0,1]
  v_pk_fma_f32 v[46:47], v[94:95], v[12:13], v[46:47] op_sel_hi:[1,0,1]
  v_pk_fma_f32 v[48:49], v[96:97], v[12:13], v[48:49] op_sel_hi:[1,0,1]
  v_pk_fma_f32 v[50:51], v[98:99], v[12:13], v[50:51] op_sel_hi:[1,0,1]
  v_pk_fma_f32 v[52:53], v[100:101], v[12:13], v[52:53] op_sel_hi:[1,0,1]
  v_pk_fma_f32 v[54:55], v[102:103], v[12:13], v[54:55] op_sel_hi:[1,0,1]
  v_pk_fma_f32 v[56:57], v[104:105], v[12:13], v[56:57] op_sel_hi:[1,0,1]
  v_pk_fma_f32 v[58:59], v[106:107], v[12:13], v[58:59] op_sel_hi:[1,0,1]
  v_pk_fma_f32 v[60:61], v[108:109], v[12:13], v[60:61] op_sel_hi:[1,0,1]
  v_pk_fma_f32 v[62:63], v[110:111], v[12:13], v[62:63] op_sel_hi:[1,0,1]
  v_max_f32 v40, 0, v40
  v_max_f32 v41, 0, v41
  v_max_f32 v42, 0, v42
  v_max_f32 v43, 0, v43
  v_max_f32 v44, 0, v44
  v_max_f32 v45, 0, v45
  v_max_f32 v46, 0, v46
  v_max_f32 v47, 0, v47
  v_max_f32 v48, 0, v48
  v_max_f32 v49, 0, v49
  v_max_f32 v50, 0, v50
  v_max_f32 v51, 0, v51
  v_pk_mul_f32 v[52:53], v[52:53], v[12:13] op_sel:[0,1] op_sel_hi:[1,1]
  v_pk_mul_f32 v[54:55], v[54:55], v[12:13] op_sel:[0,1] op_sel_hi:[1,1]
  v_pk_mul_f32 v[56:57], v[56:57], v[12:13] op_sel:[0,1] op_sel_hi:[1,1]
  v_pk_mul_f32 v[58:59], v[58:59], v[12:13] op_sel:[0,1] op_sel_hi:[1,1]
  v_pk_mul_f32 v[60:61], v[60:61], v[12:13] op_sel:[0,1] op_sel_hi:[1,1]
  v_pk_mul_f32 v[62:63], v[62:63], v[12:13] op_sel:[0,1] op_sel_hi:[1,1]
  v_pk_mul_f32 v[40:41], v[40:41], v[52:53]
  v_pk_mul_f32 v[42:43], v[42:43], v[54:55]
  v_pk_mul_f32 v[44:45], v[44:45], v[56:57]
  v_pk_mul_f32 v[46:47], v[46:47], v[58:59]
  v_pk_mul_f32 v[48:49], v[48:49], v[60:61]
  v_pk_mul_f32 v[50:51], v[50:51], v[62:63]
  v_cvt_pk_bf16_f32 v52, v40, v41
  v_cvt_pk_bf16_f32 v53, v42, v43
  v_cvt_pk_bf16_f32 v54, v44, v45
  v_cvt_pk_bf16_f32 v55, v46, v47
  v_cvt_pk_bf16_f32 v56, v48, v49
  v_cvt_pk_bf16_f32 v57, v50, v51
  s_add_u32 s49, s52, 294912
  buffer_store_dwordx4 v[52:55], v3, s[4:7], s49 offen sc1
  buffer_store_dwordx2 v[56:57], v4, s[4:7], s49 offen sc1
  v_lshrrev_b32 v10, 5, v0
  v_mul_u32_u24 v10, 96, v10
  s_mul_i32 s48, s42, 192
  s_add_u32 s48, s48, 36864
  v_add_u32 v10, s48, v10
  ds_write_b128 v10, v[88:91] offset:0
  ds_write_b128 v10, v[92:95] offset:16
  ds_write_b128 v10, v[96:99] offset:32
  ds_write_b128 v10, v[100:103] offset:48
  ds_write_b128 v10, v[104:107] offset:64
  ds_write_b128 v10, v[108:111] offset:80
  s_add_u32 s62, s59, 4096
  buffer_load_dwordx4 v[76:79], v2, s[4:7], s62 offen offset:2048 sc1
  buffer_load_dwordx4 v[80:83], v2, s[4:7], s62 offen offset:3072 sc1
  s_add_u32 s54, s59, 8192
  buffer_load_dwordx4 v[84:87], v2, s[4:7], s54 offen offset:3072 sc1
  s_waitcnt lgkmcnt(7)
  v_mfma_f32_16x16x32_bf16 v[16:19], a[96:99], v[64:67], 0
  s_waitcnt vmcnt(11)
  ds_read_b128 v[72:75], v8 offset:4096
  ds_read_b128 v[88:91], v7 offset:0
  v_mfma_f32_16x16x32_bf16 v[20:23], a[100:103], v[64:67], 0
  ds_read_b128 v[92:95], v7 offset:1024
  ds_read_b128 v[96:99], v7 offset:2048
  ds_read_b128 v[100:103], v7 offset:3072
  v_mfma_f32_16x16x32_bf16 v[24:27], a[104:107], v[64:67], 0
  ds_read_b128 v[104:107], v7 offset:4096
  s_lshl_b32 s48, s42, 12
  v_add_u32 v3, s48, v5
  v_mfma_f32_16x16x32_bf16 v[28:31], a[108:111], v[64:67], 0
  s_lshl_b32 s48, s42, 10
  v_add_u32 v13, s48, v5
  v_and_b32 v4, 15, v0
  v_mfma_f32_16x16x32_bf16 v[32:35], a[112:115], v[64:67], 0
  v_lshrrev_b32 v15, 4, v0
  v_lshlrev_b32 v4, 4, v4
  s_waitcnt lgkmcnt(12)
  v_mfma_f32_16x16x32_bf16 v[16:19], a[116:119], v[68:71], v[16:19]
  s_waitcnt vmcnt(13)
  ds_read_b128 v[64:67], v8 offset:2048
  v_and_b32 v15, 1, v15
  v_mfma_f32_16x16x32_bf16 v[20:23], a[120:123], v[68:71], v[20:23]
  v_lshl_add_u32 v4, v15, 3, v4
  v_lshrrev_b32 v15, 5, v0
  v_lshl_add_u32 v4, v15, 10, v4
  v_mfma_f32_16x16x32_bf16 v[24:27], a[124:127], v[68:71], v[24:27]
  s_and_b32 s63, s41, 7
  s_mul_i32 s48, s63, 10
  s_lshl_b32 s49, s42, 1
  v_mfma_f32_16x16x32_bf16 v[28:31], a[128:131], v[68:71], v[28:31]
  s_add_u32 s50, s48, s49
  s_add_u32 s51, s48, 8
  v_mfma_f32_16x16x32_bf16 v[32:35], a[132:135], v[68:71], v[32:35]
  s_waitcnt lgkmcnt(6)
  s_waitcnt lgkmcnt(1)
  v_mfma_f32_16x16x32_bf16 v[16:19], v[88:91], v[72:75], v[16:19]
  s_waitcnt vmcnt(12)
  ds_read_b128 v[68:71], v8 offset:3072
  s_add_u32 s60, s59, 49152
  v_mfma_f32_16x16x32_bf16 v[20:23], v[92:95], v[72:75], v[20:23]
  buffer_load_dwordx4 v[56:59], v2, s[4:7], s60 offen offset:0 sc1
  s_mul_i32 s48, s50, 205
  s_lshr_b32 s48, s48, 12
  v_mfma_f32_16x16x32_bf16 v[24:27], v[96:99], v[72:75], v[24:27]
  s_mul_i32 s49, s48, 20
  s_sub_u32 s50, s50, s49
  v_mfma_f32_16x16x32_bf16 v[28:31], v[100:103], v[72:75], v[28:31]
  s_sub_u32 s50, s50, s67
  s_add_u32 s49, s50, 20
  v_mfma_f32_16x16x32_bf16 v[32:35], v[104:107], v[72:75], v[32:35]
  ds_read_b128 v[88:91], v7 offset:5120
  ds_read_b128 v[92:95], v7 offset:6144
  s_waitcnt lgkmcnt(3)
  v_mfma_f32_16x16x32_bf16 v[16:19], a[136:139], v[64:67], v[16:19]
  s_waitcnt vmcnt(11)
  ds_read_b128 v[72:75], v8 offset:5120
  buffer_load_dwordx4 v[60:63], v2, s[4:7], s60 offen offset:1024 sc1
  v_mfma_f32_16x16x32_bf16 v[20:23], a[140:143], v[64:67], v[20:23]
  ds_read_b128 v[96:99], v7 offset:7168
  ds_read_b128 v[100:103], v7 offset:8192
  ds_read_b128 v[104:107], v7 offset:9216
  v_mfma_f32_16x16x32_bf16 v[24:27], a[144:147], v[64:67], v[24:27]
  s_min_u32 s50, s50, s49
  s_lshl_b32 s50, s50, 2
  s_add_u32 s50, s50, s48
  v_mfma_f32_16x16x32_bf16 v[28:31], a[148:151], v[64:67], v[28:31]
  s_mul_i32 s48, s51, 205
  s_lshr_b32 s48, s48, 12
  v_mfma_f32_16x16x32_bf16 v[32:35], a[152:155], v[64:67], v[32:35]
  s_mul_i32 s49, s48, 20
  s_waitcnt lgkmcnt(6)
  v_mfma_f32_16x16x32_bf16 v[16:19], a[156:159], v[68:71], v[16:19]
  s_waitcnt vmcnt(10)
  ds_read_b128 v[64:67], v8 offset:7168
  v_mfma_f32_16x16x32_bf16 v[20:23], a[160:163], v[68:71], v[20:23]
  s_sub_u32 s51, s51, s49
  s_sub_u32 s51, s51, s67
  v_mfma_f32_16x16x32_bf16 v[24:27], a[164:167], v[68:71], v[24:27]
  s_add_u32 s49, s51, 20
  s_min_u32 s51, s51, s49
  v_mfma_f32_16x16x32_bf16 v[28:31], a[168:171], v[68:71], v[28:31]
  s_lshl_b32 s51, s51, 2
  s_add_u32 s51, s51, s48
  v_mfma_f32_16x16x32_bf16 v[32:35], a[172:175], v[68:71], v[32:35]
  s_waitcnt lgkmcnt(4)
  s_waitcnt lgkmcnt(1)
  v_mfma_f32_16x16x32_bf16 v[16:19], v[88:91], v[72:75], v[16:19]
  s_waitcnt vmcnt(9)
  ds_read_b128 v[68:71], v8 offset:8192
  v_mfma_f32_16x16x32_bf16 v[20:23], v[92:95], v[72:75], v[20:23]
  s_lshl_b32 s50, s50, 8
  s_lshl_b32 s51, s51, 8
  v_mfma_f32_16x16x32_bf16 v[24:27], v[96:99], v[72:75], v[24:27]
  s_lshr_b32 s48, s41, 3
  s_lshl_b32 s49, s40, 2
  v_mfma_f32_16x16x32_bf16 v[28:31], v[100:103], v[72:75], v[28:31]
  s_add_u32 s48, s48, s49
  s_mul_i32 s48, s48, 81920
  v_mfma_f32_16x16x32_bf16 v[32:35], v[104:107], v[72:75], v[32:35]
  ds_read_b128 v[88:91], v7 offset:10240
  s_waitcnt lgkmcnt(2)
  v_mfma_f32_16x16x32_bf16 v[16:19], a[176:179], v[64:67], v[16:19]
  s_waitcnt vmcnt(11)
  ds_read_b128 v[72:75], v8 offset:6144
  ds_read_b128 v[92:95], v7 offset:11264
  v_mfma_f32_16x16x32_bf16 v[20:23], a[180:183], v[64:67], v[20:23]
  ds_read_b128 v[96:99], v7 offset:12288
  ds_read_b128 v[100:103], v7 offset:13312
  ds_read_b128 v[104:107], v7 offset:14336
  v_mfma_f32_16x16x32_bf16 v[24:27], a[184:187], v[64:67], v[24:27]
  s_add_u32 s49, s48, 1048576
  s_add_u32 s50, s50, s49
  v_mfma_f32_16x16x32_bf16 v[28:31], a[188:191], v[64:67], v[28:31]
  s_add_u32 s51, s51, s49
  s_lshl_b32 s48, s42, 12
  v_mfma_f32_16x16x32_bf16 v[32:35], a[192:195], v[64:67], v[32:35]
  v_lshlrev_b32 v14, 6, v0
  s_waitcnt lgkmcnt(6)
  v_mfma_f32_16x16x32_bf16 v[16:19], a[196:199], v[68:71], v[16:19]
  s_add_u32 s54, s59, 57344
  buffer_load_dwordx4 v[64:67], v2, s[4:7], s54 offen offset:0 sc1
  v_mfma_f32_16x16x32_bf16 v[20:23], a[200:203], v[68:71], v[20:23]
  v_add_u32 v14, s48, v14
  s_mul_i32 s58, s42, 3072
  v_mfma_f32_16x16x32_bf16 v[24:27], a[204:207], v[68:71], v[24:27]
  s_add_u32 s58, s58, 0
  s_lshl_b32 s48, s40, 3
  v_mfma_f32_16x16x32_bf16 v[28:31], a[208:211], v[68:71], v[28:31]
  s_lshr_b32 s61, s41, 2
  s_add_u32 s61, s61, s48
  v_mfma_f32_16x16x32_bf16 v[32:35], a[212:215], v[68:71], v[32:35]
  s_waitcnt vmcnt(6)
  s_add_u32 s46, s64, 12288
  s_mov_b64 exec, 1
  buffer_store_dword v1, off, s[4:7], s46
  s_mov_b64 exec, -1
  s_waitcnt lgkmcnt(4)
  s_waitcnt lgkmcnt(0)
  v_mfma_f32_16x16x32_bf16 v[16:19], v[88:91], v[72:75], v[16:19]
  buffer_load_dwordx4 v[68:71], v2, s[4:7], s60 offen offset:2048 sc1
  s_mul_i32 s61, s61, 40960
  v_mfma_f32_16x16x32_bf16 v[20:23], v[92:95], v[72:75], v[20:23]
  s_and_b32 s48, s41, 3
  s_lshl_b32 s48, s48, 4
  v_mfma_f32_16x16x32_bf16 v[24:27], v[96:99], v[72:75], v[24:27]
  s_add_u32 s61, s61, s48
  s_add_u32 s61, s61, 7340032
  v_mfma_f32_16x16x32_bf16 v[28:31], v[100:103], v[72:75], v[28:31]
  s_mul_i32 s48, s42, 20480
  s_add_u32 s51, s51, s48
  v_mfma_f32_16x16x32_bf16 v[32:35], v[104:107], v[72:75], v[32:35]
  ds_read_b128 v[88:91], v7 offset:15360
  s_waitcnt vmcnt(7)
  v_mfma_f32_16x16x32_bf16 v[16:19], a[216:219], v[76:79], v[16:19]
  buffer_load_dwordx4 v[72:75], v2, s[4:7], s60 offen offset:3072 sc1
  ds_read_b128 v[92:95], v7 offset:16384
  v_mfma_f32_16x16x32_bf16 v[20:23], a[220:223], v[76:79], v[20:23]
  ds_read_b128 v[96:99], v7 offset:17408
  ds_read_b128 v[100:103], v7 offset:18432
  v_mfma_f32_16x16x32_bf16 v[24:27], a[224:227], v[76:79], v[24:27]
  ds_read_b128 v[104:107], v7 offset:19456
  s_lshl_b32 s49, s42, 10
  v_mfma_f32_16x16x32_bf16 v[28:31], a[228:231], v[76:79], v[28:31]
  s_add_u32 s49, s49, 16384
  v_add_u32 v15, s49, v2
  v_mfma_f32_16x16x32_bf16 v[32:35], a[232:235], v[76:79], v[32:35]
  s_mul_i32 s49, s42, 3072
  s_waitcnt vmcnt(7)
  v_mfma_f32_16x16x32_bf16 v[16:19], a[236:239], v[80:83], v[16:19]
  s_add_u32 s55, s50, 0
  buffer_load_dwordx2 v[108:109], v4, s[4:7], s55 offen sc1
  v_mfma_f32_16x16x32_bf16 v[20:23], a[240:243], v[80:83], v[20:23]
  buffer_load_dwordx4 v[76:79], v2, s[4:7], s54 offen offset:1024 sc1
  v_add_u32 v5, s49, v15
  v_mfma_f32_16x16x32_bf16 v[24:27], a[244:247], v[80:83], v[24:27]
  v_mfma_f32_16x16x32_bf16 v[28:31], a[248:251], v[80:83], v[28:31]
  v_mfma_f32_16x16x32_bf16 v[32:35], a[252:255], v[80:83], v[32:35]
  s_barrier
  s_waitcnt vmcnt(8)
  s_waitcnt lgkmcnt(0)
  v_mfma_f32_16x16x32_bf16 v[16:19], v[88:91], v[84:87], v[16:19]
  s_add_u32 s55, s65, 12288
  buffer_load_dwordx4 v[8:11], v6, s[4:7], s55 offen sc1
  v_mfma_f32_16x16x32_bf16 v[20:23], v[92:95], v[84:87], v[20:23]
  s_add_u32 s62, s59, 53248
  buffer_load_dwordx4 v[80:83], v2, s[4:7], s62 offen offset:0 sc1
  v_mfma_f32_16x16x32_bf16 v[24:27], v[96:99], v[84:87], v[24:27]
  v_mfma_f32_16x16x32_bf16 v[28:31], v[100:103], v[84:87], v[28:31]
  v_mfma_f32_16x16x32_bf16 v[32:35], v[104:107], v[84:87], v[32:35]
  ds_read_b128 v[88:91], v7 offset:0
  ds_read_b128 v[92:95], v7 offset:1024
  s_waitcnt vmcnt(9)
  v_mfma_f32_16x16x32_bf16 v[36:39], a[96:99], v[56:59], 0
  buffer_load_dwordx4 v[84:87], v2, s[4:7], s62 offen offset:1024 sc1
  ds_read_b128 v[96:99], v7 offset:2048
  v_mfma_f32_16x16x32_bf16 v[40:43], a[100:103], v[56:59], 0
  ds_read_b128 v[100:103], v7 offset:3072
  ds_read_b128 v[104:107], v7 offset:4096
  v_mfma_f32_16x16x32_bf16 v[44:47], a[104:107], v[56:59], 0
  ds_write_b128 v3, v[16:19] offset:0
  v_mfma_f32_16x16x32_bf16 v[48:51], a[108:111], v[56:59], 0
  ds_write_b128 v3, v[20:23] offset:1024
  v_mfma_f32_16x16x32_bf16 v[52:55], a[112:115], v[56:59], 0
  s_waitcnt vmcnt(9)
  v_mfma_f32_16x16x32_bf16 v[36:39], a[116:119], v[60:63], v[36:39]
  buffer_load_dwordx4 v[56:59], v2, s[4:7], s54 offen offset:2048 sc1
  v_mfma_f32_16x16x32_bf16 v[40:43], a[120:123], v[60:63], v[40:43]
  ds_write_b128 v3, v[24:27] offset:2048
  v_mfma_f32_16x16x32_bf16 v[44:47], a[124:127], v[60:63], v[44:47]
  ds_write_b128 v3, v[28:31] offset:3072
  v_mfma_f32_16x16x32_bf16 v[48:51], a[128:131], v[60:63], v[48:51]
  ds_write_b128 v15, v[32:35] offset:0
  v_mfma_f32_16x16x32_bf16 v[52:55], a[132:135], v[60:63], v[52:55]
  s_waitcnt vmcnt(9)
  s_waitcnt lgkmcnt(5)
  v_mfma_f32_16x16x32_bf16 v[36:39], v[88:91], v[64:67], v[36:39]
  buffer_load_dwordx4 v[60:63], v2, s[4:7], s62 offen offset:2048 sc1
  v_mfma_f32_16x16x32_bf16 v[40:43], v[92:95], v[64:67], v[40:43]
  v_mfma_f32_16x16x32_bf16 v[44:47], v[96:99], v[64:67], v[44:47]
  v_mfma_f32_16x16x32_bf16 v[48:51], v[100:103], v[64:67], v[48:51]
  v_mfma_f32_16x16x32_bf16 v[52:55], v[104:107], v[64:67], v[52:55]
  ds_read_b128 v[88:91], v7 offset:5120
  s_waitcnt vmcnt(8)
  v_mfma_f32_16x16x32_bf16 v[36:39], a[136:139], v[68:71], v[36:39]
  buffer_load_dwordx4 v[64:67], v2, s[4:7], s62 offen offset:3072 sc1
  ds_read_b128 v[92:95], v7 offset:6144
  v_mfma_f32_16x16x32_bf16 v[40:43], a[140:143], v[68:71], v[40:43]
  ds_read_b128 v[96:99], v7 offset:7168
  ds_read_b128 v[100:103], v7 offset:8192
  v_mfma_f32_16x16x32_bf16 v[44:47], a[144:147], v[68:71], v[44:47]
  ds_read_b128 v[104:107], v7 offset:9216
  v_mfma_f32_16x16x32_bf16 v[48:51], a[148:151], v[68:71], v[48:51]
  v_mfma_f32_16x16x32_bf16 v[52:55], a[152:155], v[68:71], v[52:55]
  s_waitcnt lgkmcnt(5)
  s_barrier
  s_waitcnt vmcnt(8)
  v_mfma_f32_16x16x32_bf16 v[36:39], a[156:159], v[72:75], v[36:39]
  buffer_load_dwordx4 v[68:71], v2, s[4:7], s54 offen offset:3072 sc1
  ds_read_b128 v[16:19], v13 offset:0
  v_mfma_f32_16x16x32_bf16 v[40:43], a[160:163], v[72:75], v[40:43]
  ds_read_b128 v[20:23], v13 offset:4096
  ds_read_b128 v[24:27], v13 offset:8192
  v_mfma_f32_16x16x32_bf16 v[44:47], a[164:167], v[72:75], v[44:47]
  ds_read_b128 v[28:31], v13 offset:12288
  s_waitcnt vmcnt(8)
  v_mfma_f32_16x16x32_bf16 v[48:51], a[168:171], v[72:75], v[48:51]
  v_lshlrev_b32 v32, 16, v108
  v_and_b32 v33, 0xffff0000, v108
  v_mfma_f32_16x16x32_bf16 v[52:55], a[172:175], v[72:75], v[52:55]
  s_waitcnt vmcnt(7)
  s_waitcnt lgkmcnt(4)
  v_mfma_f32_16x16x32_bf16 v[36:39], v[88:91], v[76:79], v[36:39]
  s_waitcnt vmcnt(6)
  v_bitop3_b32 v8, v8, v9, v1 bitop3:0x7e
  v_mfma_f32_16x16x32_bf16 v[40:43], v[92:95], v[76:79], v[40:43]
  v_bitop3_b32 v10, v10, v11, v1 bitop3:0x7e
  v_or_b32 v8, v8, v10
  v_mfma_f32_16x16x32_bf16 v[44:47], v[96:99], v[76:79], v[44:47]
  v_cmp_ne_u32 vcc, 0, v8
  s_nop 0
  v_mfma_f32_16x16x32_bf16 v[48:51], v[100:103], v[76:79], v[48:51]
  s_nop 1
  s_cbranch_vccz Lsckd_27
Lsck_26:
  s_add_u32 s55, s65, 12288
  buffer_load_dwordx4 v[8:11], v6, s[4:7], s55 offen sc1
  s_waitcnt vmcnt(0)
  v_bitop3_b32 v8, v8, v9, v1 bitop3:0x7e
  v_bitop3_b32 v10, v10, v11, v1 bitop3:0x7e
  v_or_b32 v8, v8, v10
  v_cmp_ne_u32 vcc, 0, v8
  s_nop 1
  s_nop 1
  s_cbranch_vccnz Lsck_26
Lsckd_27:
  v_mfma_f32_16x16x32_bf16 v[52:55], v[104:107], v[76:79], v[52:55]
  ds_read_b128 v[88:91], v7 offset:10240
  s_waitcnt vmcnt(5)
  v_mfma_f32_16x16x32_bf16 v[36:39], a[176:179], v[80:83], v[36:39]
  s_add_u32 s60, s59, 98304
  buffer_load_dwordx4 v[72:75], v2, s[4:7], s60 offen offset:0 sc1
  v_mfma_f32_16x16x32_bf16 v[40:43], a[180:183], v[80:83], v[40:43]
  buffer_load_dwordx4 v[76:79], v2, s[4:7], s60 offen offset:1024 sc1
  ds_read_b128 v[92:95], v7 offset:11264
  v_mfma_f32_16x16x32_bf16 v[44:47], a[184:187], v[80:83], v[44:47]
  ds_read_b128 v[96:99], v7 offset:12288
  ds_read_b128 v[100:103], v7 offset:13312
  v_mfma_f32_16x16x32_bf16 v[48:51], a[188:191], v[80:83], v[48:51]
  ds_read_b128 v[104:107], v7 offset:14336
  v_lshlrev_b32 v34, 16, v109
  v_mfma_f32_16x16x32_bf16 v[52:55], a[192:195], v[80:83], v[52:55]
  v_and_b32 v35, 0xffff0000, v109
  s_waitcnt vmcnt(6)
  v_mfma_f32_16x16x32_bf16 v[36:39], a[196:199], v[84:87], v[36:39]
  s_add_u32 s54, s59, 106496
  buffer_load_dwordx4 v[8:11], v2, s[4:7], s54 offen offset:0 sc1
  v_mfma_f32_16x16x32_bf16 v[40:43], a[200:203], v[84:87], v[40:43]
  buffer_load_dwordx4 v[80:83], v2, s[4:7], s60 offen offset:2048 sc1
  s_waitcnt lgkmcnt(5)
  v_mfma_f32_16x16x32_bf16 v[44:47], a[204:207], v[84:87], v[44:47]
  v_add_f32 v16, v16, v20
  v_add_f32 v17, v17, v21
  v_mfma_f32_16x16x32_bf16 v[48:51], a[208:211], v[84:87], v[48:51]
  v_add_f32 v18, v18, v22
  v_add_f32 v19, v19, v23
  v_mfma_f32_16x16x32_bf16 v[52:55], a[212:215], v[84:87], v[52:55]
  s_waitcnt vmcnt(7)
  s_waitcnt lgkmcnt(0)
  v_mfma_f32_16x16x32_bf16 v[36:39], v[88:91], v[56:59], v[36:39]
  s_add_u32 s55, s50, 20480
  buffer_load_dwordx2 v[110:111], v4, s[4:7], s55 offen sc1
  v_mfma_f32_16x16x32_bf16 v[40:43], v[92:95], v[56:59], v[40:43]
  buffer_load_dwordx4 v[84:87], v2, s[4:7], s60 offen offset:3072 sc1
  v_add_f32 v24, v24, v28
  v_mfma_f32_16x16x32_bf16 v[44:47], v[96:99], v[56:59], v[44:47]
  v_add_f32 v25, v25, v29
  v_add_f32 v26, v26, v30
  v_mfma_f32_16x16x32_bf16 v[48:51], v[100:103], v[56:59], v[48:51]
  v_add_f32 v27, v27, v31
  v_add_f32 v16, v16, v32
  v_mfma_f32_16x16x32_bf16 v[52:55], v[104:107], v[56:59], v[52:55]
  ds_read_b128 v[88:91], v7 offset:15360
  s_waitcnt vmcnt(8)
  v_mfma_f32_16x16x32_bf16 v[36:39], a[216:219], v[60:63], v[36:39]
  buffer_load_dwordx4 v[56:59], v2, s[4:7], s54 offen offset:1024 sc1
  ds_read_b128 v[92:95], v7 offset:16384
  v_mfma_f32_16x16x32_bf16 v[40:43], a[220:223], v[60:63], v[40:43]
  ds_read_b128 v[96:99], v7 offset:17408
  ds_read_b128 v[100:103], v7 offset:18432
  v_mfma_f32_16x16x32_bf16 v[44:47], a[224:227], v[60:63], v[44:47]
  ds_read_b128 v[104:107], v7 offset:19456
  v_add_f32 v17, v17, v33
  v_mfma_f32_16x16x32_bf16 v[48:51], a[228:231], v[60:63], v[48:51]
  v_add_f32 v18, v18, v34
  v_add_f32 v19, v19, v35
  v_mfma_f32_16x16x32_bf16 v[52:55], a[232:235], v[60:63], v[52:55]
  v_add_f32 v16, v16, v24
  s_waitcnt vmcnt(8)
  v_mfma_f32_16x16x32_bf16 v[36:39], a[236:239], v[64:67], v[36:39]
  s_add_u32 m0, s58, 0
  s_add_u32 s48, s61, 0
  v_mfma_f32_16x16x32_bf16 v[40:43], a[240:243], v[64:67], v[40:43]
  buffer_load_dwordx4 v14, s[4:7], s48 offen sc1 lds
  s_add_u32 s62, s59, 102400
  v_mfma_f32_16x16x32_bf16 v[44:47], a[244:247], v[64:67], v[44:47]
  buffer_load_dwordx4 v[60:63], v2, s[4:7], s62 offen offset:0 sc1
  v_add_f32 v17, v17, v25
  v_mfma_f32_16x16x32_bf16 v[48:51], a[248:251], v[64:67], v[48:51]
  v_add_f32 v18, v18, v26
  v_add_f32 v19, v19, v27
  v_mfma_f32_16x16x32_bf16 v[52:55], a[252:255], v[64:67], v[52:55]
  s_waitcnt vmcnt(9)
  s_waitcnt lgkmcnt(0)
  v_mfma_f32_16x16x32_bf16 v[36:39], v[88:91], v[68:71], v[36:39]
  s_add_u32 m0, s58, 1024
  s_add_u32 s48, s61, 16384
  v_mfma_f32_16x16x32_bf16 v[40:43], v[92:95], v[68:71], v[40:43]
  buffer_load_dwordx4 v14, s[4:7], s48 offen sc1 lds
  buffer_load_dwordx4 v[64:67], v2, s[4:7], s62 offen offset:1024 sc1
  v_mfma_f32_16x16x32_bf16 v[44:47], v[96:99], v[68:71], v[44:47]
  v_cvt_pk_bf16_f32 v20, v16, v17
  v_cvt_pk_bf16_f32 v21, v18, v19
  v_mfma_f32_16x16x32_bf16 v[48:51], v[100:103], v[68:71], v[48:51]
  s_add_u32 s49, s50, 0
  buffer_store_dwordx2 v[20:21], v4, s[4:7], s49 offen
  v_mfma_f32_16x16x32_bf16 v[52:55], v[104:107], v[68:71], v[52:55]
  ds_read_b128 v[88:91], v7 offset:0
  s_waitcnt vmcnt(11)
  v_mfma_f32_16x16x32_bf16 v[16:19], a[96:99], v[72:75], 0
  buffer_load_dwordx4 v[68:71], v2, s[4:7], s54 offen offset:2048 sc1
  ds_read_b128 v[92:95], v7 offset:1024
  v_mfma_f32_16x16x32_bf16 v[20:23], a[100:103], v[72:75], 0
  ds_read_b128 v[96:99], v7 offset:2048
  ds_read_b128 v[100:103], v7 offset:3072
  v_mfma_f32_16x16x32_bf16 v[24:27], a[104:107], v[72:75], 0
  ds_read_b128 v[104:107], v7 offset:4096
  v_mfma_f32_16x16x32_bf16 v[28:31], a[108:111], v[72:75], 0
  ds_write_b128 v3, v[36:39] offset:16384
  v_mfma_f32_16x16x32_bf16 v[32:35], a[112:115], v[72:75], 0
  s_waitcnt vmcnt(11)
  v_mfma_f32_16x16x32_bf16 v[16:19], a[116:119], v[76:79], v[16:19]
  buffer_load_dwordx4 v[72:75], v2, s[4:7], s62 offen offset:2048 sc1
  v_mfma_f32_16x16x32_bf16 v[20:23], a[120:123], v[76:79], v[20:23]
  ds_write_b128 v3, v[40:43] offset:17408
  v_mfma_f32_16x16x32_bf16 v[24:27], a[124:127], v[76:79], v[24:27]
  ds_write_b128 v3, v[44:47] offset:18432
  v_mfma_f32_16x16x32_bf16 v[28:31], a[128:131], v[76:79], v[28:31]
  ds_write_b128 v3, v[48:51] offset:19456
  v_mfma_f32_16x16x32_bf16 v[32:35], a[132:135], v[76:79], v[32:35]
  s_waitcnt vmcnt(11)
  s_waitcnt lgkmcnt(4)
  v_mfma_f32_16x16x32_bf16 v[16:19], v[88:91], v[8:11], v[16:19]
  buffer_load_dwordx4 v[76:79], v2, s[4:7], s62 offen offset:3072 sc1
  v_mfma_f32_16x16x32_bf16 v[20:23], v[92:95], v[8:11], v[20:23]
  ds_write_b128 v15, v[52:55] offset:4096
  v_mfma_f32_16x16x32_bf16 v[24:27], v[96:99], v[8:11], v[24:27]
  v_mfma_f32_16x16x32_bf16 v[28:31], v[100:103], v[8:11], v[28:31]
  v_mfma_f32_16x16x32_bf16 v[32:35], v[104:107], v[8:11], v[32:35]
  ds_read_b128 v[88:91], v7 offset:5120
  s_waitcnt vmcnt(11)
  v_mfma_f32_16x16x32_bf16 v[16:19], a[136:139], v[80:83], v[16:19]
  buffer_load_dwordx4 v[8:11], v2, s[4:7], s54 offen offset:3072 sc1
  ds_read_b128 v[92:95], v7 offset:6144
  v_mfma_f32_16x16x32_bf16 v[20:23], a[140:143], v[80:83], v[20:23]
  ds_read_b128 v[96:99], v7 offset:7168
  ds_read_b128 v[100:103], v7 offset:8192
  v_mfma_f32_16x16x32_bf16 v[24:27], a[144:147], v[80:83], v[24:27]
  ds_read_b128 v[104:107], v7 offset:9216
  v_mfma_f32_16x16x32_bf16 v[28:31], a[148:151], v[80:83], v[28:31]
  v_mfma_f32_16x16x32_bf16 v[32:35], a[152:155], v[80:83], v[32:35]
  s_waitcnt lgkmcnt(5)
  s_barrier
  s_waitcnt vmcnt(10)
  v_mfma_f32_16x16x32_bf16 v[16:19], a[156:159], v[84:87], v[16:19]
  s_add_u32 s60, s59, 147456
  buffer_load_dwordx4 v[80:83], v2, s[4:7], s60 offen offset:0 sc1
  v_mfma_f32_16x16x32_bf16 v[20:23], a[160:163], v[84:87], v[20:23]
  ds_read_b128 v[36:39], v13 offset:16384
  ds_read_b128 v[40:43], v13 offset:20480
  v_mfma_f32_16x16x32_bf16 v[24:27], a[164:167], v[84:87], v[24:27]
  ds_read_b128 v[44:47], v13 offset:24576
  ds_read_b128 v[48:51], v13 offset:28672
  v_mfma_f32_16x16x32_bf16 v[28:31], a[168:171], v[84:87], v[28:31]
  s_waitcnt vmcnt(12)
  v_lshlrev_b32 v52, 16, v110
  v_mfma_f32_16x16x32_bf16 v[32:35], a[172:175], v[84:87], v[32:35]
  s_waitcnt vmcnt(10)
  s_waitcnt lgkmcnt(4)
  v_mfma_f32_16x16x32_bf16 v[16:19], v[88:91], v[56:59], v[16:19]
  buffer_load_dwordx4 v[84:87], v2, s[4:7], s60 offen offset:1024 sc1
  v_and_b32 v53, 0xffff0000, v110
  v_mfma_f32_16x16x32_bf16 v[20:23], v[92:95], v[56:59], v[20:23]
  v_lshlrev_b32 v54, 16, v111
  v_and_b32 v55, 0xffff0000, v111
  v_mfma_f32_16x16x32_bf16 v[24:27], v[96:99], v[56:59], v[24:27]
  v_mfma_f32_16x16x32_bf16 v[28:31], v[100:103], v[56:59], v[28:31]
  v_mfma_f32_16x16x32_bf16 v[32:35], v[104:107], v[56:59], v[32:35]
  ds_read_b128 v[88:91], v7 offset:10240
  s_waitcnt vmcnt(9)
  v_mfma_f32_16x16x32_bf16 v[16:19], a[176:179], v[60:63], v[16:19]
  s_add_u32 s54, s59, 155648
  buffer_load_dwordx4 v[56:59], v2, s[4:7], s54 offen offset:0 sc1
  v_mfma_f32_16x16x32_bf16 v[20:23], a[180:183], v[60:63], v[20:23]
  ds_read_b128 v[92:95], v7 offset:11264
  ds_read_b128 v[96:99], v7 offset:12288
  v_mfma_f32_16x16x32_bf16 v[24:27], a[184:187], v[60:63], v[24:27]
  ds_read_b128 v[100:103], v7 offset:13312
  ds_read_b128 v[104:107], v7 offset:14336
  v_mfma_f32_16x16x32_bf16 v[28:31], a[188:191], v[60:63], v[28:31]
  s_waitcnt lgkmcnt(5)
  v_add_f32 v36, v36, v40
  v_mfma_f32_16x16x32_bf16 v[32:35], a[192:195], v[60:63], v[32:35]
  v_add_f32 v37, v37, v41
  s_waitcnt vmcnt(8)
  v_mfma_f32_16x16x32_bf16 v[16:19], a[196:199], v[64:67], v[16:19]
  buffer_load_dwordx4 v[60:63], v2, s[4:7], s60 offen offset:2048 sc1
  v_add_f32 v38, v38, v42
  v_mfma_f32_16x16x32_bf16 v[20:23], a[200:203], v[64:67], v[20:23]
  v_add_f32 v39, v39, v43
  v_add_f32 v44, v44, v48
  v_mfma_f32_16x16x32_bf16 v[24:27], a[204:207], v[64:67], v[24:27]
  v_add_f32 v45, v45, v49
  v_add_f32 v46, v46, v50
  v_mfma_f32_16x16x32_bf16 v[28:31], a[208:211], v[64:67], v[28:31]
  v_add_f32 v47, v47, v51
  v_add_f32 v36, v36, v52
  v_mfma_f32_16x16x32_bf16 v[32:35], a[212:215], v[64:67], v[32:35]
  s_waitcnt vmcnt(7)
  s_waitcnt lgkmcnt(0)
  v_mfma_f32_16x16x32_bf16 v[16:19], v[88:91], v[68:71], v[16:19]
  s_add_u32 s55, s50, 40960
  buffer_load_dwordx2 v[108:109], v4, s[4:7], s55 offen sc1
  v_mfma_f32_16x16x32_bf16 v[20:23], v[92:95], v[68:71], v[20:23]
  buffer_load_dwordx4 v[64:67], v2, s[4:7], s60 offen offset:3072 sc1
  v_add_f32 v37, v37, v53
  v_mfma_f32_16x16x32_bf16 v[24:27], v[96:99], v[68:71], v[24:27]
  v_add_f32 v38, v38, v54
  v_add_f32 v39, v39, v55
  v_mfma_f32_16x16x32_bf16 v[28:31], v[100:103], v[68:71], v[28:31]
  v_add_f32 v36, v36, v44
  v_add_f32 v37, v37, v45
  v_mfma_f32_16x16x32_bf16 v[32:35], v[104:107], v[68:71], v[32:35]
  ds_read_b128 v[88:91], v7 offset:15360
  s_waitcnt vmcnt(8)
  v_mfma_f32_16x16x32_bf16 v[16:19], a[216:219], v[72:75], v[16:19]
  buffer_load_dwordx4 v[68:71], v2, s[4:7], s54 offen offset:1024 sc1
  ds_read_b128 v[92:95], v7 offset:16384
  v_mfma_f32_16x16x32_bf16 v[20:23], a[220:223], v[72:75], v[20:23]
  ds_read_b128 v[96:99], v7 offset:17408
  ds_read_b128 v[100:103], v7 offset:18432
  v_mfma_f32_16x16x32_bf16 v[24:27], a[224:227], v[72:75], v[24:27]
  ds_read_b128 v[104:107], v7 offset:19456
  v_add_f32 v38, v38, v46
  v_mfma_f32_16x16x32_bf16 v[28:31], a[228:231], v[72:75], v[28:31]
  v_add_f32 v39, v39, v47
  v_cvt_pk_bf16_f32 v40, v36, v37
  v_mfma_f32_16x16x32_bf16 v[32:35], a[232:235], v[72:75], v[32:35]
  v_cvt_pk_bf16_f32 v41, v38, v39
  s_waitcnt vmcnt(8)
  v_mfma_f32_16x16x32_bf16 v[16:19], a[236:239], v[76:79], v[16:19]
  s_add_u32 s62, s59, 151552
  buffer_load_dwordx4 v[72:75], v2, s[4:7], s62 offen offset:0 sc1
  v_mfma_f32_16x16x32_bf16 v[20:23], a[240:243], v[76:79], v[20:23]
  s_add_u32 s49, s50, 20480
  buffer_store_dwordx2 v[40:41], v4, s[4:7], s49 offen
  v_mfma_f32_16x16x32_bf16 v[24:27], a[244:247], v[76:79], v[24:27]
  v_mfma_f32_16x16x32_bf16 v[28:31], a[248:251], v[76:79], v[28:31]
  v_mfma_f32_16x16x32_bf16 v[32:35], a[252:255], v[76:79], v[32:35]
  s_waitcnt vmcnt(9)
  s_waitcnt lgkmcnt(0)
  v_mfma_f32_16x16x32_bf16 v[16:19], v[88:91], v[8:11], v[16:19]
  s_add_u32 m0, s58, 2048
  s_add_u32 s48, s61, 32768
  v_mfma_f32_16x16x32_bf16 v[20:23], v[92:95], v[8:11], v[20:23]
  s_add_u32 s48, s48, s66
  buffer_load_dwordx4 v14, s[4:7], s48 offen sc1 lds
  v_mfma_f32_16x16x32_bf16 v[24:27], v[96:99], v[8:11], v[24:27]
  buffer_load_dwordx4 v[76:79], v2, s[4:7], s62 offen offset:1024 sc1
  v_mfma_f32_16x16x32_bf16 v[28:31], v[100:103], v[8:11], v[28:31]
  v_mfma_f32_16x16x32_bf16 v[32:35], v[104:107], v[8:11], v[32:35]
  ds_read_b128 v[88:91], v7 offset:0
  s_waitcnt vmcnt(9)
  v_mfma_f32_16x16x32_bf16 v[36:39], a[96:99], v[80:83], 0
  buffer_load_dwordx4 v[8:11], v2, s[4:7], s54 offen offset:2048 sc1
  ds_read_b128 v[92:95], v7 offset:1024
  v_mfma_f32_16x16x32_bf16 v[40:43], a[100:103], v[80:83], 0
  ds_read_b128 v[96:99], v7 offset:2048
  ds_read_b128 v[100:103], v7 offset:3072
  v_mfma_f32_16x16x32_bf16 v[44:47], a[104:107], v[80:83], 0
  ds_read_b128 v[104:107], v7 offset:4096
  v_mfma_f32_16x16x32_bf16 v[48:51], a[108:111], v[80:83], 0
  ds_write_b128 v3, v[16:19] offset:0
  v_mfma_f32_16x16x32_bf16 v[52:55], a[112:115], v[80:83], 0
  s_waitcnt vmcnt(9)
  v_mfma_f32_16x16x32_bf16 v[36:39], a[116:119], v[84:87], v[36:39]
  buffer_load_dwordx4 v[80:83], v2, s[4:7], s62 offen offset:2048 sc1
  v_mfma_f32_16x16x32_bf16 v[40:43], a[120:123], v[84:87], v[40:43]
  ds_write_b128 v3, v[20:23] offset:1024
  v_mfma_f32_16x16x32_bf16 v[44:47], a[124:127], v[84:87], v[44:47]
  ds_write_b128 v3, v[24:27] offset:2048
  v_mfma_f32_16x16x32_bf16 v[48:51], a[128:131], v[84:87], v[48:51]
  ds_write_b128 v3, v[28:31] offset:3072
  v_mfma_f32_16x16x32_bf16 v[52:55], a[132:135], v[84:87], v[52:55]
  s_waitcnt vmcnt(9)
  s_waitcnt lgkmcnt(4)
  v_mfma_f32_16x16x32_bf16 v[36:39], v[88:91], v[56:59], v[36:39]
  buffer_load_dwordx4 v[84:87], v2, s[4:7], s62 offen offset:3072 sc1
  v_mfma_f32_16x16x32_bf16 v[40:43], v[92:95], v[56:59], v[40:43]
  ds_write_b128 v15, v[32:35] offset:8192
  v_mfma_f32_16x16x32_bf16 v[44:47], v[96:99], v[56:59], v[44:47]
  v_mfma_f32_16x16x32_bf16 v[48:51], v[100:103], v[56:59], v[48:51]
  v_mfma_f32_16x16x32_bf16 v[52:55], v[104:107], v[56:59], v[52:55]
  ds_read_b128 v[88:91], v7 offset:5120
  s_waitcnt vmcnt(9)
  v_mfma_f32_16x16x32_bf16 v[36:39], a[136:139], v[60:63], v[36:39]
  buffer_load_dwordx4 v[56:59], v2, s[4:7], s54 offen offset:3072 sc1
  ds_read_b128 v[92:95], v7 offset:6144
  v_mfma_f32_16x16x32_bf16 v[40:43], a[140:143], v[60:63], v[40:43]
  ds_read_b128 v[96:99], v7 offset:7168
  ds_read_b128 v[100:103], v7 offset:8192
  v_mfma_f32_16x16x32_bf16 v[44:47], a[144:147], v[60:63], v[44:47]
  ds_read_b128 v[104:107], v7 offset:9216
  v_mfma_f32_16x16x32_bf16 v[48:51], a[148:151], v[60:63], v[48:51]
  v_mfma_f32_16x16x32_bf16 v[52:55], a[152:155], v[60:63], v[52:55]
  s_waitcnt lgkmcnt(5)
  s_barrier
  s_waitcnt vmcnt(8)
  v_mfma_f32_16x16x32_bf16 v[36:39], a[156:159], v[64:67], v[36:39]
  ds_read_b128 v[16:19], v13 offset:0
  ds_read_b128 v[20:23], v13 offset:4096
  v_mfma_f32_16x16x32_bf16 v[40:43], a[160:163], v[64:67], v[40:43]
  ds_read_b128 v[24:27], v13 offset:8192
  ds_read_b128 v[28:31], v13 offset:12288
  v_mfma_f32_16x16x32_bf16 v[44:47], a[164:167], v[64:67], v[44:47]
  s_waitcnt vmcnt(9)
  v_lshlrev_b32 v32, 16, v108
  v_mfma_f32_16x16x32_bf16 v[48:51], a[168:171], v[64:67], v[48:51]
  v_and_b32 v33, 0xffff0000, v108
  v_lshlrev_b32 v34, 16, v109
  v_mfma_f32_16x16x32_bf16 v[52:55], a[172:175], v[64:67], v[52:55]
  s_waitcnt vmcnt(7)
  s_waitcnt lgkmcnt(4)
  v_mfma_f32_16x16x32_bf16 v[36:39], v[88:91], v[68:71], v[36:39]
  v_and_b32 v35, 0xffff0000, v109
  v_mfma_f32_16x16x32_bf16 v[40:43], v[92:95], v[68:71], v[40:43]
  v_mfma_f32_16x16x32_bf16 v[44:47], v[96:99], v[68:71], v[44:47]
  v_mfma_f32_16x16x32_bf16 v[48:51], v[100:103], v[68:71], v[48:51]
  s_waitcnt lgkmcnt(0)
  v_add_f32 v16, v16, v20
  v_mfma_f32_16x16x32_bf16 v[52:55], v[104:107], v[68:71], v[52:55]
  ds_read_b128 v[88:91], v7 offset:10240
  s_waitcnt vmcnt(6)
  v_mfma_f32_16x16x32_bf16 v[36:39], a[176:179], v[72:75], v[36:39]
  ds_read_b128 v[92:95], v7 offset:11264
  ds_read_b128 v[96:99], v7 offset:12288
  v_mfma_f32_16x16x32_bf16 v[40:43], a[180:183], v[72:75], v[40:43]
  ds_read_b128 v[100:103], v7 offset:13312
  ds_read_b128 v[104:107], v7 offset:14336
  v_mfma_f32_16x16x32_bf16 v[44:47], a[184:187], v[72:75], v[44:47]
  v_add_f32 v17, v17, v21
  v_add_f32 v18, v18, v22
  v_mfma_f32_16x16x32_bf16 v[48:51], a[188:191], v[72:75], v[48:51]
  v_add_f32 v19, v19, v23
  v_add_f32 v24, v24, v28
  v_mfma_f32_16x16x32_bf16 v[52:55], a[192:195], v[72:75], v[52:55]
  v_add_f32 v25, v25, v29
  s_waitcnt vmcnt(4)
  v_mfma_f32_16x16x32_bf16 v[36:39], a[196:199], v[76:79], v[36:39]
  v_add_f32 v26, v26, v30
  v_add_f32 v27, v27, v31
  v_mfma_f32_16x16x32_bf16 v[40:43], a[200:203], v[76:79], v[40:43]
  v_add_f32 v16, v16, v32
  v_add_f32 v17, v17, v33
  v_mfma_f32_16x16x32_bf16 v[44:47], a[204:207], v[76:79], v[44:47]
  v_add_f32 v18, v18, v34
  v_add_f32 v19, v19, v35
  v_mfma_f32_16x16x32_bf16 v[48:51], a[208:211], v[76:79], v[48:51]
  v_add_f32 v16, v16, v24
  v_add_f32 v17, v17, v25
  v_mfma_f32_16x16x32_bf16 v[52:55], a[212:215], v[76:79], v[52:55]
  s_waitcnt vmcnt(3)
  s_waitcnt lgkmcnt(0)
  v_mfma_f32_16x16x32_bf16 v[36:39], v[88:91], v[8:11], v[36:39]
  s_add_u32 s55, s50, 61440
  buffer_load_dwordx2 v[110:111], v4, s[4:7], s55 offen sc1
  v_mfma_f32_16x16x32_bf16 v[40:43], v[92:95], v[8:11], v[40:43]
  s_add_u32 s55, s51, 0
  buffer_load_dwordx2 v[60:61], v4, s[4:7], s55 offen sc1
  v_mfma_f32_16x16x32_bf16 v[44:47], v[96:99], v[8:11], v[44:47]
  v_add_f32 v18, v18, v26
  v_add_f32 v19, v19, v27
  v_mfma_f32_16x16x32_bf16 v[48:51], v[100:103], v[8:11], v[48:51]
  v_cvt_pk_bf16_f32 v20, v16, v17
  v_cvt_pk_bf16_f32 v21, v18, v19
  v_mfma_f32_16x16x32_bf16 v[52:55], v[104:107], v[8:11], v[52:55]
  ds_read_b128 v[88:91], v7 offset:15360
  s_waitcnt vmcnt(4)
  v_mfma_f32_16x16x32_bf16 v[36:39], a[216:219], v[80:83], v[36:39]
  ds_read_b128 v[92:95], v7 offset:16384
  ds_read_b128 v[96:99], v7 offset:17408
  v_mfma_f32_16x16x32_bf16 v[40:43], a[220:223], v[80:83], v[40:43]
  ds_read_b128 v[100:103], v7 offset:18432
  ds_read_b128 v[104:107], v7 offset:19456
  v_mfma_f32_16x16x32_bf16 v[44:47], a[224:227], v[80:83], v[44:47]
  s_add_u32 s49, s50, 40960
  buffer_store_dwordx2 v[20:21], v4, s[4:7], s49 offen
  v_mfma_f32_16x16x32_bf16 v[48:51], a[228:231], v[80:83], v[48:51]
  v_mfma_f32_16x16x32_bf16 v[52:55], a[232:235], v[80:83], v[52:55]
  s_waitcnt vmcnt(4)
  v_mfma_f32_16x16x32_bf16 v[36:39], a[236:239], v[84:87], v[36:39]
  v_mfma_f32_16x16x32_bf16 v[40:43], a[240:243], v[84:87], v[40:43]
  v_mfma_f32_16x16x32_bf16 v[44:47], a[244:247], v[84:87], v[44:47]
  v_mfma_f32_16x16x32_bf16 v[48:51], a[248:251], v[84:87], v[48:51]
  v_mfma_f32_16x16x32_bf16 v[52:55], a[252:255], v[84:87], v[52:55]
  s_waitcnt vmcnt(3)
  s_waitcnt lgkmcnt(0)
  v_mfma_f32_16x16x32_bf16 v[36:39], v[88:91], v[56:59], v[36:39]
  v_mfma_f32_16x16x32_bf16 v[40:43], v[92:95], v[56:59], v[40:43]
  v_mfma_f32_16x16x32_bf16 v[44:47], v[96:99], v[56:59], v[44:47]
  v_mfma_f32_16x16x32_bf16 v[48:51], v[100:103], v[56:59], v[48:51]
  v_mfma_f32_16x16x32_bf16 v[52:55], v[104:107], v[56:59], v[52:55]
  s_nop 3
  ds_write_b128 v3, v[36:39] offset:16384
  ds_write_b128 v3, v[40:43] offset:17408
  ds_write_b128 v3, v[44:47] offset:18432
  ds_write_b128 v3, v[48:51] offset:19456
  ds_write_b128 v15, v[52:55] offset:12288
  s_waitcnt vmcnt(1)
  v_lshlrev_b32 v104, 16, v60
  v_and_b32 v105, 0xffff0000, v60
  v_lshlrev_b32 v106, 16, v61
  v_and_b32 v107, 0xffff0000, v61
  v_lshlrev_b32 v32, 16, v110
  v_and_b32 v33, 0xffff0000, v110
  v_lshlrev_b32 v34, 16, v111
  v_and_b32 v35, 0xffff0000, v111
  s_waitcnt lgkmcnt(0)
  s_barrier
  ds_read_b128 v[16:19], v13 offset:16384
  ds_read_b128 v[20:23], v13 offset:20480
  ds_read_b128 v[24:27], v13 offset:24576
  ds_read_b128 v[28:31], v13 offset:28672
  ds_read_b128 v[88:91], v5 offset:0
  ds_read_b128 v[92:95], v5 offset:1024
  ds_read_b128 v[96:99], v5 offset:2048
  ds_read_b128 v[100:103], v5 offset:3072
  s_waitcnt lgkmcnt(4)
  v_pk_add_f32 v[16:17], v[16:17], v[20:21]
  v_pk_add_f32 v[24:25], v[24:25], v[28:29]
  v_pk_add_f32 v[18:19], v[18:19], v[22:23]
  v_pk_add_f32 v[26:27], v[26:27], v[30:31]
  v_pk_add_f32 v[16:17], v[16:17], v[32:33]
  v_pk_add_f32 v[18:19], v[18:19], v[34:35]
  v_pk_add_f32 v[16:17], v[16:17], v[24:25]
  v_pk_add_f32 v[18:19], v[18:19], v[26:27]
  v_cvt_pk_bf16_f32 v20, v16, v17
  v_cvt_pk_bf16_f32 v21, v18, v19
  s_add_u32 s49, s50, 61440
  buffer_store_dwordx2 v[20:21], v4, s[4:7], s49 offen
  s_waitcnt lgkmcnt(0)
  v_pk_add_f32 v[88:89], v[88:89], v[92:93]
  v_pk_add_f32 v[96:97], v[96:97], v[100:101]
  v_pk_add_f32 v[90:91], v[90:91], v[94:95]
  v_pk_add_f32 v[98:99], v[98:99], v[102:103]
  v_pk_add_f32 v[88:89], v[88:89], v[104:105]
  v_pk_add_f32 v[90:91], v[90:91], v[106:107]
  v_pk_add_f32 v[88:89], v[88:89], v[96:97]
  v_pk_add_f32 v[90:91], v[90:91], v[98:99]
  v_cvt_pk_bf16_f32 v92, v88, v89
  v_cvt_pk_bf16_f32 v93, v90, v91
  s_add_u32 s49, s51, 0
  buffer_store_dwordx2 v[92:93], v4, s[4:7], s49 offen
  v_and_b32 v24, 7, v0
  v_lshrrev_b32 v25, 3, v0
  s_lshl_b32 s48, s42, 3
  v_add_u32 v25, s48, v25
  v_lshlrev_b32 v3, 4, v24
  s_lshl_b32 s48, s67, 2
  v_subrev_u32 v26, s48, v25
  v_add_u32 v27, 0, v25
  v_mul_u32_u24 v26, 205, v27
  v_lshrrev_b32 v26, 12, v26
  v_mul_u32_u24 v98, 20, v26
  v_sub_u32 v27, v27, v98
  v_subrev_u32 v27, s67, v27
  v_add_u32 v98, 20, v27
  v_min_u32 v27, v27, v98
  v_lshl_add_u32 v27, v27, 2, v26
  v_lshl_add_u32 v99, v27, 8, v3
  v_add_u32 v27, 32, v25
  v_mul_u32_u24 v26, 205, v27
  v_lshrrev_b32 v26, 12, v26
  v_mul_u32_u24 v98, 20, v26
  v_sub_u32 v27, v27, v98
  v_subrev_u32 v27, s67, v27
  v_add_u32 v98, 20, v27
  v_min_u32 v27, v27, v98
  v_lshl_add_u32 v27, v27, 2, v26
  v_lshl_add_u32 v100, v27, 8, v3
  v_add_u32 v27, 64, v25
  v_mul_u32_u24 v26, 205, v27
  v_lshrrev_b32 v26, 12, v26
  v_mul_u32_u24 v98, 20, v26
  v_sub_u32 v27, v27, v98
  v_subrev_u32 v27, s67, v27
  v_add_u32 v98, 20, v27
  v_min_u32 v27, v27, v98
  v_lshl_add_u32 v27, v27, 2, v26
  v_lshl_add_u32 v101, v27, 8, v3
  v_lshrrev_b32 v25, 4, v0
  v_lshlrev_b32 v6, 8, v25
  v_bfe_u32 v26, v0, 1, 1
  v_lshl_add_u32 v6, v26, 7, v6
  v_bfe_u32 v26, v0, 2, 2
  v_lshl_add_u32 v6, v26, 4, v6
  v_and_b32 v26, 1, v0
  v_lshl_add_u32 v6, v26, 3, v6
  v_add_u32 v6, s58, v6
  v_lshlrev_b32 v90, 5, v24
  v_add_u32 v90, 12288, v90
  v_and_b32 v25, 1, v25
  v_lshl_add_u32 v7, v25, 4, v90
  s_lshl_b32 s48, s42, 2
  v_add_u32 v7, s48, v7
  s_lshl_b32 s48, s40, 5
  s_add_u32 s48, s48, s41
  s_lshl_b32 s59, s48, 7
  s_add_u32 s59, s59, 131072
  s_cmp_eq_u32 s42, 0
  s_cselect_b32 s59, s59, 0x80000000
  s_lshr_b32 s49, s48, 1
  s_mul_i32 s60, s49, 20480
  s_and_b32 s49, s41, 1
  s_lshl_b32 s49, s49, 7
  s_add_u32 s60, s60, s49
  s_add_u32 s60, s60, 1048576
  s_waitcnt vmcnt(0)
  s_add_u32 s46, s64, 16384
  s_mov_b64 exec, 1
  buffer_store_dword v1, off, s[4:7], s46
  s_mov_b64 exec, -1
L_r2_f:
  s_and_b32 s49, s41, 24
  v_and_b32 v88, 7, v0
  v_add_u32 v88, s49, v88
  v_lshlrev_b32 v88, 4, v88
  s_waitcnt vmcnt(11)
  ds_read_b64_tr_b16 v[20:21], v6 offset:0
  ds_read_b64_tr_b16 v[22:23], v6 offset:64
  ds_read_b64_tr_b16 v[24:25], v6 offset:1024
  ds_read_b64_tr_b16 v[26:27], v6 offset:1088
  ds_read_b64_tr_b16 v[28:29], v6 offset:2048
  ds_read_b64_tr_b16 v[30:31], v6 offset:2112
  s_waitcnt lgkmcnt(0)
  s_add_u32 s55, s65, 16384
  buffer_load_dwordx4 v[8:11], v88, s[4:7], s55 offen sc1
  v_lshlrev_b32 v56, 16, v20
  v_and_b32 v57, 0xffff0000, v20
  v_lshlrev_b32 v58, 16, v21
  v_and_b32 v59, 0xffff0000, v21
  v_lshlrev_b32 v60, 16, v22
  v_and_b32 v61, 0xffff0000, v22
  v_lshlrev_b32 v62, 16, v23
  v_and_b32 v63, 0xffff0000, v23
  v_lshlrev_b32 v64, 16, v24
  v_and_b32 v65, 0xffff0000, v24
  v_lshlrev_b32 v66, 16, v25
  v_and_b32 v67, 0xffff0000, v25
  v_lshlrev_b32 v68, 16, v26
  v_and_b32 v69, 0xffff0000, v26
  v_lshlrev_b32 v70, 16, v27
  v_and_b32 v71, 0xffff0000, v27
  v_lshlrev_b32 v72, 16, v28
  v_and_b32 v73, 0xffff0000, v28
  v_lshlrev_b32 v74, 16, v29
  v_and_b32 v75, 0xffff0000, v29
  v_lshlrev_b32 v76, 16, v30
  v_and_b32 v77, 0xffff0000, v30
  v_lshlrev_b32 v78, 16, v31
  v_and_b32 v79, 0xffff0000, v31
  s_waitcnt vmcnt(0)
Lchk_28:
  v_bitop3_b32 v8, v8, v9, v1 bitop3:0x7e
  v_bitop3_b32 v10, v10, v11, v1 bitop3:0x7e
  v_or_b32 v8, v8, v10
  v_cmp_ne_u32 vcc, 0, v8
  s_nop 3
  s_cbranch_vccz Lchkd_29
  s_add_u32 s55, s65, 16384
  buffer_load_dwordx4 v[8:11], v88, s[4:7], s55 offen sc1
  s_waitcnt vmcnt(0)
  s_branch Lchk_28
Lchkd_29:
  s_add_u32 s49, s60, s66
  buffer_load_dwordx4 v[8:11], v99, s[4:7], s60 offen sc1
  buffer_load_dwordx4 v[12:15], v100, s[4:7], s60 offen sc1
  buffer_load_dwordx4 v[16:19], v101, s[4:7], s49 offen sc1
  v_mov_b32 v84, 0x3f803f80
  s_waitcnt vmcnt(1)
  v_dot2_f32_bf16 v80, v8, v84, 0
  v_dot2_f32_bf16 v82, v8, v8, 0
  v_dot2_f32_bf16 v81, v9, v84, 0
  v_dot2_f32_bf16 v83, v9, v9, 0
  v_dot2_f32_bf16 v80, v10, v84, v80
  v_dot2_f32_bf16 v82, v10, v10, v82
  v_dot2_f32_bf16 v81, v11, v84, v81
  v_dot2_f32_bf16 v83, v11, v11, v83
  s_waitcnt vmcnt(0)
  v_dot2_f32_bf16 v80, v12, v84, v80
  v_dot2_f32_bf16 v82, v12, v12, v82
  v_dot2_f32_bf16 v81, v13, v84, v81
  v_dot2_f32_bf16 v83, v13, v13, v83
  v_dot2_f32_bf16 v80, v14, v84, v80
  v_dot2_f32_bf16 v82, v14, v14, v82
  v_dot2_f32_bf16 v81, v15, v84, v81
  v_dot2_f32_bf16 v83, v15, v15, v83
  s_waitcnt vmcnt(0)
  v_dot2_f32_bf16 v80, v16, v84, v80
  v_dot2_f32_bf16 v82, v16, v16, v82
  v_dot2_f32_bf16 v81, v17, v84, v81
  v_dot2_f32_bf16 v83, v17, v17, v83
  v_dot2_f32_bf16 v80, v18, v84, v80
  v_dot2_f32_bf16 v82, v18, v18, v82
  v_dot2_f32_bf16 v81, v19, v84, v81
  v_dot2_f32_bf16 v83, v19, v19, v83
  s_nop 1
  v_add_f32 v80, v80, v81
  v_add_f32 v82, v82, v83
  s_nop 0
  v_add_f32_dpp v80, v80, v80 row_ror:8 row_mask:0xf bank_mask:0xf
  v_add_f32_dpp v82, v82, v82 row_ror:8 row_mask:0xf bank_mask:0xf
  s_nop 1
  v_permlane16_swap_b32 v80, v82
  v_add_f32 v80, v80, v82
  v_mov_b32 v82, v80
  s_nop 1
  v_permlane32_swap_b32 v80, v82
  v_add_f32 v80, v80, v82
  s_mov_b64 exec, 0x00ff00ff
  ds_write_b32 v7, v80 offset:0
  s_mov_b64 exec, -1
  v_lshlrev_b32 v32, 16, v8
  v_and_b32 v33, 0xffff0000, v8
  v_lshlrev_b32 v34, 16, v9
  v_and_b32 v35, 0xffff0000, v9
  v_lshlrev_b32 v36, 16, v10
  v_and_b32 v37, 0xffff0000, v10
  v_lshlrev_b32 v38, 16, v11
  v_and_b32 v39, 0xffff0000, v11
  v_lshlrev_b32 v40, 16, v12
  v_and_b32 v41, 0xffff0000, v12
  v_lshlrev_b32 v42, 16, v13
  v_and_b32 v43, 0xffff0000, v13
  v_lshlrev_b32 v44, 16, v14
  v_and_b32 v45, 0xffff0000, v14
  v_lshlrev_b32 v46, 16, v15
  v_and_b32 v47, 0xffff0000, v15
  v_lshlrev_b32 v48, 16, v16
  v_and_b32 v49, 0xffff0000, v16
  v_lshlrev_b32 v50, 16, v17
  v_and_b32 v51, 0xffff0000, v17
  v_lshlrev_b32 v52, 16, v18
  v_and_b32 v53, 0xffff0000, v18
  v_lshlrev_b32 v54, 16, v19
  v_and_b32 v55, 0xffff0000, v19
  s_waitcnt lgkmcnt(0)
  s_barrier
  ds_read_b128 v[80:83], v90 offset:0
  ds_read_b128 v[84:87], v90 offset:16
  s_waitcnt lgkmcnt(0)
  v_pk_add_f32 v[80:81], v[80:81], v[82:83]
  v_pk_add_f32 v[84:85], v[84:85], v[86:87]
  v_add_f32 v80, v80, v81
  v_add_f32 v84, v84, v85
  v_mul_f32 v80, 0.0015625, v80
  v_mul_f32 v84, 0.0015625, v84
  v_fma_f32 v84, -v80, v80, v84
  v_max_f32 v84, 0, v84
  v_cvt_pk_bf16_f32 v84, v84, v80
  v_and_b32 v80, 0xffff0000, v84
  v_lshlrev_b32 v84, 16, v84
  v_add_f32 v84, 0x3727c5ac, v84
  v_cvt_pk_bf16_f32 v84, v84, v84
  v_lshlrev_b32 v84, 16, v84
  v_sqrt_f32 v84, v84
  s_nop 0
  v_cvt_pk_bf16_f32 v84, v84, v84
  v_lshlrev_b32 v84, 16, v84
  v_rcp_f32 v88, v84
  s_nop 0
  v_mul_f32 v89, v80, v88
  v_sub_f32 v89, 0, v89
  s_add_u32 s49, s60, s66
  v_pk_fma_f32 v[92:93], v[32:33], v[88:89], v[88:89] op_sel:[0,0,1] op_sel_hi:[1,0,1]
  v_pk_fma_f32 v[32:33], v[92:93], v[56:57], v[32:33]
  v_cvt_pk_bf16_f32 v20, v32, v33
  v_pk_fma_f32 v[94:95], v[34:35], v[88:89], v[88:89] op_sel:[0,0,1] op_sel_hi:[1,0,1]
  v_pk_fma_f32 v[34:35], v[94:95], v[58:59], v[34:35]
  v_cvt_pk_bf16_f32 v21, v34, v35
  v_pk_fma_f32 v[92:93], v[36:37], v[88:89], v[88:89] op_sel:[0,0,1] op_sel_hi:[1,0,1]
  v_pk_fma_f32 v[36:37], v[92:93], v[60:61], v[36:37]
  v_cvt_pk_bf16_f32 v22, v36, v37
  v_pk_fma_f32 v[94:95], v[38:39], v[88:89], v[88:89] op_sel:[0,0,1] op_sel_hi:[1,0,1]
  v_pk_fma_f32 v[38:39], v[94:95], v[62:63], v[38:39]
  v_cvt_pk_bf16_f32 v23, v38, v39
  buffer_store_dwordx4 v[20:23], v99, s[4:7], s60 offen
  v_pk_fma_f32 v[92:93], v[40:41], v[88:89], v[88:89] op_sel:[0,0,1] op_sel_hi:[1,0,1]
  v_pk_fma_f32 v[40:41], v[92:93], v[64:65], v[40:41]
  v_cvt_pk_bf16_f32 v24, v40, v41
  v_pk_fma_f32 v[94:95], v[42:43], v[88:89], v[88:89] op_sel:[0,0,1] op_sel_hi:[1,0,1]
  v_pk_fma_f32 v[42:43], v[94:95], v[66:67], v[42:43]
  v_cvt_pk_bf16_f32 v25, v42, v43
  v_pk_fma_f32 v[92:93], v[44:45], v[88:89], v[88:89] op_sel:[0,0,1] op_sel_hi:[1,0,1]
  v_pk_fma_f32 v[44:45], v[92:93], v[68:69], v[44:45]
  v_cvt_pk_bf16_f32 v26, v44, v45
  v_pk_fma_f32 v[94:95], v[46:47], v[88:89], v[88:89] op_sel:[0,0,1] op_sel_hi:[1,0,1]
  v_pk_fma_f32 v[46:47], v[94:95], v[70:71], v[46:47]
  v_cvt_pk_bf16_f32 v27, v46, v47
  buffer_store_dwordx4 v[24:27], v100, s[4:7], s60 offen
  v_pk_fma_f32 v[92:93], v[48:49], v[88:89], v[88:89] op_sel:[0,0,1] op_sel_hi:[1,0,1]
  v_pk_fma_f32 v[48:49], v[92:93], v[72:73], v[48:49]
  v_cvt_pk_bf16_f32 v28, v48, v49
  v_pk_fma_f32 v[94:95], v[50:51], v[88:89], v[88:89] op_sel:[0,0,1] op_sel_hi:[1,0,1]
  v_pk_fma_f32 v[50:51], v[94:95], v[74:75], v[50:51]
  v_cvt_pk_bf16_f32 v29, v50, v51
  v_pk_fma_f32 v[92:93], v[52:53], v[88:89], v[88:89] op_sel:[0,0,1] op_sel_hi:[1,0,1]
  v_pk_fma_f32 v[52:53], v[92:93], v[76:77], v[52:53]
  v_cvt_pk_bf16_f32 v30, v52, v53
  v_pk_fma_f32 v[94:95], v[54:55], v[88:89], v[88:89] op_sel:[0,0,1] op_sel_hi:[1,0,1]
  v_pk_fma_f32 v[54:55], v[94:95], v[78:79], v[54:55]
  v_cvt_pk_bf16_f32 v31, v54, v55
  buffer_store_dwordx4 v[28:31], v101, s[4:7], s49 offen
  v_mov_b32 v93, v3
  s_mov_b32 s58, s59
  v_mov_b32 v84, 0x3f803f80
  v_dot2_f32_bf16 v80, v20, v84, 0
  v_dot2_f32_bf16 v82, v20, v20, 0
  v_dot2_f32_bf16 v81, v21, v84, 0
  v_dot2_f32_bf16 v83, v21, v21, 0
  v_dot2_f32_bf16 v80, v22, v84, v80
  v_dot2_f32_bf16 v82, v22, v22, v82
  v_dot2_f32_bf16 v81, v23, v84, v81
  v_dot2_f32_bf16 v83, v23, v23, v83
  v_dot2_f32_bf16 v80, v24, v84, v80
  v_dot2_f32_bf16 v82, v24, v24, v82
  v_dot2_f32_bf16 v81, v25, v84, v81
  v_dot2_f32_bf16 v83, v25, v25, v83
  v_dot2_f32_bf16 v80, v26, v84, v80
  v_dot2_f32_bf16 v82, v26, v26, v82
  v_dot2_f32_bf16 v81, v27, v84, v81
  v_dot2_f32_bf16 v83, v27, v27, v83
  v_dot2_f32_bf16 v80, v28, v84, v80
  v_dot2_f32_bf16 v82, v28, v28, v82
  v_dot2_f32_bf16 v81, v29, v84, v81
  v_dot2_f32_bf16 v83, v29, v29, v83
  v_dot2_f32_bf16 v80, v30, v84, v80
  v_dot2_f32_bf16 v82, v30, v30, v82
  v_dot2_f32_bf16 v81, v31, v84, v81
  v_dot2_f32_bf16 v83, v31, v31, v83
  s_nop 1
  v_add_f32 v80, v80, v81
  v_add_f32 v82, v82, v83
  s_nop 0
  v_add_f32_dpp v80, v80, v80 row_ror:8 row_mask:0xf bank_mask:0xf
  v_add_f32_dpp v82, v82, v82 row_ror:8 row_mask:0xf bank_mask:0xf
  s_nop 1
  v_permlane16_swap_b32 v80, v82
  v_add_f32 v80, v80, v82
  v_mov_b32 v82, v80
  s_nop 1
  v_permlane32_swap_b32 v80, v82
  v_add_f32 v80, v80, v82
  s_mov_b64 exec, 0x00ff00ff
  ds_write_b32 v7, v80 offset:256
  s_mov_b64 exec, -1
  s_waitcnt vmcnt(0)
  s_add_u32 s46, s64, 20480
  s_mov_b64 exec, 1
  buffer_store_dword v1, off, s[4:7], s46
  s_mov_b64 exec, -1
  v_and_b32 v5, 15, v0
  v_lshlrev_b32 v5, 4, v5
  v_bfe_u32 v6, v0, 4, 1
  v_lshl_add_u32 v7, v6, 8, v5
  s_lshl_b32 s48, s42, 8
  v_add_u32 v5, s48, v5
  v_mul_u32_u24 v6, 49152, v6
  v_add_u32 v5, v5, v6
  v_lshrrev_b32 v6, 5, v0
  v_lshl_add_u32 v3, v6, 10, v5
  v_lshl_add_u32 v4, v6, 3, v5
  v_add_u32 v4, 2048, v4
  v_mul_u32_u24 v13, 96, v6
  s_mul_i32 s48, s42, 192
  s_add_u32 s48, s48, 36864
  v_add_u32 v13, s48, v13
  v_add_u32 v5, 40960, v2
  s_lshr_b32 s49, s41, 4
  s_lshl_b32 s50, s40, 1
  s_add_u32 s50, s50, s49
  s_lshl_b32 s50, s50, 3
  s_and_b32 s48, s42, 1
  s_mul_i32 s48, s48, 20480
  s_lshr_b32 s53, s42, 1
  s_lshl_b32 s53, s53, 10
  s_add_u32 s53, s53, s48
  s_mul_i32 s51, s50, 20480
  s_add_u32 s51, s51, s53
  s_add_u32 s51, s51, 1048576
  s_lshl_b32 s48, s36, 10
  s_add_u32 s51, s51, s48
  s_cmp_eq_u32 s36, 0
  s_cselect_b32 s48, 0, 20480
  s_sub_u32 s61, s51, s48
  s_and_b32 s48, s41, 15
  s_mul_i32 s48, s48, 3072
  s_mul_i32 s52, s50, 49152
  s_add_u32 s52, s52, s48
  s_add_u32 s52, s52, 10485760
  s_lshl_b32 s62, s50, 8
  s_add_u32 s62, s62, 131072
  s_lshr_b32 s48, s41, 3
  s_lshl_b32 s59, s40, 2
  s_add_u32 s59, s59, s48
  s_mul_i32 s59, s59, 196608
  s_mul_i32 s48, s42, 12288
  s_add_u32 s59, s59, s48
  s_add_u32 s59, s59, 10485760
  s_mul_i32 s60, s42, 9216
  s_lshl_b32 s49, s49, 4
  v_and_b32 v6, 15, v0
  v_add_u32 v6, s49, v6
  v_lshlrev_b32 v6, 4, v6
  s_add_u32 s46, s65, 20480
Lpoll_30:
  buffer_load_dwordx4 v[8:11], v6, s[4:7], s46 offen sc1
  s_waitcnt vmcnt(0)
  v_bitop3_b32 v8, v8, v9, v1 bitop3:0x7e
  v_bitop3_b32 v10, v10, v11, v1 bitop3:0x7e
  v_or_b32 v8, v8, v10
  v_cmp_ne_u32 vcc, 0, v8
  s_nop 3
  s_cbranch_vccnz Lpoll_30
  s_add_u32 m0, s53, 0
  s_add_u32 s48, s51, 0
  buffer_load_dwordx4 v2, s[4:7], s48 offen offset:0 sc1 lds
  buffer_load_dwordx4 v2, s[4:7], s48 offen offset:2048 sc1 lds
  s_add_u32 m0, s53, 4096
  s_add_u32 s48, s51, 4096
  buffer_load_dwordx4 v2, s[4:7], s48 offen offset:0 sc1 lds
  buffer_load_dwordx4 v2, s[4:7], s48 offen offset:2048 sc1 lds
  s_lshl_b32 s55, s42, 2
  s_add_u32 s49, s49, s55
  v_and_b32 v6, 3, v0
  v_add_u32 v6, s49, v6
  v_lshlrev_b32 v6, 4, v6
  s_waitcnt lgkmcnt(0)
  s_barrier
  ds_read_b128 v[80:83], v90 offset:256
  ds_read_b128 v[84:87], v90 offset:272
  s_waitcnt lgkmcnt(0)
  v_pk_add_f32 v[80:81], v[80:81], v[82:83]
  v_pk_add_f32 v[84:85], v[84:85], v[86:87]
  v_add_f32 v80, v80, v81
  v_add_f32 v84, v84, v85
  v_mul_f32 v80, 0.0015625, v80
  v_mul_f32 v84, 0.0015625, v84
  v_fma_f32 v84, -v80, v80, v84
  v_max_f32 v84, 0, v84
  v_cvt_pk_bf16_f32 v84, v84, v80
  v_and_b32 v80, 0xffff0000, v84
  v_lshlrev_b32 v84, 16, v84
  v_add_f32 v84, 0x3727c5ac, v84
  v_cvt_pk_bf16_f32 v84, v84, v84
  v_lshlrev_b32 v84, 16, v84
  v_sqrt_f32 v84, v84
  s_nop 0
  v_cvt_pk_bf16_f32 v84, v84, v84
  v_lshlrev_b32 v84, 16, v84
  v_rcp_f32 v88, v84
  s_nop 0
  v_mul_f32 v89, v88, v88
  v_sub_f32 v88, 0, v80
  v_mov_b32 v90, v1
  v_mov_b32 v91, v1
  s_mov_b64 exec, 0xff
  buffer_store_dwordx4 v[88:91], v93, s[4:7], s58 offen
  s_mov_b64 exec, -1
  ds_read_b128 v[88:91], v13 offset:0
  ds_read_b128 v[92:95], v13 offset:16
  ds_read_b128 v[96:99], v13 offset:32
  ds_read_b128 v[100:103], v13 offset:48
  ds_read_b128 v[104:107], v13 offset:64
  ds_read_b128 v[108:111], v13 offset:80
  s_waitcnt lgkmcnt(0)
  s_waitcnt vmcnt(2)
  s_barrier
  ds_read_b128 v[64:67], v2 offset:0
  ds_read_b128 v[68:71], v2 offset:20480
  ds_read_b128 v[72:75], v2 offset:1024
  ds_read_b128 v[76:79], v2 offset:21504
  s_waitcnt lgkmcnt(2)
  v_mfma_f32_16x16x32_bf16 v[16:19], v[112:115], v[64:67], 0
  ds_read_b128 v[80:83], v2 offset:2048
  s_add_u32 m0, s53, 8192
  v_mfma_f32_16x16x32_bf16 v[28:31], v[112:115], v[68:71], 0
  ds_read_b128 v[84:87], v2 offset:22528
  s_add_u32 s48, s61, 8192
  v_mfma_f32_16x16x32_bf16 v[20:23], v[116:119], v[64:67], 0
  buffer_load_dwordx4 v2, s[4:7], s48 offen offset:0 sc1 lds
  buffer_load_dwordx4 v2, s[4:7], s48 offen offset:2048 sc1 lds
  v_mfma_f32_16x16x32_bf16 v[32:35], v[116:119], v[68:71], 0
  v_mfma_f32_16x16x32_bf16 v[24:27], v[120:123], v[64:67], 0
  v_mfma_f32_16x16x32_bf16 v[36:39], v[120:123], v[68:71], 0
  s_waitcnt lgkmcnt(2)
  v_mfma_f32_16x16x32_bf16 v[16:19], v[124:127], v[72:75], v[16:19]
  ds_read_b128 v[64:67], v2 offset:3072
  s_add_u32 m0, s53, 12288
  v_mfma_f32_16x16x32_bf16 v[28:31], v[124:127], v[76:79], v[28:31]
  ds_read_b128 v[68:71], v2 offset:23552
  s_add_u32 s48, s61, 12288
  v_mfma_f32_16x16x32_bf16 v[20:23], v[128:131], v[72:75], v[20:23]
  buffer_load_dwordx4 v2, s[4:7], s48 offen offset:0 sc1 lds
  buffer_load_dwordx4 v2, s[4:7], s48 offen offset:2048 sc1 lds
  v_mfma_f32_16x16x32_bf16 v[32:35], v[128:131], v[76:79], v[32:35]
  v_mfma_f32_16x16x32_bf16 v[24:27], v[132:135], v[72:75], v[24:27]
  v_mfma_f32_16x16x32_bf16 v[36:39], v[132:135], v[76:79], v[36:39]
  s_waitcnt lgkmcnt(2)
  v_mfma_f32_16x16x32_bf16 v[16:19], v[136:139], v[80:83], v[16:19]
  s_waitcnt vmcnt(4)
  s_barrier
  ds_read_b128 v[72:75], v2 offset:4096
  v_mfma_f32_16x16x32_bf16 v[28:31], v[136:139], v[84:87], v[28:31]
  ds_read_b128 v[76:79], v2 offset:24576
  s_add_u32 m0, s53, 16384
  v_mfma_f32_16x16x32_bf16 v[20:23], v[140:143], v[80:83], v[20:23]
  s_add_u32 s48, s61, 16384
  buffer_load_dwordx4 v2, s[4:7], s48 offen offset:0 sc1 lds
  v_mfma_f32_16x16x32_bf16 v[32:35], v[140:143], v[84:87], v[32:35]
  buffer_load_dwordx4 v2, s[4:7], s48 offen offset:2048 sc1 lds
  v_mfma_f32_16x16x32_bf16 v[24:27], v[144:147], v[80:83], v[24:27]
  v_mfma_f32_16x16x32_bf16 v[36:39], v[144:147], v[84:87], v[36:39]
  s_waitcnt lgkmcnt(2)
  v_mfma_f32_16x16x32_bf16 v[16:19], v[148:151], v[64:67], v[16:19]
  ds_read_b128 v[80:83], v2 offset:5120
  s_add_u32 m0, s53, 40960
  v_mfma_f32_16x16x32_bf16 v[28:31], v[148:151], v[68:71], v[28:31]
  ds_read_b128 v[84:87], v2 offset:25600
  s_add_u32 s48, s51, 81920
  v_mfma_f32_16x16x32_bf16 v[20:23], v[152:155], v[64:67], v[20:23]
  buffer_load_dwordx4 v2, s[4:7], s48 offen offset:0 sc1 lds
  buffer_load_dwordx4 v2, s[4:7], s48 offen offset:2048 sc1 lds
  v_mfma_f32_16x16x32_bf16 v[32:35], v[152:155], v[68:71], v[32:35]
  v_mfma_f32_16x16x32_bf16 v[24:27], v[156:159], v[64:67], v[24:27]
  v_mfma_f32_16x16x32_bf16 v[36:39], v[156:159], v[68:71], v[36:39]
  s_waitcnt lgkmcnt(2)
  v_mfma_f32_16x16x32_bf16 v[16:19], v[160:163], v[72:75], v[16:19]
  ds_read_b128 v[64:67], v2 offset:6144
  s_add_u32 m0, s53, 45056
  v_mfma_f32_16x16x32_bf16 v[28:31], v[160:163], v[76:79], v[28:31]
  ds_read_b128 v[68:71], v2 offset:26624
  s_add_u32 s48, s51, 86016
  v_mfma_f32_16x16x32_bf16 v[20:23], v[164:167], v[72:75], v[20:23]
  buffer_load_dwordx4 v2, s[4:7], s48 offen offset:0 sc1 lds
  v_mfma_f32_16x16x32_bf16 v[32:35], v[164:167], v[76:79], v[32:35]
  v_mfma_f32_16x16x32_bf16 v[24:27], v[168:171], v[72:75], v[24:27]
  v_mfma_f32_16x16x32_bf16 v[36:39], v[168:171], v[76:79], v[36:39]
  s_waitcnt lgkmcnt(2)
  v_mfma_f32_16x16x32_bf16 v[16:19], v[172:175], v[80:83], v[16:19]
  ds_read_b128 v[72:75], v2 offset:7168
  buffer_load_dwordx4 v2, s[4:7], s48 offen offset:2048 sc1 lds
  v_mfma_f32_16x16x32_bf16 v[28:31], v[172:175], v[84:87], v[28:31]
  ds_read_b128 v[76:79], v2 offset:27648
  v_mfma_f32_16x16x32_bf16 v[20:23], v[176:179], v[80:83], v[20:23]
  v_mfma_f32_16x16x32_bf16 v[32:35], v[176:179], v[84:87], v[32:35]
  v_mfma_f32_16x16x32_bf16 v[24:27], v[180:183], v[80:83], v[24:27]
  v_mfma_f32_16x16x32_bf16 v[36:39], v[180:183], v[84:87], v[36:39]
  s_waitcnt lgkmcnt(2)
  v_mfma_f32_16x16x32_bf16 v[16:19], v[184:187], v[64:67], v[16:19]
  s_waitcnt vmcnt(7)
  s_barrier
  ds_read_b128 v[80:83], v2 offset:8192
  v_mfma_f32_16x16x32_bf16 v[28:31], v[184:187], v[68:71], v[28:31]
  ds_read_b128 v[84:87], v2 offset:28672
  s_add_u32 m0, s53, 49152
  v_mfma_f32_16x16x32_bf16 v[20:23], v[188:191], v[64:67], v[20:23]
  s_add_u32 s48, s61, 90112
  buffer_load_dwordx4 v2, s[4:7], s48 offen offset:0 sc1 lds
  v_mfma_f32_16x16x32_bf16 v[32:35], v[188:191], v[68:71], v[32:35]
  v_mfma_f32_16x16x32_bf16 v[24:27], v[192:195], v[64:67], v[24:27]
  v_mfma_f32_16x16x32_bf16 v[36:39], v[192:195], v[68:71], v[36:39]
  s_waitcnt lgkmcnt(2)
  v_mfma_f32_16x16x32_bf16 v[16:19], v[196:199], v[72:75], v[16:19]
  ds_read_b128 v[64:67], v2 offset:9216
  buffer_load_dwordx4 v2, s[4:7], s48 offen offset:2048 sc1 lds
  v_mfma_f32_16x16x32_bf16 v[28:31], v[196:199], v[76:79], v[28:31]
  ds_read_b128 v[68:71], v2 offset:29696
  v_mfma_f32_16x16x32_bf16 v[20:23], v[200:203], v[72:75], v[20:23]
  v_mfma_f32_16x16x32_bf16 v[32:35], v[200:203], v[76:79], v[32:35]
  v_mfma_f32_16x16x32_bf16 v[24:27], v[204:207], v[72:75], v[24:27]
  v_mfma_f32_16x16x32_bf16 v[36:39], v[204:207], v[76:79], v[36:39]
  s_waitcnt lgkmcnt(2)
  v_mfma_f32_16x16x32_bf16 v[16:19], v[208:211], v[80:83], v[16:19]
  ds_read_b128 v[72:75], v2 offset:10240
  s_add_u32 m0, s53, 53248
  v_mfma_f32_16x16x32_bf16 v[28:31], v[208:211], v[84:87], v[28:31]
  ds_read_b128 v[76:79], v2 offset:30720
  s_add_u32 s48, s61, 94208
  v_mfma_f32_16x16x32_bf16 v[20:23], v[212:215], v[80:83], v[20:23]
  buffer_load_dwordx4 v2, s[4:7], s48 offen offset:0 sc1 lds
  v_mfma_f32_16x16x32_bf16 v[32:35], v[212:215], v[84:87], v[32:35]
  v_mfma_f32_16x16x32_bf16 v[24:27], v[216:219], v[80:83], v[24:27]
  v_mfma_f32_16x16x32_bf16 v[36:39], v[216:219], v[84:87], v[36:39]
  s_waitcnt lgkmcnt(2)
  v_mfma_f32_16x16x32_bf16 v[16:19], v[220:223], v[64:67], v[16:19]
  ds_read_b128 v[80:83], v2 offset:11264
  buffer_load_dwordx4 v2, s[4:7], s48 offen offset:2048 sc1 lds
  v_mfma_f32_16x16x32_bf16 v[28:31], v[220:223], v[68:71], v[28:31]
  ds_read_b128 v[84:87], v2 offset:31744
  v_mfma_f32_16x16x32_bf16 v[20:23], v[224:227], v[64:67], v[20:23]
  v_mfma_f32_16x16x32_bf16 v[32:35], v[224:227], v[68:71], v[32:35]
  v_mfma_f32_16x16x32_bf16 v[24:27], v[228:231], v[64:67], v[24:27]
  v_mfma_f32_16x16x32_bf16 v[36:39], v[228:231], v[68:71], v[36:39]
  s_waitcnt lgkmcnt(2)
  v_mfma_f32_16x16x32_bf16 v[16:19], v[232:235], v[72:75], v[16:19]
  ds_read_b128 v[64:67], v2 offset:12288
  s_add_u32 m0, s53, 57344
  v_mfma_f32_16x16x32_bf16 v[28:31], v[232:235], v[76:79], v[28:31]
  ds_read_b128 v[68:71], v2 offset:32768
  s_add_u32 s48, s61, 98304
  v_mfma_f32_16x16x32_bf16 v[20:23], v[236:239], v[72:75], v[20:23]
  buffer_load_dwordx4 v2, s[4:7], s48 offen offset:0 sc1 lds
  v_mfma_f32_16x16x32_bf16 v[32:35], v[236:239], v[76:79], v[32:35]
  v_mfma_f32_16x16x32_bf16 v[24:27], v[240:243], v[72:75], v[24:27]
  v_mfma_f32_16x16x32_bf16 v[36:39], v[240:243], v[76:79], v[36:39]
  s_waitcnt lgkmcnt(2)
  v_mfma_f32_16x16x32_bf16 v[16:19], v[244:247], v[80:83], v[16:19]
  ds_read_b128 v[72:75], v2 offset:13312
  buffer_load_dwordx4 v2, s[4:7], s48 offen offset:2048 sc1 lds
  v_mfma_f32_16x16x32_bf16 v[28:31], v[244:247], v[84:87], v[28:31]
  ds_read_b128 v[76:79], v2 offset:33792
  v_mfma_f32_16x16x32_bf16 v[20:23], v[248:251], v[80:83], v[20:23]
  v_mfma_f32_16x16x32_bf16 v[32:35], v[248:251], v[84:87], v[32:35]
  v_mfma_f32_16x16x32_bf16 v[24:27], v[252:255], v[80:83], v[24:27]
  v_mfma_f32_16x16x32_bf16 v[36:39], v[252:255], v[84:87], v[36:39]
  s_waitcnt lgkmcnt(2)
  v_mfma_f32_16x16x32_bf16 v[16:19], a[0:3], v[64:67], v[16:19]
  s_waitcnt vmcnt(10)
  s_barrier
  ds_read_b128 v[80:83], v2 offset:14336
  v_mfma_f32_16x16x32_bf16 v[28:31], a[0:3], v[68:71], v[28:31]
  ds_read_b128 v[84:87], v2 offset:34816
  s_add_u32 s55, s62, 0
  v_mfma_f32_16x16x32_bf16 v[20:23], a[4:7], v[64:67], v[20:23]
  buffer_load_dwordx4 v[8:11], v7, s[4:7], s55 offen sc1
  v_mfma_f32_16x16x32_bf16 v[32:35], a[4:7], v[68:71], v[32:35]
  v_mfma_f32_16x16x32_bf16 v[24:27], a[8:11], v[64:67], v[24:27]
  v_mfma_f32_16x16x32_bf16 v[36:39], a[8:11], v[68:71], v[36:39]
  s_waitcnt lgkmcnt(2)
  v_mfma_f32_16x16x32_bf16 v[16:19], a[12:15], v[72:75], v[16:19]
  ds_read_b128 v[64:67], v2 offset:15360
  v_mfma_f32_16x16x32_bf16 v[28:31], a[12:15], v[76:79], v[28:31]
  ds_read_b128 v[68:71], v2 offset:35840
  v_mfma_f32_16x16x32_bf16 v[20:23], a[16:19], v[72:75], v[20:23]
  v_mfma_f32_16x16x32_bf16 v[32:35], a[16:19], v[76:79], v[32:35]
  v_mfma_f32_16x16x32_bf16 v[24:27], a[20:23], v[72:75], v[24:27]
  v_mfma_f32_16x16x32_bf16 v[36:39], a[20:23], v[76:79], v[36:39]
  s_waitcnt lgkmcnt(2)
  v_mfma_f32_16x16x32_bf16 v[16:19], a[24:27], v[80:83], v[16:19]
  ds_read_b128 v[72:75], v2 offset:16384
  v_mfma_f32_16x16x32_bf16 v[28:31], a[24:27], v[84:87], v[28:31]
  ds_read_b128 v[76:79], v2 offset:36864
  v_mfma_f32_16x16x32_bf16 v[20:23], a[28:31], v[80:83], v[20:23]
  v_mfma_f32_16x16x32_bf16 v[32:35], a[28:31], v[84:87], v[32:35]
  v_mfma_f32_16x16x32_bf16 v[24:27], a[32:35], v[80:83], v[24:27]
  v_mfma_f32_16x16x32_bf16 v[36:39], a[32:35], v[84:87], v[36:39]
  s_waitcnt lgkmcnt(2)
  v_mfma_f32_16x16x32_bf16 v[16:19], a[36:39], v[64:67], v[16:19]
  ds_read_b128 v[80:83], v2 offset:17408
  v_mfma_f32_16x16x32_bf16 v[28:31], a[36:39], v[68:71], v[28:31]
  ds_read_b128 v[84:87], v2 offset:37888
  v_mfma_f32_16x16x32_bf16 v[20:23], a[40:43], v[64:67], v[20:23]
  v_mfma_f32_16x16x32_bf16 v[32:35], a[40:43], v[68:71], v[32:35]
  v_mfma_f32_16x16x32_bf16 v[24:27], a[44:47], v[64:67], v[24:27]
  v_mfma_f32_16x16x32_bf16 v[36:39], a[44:47], v[68:71], v[36:39]
  s_waitcnt lgkmcnt(2)
  v_mfma_f32_16x16x32_bf16 v[16:19], a[48:51], v[72:75], v[16:19]
  ds_read_b128 v[64:67], v2 offset:18432
  v_mfma_f32_16x16x32_bf16 v[28:31], a[48:51], v[76:79], v[28:31]
  ds_read_b128 v[68:71], v2 offset:38912
  v_mfma_f32_16x16x32_bf16 v[20:23], a[52:55], v[72:75], v[20:23]
  v_mfma_f32_16x16x32_bf16 v[32:35], a[52:55], v[76:79], v[32:35]
  v_mfma_f32_16x16x32_bf16 v[24:27], a[56:59], v[72:75], v[24:27]
  v_mfma_f32_16x16x32_bf16 v[36:39], a[56:59], v[76:79], v[36:39]
  s_waitcnt lgkmcnt(2)
  v_mfma_f32_16x16x32_bf16 v[16:19], a[60:63], v[80:83], v[16:19]
  ds_read_b128 v[72:75], v2 offset:19456
  v_mfma_f32_16x16x32_bf16 v[28:31], a[60:63], v[84:87], v[28:31]
  ds_read_b128 v[76:79], v2 offset:39936
  v_mfma_f32_16x16x32_bf16 v[20:23], a[64:67], v[80:83], v[20:23]
  v_mfma_f32_16x16x32_bf16 v[32:35], a[64:67], v[84:87], v[32:35]
  v_mfma_f32_16x16x32_bf16 v[24:27], a[68:71], v[80:83], v[24:27]
  v_mfma_f32_16x16x32_bf16 v[36:39], a[68:71], v[84:87], v[36:39]
  s_waitcnt lgkmcnt(2)
  v_mfma_f32_16x16x32_bf16 v[16:19], a[72:75], v[64:67], v[16:19]
  s_waitcnt vmcnt(1) lgkmcnt(0)
  s_barrier
  ds_read_b128 v[80:83], v5 offset:0
  v_mfma_f32_16x16x32_bf16 v[28:31], a[72:75], v[68:71], v[28:31]
  ds_read_b128 v[84:87], v5 offset:20480
  v_mfma_f32_16x16x32_bf16 v[20:23], a[76:79], v[64:67], v[20:23]
  v_mfma_f32_16x16x32_bf16 v[32:35], a[76:79], v[68:71], v[32:35]
  v_mfma_f32_16x16x32_bf16 v[24:27], a[80:83], v[64:67], v[24:27]
  v_mfma_f32_16x16x32_bf16 v[36:39], a[80:83], v[68:71], v[36:39]
  s_waitcnt lgkmcnt(2)
  v_mfma_f32_16x16x32_bf16 v[16:19], a[84:87], v[72:75], v[16:19]
  ds_read_b128 v[64:67], v5 offset:1024
  v_mfma_f32_16x16x32_bf16 v[28:31], a[84:87], v[76:79], v[28:31]
  ds_read_b128 v[68:71], v5 offset:21504
  v_mfma_f32_16x16x32_bf16 v[20:23], a[88:91], v[72:75], v[20:23]
  v_mfma_f32_16x16x32_bf16 v[32:35], a[88:91], v[76:79], v[32:35]
  v_mfma_f32_16x16x32_bf16 v[24:27], a[92:95], v[72:75], v[24:27]
  v_mfma_f32_16x16x32_bf16 v[36:39], a[92:95], v[76:79], v[36:39]
  s_waitcnt lgkmcnt(2)
  v_mfma_f32_16x16x32_bf16 v[40:43], v[112:115], v[80:83], 0
  ds_read_b128 v[72:75], v5 offset:2048
  s_add_u32 m0, s53, 0
  v_mfma_f32_16x16x32_bf16 v[52:55], v[112:115], v[84:87], 0
  ds_read_b128 v[76:79], v5 offset:22528
  s_add_u32 s48, s51, 40960
  v_mfma_f32_16x16x32_bf16 v[44:47], v[116:119], v[80:83], 0
  buffer_load_dwordx4 v2, s[4:7], s48 offen offset:0 sc1 lds
  v_mfma_f32_16x16x32_bf16 v[56:59], v[116:119], v[84:87], 0
  v_mfma_f32_16x16x32_bf16 v[48:51], v[120:123], v[80:83], 0
  v_mfma_f32_16x16x32_bf16 v[60:63], v[120:123], v[84:87], 0
  s_waitcnt lgkmcnt(2)
  v_mfma_f32_16x16x32_bf16 v[40:43], v[124:127], v[64:67], v[40:43]
  ds_read_b128 v[80:83], v5 offset:3072
  buffer_load_dwordx4 v2, s[4:7], s48 offen offset:2048 sc1 lds
  v_mfma_f32_16x16x32_bf16 v[52:55], v[124:127], v[68:71], v[52:55]
  ds_read_b128 v[84:87], v5 offset:23552
  v_mfma_f32_16x16x32_bf16 v[44:47], v[128:131], v[64:67], v[44:47]
  v_permlane16_swap_b32 v16, v28
  v_mfma_f32_16x16x32_bf16 v[56:59], v[128:131], v[68:71], v[56:59]
  v_permlane16_swap_b32 v17, v29
  v_mfma_f32_16x16x32_bf16 v[48:51], v[132:135], v[64:67], v[48:51]
  v_permlane16_swap_b32 v18, v30
  v_mfma_f32_16x16x32_bf16 v[60:63], v[132:135], v[68:71], v[60:63]
  s_waitcnt lgkmcnt(2)
  v_mfma_f32_16x16x32_bf16 v[40:43], v[136:139], v[72:75], v[40:43]
  ds_read_b128 v[64:67], v5 offset:4096
  s_add_u32 m0, s53, 4096
  v_mfma_f32_16x16x32_bf16 v[52:55], v[136:139], v[76:79], v[52:55]
  ds_read_b128 v[68:71], v5 offset:24576
  s_add_u32 s48, s51, 45056
  v_mfma_f32_16x16x32_bf16 v[44:47], v[140:143], v[72:75], v[44:47]
  buffer_load_dwordx4 v2, s[4:7], s48 offen offset:0 sc1 lds
  v_mfma_f32_16x16x32_bf16 v[56:59], v[140:143], v[76:79], v[56:59]
  v_permlane16_swap_b32 v19, v31
  v_mfma_f32_16x16x32_bf16 v[48:51], v[144:147], v[72:75], v[48:51]
  v_permlane16_swap_b32 v20, v32
  v_mfma_f32_16x16x32_bf16 v[60:63], v[144:147], v[76:79], v[60:63]
  s_waitcnt lgkmcnt(2)
  v_mfma_f32_16x16x32_bf16 v[40:43], v[148:151], v[80:83], v[40:43]
  ds_read_b128 v[72:75], v5 offset:5120
  buffer_load_dwordx4 v2, s[4:7], s48 offen offset:2048 sc1 lds
  v_mfma_f32_16x16x32_bf16 v[52:55], v[148:151], v[84:87], v[52:55]
  ds_read_b128 v[76:79], v5 offset:25600
  v_mfma_f32_16x16x32_bf16 v[44:47], v[152:155], v[80:83], v[44:47]
  v_permlane16_swap_b32 v21, v33
  v_mfma_f32_16x16x32_bf16 v[56:59], v[152:155], v[84:87], v[56:59]
  v_permlane16_swap_b32 v22, v34
  v_mfma_f32_16x16x32_bf16 v[48:51], v[156:159], v[80:83], v[48:51]
  v_permlane16_swap_b32 v23, v35
  v_mfma_f32_16x16x32_bf16 v[60:63], v[156:159], v[84:87], v[60:63]
  s_waitcnt vmcnt(4)
  s_waitcnt lgkmcnt(2)
  v_mfma_f32_16x16x32_bf16 v[40:43], v[160:163], v[64:67], v[40:43]
  ds_read_b128 v[80:83], v5 offset:6144
  s_add_u32 m0, s53, 8192
  v_mfma_f32_16x16x32_bf16 v[52:55], v[160:163], v[68:71], v[52:55]
  ds_read_b128 v[84:87], v5 offset:26624
  s_add_u32 s48, s61, 49152
  v_mfma_f32_16x16x32_bf16 v[44:47], v[164:167], v[64:67], v[44:47]
  buffer_load_dwordx4 v2, s[4:7], s48 offen offset:0 sc1 lds
  v_bitop3_b32 v10, v10, v11, v1 bitop3:0x7e
  v_mfma_f32_16x16x32_bf16 v[56:59], v[164:167], v[68:71], v[56:59]
  v_cmp_ne_u32 vcc, 0, v10
  v_mfma_f32_16x16x32_bf16 v[48:51], v[168:171], v[64:67], v[48:51]
  v_permlane16_swap_b32 v24, v36
  v_mfma_f32_16x16x32_bf16 v[60:63], v[168:171], v[68:71], v[60:63]
  s_waitcnt lgkmcnt(2)
  v_mfma_f32_16x16x32_bf16 v[40:43], v[172:175], v[72:75], v[40:43]
  ds_read_b128 v[64:67], v5 offset:7168
  buffer_load_dwordx4 v2, s[4:7], s48 offen offset:2048 sc1 lds
  v_mfma_f32_16x16x32_bf16 v[52:55], v[172:175], v[76:79], v[52:55]
  ds_read_b128 v[68:71], v5 offset:27648
  v_mfma_f32_16x16x32_bf16 v[44:47], v[176:179], v[72:75], v[44:47]
  v_permlane16_swap_b32 v25, v37
  v_mfma_f32_16x16x32_bf16 v[56:59], v[176:179], v[76:79], v[56:59]
  v_permlane16_swap_b32 v26, v38
  v_mfma_f32_16x16x32_bf16 v[48:51], v[180:183], v[72:75], v[48:51]
  v_permlane16_swap_b32 v27, v39
  v_mfma_f32_16x16x32_bf16 v[60:63], v[180:183], v[76:79], v[60:63]
  s_cbranch_vccz Lsckd_32
Lsck_31:
  s_add_u32 s55, s62, 0
  buffer_load_dwordx4 v[8:11], v7, s[4:7], s55 offen sc1
  s_waitcnt vmcnt(0)
  v_bitop3_b32 v10, v10, v11, v1 bitop3:0x7e
  v_cmp_ne_u32 vcc, 0, v10
  s_nop 1
  s_nop 1
  s_cbranch_vccnz Lsck_31
Lsckd_32:
  s_waitcnt lgkmcnt(2)
  v_mfma_f32_16x16x32_bf16 v[40:43], v[184:187], v[80:83], v[40:43]
  ds_read_b128 v[72:75], v5 offset:8192
  s_add_u32 m0, s53, 12288
  v_mfma_f32_16x16x32_bf16 v[52:55], v[184:187], v[84:87], v[52:55]
  ds_read_b128 v[76:79], v5 offset:28672
  s_add_u32 s48, s61, 53248
  v_mfma_f32_16x16x32_bf16 v[44:47], v[188:191], v[80:83], v[44:47]
  buffer_load_dwordx4 v2, s[4:7], s48 offen offset:0 sc1 lds
  v_fmac_f32 v16, v8, v88
  v_mfma_f32_16x16x32_bf16 v[56:59], v[188:191], v[84:87], v[56:59]
  v_fmac_f32 v17, v8, v89
  v_fmac_f32 v18, v8, v90
  v_mfma_f32_16x16x32_bf16 v[48:51], v[192:195], v[80:83], v[48:51]
  v_fmac_f32 v19, v8, v91
  v_fmac_f32 v20, v8, v92
  v_mfma_f32_16x16x32_bf16 v[60:63], v[192:195], v[84:87], v[60:63]
  v_fmac_f32 v21, v8, v93
  s_waitcnt lgkmcnt(2)
  v_mfma_f32_16x16x32_bf16 v[40:43], v[196:199], v[64:67], v[40:43]
  ds_read_b128 v[80:83], v5 offset:9216
  buffer_load_dwordx4 v2, s[4:7], s48 offen offset:2048 sc1 lds
  v_mfma_f32_16x16x32_bf16 v[52:55], v[196:199], v[68:71], v[52:55]
  ds_read_b128 v[84:87], v5 offset:29696
  v_fmac_f32 v22, v8, v94
  v_mfma_f32_16x16x32_bf16 v[44:47], v[200:203], v[64:67], v[44:47]
  v_fmac_f32 v23, v8, v95
  v_fmac_f32 v24, v8, v96
  v_mfma_f32_16x16x32_bf16 v[56:59], v[200:203], v[68:71], v[56:59]
  v_fmac_f32 v25, v8, v97
  v_fmac_f32 v26, v8, v98
  v_mfma_f32_16x16x32_bf16 v[48:51], v[204:207], v[64:67], v[48:51]
  v_fmac_f32 v27, v8, v99
  v_fmac_f32 v28, v8, v100
  v_mfma_f32_16x16x32_bf16 v[60:63], v[204:207], v[68:71], v[60:63]
  v_fmac_f32 v29, v8, v101
  s_waitcnt lgkmcnt(2)
  v_mfma_f32_16x16x32_bf16 v[40:43], v[208:211], v[72:75], v[40:43]
  ds_read_b128 v[64:67], v5 offset:10240
  s_add_u32 m0, s53, 16384
  v_mfma_f32_16x16x32_bf16 v[52:55], v[208:211], v[76:79], v[52:55]
  ds_read_b128 v[68:71], v5 offset:30720
  s_add_u32 s48, s61, 57344
  v_mfma_f32_16x16x32_bf16 v[44:47], v[212:215], v[72:75], v[44:47]
  buffer_load_dwordx4 v2, s[4:7], s48 offen offset:0 sc1 lds
  v_fmac_f32 v30, v8, v102
  v_mfma_f32_16x16x32_bf16 v[56:59], v[212:215], v[76:79], v[56:59]
  v_fmac_f32 v31, v8, v103
  v_fmac_f32 v32, v8, v104
  v_mfma_f32_16x16x32_bf16 v[48:51], v[216:219], v[72:75], v[48:51]
  v_fmac_f32 v33, v8, v105
  v_fmac_f32 v34, v8, v106
  v_mfma_f32_16x16x32_bf16 v[60:63], v[216:219], v[76:79], v[60:63]
  v_fmac_f32 v35, v8, v107
  s_waitcnt lgkmcnt(2)
  v_mfma_f32_16x16x32_bf16 v[40:43], v[220:223], v[80:83], v[40:43]
  ds_read_b128 v[72:75], v5 offset:11264
  buffer_load_dwordx4 v2, s[4:7], s48 offen offset:2048 sc1 lds
  v_mfma_f32_16x16x32_bf16 v[52:55], v[220:223], v[84:87], v[52:55]
  ds_read_b128 v[76:79], v5 offset:31744
  v_fmac_f32 v36, v8, v108
  v_mfma_f32_16x16x32_bf16 v[44:47], v[224:227], v[80:83], v[44:47]
  v_fmac_f32 v37, v8, v109
  v_fmac_f32 v38, v8, v110
  v_mfma_f32_16x16x32_bf16 v[56:59], v[224:227], v[84:87], v[56:59]
  v_fmac_f32 v39, v8, v111
  v_max_f32 v16, 0, v16
  v_mfma_f32_16x16x32_bf16 v[48:51], v[228:231], v[80:83], v[48:51]
  v_mul_f32 v28, v9, v28
  v_max_f32 v17, 0, v17
  v_mfma_f32_16x16x32_bf16 v[60:63], v[228:231], v[84:87], v[60:63]
  v_mul_f32 v29, v9, v29
  s_waitcnt lgkmcnt(2)
  v_mfma_f32_16x16x32_bf16 v[40:43], v[232:235], v[64:67], v[40:43]
  ds_read_b128 v[80:83], v5 offset:12288
  v_max_f32 v18, 0, v18
  v_mfma_f32_16x16x32_bf16 v[52:55], v[232:235], v[68:71], v[52:55]
  ds_read_b128 v[84:87], v5 offset:32768
  v_mul_f32 v30, v9, v30
  v_mfma_f32_16x16x32_bf16 v[44:47], v[236:239], v[64:67], v[44:47]
  v_max_f32 v19, 0, v19
  v_mul_f32 v31, v9, v31
  v_mfma_f32_16x16x32_bf16 v[56:59], v[236:239], v[68:71], v[56:59]
  v_max_f32 v20, 0, v20
  v_mul_f32 v32, v9, v32
  v_mfma_f32_16x16x32_bf16 v[48:51], v[240:243], v[64:67], v[48:51]
  v_max_f32 v21, 0, v21
  v_mul_f32 v33, v9, v33
  v_mfma_f32_16x16x32_bf16 v[60:63], v[240:243], v[68:71], v[60:63]
  v_max_f32 v22, 0, v22
  s_waitcnt lgkmcnt(2)
  v_mfma_f32_16x16x32_bf16 v[40:43], v[244:247], v[72:75], v[40:43]
  ds_read_b128 v[64:67], v5 offset:13312
  v_mul_f32 v34, v9, v34
  v_mfma_f32_16x16x32_bf16 v[52:55], v[244:247], v[76:79], v[52:55]
  ds_read_b128 v[68:71], v5 offset:33792
  v_max_f32 v23, 0, v23
  v_mfma_f32_16x16x32_bf16 v[44:47], v[248:251], v[72:75], v[44:47]
  v_mul_f32 v35, v9, v35
  v_max_f32 v24, 0, v24
  v_mfma_f32_16x16x32_bf16 v[56:59], v[248:251], v[76:79], v[56:59]
  v_mul_f32 v36, v9, v36
  v_max_f32 v25, 0, v25
  v_mfma_f32_16x16x32_bf16 v[48:51], v[252:255], v[72:75], v[48:51]
  v_mul_f32 v37, v9, v37
  v_max_f32 v26, 0, v26
  v_mfma_f32_16x16x32_bf16 v[60:63], v[252:255], v[76:79], v[60:63]
  v_mul_f32 v38, v9, v38
  s_waitcnt lgkmcnt(2)
  v_mfma_f32_16x16x32_bf16 v[40:43], a[0:3], v[80:83], v[40:43]
  ds_read_b128 v[72:75], v5 offset:14336
  s_add_u32 s55, s62, 1024
  v_mfma_f32_16x16x32_bf16 v[52:55], a[0:3], v[84:87], v[52:55]
  ds_read_b128 v[76:79], v5 offset:34816
  buffer_load_dwordx4 v[12:15], v7, s[4:7], s55 offen sc1
  v_mfma_f32_16x16x32_bf16 v[44:47], a[4:7], v[80:83], v[44:47]
  v_max_f32 v27, 0, v27
  v_mul_f32 v39, v9, v39
  v_mfma_f32_16x16x32_bf16 v[56:59], a[4:7], v[84:87], v[56:59]
  v_mul_f32 v16, v16, v28
  v_mul_f32 v17, v17, v29
  v_mfma_f32_16x16x32_bf16 v[48:51], a[8:11], v[80:83], v[48:51]
  v_mul_f32 v18, v18, v30
  v_mul_f32 v19, v19, v31
  v_mfma_f32_16x16x32_bf16 v[60:63], a[8:11], v[84:87], v[60:63]
  v_mul_f32 v20, v20, v32
  s_waitcnt lgkmcnt(2)
  v_mfma_f32_16x16x32_bf16 v[40:43], a[12:15], v[64:67], v[40:43]
  ds_read_b128 v[80:83], v5 offset:15360
  v_mul_f32 v21, v21, v33
  v_mfma_f32_16x16x32_bf16 v[52:55], a[12:15], v[68:71], v[52:55]
  ds_read_b128 v[84:87], v5 offset:35840
  v_mul_f32 v22, v22, v34
  v_mfma_f32_16x16x32_bf16 v[44:47], a[16:19], v[64:67], v[44:47]
  v_mul_f32 v23, v23, v35
  v_mul_f32 v24, v24, v36
  v_mfma_f32_16x16x32_bf16 v[56:59], a[16:19], v[68:71], v[56:59]
  v_mul_f32 v25, v25, v37
  v_mul_f32 v26, v26, v38
  v_mfma_f32_16x16x32_bf16 v[48:51], a[20:23], v[64:67], v[48:51]
  v_mul_f32 v27, v27, v39
  v_cvt_pk_bf16_f32 v28, v16, v17
  v_mfma_f32_16x16x32_bf16 v[60:63], a[20:23], v[68:71], v[60:63]
  v_cvt_pk_bf16_f32 v29, v18, v19
  s_waitcnt lgkmcnt(2)
  v_mfma_f32_16x16x32_bf16 v[40:43], a[24:27], v[72:75], v[40:43]
  ds_read_b128 v[64:67], v5 offset:16384
  v_cvt_pk_bf16_f32 v30, v20, v21
  v_mfma_f32_16x16x32_bf16 v[52:55], a[24:27], v[76:79], v[52:55]
  ds_read_b128 v[68:71], v5 offset:36864
  v_cvt_pk_bf16_f32 v31, v22, v23
  v_mfma_f32_16x16x32_bf16 v[44:47], a[28:31], v[72:75], v[44:47]
  v_cvt_pk_bf16_f32 v32, v24, v25
  v_cvt_pk_bf16_f32 v33, v26, v27
  v_mfma_f32_16x16x32_bf16 v[56:59], a[28:31], v[76:79], v[56:59]
  s_add_u32 s49, s52, 0
  buffer_store_dwordx4 v[28:31], v3, s[4:7], s49 offen sc1
  v_mfma_f32_16x16x32_bf16 v[48:51], a[32:35], v[72:75], v[48:51]
  buffer_store_dwordx2 v[32:33], v4, s[4:7], s49 offen sc1
  v_mfma_f32_16x16x32_bf16 v[60:63], a[32:35], v[76:79], v[60:63]
  s_waitcnt lgkmcnt(2)
  v_mfma_f32_16x16x32_bf16 v[40:43], a[36:39], v[80:83], v[40:43]
  ds_read_b128 v[72:75], v5 offset:17408
  v_mfma_f32_16x16x32_bf16 v[52:55], a[36:39], v[84:87], v[52:55]
  ds_read_b128 v[76:79], v5 offset:37888
  v_mfma_f32_16x16x32_bf16 v[44:47], a[40:43], v[80:83], v[44:47]
  v_mfma_f32_16x16x32_bf16 v[56:59], a[40:43], v[84:87], v[56:59]
  v_mfma_f32_16x16x32_bf16 v[48:51], a[44:47], v[80:83], v[48:51]
  v_mfma_f32_16x16x32_bf16 v[60:63], a[44:47], v[84:87], v[60:63]
  s_waitcnt lgkmcnt(2)
  v_mfma_f32_16x16x32_bf16 v[40:43], a[48:51], v[64:67], v[40:43]
  ds_read_b128 v[80:83], v5 offset:18432
  v_mfma_f32_16x16x32_bf16 v[52:55], a[48:51], v[68:71], v[52:55]
  ds_read_b128 v[84:87], v5 offset:38912
  v_mfma_f32_16x16x32_bf16 v[44:47], a[52:55], v[64:67], v[44:47]
  v_mfma_f32_16x16x32_bf16 v[56:59], a[52:55], v[68:71], v[56:59]
  v_mfma_f32_16x16x32_bf16 v[48:51], a[56:59], v[64:67], v[48:51]
  v_mfma_f32_16x16x32_bf16 v[60:63], a[56:59], v[68:71], v[60:63]
  s_waitcnt lgkmcnt(2)
  v_mfma_f32_16x16x32_bf16 v[40:43], a[60:63], v[72:75], v[40:43]
  ds_read_b128 v[64:67], v5 offset:19456
  v_mfma_f32_16x16x32_bf16 v[52:55], a[60:63], v[76:79], v[52:55]
  ds_read_b128 v[68:71], v5 offset:39936
  v_mfma_f32_16x16x32_bf16 v[44:47], a[64:67], v[72:75], v[44:47]
  v_mfma_f32_16x16x32_bf16 v[56:59], a[64:67], v[76:79], v[56:59]
  v_mfma_f32_16x16x32_bf16 v[48:51], a[68:71], v[72:75], v[48:51]
  v_mfma_f32_16x16x32_bf16 v[60:63], a[68:71], v[76:79], v[60:63]
  s_waitcnt lgkmcnt(2)
  v_mfma_f32_16x16x32_bf16 v[40:43], a[72:75], v[80:83], v[40:43]
  s_waitcnt vmcnt(3) lgkmcnt(0)
  s_barrier
  ds_read_b128 v[72:75], v2 offset:0
  v_mfma_f32_16x16x32_bf16 v[52:55], a[72:75], v[84:87], v[52:55]
  ds_read_b128 v[76:79], v2 offset:20480
  v_mfma_f32_16x16x32_bf16 v[44:47], a[76:79], v[80:83], v[44:47]
  v_mfma_f32_16x16x32_bf16 v[56:59], a[76:79], v[84:87], v[56:59]
  v_mfma_f32_16x16x32_bf16 v[48:51], a[80:83], v[80:83], v[48:51]
  v_mfma_f32_16x16x32_bf16 v[60:63], a[80:83], v[84:87], v[60:63]
  s_waitcnt lgkmcnt(2)
  v_mfma_f32_16x16x32_bf16 v[40:43], a[84:87], v[64:67], v[40:43]
  ds_read_b128 v[80:83], v2 offset:1024
  v_mfma_f32_16x16x32_bf16 v[52:55], a[84:87], v[68:71], v[52:55]
  ds_read_b128 v[84:87], v2 offset:21504
  v_mfma_f32_16x16x32_bf16 v[44:47], a[88:91], v[64:67], v[44:47]
  v_mfma_f32_16x16x32_bf16 v[56:59], a[88:91], v[68:71], v[56:59]
  v_mfma_f32_16x16x32_bf16 v[48:51], a[92:95], v[64:67], v[48:51]
  v_mfma_f32_16x16x32_bf16 v[60:63], a[92:95], v[68:71], v[60:63]
  s_waitcnt lgkmcnt(2)
  v_mfma_f32_16x16x32_bf16 v[16:19], v[112:115], v[72:75], 0
  ds_read_b128 v[64:67], v2 offset:2048
  v_mfma_f32_16x16x32_bf16 v[28:31], v[112:115], v[76:79], 0
  ds_read_b128 v[68:71], v2 offset:22528
  v_mfma_f32_16x16x32_bf16 v[20:23], v[116:119], v[72:75], 0
  v_mfma_f32_16x16x32_bf16 v[32:35], v[116:119], v[76:79], 0
  v_mfma_f32_16x16x32_bf16 v[24:27], v[120:123], v[72:75], 0
  v_mfma_f32_16x16x32_bf16 v[36:39], v[120:123], v[76:79], 0
  s_waitcnt lgkmcnt(2)
  v_mfma_f32_16x16x32_bf16 v[16:19], v[124:127], v[80:83], v[16:19]
  ds_read_b128 v[72:75], v2 offset:3072
  v_mfma_f32_16x16x32_bf16 v[28:31], v[124:127], v[84:87], v[28:31]
  ds_read_b128 v[76:79], v2 offset:23552
  v_mfma_f32_16x16x32_bf16 v[20:23], v[128:131], v[80:83], v[20:23]
  v_permlane16_swap_b32 v40, v52
  v_mfma_f32_16x16x32_bf16 v[32:35], v[128:131], v[84:87], v[32:35]
  v_permlane16_swap_b32 v41, v53
  v_mfma_f32_16x16x32_bf16 v[24:27], v[132:135], v[80:83], v[24:27]
  v_permlane16_swap_b32 v42, v54
  v_mfma_f32_16x16x32_bf16 v[36:39], v[132:135], v[84:87], v[36:39]
  s_waitcnt lgkmcnt(2)
  v_mfma_f32_16x16x32_bf16 v[16:19], v[136:139], v[64:67], v[16:19]
  ds_read_b128 v[80:83], v2 offset:4096
  v_mfma_f32_16x16x32_bf16 v[28:31], v[136:139], v[68:71], v[28:31]
  ds_read_b128 v[84:87], v2 offset:24576
  v_mfma_f32_16x16x32_bf16 v[20:23], v[140:143], v[64:67], v[20:23]
  v_permlane16_swap_b32 v43, v55
  v_mfma_f32_16x16x32_bf16 v[32:35], v[140:143], v[68:71], v[32:35]
  v_permlane16_swap_b32 v44, v56
  v_mfma_f32_16x16x32_bf16 v[24:27], v[144:147], v[64:67], v[24:27]
  v_permlane16_swap_b32 v45, v57
  v_mfma_f32_16x16x32_bf16 v[36:39], v[144:147], v[68:71], v[36:39]
  s_waitcnt lgkmcnt(2)
  v_mfma_f32_16x16x32_bf16 v[16:19], v[148:151], v[72:75], v[16:19]
  ds_read_b128 v[64:67], v2 offset:5120
  v_mfma_f32_16x16x32_bf16 v[28:31], v[148:151], v[76:79], v[28:31]
  ds_read_b128 v[68:71], v2 offset:25600
  v_mfma_f32_16x16x32_bf16 v[20:23], v[152:155], v[72:75], v[20:23]
  v_permlane16_swap_b32 v46, v58
  v_mfma_f32_16x16x32_bf16 v[32:35], v[152:155], v[76:79], v[32:35]
  v_permlane16_swap_b32 v47, v59
  v_mfma_f32_16x16x32_bf16 v[24:27], v[156:159], v[72:75], v[24:27]
  s_waitcnt vmcnt(2)
  v_bitop3_b32 v14, v14, v15, v1 bitop3:0x7e
  v_mfma_f32_16x16x32_bf16 v[36:39], v[156:159], v[76:79], v[36:39]
  v_cmp_ne_u32 vcc, 0, v14
  s_waitcnt lgkmcnt(2)
  v_mfma_f32_16x16x32_bf16 v[16:19], v[160:163], v[80:83], v[16:19]
  ds_read_b128 v[72:75], v2 offset:6144
  v_mfma_f32_16x16x32_bf16 v[28:31], v[160:163], v[84:87], v[28:31]
  ds_read_b128 v[76:79], v2 offset:26624
  v_mfma_f32_16x16x32_bf16 v[20:23], v[164:167], v[80:83], v[20:23]
  v_permlane16_swap_b32 v48, v60
  v_mfma_f32_16x16x32_bf16 v[32:35], v[164:167], v[84:87], v[32:35]
  v_permlane16_swap_b32 v49, v61
  v_mfma_f32_16x16x32_bf16 v[24:27], v[168:171], v[80:83], v[24:27]
  v_permlane16_swap_b32 v50, v62
  v_mfma_f32_16x16x32_bf16 v[36:39], v[168:171], v[84:87], v[36:39]
  s_waitcnt lgkmcnt(2)
  v_mfma_f32_16x16x32_bf16 v[16:19], v[172:175], v[64:67], v[16:19]
  ds_read_b128 v[80:83], v2 offset:7168
  v_mfma_f32_16x16x32_bf16 v[28:31], v[172:175], v[68:71], v[28:31]
  ds_read_b128 v[84:87], v2 offset:27648
  v_mfma_f32_16x16x32_bf16 v[20:23], v[176:179], v[64:67], v[20:23]
  v_permlane16_swap_b32 v51, v63
  v_mfma_f32_16x16x32_bf16 v[32:35], v[176:179], v[68:71], v[32:35]
  s_cbranch_vccz Lsckd_34
Lsck_33:
  s_add_u32 s55, s62, 1024
  buffer_load_dwordx4 v[12:15], v7, s[4:7], s55 offen sc1
  s_waitcnt vmcnt(0)
  v_bitop3_b32 v14, v14, v15, v1 bitop3:0x7e
  v_cmp_ne_u32 vcc, 0, v14
  s_nop 1
  s_nop 1
  s_cbranch_vccnz Lsck_33
Lsckd_34:
  v_fmac_f32 v40, v12, v88
  v_mfma_f32_16x16x32_bf16 v[24:27], v[180:183], v[64:67], v[24:27]
  v_fmac_f32 v41, v12, v89
  v_fmac_f32 v42, v12, v90
  v_mfma_f32_16x16x32_bf16 v[36:39], v[180:183], v[68:71], v[36:39]
  v_fmac_f32 v43, v12, v91
  s_waitcnt lgkmcnt(2)
  v_mfma_f32_16x16x32_bf16 v[16:19], v[184:187], v[72:75], v[16:19]
  ds_read_b128 v[64:67], v2 offset:8192
  s_add_u32 m0, s53, 40960
  v_mfma_f32_16x16x32_bf16 v[28:31], v[184:187], v[76:79], v[28:31]
  ds_read_b128 v[68:71], v2 offset:28672
  s_add_u32 s48, s51, 122880
  v_mfma_f32_16x16x32_bf16 v[20:23], v[188:191], v[72:75], v[20:23]
  buffer_load_dwordx4 v2, s[4:7], s48 offen offset:0 sc1 lds
  buffer_load_dwordx4 v2, s[4:7], s48 offen offset:2048 sc1 lds
  v_mfma_f32_16x16x32_bf16 v[32:35], v[188:191], v[76:79], v[32:35]
  v_fmac_f32 v44, v12, v92
  v_fmac_f32 v45, v12, v93
  v_mfma_f32_16x16x32_bf16 v[24:27], v[192:195], v[72:75], v[24:27]
  v_fmac_f32 v46, v12, v94
  v_fmac_f32 v47, v12, v95
  v_mfma_f32_16x16x32_bf16 v[36:39], v[192:195], v[76:79], v[36:39]
  v_fmac_f32 v48, v12, v96
  s_waitcnt lgkmcnt(2)
  v_mfma_f32_16x16x32_bf16 v[16:19], v[196:199], v[80:83], v[16:19]
  ds_read_b128 v[72:75], v2 offset:9216
  s_add_u32 m0, s53, 45056
  v_mfma_f32_16x16x32_bf16 v[28:31], v[196:199], v[84:87], v[28:31]
  ds_read_b128 v[76:79], v2 offset:29696
  s_add_u32 s48, s51, 126976
  v_mfma_f32_16x16x32_bf16 v[20:23], v[200:203], v[80:83], v[20:23]
  buffer_load_dwordx4 v2, s[4:7], s48 offen offset:0 sc1 lds
  v_fmac_f32 v49, v12, v97
  v_mfma_f32_16x16x32_bf16 v[32:35], v[200:203], v[84:87], v[32:35]
  v_fmac_f32 v50, v12, v98
  v_fmac_f32 v51, v12, v99
  v_mfma_f32_16x16x32_bf16 v[24:27], v[204:207], v[80:83], v[24:27]
  v_fmac_f32 v52, v12, v100
  v_fmac_f32 v53, v12, v101
  v_mfma_f32_16x16x32_bf16 v[36:39], v[204:207], v[84:87], v[36:39]
  v_fmac_f32 v54, v12, v102
  s_waitcnt lgkmcnt(2)
  v_mfma_f32_16x16x32_bf16 v[16:19], v[208:211], v[64:67], v[16:19]
  ds_read_b128 v[80:83], v2 offset:10240
  buffer_load_dwordx4 v2, s[4:7], s48 offen offset:2048 sc1 lds
  v_mfma_f32_16x16x32_bf16 v[28:31], v[208:211], v[68:71], v[28:31]
  ds_read_b128 v[84:87], v2 offset:30720
  v_fmac_f32 v55, v12, v103
  v_mfma_f32_16x16x32_bf16 v[20:23], v[212:215], v[64:67], v[20:23]
  v_fmac_f32 v56, v12, v104
  v_fmac_f32 v57, v12, v105
  v_mfma_f32_16x16x32_bf16 v[32:35], v[212:215], v[68:71], v[32:35]
  v_fmac_f32 v58, v12, v106
  v_fmac_f32 v59, v12, v107
  v_mfma_f32_16x16x32_bf16 v[24:27], v[216:219], v[64:67], v[24:27]
  v_fmac_f32 v60, v12, v108
  v_fmac_f32 v61, v12, v109
  v_mfma_f32_16x16x32_bf16 v[36:39], v[216:219], v[68:71], v[36:39]
  v_fmac_f32 v62, v12, v110
  s_waitcnt lgkmcnt(2)
  v_mfma_f32_16x16x32_bf16 v[16:19], v[220:223], v[72:75], v[16:19]
  ds_read_b128 v[64:67], v2 offset:11264
  s_add_u32 m0, s53, 49152
  v_mfma_f32_16x16x32_bf16 v[28:31], v[220:223], v[76:79], v[28:31]
  ds_read_b128 v[68:71], v2 offset:31744
  s_add_u32 s48, s61, 131072
  v_mfma_f32_16x16x32_bf16 v[20:23], v[224:227], v[72:75], v[20:23]
  buffer_load_dwordx4 v2, s[4:7], s48 offen offset:0 sc1 lds
  v_fmac_f32 v63, v12, v111
  v_mfma_f32_16x16x32_bf16 v[32:35], v[224:227], v[76:79], v[32:35]
  v_max_f32 v40, 0, v40
  v_mul_f32 v52, v13, v52
  v_mfma_f32_16x16x32_bf16 v[24:27], v[228:231], v[72:75], v[24:27]
  v_max_f32 v41, 0, v41
  v_mul_f32 v53, v13, v53
  v_mfma_f32_16x16x32_bf16 v[36:39], v[228:231], v[76:79], v[36:39]
  v_max_f32 v42, 0, v42
  s_waitcnt lgkmcnt(2)
  v_mfma_f32_16x16x32_bf16 v[16:19], v[232:235], v[80:83], v[16:19]
  ds_read_b128 v[72:75], v2 offset:12288
  buffer_load_dwordx4 v2, s[4:7], s48 offen offset:2048 sc1 lds
  v_mfma_f32_16x16x32_bf16 v[28:31], v[232:235], v[84:87], v[28:31]
  ds_read_b128 v[76:79], v2 offset:32768
  v_mul_f32 v54, v13, v54
  v_mfma_f32_16x16x32_bf16 v[20:23], v[236:239], v[80:83], v[20:23]
  v_max_f32 v43, 0, v43
  v_mul_f32 v55, v13, v55
  v_mfma_f32_16x16x32_bf16 v[32:35], v[236:239], v[84:87], v[32:35]
  v_max_f32 v44, 0, v44
  v_mul_f32 v56, v13, v56
  v_mfma_f32_16x16x32_bf16 v[24:27], v[240:243], v[80:83], v[24:27]
  v_max_f32 v45, 0, v45
  v_mul_f32 v57, v13, v57
  v_mfma_f32_16x16x32_bf16 v[36:39], v[240:243], v[84:87], v[36:39]
  v_max_f32 v46, 0, v46
  s_waitcnt lgkmcnt(2)
  v_mfma_f32_16x16x32_bf16 v[16:19], v[244:247], v[64:67], v[16:19]
  ds_read_b128 v[80:83], v2 offset:13312
  s_add_u32 m0, s53, 53248
  v_mfma_f32_16x16x32_bf16 v[28:31], v[244:247], v[68:71], v[28:31]
  ds_read_b128 v[84:87], v2 offset:33792
  s_add_u32 s48, s61, 135168
  v_mfma_f32_16x16x32_bf16 v[20:23], v[248:251], v[64:67], v[20:23]
  buffer_load_dwordx4 v2, s[4:7], s48 offen offset:0 sc1 lds
  v_mul_f32 v58, v13, v58
  v_mfma_f32_16x16x32_bf16 v[32:35], v[248:251], v[68:71], v[32:35]
  v_max_f32 v47, 0, v47
  v_mul_f32 v59, v13, v59
  v_mfma_f32_16x16x32_bf16 v[24:27], v[252:255], v[64:67], v[24:27]
  v_max_f32 v48, 0, v48
  v_mul_f32 v60, v13, v60
  v_mfma_f32_16x16x32_bf16 v[36:39], v[252:255], v[68:71], v[36:39]
  v_max_f32 v49, 0, v49
  s_waitcnt lgkmcnt(2)
  v_mfma_f32_16x16x32_bf16 v[16:19], a[0:3], v[72:75], v[16:19]
  ds_read_b128 v[64:67], v2 offset:14336
  buffer_load_dwordx4 v2, s[4:7], s48 offen offset:2048 sc1 lds
  v_mfma_f32_16x16x32_bf16 v[28:31], a[0:3], v[76:79], v[28:31]
  ds_read_b128 v[68:71], v2 offset:34816
  v_mul_f32 v61, v13, v61
  v_mfma_f32_16x16x32_bf16 v[20:23], a[4:7], v[72:75], v[20:23]
  v_max_f32 v50, 0, v50
  v_mul_f32 v62, v13, v62
  v_mfma_f32_16x16x32_bf16 v[32:35], a[4:7], v[76:79], v[32:35]
  v_max_f32 v51, 0, v51
  v_mul_f32 v63, v13, v63
  v_mfma_f32_16x16x32_bf16 v[24:27], a[8:11], v[72:75], v[24:27]
  v_mul_f32 v40, v40, v52
  v_mul_f32 v41, v41, v53
  v_mfma_f32_16x16x32_bf16 v[36:39], a[8:11], v[76:79], v[36:39]
  v_mul_f32 v42, v42, v54
  s_waitcnt lgkmcnt(2)
  v_mfma_f32_16x16x32_bf16 v[16:19], a[12:15], v[80:83], v[16:19]
  ds_read_b128 v[72:75], v2 offset:15360
  s_add_u32 m0, s53, 57344
  v_mfma_f32_16x16x32_bf16 v[28:31], a[12:15], v[84:87], v[28:31]
  ds_read_b128 v[76:79], v2 offset:35840
  s_add_u32 s48, s61, 139264
  v_mfma_f32_16x16x32_bf16 v[20:23], a[16:19], v[80:83], v[20:23]
  buffer_load_dwordx4 v2, s[4:7], s48 offen offset:0 sc1 lds
  v_mul_f32 v43, v43, v55
  v_mfma_f32_16x16x32_bf16 v[32:35], a[16:19], v[84:87], v[32:35]
  v_mul_f32 v44, v44, v56
  v_mul_f32 v45, v45, v57
  v_mfma_f32_16x16x32_bf16 v[24:27], a[20:23], v[80:83], v[24:27]
  v_mul_f32 v46, v46, v58
  v_mul_f32 v47, v47, v59
  v_mfma_f32_16x16x32_bf16 v[36:39], a[20:23], v[84:87], v[36:39]
  v_mul_f32 v48, v48, v60
  s_waitcnt lgkmcnt(2)
  v_mfma_f32_16x16x32_bf16 v[16:19], a[24:27], v[64:67], v[16:19]
  ds_read_b128 v[80:83], v2 offset:16384
  buffer_load_dwordx4 v2, s[4:7], s48 offen offset:2048 sc1 lds
  v_mfma_f32_16x16x32_bf16 v[28:31], a[24:27], v[68:71], v[28:31]
  ds_read_b128 v[84:87], v2 offset:36864
  v_mul_f32 v49, v49, v61
  v_mfma_f32_16x16x32_bf16 v[20:23], a[28:31], v[64:67], v[20:23]
  v_mul_f32 v50, v50, v62
  v_mul_f32 v51, v51, v63
  v_mfma_f32_16x16x32_bf16 v[32:35], a[28:31], v[68:71], v[32:35]
  v_cvt_pk_bf16_f32 v52, v40, v41
  v_cvt_pk_bf16_f32 v53, v42, v43
  v_mfma_f32_16x16x32_bf16 v[24:27], a[32:35], v[64:67], v[24:27]
  v_cvt_pk_bf16_f32 v54, v44, v45
  v_cvt_pk_bf16_f32 v55, v46, v47
  v_mfma_f32_16x16x32_bf16 v[36:39], a[32:35], v[68:71], v[36:39]
  v_cvt_pk_bf16_f32 v56, v48, v49
  s_waitcnt lgkmcnt(2)
  v_mfma_f32_16x16x32_bf16 v[16:19], a[36:39], v[72:75], v[16:19]
  ds_read_b128 v[64:67], v2 offset:17408
  s_add_u32 s55, s62, 512
  v_mfma_f32_16x16x32_bf16 v[28:31], a[36:39], v[76:79], v[28:31]
  ds_read_b128 v[68:71], v2 offset:37888
  buffer_load_dwordx4 v[8:11], v7, s[4:7], s55 offen sc1
  v_mfma_f32_16x16x32_bf16 v[20:23], a[40:43], v[72:75], v[20:23]
  v_cvt_pk_bf16_f32 v57, v50, v51
  s_add_u32 s49, s52, 196608
  v_mfma_f32_16x16x32_bf16 v[32:35], a[40:43], v[76:79], v[32:35]
  buffer_store_dwordx4 v[52:55], v3, s[4:7], s49 offen sc1
  buffer_store_dwordx2 v[56:57], v4, s[4:7], s49 offen sc1
  v_mfma_f32_16x16x32_bf16 v[24:27], a[44:47], v[72:75], v[24:27]
  v_mfma_f32_16x16x32_bf16 v[36:39], a[44:47], v[76:79], v[36:39]
  s_waitcnt lgkmcnt(2)
  v_mfma_f32_16x16x32_bf16 v[16:19], a[48:51], v[80:83], v[16:19]
  ds_read_b128 v[72:75], v2 offset:18432
  v_mfma_f32_16x16x32_bf16 v[28:31], a[48:51], v[84:87], v[28:31]
  ds_read_b128 v[76:79], v2 offset:38912
  v_mfma_f32_16x16x32_bf16 v[20:23], a[52:55], v[80:83], v[20:23]
  v_mfma_f32_16x16x32_bf16 v[32:35], a[52:55], v[84:87], v[32:35]
  v_mfma_f32_16x16x32_bf16 v[24:27], a[56:59], v[80:83], v[24:27]
  v_mfma_f32_16x16x32_bf16 v[36:39], a[56:59], v[84:87], v[36:39]
  s_waitcnt lgkmcnt(2)
  v_mfma_f32_16x16x32_bf16 v[16:19], a[60:63], v[64:67], v[16:19]
  ds_read_b128 v[80:83], v2 offset:19456
  v_mfma_f32_16x16x32_bf16 v[28:31], a[60:63], v[68:71], v[28:31]
  ds_read_b128 v[84:87], v2 offset:39936
  v_mfma_f32_16x16x32_bf16 v[20:23], a[64:67], v[64:67], v[20:23]
  v_mfma_f32_16x16x32_bf16 v[32:35], a[64:67], v[68:71], v[32:35]
  v_mfma_f32_16x16x32_bf16 v[24:27], a[68:71], v[64:67], v[24:27]
  v_mfma_f32_16x16x32_bf16 v[36:39], a[68:71], v[68:71], v[36:39]
  s_waitcnt lgkmcnt(2)
  v_mfma_f32_16x16x32_bf16 v[16:19], a[72:75], v[72:75], v[16:19]
  s_waitcnt vmcnt(3) lgkmcnt(0)
  s_barrier
  ds_read_b128 v[64:67], v5 offset:0
  v_mfma_f32_16x16x32_bf16 v[28:31], a[72:75], v[76:79], v[28:31]
  ds_read_b128 v[68:71], v5 offset:20480
  v_mfma_f32_16x16x32_bf16 v[20:23], a[76:79], v[72:75], v[20:23]
  v_mfma_f32_16x16x32_bf16 v[32:35], a[76:79], v[76:79], v[32:35]
  v_mfma_f32_16x16x32_bf16 v[24:27], a[80:83], v[72:75], v[24:27]
  v_mfma_f32_16x16x32_bf16 v[36:39], a[80:83], v[76:79], v[36:39]
  s_waitcnt lgkmcnt(2)
  v_mfma_f32_16x16x32_bf16 v[16:19], a[84:87], v[80:83], v[16:19]
  ds_read_b128 v[72:75], v5 offset:1024
  v_mfma_f32_16x16x32_bf16 v[28:31], a[84:87], v[84:87], v[28:31]
  ds_read_b128 v[76:79], v5 offset:21504
  v_mfma_f32_16x16x32_bf16 v[20:23], a[88:91], v[80:83], v[20:23]
  v_mfma_f32_16x16x32_bf16 v[32:35], a[88:91], v[84:87], v[32:35]
  v_mfma_f32_16x16x32_bf16 v[24:27], a[92:95], v[80:83], v[24:27]
  v_mfma_f32_16x16x32_bf16 v[36:39], a[92:95], v[84:87], v[36:39]
  s_waitcnt lgkmcnt(2)
  v_mfma_f32_16x16x32_bf16 v[40:43], v[112:115], v[64:67], 0
  ds_read_b128 v[80:83], v5 offset:2048
  v_mfma_f32_16x16x32_bf16 v[52:55], v[112:115], v[68:71], 0
  ds_read_b128 v[84:87], v5 offset:22528
  v_mfma_f32_16x16x32_bf16 v[44:47], v[116:119], v[64:67], 0
  v_mfma_f32_16x16x32_bf16 v[56:59], v[116:119], v[68:71], 0
  v_mfma_f32_16x16x32_bf16 v[48:51], v[120:123], v[64:67], 0
  v_mfma_f32_16x16x32_bf16 v[60:63], v[120:123], v[68:71], 0
  s_waitcnt lgkmcnt(2)
  v_mfma_f32_16x16x32_bf16 v[40:43], v[124:127], v[72:75], v[40:43]
  ds_read_b128 v[64:67], v5 offset:3072
  v_mfma_f32_16x16x32_bf16 v[52:55], v[124:127], v[76:79], v[52:55]
  ds_read_b128 v[68:71], v5 offset:23552
  v_mfma_f32_16x16x32_bf16 v[44:47], v[128:131], v[72:75], v[44:47]
  v_permlane16_swap_b32 v16, v28
  v_mfma_f32_16x16x32_bf16 v[56:59], v[128:131], v[76:79], v[56:59]
  v_permlane16_swap_b32 v17, v29
  v_mfma_f32_16x16x32_bf16 v[48:51], v[132:135], v[72:75], v[48:51]
  v_permlane16_swap_b32 v18, v30
  v_mfma_f32_16x16x32_bf16 v[60:63], v[132:135], v[76:79], v[60:63]
  s_waitcnt lgkmcnt(2)
  v_mfma_f32_16x16x32_bf16 v[40:43], v[136:139], v[80:83], v[40:43]
  ds_read_b128 v[72:75], v5 offset:4096
  v_mfma_f32_16x16x32_bf16 v[52:55], v[136:139], v[84:87], v[52:55]
  ds_read_b128 v[76:79], v5 offset:24576
  v_mfma_f32_16x16x32_bf16 v[44:47], v[140:143], v[80:83], v[44:47]
  s_waitcnt vmcnt(0)
  s_add_u32 s46, s64, 32768
  s_mov_b64 exec, 1
  buffer_store_dword v1, off, s[4:7], s46
  s_mov_b64 exec, -1
  v_mfma_f32_16x16x32_bf16 v[56:59], v[140:143], v[84:87], v[56:59]
  v_permlane16_swap_b32 v19, v31
  v_mfma_f32_16x16x32_bf16 v[48:51], v[144:147], v[80:83], v[48:51]
  v_permlane16_swap_b32 v20, v32
  v_mfma_f32_16x16x32_bf16 v[60:63], v[144:147], v[84:87], v[60:63]
  s_waitcnt lgkmcnt(2)
  v_mfma_f32_16x16x32_bf16 v[40:43], v[148:151], v[64:67], v[40:43]
  ds_read_b128 v[80:83], v5 offset:5120
  v_mfma_f32_16x16x32_bf16 v[52:55], v[148:151], v[68:71], v[52:55]
  ds_read_b128 v[84:87], v5 offset:25600
  v_mfma_f32_16x16x32_bf16 v[44:47], v[152:155], v[64:67], v[44:47]
  v_permlane16_swap_b32 v21, v33
  v_mfma_f32_16x16x32_bf16 v[56:59], v[152:155], v[68:71], v[56:59]
  v_permlane16_swap_b32 v22, v34
  v_mfma_f32_16x16x32_bf16 v[48:51], v[156:159], v[64:67], v[48:51]
  v_permlane16_swap_b32 v23, v35
  v_mfma_f32_16x16x32_bf16 v[60:63], v[156:159], v[68:71], v[60:63]
  s_waitcnt vmcnt(3)
  s_waitcnt lgkmcnt(2)
  v_mfma_f32_16x16x32_bf16 v[40:43], v[160:163], v[72:75], v[40:43]
  ds_read_b128 v[64:67], v5 offset:6144
  v_bitop3_b32 v10, v10, v11, v1 bitop3:0x7e
  v_mfma_f32_16x16x32_bf16 v[52:55], v[160:163], v[76:79], v[52:55]
  ds_read_b128 v[68:71], v5 offset:26624
  v_cmp_ne_u32 vcc, 0, v10
  v_mfma_f32_16x16x32_bf16 v[44:47], v[164:167], v[72:75], v[44:47]
  v_permlane16_swap_b32 v24, v36
  v_mfma_f32_16x16x32_bf16 v[56:59], v[164:167], v[76:79], v[56:59]
  v_permlane16_swap_b32 v25, v37
  v_mfma_f32_16x16x32_bf16 v[48:51], v[168:171], v[72:75], v[48:51]
  v_permlane16_swap_b32 v26, v38
  v_mfma_f32_16x16x32_bf16 v[60:63], v[168:171], v[76:79], v[60:63]
  s_waitcnt lgkmcnt(2)
  v_mfma_f32_16x16x32_bf16 v[40:43], v[172:175], v[80:83], v[40:43]
  ds_read_b128 v[72:75], v5 offset:7168
  s_add_u32 s55, s65, 32768
  v_mfma_f32_16x16x32_bf16 v[52:55], v[172:175], v[84:87], v[52:55]
  ds_read_b128 v[76:79], v5 offset:27648
  buffer_load_dwordx4 v[12:15], v6, s[4:7], s55 offen sc1
  v_mfma_f32_16x16x32_bf16 v[44:47], v[176:179], v[80:83], v[44:47]
  v_permlane16_swap_b32 v27, v39
  v_mfma_f32_16x16x32_bf16 v[56:59], v[176:179], v[84:87], v[56:59]
  s_cbranch_vccz Lsckd_36
Lsck_35:
  s_add_u32 s55, s62, 512
  buffer_load_dwordx4 v[8:11], v7, s[4:7], s55 offen sc1
  s_waitcnt vmcnt(0)
  v_bitop3_b32 v10, v10, v11, v1 bitop3:0x7e
  v_cmp_ne_u32 vcc, 0, v10
  s_nop 1
  s_nop 1
  s_cbranch_vccnz Lsck_35
Lsckd_36:
  v_fmac_f32 v16, v8, v88
  v_mfma_f32_16x16x32_bf16 v[48:51], v[180:183], v[80:83], v[48:51]
  v_fmac_f32 v17, v8, v89
  v_fmac_f32 v18, v8, v90
  v_mfma_f32_16x16x32_bf16 v[60:63], v[180:183], v[84:87], v[60:63]
  v_fmac_f32 v19, v8, v91
  s_waitcnt lgkmcnt(2)
  v_mfma_f32_16x16x32_bf16 v[40:43], v[184:187], v[64:67], v[40:43]
  ds_read_b128 v[80:83], v5 offset:8192
  v_fmac_f32 v20, v8, v92
  v_mfma_f32_16x16x32_bf16 v[52:55], v[184:187], v[68:71], v[52:55]
  ds_read_b128 v[84:87], v5 offset:28672
  v_fmac_f32 v21, v8, v93
  v_mfma_f32_16x16x32_bf16 v[44:47], v[188:191], v[64:67], v[44:47]
  v_fmac_f32 v22, v8, v94
  v_fmac_f32 v23, v8, v95
  v_mfma_f32_16x16x32_bf16 v[56:59], v[188:191], v[68:71], v[56:59]
  v_fmac_f32 v24, v8, v96
  v_fmac_f32 v25, v8, v97
  v_mfma_f32_16x16x32_bf16 v[48:51], v[192:195], v[64:67], v[48:51]
  v_fmac_f32 v26, v8, v98
  v_fmac_f32 v27, v8, v99
  v_mfma_f32_16x16x32_bf16 v[60:63], v[192:195], v[68:71], v[60:63]
  v_fmac_f32 v28, v8, v100
  s_waitcnt lgkmcnt(2)
  v_mfma_f32_16x16x32_bf16 v[40:43], v[196:199], v[72:75], v[40:43]
  ds_read_b128 v[64:67], v5 offset:9216
  v_fmac_f32 v29, v8, v101
  v_mfma_f32_16x16x32_bf16 v[52:55], v[196:199], v[76:79], v[52:55]
  ds_read_b128 v[68:71], v5 offset:29696
  v_fmac_f32 v30, v8, v102
  v_mfma_f32_16x16x32_bf16 v[44:47], v[200:203], v[72:75], v[44:47]
  v_fmac_f32 v31, v8, v103
  v_fmac_f32 v32, v8, v104
  v_mfma_f32_16x16x32_bf16 v[56:59], v[200:203], v[76:79], v[56:59]
  v_fmac_f32 v33, v8, v105
  v_fmac_f32 v34, v8, v106
  v_mfma_f32_16x16x32_bf16 v[48:51], v[204:207], v[72:75], v[48:51]
  v_fmac_f32 v35, v8, v107
  v_fmac_f32 v36, v8, v108
  v_mfma_f32_16x16x32_bf16 v[60:63], v[204:207], v[76:79], v[60:63]
  v_fmac_f32 v37, v8, v109
  s_waitcnt lgkmcnt(2)
  v_mfma_f32_16x16x32_bf16 v[40:43], v[208:211], v[80:83], v[40:43]
  ds_read_b128 v[72:75], v5 offset:10240
  v_fmac_f32 v38, v8, v110
  v_mfma_f32_16x16x32_bf16 v[52:55], v[208:211], v[84:87], v[52:55]
  ds_read_b128 v[76:79], v5 offset:30720
  v_fmac_f32 v39, v8, v111
  v_mfma_f32_16x16x32_bf16 v[44:47], v[212:215], v[80:83], v[44:47]
  s_waitcnt vmcnt(0)
  v_bitop3_b32 v12, v12, v13, v1 bitop3:0x7e
  v_mfma_f32_16x16x32_bf16 v[56:59], v[212:215], v[84:87], v[56:59]
  v_bitop3_b32 v14, v14, v15, v1 bitop3:0x7e
  v_or_b32 v12, v12, v14
  v_mfma_f32_16x16x32_bf16 v[48:51], v[216:219], v[80:83], v[48:51]
  v_cmp_ne_u32 vcc, 0, v12
  v_max_f32 v16, 0, v16
  v_mfma_f32_16x16x32_bf16 v[60:63], v[216:219], v[84:87], v[60:63]
  v_mul_f32 v28, v9, v28
  s_waitcnt lgkmcnt(2)
  v_mfma_f32_16x16x32_bf16 v[40:43], v[220:223], v[64:67], v[40:43]
  ds_read_b128 v[80:83], v5 offset:11264
  s_cbranch_vccz Lsckd_38
Lsck_37:
  s_add_u32 s55, s65, 32768
  buffer_load_dwordx4 v[12:15], v6, s[4:7], s55 offen sc1
  s_waitcnt vmcnt(0)
  v_bitop3_b32 v12, v12, v13, v1 bitop3:0x7e
  v_bitop3_b32 v14, v14, v15, v1 bitop3:0x7e
  v_or_b32 v12, v12, v14
  v_cmp_ne_u32 vcc, 0, v12
  s_nop 1
  s_nop 1
  s_cbranch_vccnz Lsck_37
Lsckd_38:
  v_mfma_f32_16x16x32_bf16 v[52:55], v[220:223], v[68:71], v[52:55]
  ds_read_b128 v[84:87], v5 offset:31744
  v_mfma_f32_16x16x32_bf16 v[44:47], v[224:227], v[64:67], v[44:47]
  v_max_f32 v17, 0, v17
  v_mul_f32 v29, v9, v29
  v_mfma_f32_16x16x32_bf16 v[56:59], v[224:227], v[68:71], v[56:59]
  v_max_f32 v18, 0, v18
  v_mul_f32 v30, v9, v30
  v_mfma_f32_16x16x32_bf16 v[48:51], v[228:231], v[64:67], v[48:51]
  v_max_f32 v19, 0, v19
  v_mul_f32 v31, v9, v31
  v_mfma_f32_16x16x32_bf16 v[60:63], v[228:231], v[68:71], v[60:63]
  v_max_f32 v20, 0, v20
  s_waitcnt lgkmcnt(2)
  v_mfma_f32_16x16x32_bf16 v[40:43], v[232:235], v[72:75], v[40:43]
  ds_read_b128 v[64:67], v5 offset:12288
  s_add_u32 s55, s62, 1536
  buffer_load_dwordx4 v[12:15], v7, s[4:7], s55 offen sc1
  v_mfma_f32_16x16x32_bf16 v[52:55], v[232:235], v[76:79], v[52:55]
  ds_read_b128 v[68:71], v5 offset:32768
  s_add_u32 m0, s60, 0
  v_mfma_f32_16x16x32_bf16 v[44:47], v[236:239], v[72:75], v[44:47]
  s_add_u32 s48, s59, 0
  buffer_load_dwordx4 v2, s[4:7], s48 offen offset:0 sc1 lds
  v_mfma_f32_16x16x32_bf16 v[56:59], v[236:239], v[76:79], v[56:59]
  buffer_load_dwordx4 v2, s[4:7], s48 offen offset:1024 sc1 lds
  v_mul_f32 v32, v9, v32
  v_mfma_f32_16x16x32_bf16 v[48:51], v[240:243], v[72:75], v[48:51]
  v_max_f32 v21, 0, v21
  v_mul_f32 v33, v9, v33
  v_mfma_f32_16x16x32_bf16 v[60:63], v[240:243], v[76:79], v[60:63]
  v_max_f32 v22, 0, v22
  s_waitcnt lgkmcnt(2)
  v_mfma_f32_16x16x32_bf16 v[40:43], v[244:247], v[80:83], v[40:43]
  ds_read_b128 v[72:75], v5 offset:13312
  buffer_load_dwordx4 v2, s[4:7], s48 offen offset:2048 sc1 lds
  buffer_load_dwordx4 v2, s[4:7], s48 offen offset:3072 sc1 lds
  v_mfma_f32_16x16x32_bf16 v[52:55], v[244:247], v[84:87], v[52:55]
  ds_read_b128 v[76:79], v5 offset:33792
  v_mul_f32 v34, v9, v34
  v_mfma_f32_16x16x32_bf16 v[44:47], v[248:251], v[80:83], v[44:47]
  v_max_f32 v23, 0, v23
  v_mul_f32 v35, v9, v35
  v_mfma_f32_16x16x32_bf16 v[56:59], v[248:251], v[84:87], v[56:59]
  v_max_f32 v24, 0, v24
  v_mul_f32 v36, v9, v36
  v_mfma_f32_16x16x32_bf16 v[48:51], v[252:255], v[80:83], v[48:51]
  v_max_f32 v25, 0, v25
  v_mul_f32 v37, v9, v37
  v_mfma_f32_16x16x32_bf16 v[60:63], v[252:255], v[84:87], v[60:63]
  v_max_f32 v26, 0, v26
  s_waitcnt lgkmcnt(2)
  v_mfma_f32_16x16x32_bf16 v[40:43], a[0:3], v[64:67], v[40:43]
  ds_read_b128 v[80:83], v5 offset:14336
  s_add_u32 m0, s60, 4096
  v_mfma_f32_16x16x32_bf16 v[52:55], a[0:3], v[68:71], v[52:55]
  ds_read_b128 v[84:87], v5 offset:34816
  s_add_u32 s48, s59, 8192
  v_mfma_f32_16x16x32_bf16 v[44:47], a[4:7], v[64:67], v[44:47]
  buffer_load_dwordx4 v2, s[4:7], s48 offen offset:0 sc1 lds
  v_mul_f32 v38, v9, v38
  v_mfma_f32_16x16x32_bf16 v[56:59], a[4:7], v[68:71], v[56:59]
  v_max_f32 v27, 0, v27
  v_mul_f32 v39, v9, v39
  v_mfma_f32_16x16x32_bf16 v[48:51], a[8:11], v[64:67], v[48:51]
  v_mul_f32 v16, v16, v28
  v_mul_f32 v17, v17, v29
  v_mfma_f32_16x16x32_bf16 v[60:63], a[8:11], v[68:71], v[60:63]
  v_mul_f32 v18, v18, v30
  s_waitcnt lgkmcnt(2)
  v_mfma_f32_16x16x32_bf16 v[40:43], a[12:15], v[72:75], v[40:43]
  ds_read_b128 v[64:67], v5 offset:15360
  buffer_load_dwordx4 v2, s[4:7], s48 offen offset:1024 sc1 lds
  v_mfma_f32_16x16x32_bf16 v[52:55], a[12:15], v[76:79], v[52:55]
  ds_read_b128 v[68:71], v5 offset:35840
  v_mul_f32 v19, v19, v31
  v_mfma_f32_16x16x32_bf16 v[44:47], a[16:19], v[72:75], v[44:47]
  v_mul_f32 v20, v20, v32
  v_mul_f32 v21, v21, v33
  v_mfma_f32_16x16x32_bf16 v[56:59], a[16:19], v[76:79], v[56:59]
  v_mul_f32 v22, v22, v34
  v_mul_f32 v23, v23, v35
  v_mfma_f32_16x16x32_bf16 v[48:51], a[20:23], v[72:75], v[48:51]
  v_mul_f32 v24, v24, v36
  v_mul_f32 v25, v25, v37
  v_mfma_f32_16x16x32_bf16 v[60:63], a[20:23], v[76:79], v[60:63]
  v_mul_f32 v26, v26, v38
  s_waitcnt lgkmcnt(2)
  v_mfma_f32_16x16x32_bf16 v[40:43], a[24:27], v[80:83], v[40:43]
  ds_read_b128 v[72:75], v5 offset:16384
  buffer_load_dwordx4 v2, s[4:7], s48 offen offset:2048 sc1 lds
  v_mfma_f32_16x16x32_bf16 v[52:55], a[24:27], v[84:87], v[52:55]
  ds_read_b128 v[76:79], v5 offset:36864
  v_mul_f32 v27, v27, v39
  v_mfma_f32_16x16x32_bf16 v[44:47], a[28:31], v[80:83], v[44:47]
  v_cvt_pk_bf16_f32 v28, v16, v17
  v_cvt_pk_bf16_f32 v29, v18, v19
  v_mfma_f32_16x16x32_bf16 v[56:59], a[28:31], v[84:87], v[56:59]
  v_cvt_pk_bf16_f32 v30, v20, v21
  v_cvt_pk_bf16_f32 v31, v22, v23
  v_mfma_f32_16x16x32_bf16 v[48:51], a[32:35], v[80:83], v[48:51]
  v_cvt_pk_bf16_f32 v32, v24, v25
  v_cvt_pk_bf16_f32 v33, v26, v27
  v_mfma_f32_16x16x32_bf16 v[60:63], a[32:35], v[84:87], v[60:63]
  s_add_u32 s49, s52, 98304
  s_waitcnt lgkmcnt(2)
  v_mfma_f32_16x16x32_bf16 v[40:43], a[36:39], v[64:67], v[40:43]
  ds_read_b128 v[80:83], v5 offset:17408
  s_add_u32 m0, s60, 7168
  v_mfma_f32_16x16x32_bf16 v[52:55], a[36:39], v[68:71], v[52:55]
  ds_read_b128 v[84:87], v5 offset:37888
  s_add_u32 s48, s59, 4096
  v_mfma_f32_16x16x32_bf16 v[44:47], a[40:43], v[64:67], v[44:47]
  buffer_load_dwordx4 v2, s[4:7], s48 offen offset:0 sc1 lds
  buffer_store_dwordx4 v[28:31], v3, s[4:7], s49 offen sc1
  v_mfma_f32_16x16x32_bf16 v[56:59], a[40:43], v[68:71], v[56:59]
  buffer_store_dwordx2 v[32:33], v4, s[4:7], s49 offen sc1
  v_mfma_f32_16x16x32_bf16 v[48:51], a[44:47], v[64:67], v[48:51]
  v_mfma_f32_16x16x32_bf16 v[60:63], a[44:47], v[68:71], v[60:63]
  s_waitcnt lgkmcnt(2)
  v_mfma_f32_16x16x32_bf16 v[40:43], a[48:51], v[72:75], v[40:43]
  ds_read_b128 v[64:67], v5 offset:18432
  buffer_load_dwordx4 v2, s[4:7], s48 offen offset:1024 sc1 lds
  v_mfma_f32_16x16x32_bf16 v[52:55], a[48:51], v[76:79], v[52:55]
  ds_read_b128 v[68:71], v5 offset:38912
  v_mfma_f32_16x16x32_bf16 v[44:47], a[52:55], v[72:75], v[44:47]
  v_mfma_f32_16x16x32_bf16 v[56:59], a[52:55], v[76:79], v[56:59]
  v_mfma_f32_16x16x32_bf16 v[48:51], a[56:59], v[72:75], v[48:51]
  v_mfma_f32_16x16x32_bf16 v[60:63], a[56:59], v[76:79], v[60:63]
  s_waitcnt lgkmcnt(2)
  v_mfma_f32_16x16x32_bf16 v[40:43], a[60:63], v[80:83], v[40:43]
  ds_read_b128 v[72:75], v5 offset:19456
  v_mfma_f32_16x16x32_bf16 v[52:55], a[60:63], v[84:87], v[52:55]
  ds_read_b128 v[76:79], v5 offset:39936
  v_mfma_f32_16x16x32_bf16 v[44:47], a[64:67], v[80:83], v[44:47]
  v_mfma_f32_16x16x32_bf16 v[56:59], a[64:67], v[84:87], v[56:59]
  v_mfma_f32_16x16x32_bf16 v[48:51], a[68:71], v[80:83], v[48:51]
  v_mfma_f32_16x16x32_bf16 v[60:63], a[68:71], v[84:87], v[60:63]
  s_waitcnt lgkmcnt(2)
  v_mfma_f32_16x16x32_bf16 v[40:43], a[72:75], v[64:67], v[40:43]
  s_waitcnt vmcnt(11)
  v_bitop3_b32 v14, v14, v15, v1 bitop3:0x7e
  v_mfma_f32_16x16x32_bf16 v[52:55], a[72:75], v[68:71], v[52:55]
  v_cmp_ne_u32 vcc, 0, v14
  v_add_u32 v8, s60, v2
  v_mfma_f32_16x16x32_bf16 v[44:47], a[76:79], v[64:67], v[44:47]
  s_nop 0
  s_nop 0
  s_cbranch_vccz Lsckd_40
Lsck_39:
  s_add_u32 s55, s62, 1536
  buffer_load_dwordx4 v[12:15], v7, s[4:7], s55 offen sc1
  s_waitcnt vmcnt(0)
  v_bitop3_b32 v14, v14, v15, v1 bitop3:0x7e
  v_cmp_ne_u32 vcc, 0, v14
  s_nop 1
  s_nop 1
  s_cbranch_vccnz Lsck_39
Lsckd_40:
  v_mfma_f32_16x16x32_bf16 v[56:59], a[76:79], v[68:71], v[56:59]
  v_add_u32 v7, s56, v2
  v_mfma_f32_16x16x32_bf16 v[48:51], a[80:83], v[64:67], v[48:51]
  v_mfma_f32_16x16x32_bf16 v[60:63], a[80:83], v[68:71], v[60:63]
  s_waitcnt lgkmcnt(0)
  v_mfma_f32_16x16x32_bf16 v[40:43], a[84:87], v[72:75], v[40:43]
  v_mfma_f32_16x16x32_bf16 v[52:55], a[84:87], v[76:79], v[52:55]
  v_mfma_f32_16x16x32_bf16 v[44:47], a[88:91], v[72:75], v[44:47]
  v_mfma_f32_16x16x32_bf16 v[56:59], a[88:91], v[76:79], v[56:59]
  v_mfma_f32_16x16x32_bf16 v[48:51], a[92:95], v[72:75], v[48:51]
  v_mfma_f32_16x16x32_bf16 v[60:63], a[92:95], v[76:79], v[60:63]
  s_waitcnt vmcnt(9)
  ds_read_b128 v[64:67], v8 offset:0
  ds_read_b128 v[68:71], v8 offset:1024
  s_nop 0
  v_permlane16_swap_b32 v40, v52
  v_permlane16_swap_b32 v41, v53
  v_permlane16_swap_b32 v42, v54
  v_permlane16_swap_b32 v43, v55
  v_permlane16_swap_b32 v44, v56
  v_permlane16_swap_b32 v45, v57
  v_permlane16_swap_b32 v46, v58
  v_permlane16_swap_b32 v47, v59
  v_permlane16_swap_b32 v48, v60
  v_permlane16_swap_b32 v49, v61
  v_permlane16_swap_b32 v50, v62
  v_permlane16_swap_b32 v51, v63
  v_pk_fma_f32 v[40:41], v[88:89], v[12:13], v[40:41] op_sel_hi:[1,0,1]
  v_pk_fma_f32 v[42:43], v[90:91], v[12:13], v[42:43] op_sel_hi:[1,0,1]
  v_pk_fma_f32 v[44:45], v[92:93], v[12:13], v[44:45] op_sel_hi:[1,0,1]
  v_pk_fma_f32 v[46:47], v[94:95], v[12:13], v[46:47] op_sel_hi:[1,0,1]
  v_pk_fma_f32 v[48:49], v[96:97], v[12:13], v[48:49] op_sel_hi:[1,0,1]
  v_pk_fma_f32 v[50:51], v[98:99], v[12:13], v[50:51] op_sel_hi:[1,0,1]
  v_pk_fma_f32 v[52:53], v[100:101], v[12:13], v[52:53] op_sel_hi:[1,0,1]
  v_pk_fma_f32 v[54:55], v[102:103], v[12:13], v[54:55] op_sel_hi:[1,0,1]
  v_pk_fma_f32 v[56:57], v[104:105], v[12:13], v[56:57] op_sel_hi:[1,0,1]
  v_pk_fma_f32 v[58:59], v[106:107], v[12:13], v[58:59] op_sel_hi:[1,0,1]
  v_pk_fma_f32 v[60:61], v[108:109], v[12:13], v[60:61] op_sel_hi:[1,0,1]
  v_pk_fma_f32 v[62:63], v[110:111], v[12:13], v[62:63] op_sel_hi:[1,0,1]
  v_max_f32 v40, 0, v40
  v_max_f32 v41, 0, v41
  v_max_f32 v42, 0, v42
  v_max_f32 v43, 0, v43
  v_max_f32 v44, 0, v44
  v_max_f32 v45, 0, v45
  v_max_f32 v46, 0, v46
  v_max_f32 v47, 0, v47
  v_max_f32 v48, 0, v48
  v_max_f32 v49, 0, v49
  v_max_f32 v50, 0, v50
  v_max_f32 v51, 0, v51
  v_pk_mul_f32 v[52:53], v[52:53], v[12:13] op_sel:[0,1] op_sel_hi:[1,1]
  v_pk_mul_f32 v[54:55], v[54:55], v[12:13] op_sel:[0,1] op_sel_hi:[1,1]
  v_pk_mul_f32 v[56:57], v[56:57], v[12:13] op_sel:[0,1] op_sel_hi:[1,1]
  v_pk_mul_f32 v[58:59], v[58:59], v[12:13] op_sel:[0,1] op_sel_hi:[1,1]
  v_pk_mul_f32 v[60:61], v[60:61], v[12:13] op_sel:[0,1] op_sel_hi:[1,1]
  v_pk_mul_f32 v[62:63], v[62:63], v[12:13] op_sel:[0,1] op_sel_hi:[1,1]
  v_pk_mul_f32 v[40:41], v[40:41], v[52:53]
  v_pk_mul_f32 v[42:43], v[42:43], v[54:55]
  v_pk_mul_f32 v[44:45], v[44:45], v[56:57]
  v_pk_mul_f32 v[46:47], v[46:47], v[58:59]
  v_pk_mul_f32 v[48:49], v[48:49], v[60:61]
  v_pk_mul_f32 v[50:51], v[50:51], v[62:63]
  v_cvt_pk_bf16_f32 v52, v40, v41
  v_cvt_pk_bf16_f32 v53, v42, v43
  v_cvt_pk_bf16_f32 v54, v44, v45
  v_cvt_pk_bf16_f32 v55, v46, v47
  v_cvt_pk_bf16_f32 v56, v48, v49
  v_cvt_pk_bf16_f32 v57, v50, v51
  s_add_u32 s49, s52, 294912
  buffer_store_dwordx4 v[52:55], v3, s[4:7], s49 offen sc1
  buffer_store_dwordx2 v[56:57], v4, s[4:7], s49 offen sc1
  s_add_u32 s62, s59, 4096
  buffer_load_dwordx4 v[76:79], v2, s[4:7], s62 offen offset:2048 sc1
  buffer_load_dwordx4 v[80:83], v2, s[4:7], s62 offen offset:3072 sc1
  s_add_u32 s54, s59, 8192
  buffer_load_dwordx4 v[84:87], v2, s[4:7], s54 offen offset:3072 sc1
  s_waitcnt lgkmcnt(1)
  v_mfma_f32_16x16x32_bf16 v[16:19], a[96:99], v[64:67], 0
  s_waitcnt vmcnt(11)
  ds_read_b128 v[72:75], v8 offset:4096
  s_add_u32 s60, s59, 49152
  v_mfma_f32_16x16x32_bf16 v[20:23], a[100:103], v[64:67], 0
  buffer_load_dwordx4 v[112:115], v2, s[4:7], s60 offen offset:0 sc1
  ds_read_b128 v[88:91], v7 offset:0
  ds_read_b128 v[92:95], v7 offset:1024
  v_mfma_f32_16x16x32_bf16 v[24:27], a[104:107], v[64:67], 0
  ds_read_b128 v[96:99], v7 offset:2048
  ds_read_b128 v[100:103], v7 offset:3072
  ds_read_b128 v[104:107], v7 offset:4096
  v_mfma_f32_16x16x32_bf16 v[28:31], a[108:111], v[64:67], 0
  s_lshl_b32 s48, s42, 12
  v_add_u32 v3, s48, v5
  s_lshl_b32 s48, s42, 10
  v_mfma_f32_16x16x32_bf16 v[32:35], a[112:115], v[64:67], 0
  v_add_u32 v13, s48, v5
  s_waitcnt lgkmcnt(6)
  v_mfma_f32_16x16x32_bf16 v[16:19], a[116:119], v[68:71], v[16:19]
  s_waitcnt vmcnt(14)
  ds_read_b128 v[64:67], v8 offset:2048
  buffer_load_dwordx4 v[116:119], v2, s[4:7], s60 offen offset:1024 sc1
  v_mfma_f32_16x16x32_bf16 v[20:23], a[120:123], v[68:71], v[20:23]
  v_and_b32 v4, 15, v0
  v_lshrrev_b32 v15, 4, v0
  v_mul_u32_u24 v14, 1280, v4
  v_mfma_f32_16x16x32_bf16 v[24:27], a[124:127], v[68:71], v[24:27]
  v_lshl_add_u32 v14, v15, 3, v14
  v_lshlrev_b32 v4, 4, v4
  v_and_b32 v15, 1, v15
  v_mfma_f32_16x16x32_bf16 v[28:31], a[128:131], v[68:71], v[28:31]
  v_lshl_add_u32 v4, v15, 3, v4
  v_lshrrev_b32 v15, 5, v0
  v_mfma_f32_16x16x32_bf16 v[32:35], a[132:135], v[68:71], v[32:35]
  s_waitcnt lgkmcnt(6)
  s_waitcnt lgkmcnt(1)
  v_mfma_f32_16x16x32_bf16 v[16:19], v[88:91], v[72:75], v[16:19]
  s_waitcnt vmcnt(14)
  ds_read_b128 v[68:71], v8 offset:3072
  s_add_u32 s54, s59, 57344
  v_mfma_f32_16x16x32_bf16 v[20:23], v[92:95], v[72:75], v[20:23]
  buffer_load_dwordx4 v[56:59], v2, s[4:7], s54 offen offset:0 sc1
  v_lshl_add_u32 v4, v15, 10, v4
  s_and_b32 s63, s41, 7
  v_mfma_f32_16x16x32_bf16 v[24:27], v[96:99], v[72:75], v[24:27]
  s_mul_i32 s48, s63, 10
  s_lshl_b32 s49, s42, 1
  v_mfma_f32_16x16x32_bf16 v[28:31], v[100:103], v[72:75], v[28:31]
  s_add_u32 s50, s48, s49
  s_add_u32 s51, s48, 8
  v_mfma_f32_16x16x32_bf16 v[32:35], v[104:107], v[72:75], v[32:35]
  ds_read_b128 v[88:91], v7 offset:5120
  s_waitcnt lgkmcnt(2)
  v_mfma_f32_16x16x32_bf16 v[16:19], a[136:139], v[64:67], v[16:19]
  s_waitcnt vmcnt(13)
  ds_read_b128 v[72:75], v8 offset:5120
  buffer_load_dwordx4 v[60:63], v2, s[4:7], s60 offen offset:2048 sc1
  v_mfma_f32_16x16x32_bf16 v[20:23], a[140:143], v[64:67], v[20:23]
  ds_read_b128 v[92:95], v7 offset:6144
  ds_read_b128 v[96:99], v7 offset:7168
  ds_read_b128 v[100:103], v7 offset:8192
  v_mfma_f32_16x16x32_bf16 v[24:27], a[144:147], v[64:67], v[24:27]
  ds_read_b128 v[104:107], v7 offset:9216
  s_mul_i32 s48, s50, 205
  s_lshr_b32 s48, s48, 12
  v_mfma_f32_16x16x32_bf16 v[28:31], a[148:151], v[64:67], v[28:31]
  s_mul_i32 s49, s48, 20
  s_sub_u32 s50, s50, s49
  v_mfma_f32_16x16x32_bf16 v[32:35], a[152:155], v[64:67], v[32:35]
  s_sub_u32 s50, s50, s67
  s_waitcnt lgkmcnt(6)
  v_mfma_f32_16x16x32_bf16 v[16:19], a[156:159], v[68:71], v[16:19]
  s_waitcnt vmcnt(12)
  ds_read_b128 v[64:67], v8 offset:7168
  v_mfma_f32_16x16x32_bf16 v[20:23], a[160:163], v[68:71], v[20:23]
  buffer_load_dwordx4 v[120:123], v2, s[4:7], s60 offen offset:3072 sc1
  s_add_u32 s49, s50, 20
  v_mfma_f32_16x16x32_bf16 v[24:27], a[164:167], v[68:71], v[24:27]
  s_min_u32 s50, s50, s49
  s_lshl_b32 s50, s50, 2
  v_mfma_f32_16x16x32_bf16 v[28:31], a[168:171], v[68:71], v[28:31]
  s_add_u32 s50, s50, s48
  s_mul_i32 s48, s51, 205
  v_mfma_f32_16x16x32_bf16 v[32:35], a[172:175], v[68:71], v[32:35]
  s_waitcnt lgkmcnt(5)
  s_waitcnt lgkmcnt(1)
  v_mfma_f32_16x16x32_bf16 v[16:19], v[88:91], v[72:75], v[16:19]
  s_waitcnt vmcnt(10)
  ds_read_b128 v[68:71], v8 offset:8192
  v_mfma_f32_16x16x32_bf16 v[20:23], v[92:95], v[72:75], v[20:23]
  buffer_load_dwordx4 v[124:127], v2, s[4:7], s54 offen offset:1024 sc1
  s_lshr_b32 s48, s48, 12
  v_mfma_f32_16x16x32_bf16 v[24:27], v[96:99], v[72:75], v[24:27]
  s_mul_i32 s49, s48, 20
  s_sub_u32 s51, s51, s49
  v_mfma_f32_16x16x32_bf16 v[28:31], v[100:103], v[72:75], v[28:31]
  s_sub_u32 s51, s51, s67
  s_add_u32 s49, s51, 20
  v_mfma_f32_16x16x32_bf16 v[32:35], v[104:107], v[72:75], v[32:35]
  ds_read_b128 v[88:91], v7 offset:10240
  s_waitcnt lgkmcnt(2)
  v_mfma_f32_16x16x32_bf16 v[16:19], a[176:179], v[64:67], v[16:19]
  s_waitcnt vmcnt(15)
  ds_read_b128 v[72:75], v8 offset:6144
  s_add_u32 s62, s59, 53248
  v_mfma_f32_16x16x32_bf16 v[20:23], a[180:183], v[64:67], v[20:23]
  buffer_load_dwordx4 v[128:131], v2, s[4:7], s62 offen offset:0 sc1
  ds_read_b128 v[92:95], v7 offset:11264
  ds_read_b128 v[96:99], v7 offset:12288
  v_mfma_f32_16x16x32_bf16 v[24:27], a[184:187], v[64:67], v[24:27]
  ds_read_b128 v[100:103], v7 offset:13312
  ds_read_b128 v[104:107], v7 offset:14336
  s_min_u32 s51, s51, s49
  v_mfma_f32_16x16x32_bf16 v[28:31], a[188:191], v[64:67], v[28:31]
  s_lshl_b32 s51, s51, 2
  s_add_u32 s51, s51, s48
  v_mfma_f32_16x16x32_bf16 v[32:35], a[192:195], v[64:67], v[32:35]
  s_lshl_b32 s50, s50, 8
  s_waitcnt lgkmcnt(6)
  v_mfma_f32_16x16x32_bf16 v[16:19], a[196:199], v[68:71], v[16:19]
  buffer_load_dwordx4 v[132:135], v2, s[4:7], s62 offen offset:1024 sc1
  s_lshl_b32 s51, s51, 8
  s_lshr_b32 s48, s41, 3
  v_mfma_f32_16x16x32_bf16 v[20:23], a[200:203], v[68:71], v[20:23]
  s_lshl_b32 s49, s40, 2
  s_add_u32 s48, s48, s49
  v_mfma_f32_16x16x32_bf16 v[24:27], a[204:207], v[68:71], v[24:27]
  s_mul_i32 s48, s48, 81920
  s_add_u32 s49, s48, 1048576
  v_mfma_f32_16x16x32_bf16 v[28:31], a[208:211], v[68:71], v[28:31]
  s_add_u32 s50, s50, s49
  s_add_u32 s51, s51, s49
  v_mfma_f32_16x16x32_bf16 v[32:35], a[212:215], v[68:71], v[32:35]
  s_waitcnt vmcnt(11)
  s_add_u32 s46, s64, 24576
  s_mov_b64 exec, 1
  buffer_store_dword v1, off, s[4:7], s46
  s_mov_b64 exec, -1
  s_waitcnt lgkmcnt(4)
  s_waitcnt lgkmcnt(0)
  v_mfma_f32_16x16x32_bf16 v[16:19], v[88:91], v[72:75], v[16:19]
  buffer_load_dwordx4 v[64:67], v2, s[4:7], s54 offen offset:2048 sc1
  s_mul_i32 s63, s63, 160
  v_mfma_f32_16x16x32_bf16 v[20:23], v[92:95], v[72:75], v[20:23]
  s_add_u32 s48, s48, s63
  s_lshl_b32 s49, s42, 5
  v_mfma_f32_16x16x32_bf16 v[24:27], v[96:99], v[72:75], v[24:27]
  s_add_u32 s52, s48, s49
  s_add_u32 s53, s48, 128
  v_mfma_f32_16x16x32_bf16 v[28:31], v[100:103], v[72:75], v[28:31]
  s_mul_i32 s48, s42, 20480
  s_add_u32 s51, s51, s48
  v_mfma_f32_16x16x32_bf16 v[32:35], v[104:107], v[72:75], v[32:35]
  ds_read_b128 v[88:91], v7 offset:15360
  s_waitcnt vmcnt(12)
  v_mfma_f32_16x16x32_bf16 v[16:19], a[216:219], v[76:79], v[16:19]
  buffer_load_dwordx4 v[68:71], v2, s[4:7], s62 offen offset:2048 sc1
  ds_read_b128 v[92:95], v7 offset:16384
  v_mfma_f32_16x16x32_bf16 v[20:23], a[220:223], v[76:79], v[20:23]
  ds_read_b128 v[96:99], v7 offset:17408
  ds_read_b128 v[100:103], v7 offset:18432
  v_mfma_f32_16x16x32_bf16 v[24:27], a[224:227], v[76:79], v[24:27]
  ds_read_b128 v[104:107], v7 offset:19456
  s_lshl_b32 s49, s42, 10
  v_mfma_f32_16x16x32_bf16 v[28:31], a[228:231], v[76:79], v[28:31]
  s_add_u32 s49, s49, 16384
  v_add_u32 v15, s49, v2
  v_mfma_f32_16x16x32_bf16 v[32:35], a[232:235], v[76:79], v[32:35]
  s_mul_i32 s49, s42, 3072
  s_waitcnt vmcnt(12)
  v_mfma_f32_16x16x32_bf16 v[16:19], a[236:239], v[80:83], v[16:19]
  s_add_u32 s55, s65, 24576
  buffer_load_dwordx4 v[8:11], v6, s[4:7], s55 offen sc1
  v_mfma_f32_16x16x32_bf16 v[20:23], a[240:243], v[80:83], v[20:23]
  s_add_u32 s55, s50, 0
  buffer_load_dwordx2 v[108:109], v4, s[4:7], s55 offen sc1
  v_mfma_f32_16x16x32_bf16 v[24:27], a[244:247], v[80:83], v[24:27]
  buffer_load_dwordx4 v[72:75], v2, s[4:7], s62 offen offset:3072 sc1
  v_add_u32 v5, s49, v15
  v_mfma_f32_16x16x32_bf16 v[28:31], a[248:251], v[80:83], v[28:31]
  s_add_u32 s53, s53, s48
  v_mfma_f32_16x16x32_bf16 v[32:35], a[252:255], v[80:83], v[32:35]
  s_barrier
  s_waitcnt vmcnt(14)
  s_waitcnt lgkmcnt(0)
  v_mfma_f32_16x16x32_bf16 v[16:19], v[88:91], v[84:87], v[16:19]
  buffer_load_dwordx4 v[76:79], v2, s[4:7], s54 offen offset:3072 sc1
  v_mfma_f32_16x16x32_bf16 v[20:23], v[92:95], v[84:87], v[20:23]
  v_mfma_f32_16x16x32_bf16 v[24:27], v[96:99], v[84:87], v[24:27]
  v_mfma_f32_16x16x32_bf16 v[28:31], v[100:103], v[84:87], v[28:31]
  v_mfma_f32_16x16x32_bf16 v[32:35], v[104:107], v[84:87], v[32:35]
  ds_read_b128 v[88:91], v7 offset:0
  ds_read_b128 v[92:95], v7 offset:1024
  s_waitcnt vmcnt(14)
  v_mfma_f32_16x16x32_bf16 v[36:39], a[96:99], v[112:115], 0
  ds_read_b128 v[96:99], v7 offset:2048
  ds_read_b128 v[100:103], v7 offset:3072
  v_mfma_f32_16x16x32_bf16 v[40:43], a[100:103], v[112:115], 0
  ds_read_b128 v[104:107], v7 offset:4096
  v_mfma_f32_16x16x32_bf16 v[44:47], a[104:107], v[112:115], 0
  ds_write_b128 v3, v[16:19] offset:0
  v_mfma_f32_16x16x32_bf16 v[48:51], a[108:111], v[112:115], 0
  ds_write_b128 v3, v[20:23] offset:1024
  v_mfma_f32_16x16x32_bf16 v[52:55], a[112:115], v[112:115], 0
  s_waitcnt vmcnt(13)
  v_mfma_f32_16x16x32_bf16 v[36:39], a[116:119], v[116:119], v[36:39]
  ds_write_b128 v3, v[24:27] offset:2048
  v_mfma_f32_16x16x32_bf16 v[40:43], a[120:123], v[116:119], v[40:43]
  ds_write_b128 v3, v[28:31] offset:3072
  v_mfma_f32_16x16x32_bf16 v[44:47], a[124:127], v[116:119], v[44:47]
  ds_write_b128 v15, v[32:35] offset:0
  v_mfma_f32_16x16x32_bf16 v[48:51], a[128:131], v[116:119], v[48:51]
  v_mfma_f32_16x16x32_bf16 v[52:55], a[132:135], v[116:119], v[52:55]
  s_waitcnt vmcnt(12)
  s_waitcnt lgkmcnt(5)
  v_mfma_f32_16x16x32_bf16 v[36:39], v[88:91], v[56:59], v[36:39]
  v_mfma_f32_16x16x32_bf16 v[40:43], v[92:95], v[56:59], v[40:43]
  v_mfma_f32_16x16x32_bf16 v[44:47], v[96:99], v[56:59], v[44:47]
  v_mfma_f32_16x16x32_bf16 v[48:51], v[100:103], v[56:59], v[48:51]
  v_mfma_f32_16x16x32_bf16 v[52:55], v[104:107], v[56:59], v[52:55]
  ds_read_b128 v[88:91], v7 offset:5120
  s_waitcnt vmcnt(11)
  v_mfma_f32_16x16x32_bf16 v[36:39], a[136:139], v[60:63], v[36:39]
  ds_read_b128 v[92:95], v7 offset:6144
  ds_read_b128 v[96:99], v7 offset:7168
  v_mfma_f32_16x16x32_bf16 v[40:43], a[140:143], v[60:63], v[40:43]
  ds_read_b128 v[100:103], v7 offset:8192
  ds_read_b128 v[104:107], v7 offset:9216
  v_mfma_f32_16x16x32_bf16 v[44:47], a[144:147], v[60:63], v[44:47]
  v_mfma_f32_16x16x32_bf16 v[48:51], a[148:151], v[60:63], v[48:51]
  v_mfma_f32_16x16x32_bf16 v[52:55], a[152:155], v[60:63], v[52:55]
  s_waitcnt lgkmcnt(5)
  s_barrier
  s_waitcnt vmcnt(10)
  v_mfma_f32_16x16x32_bf16 v[36:39], a[156:159], v[120:123], v[36:39]
  s_waitcnt vmcnt(3)
  v_bitop3_b32 v8, v8, v9, v1 bitop3:0x7e
  v_mfma_f32_16x16x32_bf16 v[40:43], a[160:163], v[120:123], v[40:43]
  v_bitop3_b32 v10, v10, v11, v1 bitop3:0x7e
  v_or_b32 v8, v8, v10
  v_mfma_f32_16x16x32_bf16 v[44:47], a[164:167], v[120:123], v[44:47]
  v_cmp_ne_u32 vcc, 0, v8
  s_nop 0
  v_mfma_f32_16x16x32_bf16 v[48:51], a[168:171], v[120:123], v[48:51]
  s_nop 1
  s_cbranch_vccz Lsckd_42
Lsck_41:
  s_add_u32 s55, s65, 24576
  buffer_load_dwordx4 v[8:11], v6, s[4:7], s55 offen sc1
  s_waitcnt vmcnt(0)
  v_bitop3_b32 v8, v8, v9, v1 bitop3:0x7e
  v_bitop3_b32 v10, v10, v11, v1 bitop3:0x7e
  v_or_b32 v8, v8, v10
  v_cmp_ne_u32 vcc, 0, v8
  s_nop 1
  s_nop 1
  s_cbranch_vccnz Lsck_41
Lsckd_42:
  v_mfma_f32_16x16x32_bf16 v[52:55], a[172:175], v[120:123], v[52:55]
  s_waitcnt vmcnt(9)
  s_waitcnt lgkmcnt(0)
  v_mfma_f32_16x16x32_bf16 v[36:39], v[88:91], v[124:127], v[36:39]
  s_add_u32 s60, s59, 98304
  buffer_load_dwordx4 v[80:83], v2, s[4:7], s60 offen offset:0 sc1
  v_mfma_f32_16x16x32_bf16 v[40:43], v[92:95], v[124:127], v[40:43]
  buffer_load_dwordx4 v[84:87], v2, s[4:7], s60 offen offset:1024 sc1
  ds_read_b128 v[16:19], v13 offset:0
  v_mfma_f32_16x16x32_bf16 v[44:47], v[96:99], v[124:127], v[44:47]
  ds_read_b128 v[20:23], v13 offset:4096
  ds_read_b128 v[24:27], v13 offset:8192
  v_mfma_f32_16x16x32_bf16 v[48:51], v[100:103], v[124:127], v[48:51]
  ds_read_b128 v[28:31], v13 offset:12288
  s_waitcnt vmcnt(4)
  v_mfma_f32_16x16x32_bf16 v[52:55], v[104:107], v[124:127], v[52:55]
  ds_read_b128 v[88:91], v7 offset:10240
  s_waitcnt vmcnt(10)
  v_mfma_f32_16x16x32_bf16 v[36:39], a[176:179], v[128:131], v[36:39]
  s_add_u32 s54, s59, 106496
  buffer_load_dwordx4 v[8:11], v2, s[4:7], s54 offen offset:0 sc1
  v_mfma_f32_16x16x32_bf16 v[40:43], a[180:183], v[128:131], v[40:43]
  buffer_load_dwordx4 v[112:115], v2, s[4:7], s60 offen offset:2048 sc1
  ds_read_b128 v[92:95], v7 offset:11264
  v_mfma_f32_16x16x32_bf16 v[44:47], a[184:187], v[128:131], v[44:47]
  ds_read_b128 v[96:99], v7 offset:12288
  ds_read_b128 v[100:103], v7 offset:13312
  v_mfma_f32_16x16x32_bf16 v[48:51], a[188:191], v[128:131], v[48:51]
  ds_read_b128 v[104:107], v7 offset:14336
  v_lshlrev_b32 v32, 16, v108
  v_mfma_f32_16x16x32_bf16 v[52:55], a[192:195], v[128:131], v[52:55]
  v_and_b32 v33, 0xffff0000, v108
  s_waitcnt vmcnt(11)
  v_mfma_f32_16x16x32_bf16 v[36:39], a[196:199], v[132:135], v[36:39]
  buffer_load_dwordx4 v[116:119], v2, s[4:7], s60 offen offset:3072 sc1
  buffer_load_dwordx4 v[56:59], v2, s[4:7], s54 offen offset:1024 sc1
  v_mfma_f32_16x16x32_bf16 v[40:43], a[200:203], v[132:135], v[40:43]
  v_lshlrev_b32 v34, 16, v109
  v_and_b32 v35, 0xffff0000, v109
  v_mfma_f32_16x16x32_bf16 v[44:47], a[204:207], v[132:135], v[44:47]
  s_waitcnt lgkmcnt(5)
  v_add_f32 v16, v16, v20
  v_mfma_f32_16x16x32_bf16 v[48:51], a[208:211], v[132:135], v[48:51]
  v_add_f32 v17, v17, v21
  v_add_f32 v18, v18, v22
  v_mfma_f32_16x16x32_bf16 v[52:55], a[212:215], v[132:135], v[52:55]
  s_waitcnt vmcnt(11)
  s_waitcnt lgkmcnt(0)
  v_mfma_f32_16x16x32_bf16 v[36:39], v[88:91], v[64:67], v[36:39]
  s_add_u32 s55, s50, 20480
  buffer_load_dwordx2 v[110:111], v4, s[4:7], s55 offen sc1
  v_mfma_f32_16x16x32_bf16 v[40:43], v[92:95], v[64:67], v[40:43]
  s_add_u32 s62, s59, 102400
  buffer_load_dwordx4 v[60:63], v2, s[4:7], s62 offen offset:0 sc1
  v_mfma_f32_16x16x32_bf16 v[44:47], v[96:99], v[64:67], v[44:47]
  buffer_load_dwordx4 v[120:123], v2, s[4:7], s62 offen offset:1024 sc1
  v_add_f32 v19, v19, v23
  v_mfma_f32_16x16x32_bf16 v[48:51], v[100:103], v[64:67], v[48:51]
  v_add_f32 v24, v24, v28
  v_add_f32 v25, v25, v29
  v_mfma_f32_16x16x32_bf16 v[52:55], v[104:107], v[64:67], v[52:55]
  ds_read_b128 v[88:91], v7 offset:15360
  s_waitcnt vmcnt(13)
  v_mfma_f32_16x16x32_bf16 v[36:39], a[216:219], v[68:71], v[36:39]
  buffer_load_dwordx4 v[124:127], v2, s[4:7], s54 offen offset:2048 sc1
  ds_read_b128 v[92:95], v7 offset:16384
  v_mfma_f32_16x16x32_bf16 v[40:43], a[220:223], v[68:71], v[40:43]
  ds_read_b128 v[96:99], v7 offset:17408
  ds_read_b128 v[100:103], v7 offset:18432
  v_mfma_f32_16x16x32_bf16 v[44:47], a[224:227], v[68:71], v[44:47]
  ds_read_b128 v[104:107], v7 offset:19456
  v_add_f32 v26, v26, v30
  v_mfma_f32_16x16x32_bf16 v[48:51], a[228:231], v[68:71], v[48:51]
  v_add_f32 v27, v27, v31
  v_add_f32 v16, v16, v32
  v_mfma_f32_16x16x32_bf16 v[52:55], a[232:235], v[68:71], v[52:55]
  v_add_f32 v17, v17, v33
  s_waitcnt vmcnt(11)
  v_mfma_f32_16x16x32_bf16 v[36:39], a[236:239], v[72:75], v[36:39]
  buffer_load_dwordx4 v[128:131], v2, s[4:7], s62 offen offset:2048 sc1
  v_add_f32 v18, v18, v34
  v_mfma_f32_16x16x32_bf16 v[40:43], a[240:243], v[72:75], v[40:43]
  v_add_f32 v19, v19, v35
  v_add_f32 v16, v16, v24
  v_mfma_f32_16x16x32_bf16 v[44:47], a[244:247], v[72:75], v[44:47]
  v_add_f32 v17, v17, v25
  v_add_f32 v18, v18, v26
  v_mfma_f32_16x16x32_bf16 v[48:51], a[248:251], v[72:75], v[48:51]
  v_add_f32 v19, v19, v27
  v_cvt_pk_bf16_f32 v20, v16, v17
  v_mfma_f32_16x16x32_bf16 v[52:55], a[252:255], v[72:75], v[52:55]
  s_waitcnt vmcnt(11)
  s_waitcnt lgkmcnt(0)
  v_mfma_f32_16x16x32_bf16 v[36:39], v[88:91], v[76:79], v[36:39]
  buffer_load_dwordx4 v[132:135], v2, s[4:7], s62 offen offset:3072 sc1
  v_cvt_pk_bf16_f32 v21, v18, v19
  v_mfma_f32_16x16x32_bf16 v[40:43], v[92:95], v[76:79], v[40:43]
  s_add_u32 s49, s52, 0
  buffer_store_dwordx2 v[20:21], v14, s[32:35], s49 offen
  v_mfma_f32_16x16x32_bf16 v[44:47], v[96:99], v[76:79], v[44:47]
  v_mfma_f32_16x16x32_bf16 v[48:51], v[100:103], v[76:79], v[48:51]
  v_mfma_f32_16x16x32_bf16 v[52:55], v[104:107], v[76:79], v[52:55]
  ds_read_b128 v[88:91], v7 offset:0
  s_waitcnt vmcnt(12)
  v_mfma_f32_16x16x32_bf16 v[16:19], a[96:99], v[80:83], 0
  buffer_load_dwordx4 v[64:67], v2, s[4:7], s54 offen offset:3072 sc1
  ds_read_b128 v[92:95], v7 offset:1024
  v_mfma_f32_16x16x32_bf16 v[20:23], a[100:103], v[80:83], 0
  ds_read_b128 v[96:99], v7 offset:2048
  ds_read_b128 v[100:103], v7 offset:3072
  v_mfma_f32_16x16x32_bf16 v[24:27], a[104:107], v[80:83], 0
  ds_read_b128 v[104:107], v7 offset:4096
  v_mfma_f32_16x16x32_bf16 v[28:31], a[108:111], v[80:83], 0
  ds_write_b128 v3, v[36:39] offset:16384
  v_mfma_f32_16x16x32_bf16 v[32:35], a[112:115], v[80:83], 0
  s_waitcnt vmcnt(12)
  v_mfma_f32_16x16x32_bf16 v[16:19], a[116:119], v[84:87], v[16:19]
  s_add_u32 s60, s59, 147456
  buffer_load_dwordx4 v[68:71], v2, s[4:7], s60 offen offset:0 sc1
  v_mfma_f32_16x16x32_bf16 v[20:23], a[120:123], v[84:87], v[20:23]
  ds_write_b128 v3, v[40:43] offset:17408
  v_mfma_f32_16x16x32_bf16 v[24:27], a[124:127], v[84:87], v[24:27]
  ds_write_b128 v3, v[44:47] offset:18432
  v_mfma_f32_16x16x32_bf16 v[28:31], a[128:131], v[84:87], v[28:31]
  ds_write_b128 v3, v[48:51] offset:19456
  v_mfma_f32_16x16x32_bf16 v[32:35], a[132:135], v[84:87], v[32:35]
  s_waitcnt vmcnt(12)
  s_waitcnt lgkmcnt(4)
  v_mfma_f32_16x16x32_bf16 v[16:19], v[88:91], v[8:11], v[16:19]
  buffer_load_dwordx4 v[72:75], v2, s[4:7], s60 offen offset:1024 sc1
  v_mfma_f32_16x16x32_bf16 v[20:23], v[92:95], v[8:11], v[20:23]
  ds_write_b128 v15, v[52:55] offset:4096
  v_mfma_f32_16x16x32_bf16 v[24:27], v[96:99], v[8:11], v[24:27]
  v_mfma_f32_16x16x32_bf16 v[28:31], v[100:103], v[8:11], v[28:31]
  v_mfma_f32_16x16x32_bf16 v[32:35], v[104:107], v[8:11], v[32:35]
  ds_read_b128 v[88:91], v7 offset:5120
  s_waitcnt vmcnt(12)
  v_mfma_f32_16x16x32_bf16 v[16:19], a[136:139], v[112:115], v[16:19]
  s_add_u32 s54, s59, 155648
  buffer_load_dwordx4 v[76:79], v2, s[4:7], s54 offen offset:0 sc1
  v_mfma_f32_16x16x32_bf16 v[20:23], a[140:143], v[112:115], v[20:23]
  ds_read_b128 v[92:95], v7 offset:6144
  ds_read_b128 v[96:99], v7 offset:7168
  v_mfma_f32_16x16x32_bf16 v[24:27], a[144:147], v[112:115], v[24:27]
  ds_read_b128 v[100:103], v7 offset:8192
  ds_read_b128 v[104:107], v7 offset:9216
  v_mfma_f32_16x16x32_bf16 v[28:31], a[148:151], v[112:115], v[28:31]
  v_mfma_f32_16x16x32_bf16 v[32:35], a[152:155], v[112:115], v[32:35]
  s_waitcnt lgkmcnt(5)
  s_barrier
  s_waitcnt vmcnt(12)
  v_mfma_f32_16x16x32_bf16 v[16:19], a[156:159], v[116:119], v[16:19]
  buffer_load_dwordx4 v[80:83], v2, s[4:7], s60 offen offset:2048 sc1
  ds_read_b128 v[36:39], v13 offset:16384
  v_mfma_f32_16x16x32_bf16 v[20:23], a[160:163], v[116:119], v[20:23]
  ds_read_b128 v[40:43], v13 offset:20480
  ds_read_b128 v[44:47], v13 offset:24576
  v_mfma_f32_16x16x32_bf16 v[24:27], a[164:167], v[116:119], v[24:27]
  ds_read_b128 v[48:51], v13 offset:28672
  s_waitcnt vmcnt(11)
  v_mfma_f32_16x16x32_bf16 v[28:31], a[168:171], v[116:119], v[28:31]
  v_lshlrev_b32 v52, 16, v110
  v_and_b32 v53, 0xffff0000, v110
  v_mfma_f32_16x16x32_bf16 v[32:35], a[172:175], v[116:119], v[32:35]
  s_waitcnt vmcnt(12)
  s_waitcnt lgkmcnt(4)
  v_mfma_f32_16x16x32_bf16 v[16:19], v[88:91], v[56:59], v[16:19]
  buffer_load_dwordx4 v[84:87], v2, s[4:7], s60 offen offset:3072 sc1
  v_lshlrev_b32 v54, 16, v111
  v_mfma_f32_16x16x32_bf16 v[20:23], v[92:95], v[56:59], v[20:23]
  v_and_b32 v55, 0xffff0000, v111
  v_mfma_f32_16x16x32_bf16 v[24:27], v[96:99], v[56:59], v[24:27]
  v_mfma_f32_16x16x32_bf16 v[28:31], v[100:103], v[56:59], v[28:31]
  v_mfma_f32_16x16x32_bf16 v[32:35], v[104:107], v[56:59], v[32:35]
  ds_read_b128 v[88:91], v7 offset:10240
  s_waitcnt vmcnt(11)
  v_mfma_f32_16x16x32_bf16 v[16:19], a[176:179], v[60:63], v[16:19]
  buffer_load_dwordx4 v[8:11], v2, s[4:7], s54 offen offset:1024 sc1
  ds_read_b128 v[92:95], v7 offset:11264
  v_mfma_f32_16x16x32_bf16 v[20:23], a[180:183], v[60:63], v[20:23]
  ds_read_b128 v[96:99], v7 offset:12288
  ds_read_b128 v[100:103], v7 offset:13312
  v_mfma_f32_16x16x32_bf16 v[24:27], a[184:187], v[60:63], v[24:27]
  ds_read_b128 v[104:107], v7 offset:14336
  s_waitcnt lgkmcnt(5)
  v_mfma_f32_16x16x32_bf16 v[28:31], a[188:191], v[60:63], v[28:31]
  v_add_f32 v36, v36, v40
  v_add_f32 v37, v37, v41
  v_mfma_f32_16x16x32_bf16 v[32:35], a[192:195], v[60:63], v[32:35]
  v_add_f32 v38, v38, v42
  s_waitcnt vmcnt(11)
  v_mfma_f32_16x16x32_bf16 v[16:19], a[196:199], v[120:123], v[16:19]
  s_add_u32 s62, s59, 151552
  buffer_load_dwordx4 v[112:115], v2, s[4:7], s62 offen offset:0 sc1
  v_mfma_f32_16x16x32_bf16 v[20:23], a[200:203], v[120:123], v[20:23]
  v_add_f32 v39, v39, v43
  v_add_f32 v44, v44, v48
  v_mfma_f32_16x16x32_bf16 v[24:27], a[204:207], v[120:123], v[24:27]
  v_add_f32 v45, v45, v49
  v_add_f32 v46, v46, v50
  v_mfma_f32_16x16x32_bf16 v[28:31], a[208:211], v[120:123], v[28:31]
  v_add_f32 v47, v47, v51
  v_add_f32 v36, v36, v52
  v_mfma_f32_16x16x32_bf16 v[32:35], a[212:215], v[120:123], v[32:35]
  s_waitcnt vmcnt(11)
  s_waitcnt lgkmcnt(0)
  v_mfma_f32_16x16x32_bf16 v[16:19], v[88:91], v[124:127], v[16:19]
  s_add_u32 s55, s50, 40960
  buffer_load_dwordx2 v[108:109], v4, s[4:7], s55 offen sc1
  v_mfma_f32_16x16x32_bf16 v[20:23], v[92:95], v[124:127], v[20:23]
  buffer_load_dwordx4 v[116:119], v2, s[4:7], s62 offen offset:1024 sc1
  v_add_f32 v37, v37, v53
  v_mfma_f32_16x16x32_bf16 v[24:27], v[96:99], v[124:127], v[24:27]
  v_add_f32 v38, v38, v54
  v_add_f32 v39, v39, v55
  v_mfma_f32_16x16x32_bf16 v[28:31], v[100:103], v[124:127], v[28:31]
  v_add_f32 v36, v36, v44
  v_add_f32 v37, v37, v45
  v_mfma_f32_16x16x32_bf16 v[32:35], v[104:107], v[124:127], v[32:35]
  ds_read_b128 v[88:91], v7 offset:15360
  s_waitcnt vmcnt(12)
  v_mfma_f32_16x16x32_bf16 v[16:19], a[216:219], v[128:131], v[16:19]
  buffer_load_dwordx4 v[56:59], v2, s[4:7], s54 offen offset:2048 sc1
  ds_read_b128 v[92:95], v7 offset:16384
  v_mfma_f32_16x16x32_bf16 v[20:23], a[220:223], v[128:131], v[20:23]
  ds_read_b128 v[96:99], v7 offset:17408
  ds_read_b128 v[100:103], v7 offset:18432
  v_mfma_f32_16x16x32_bf16 v[24:27], a[224:227], v[128:131], v[24:27]
  ds_read_b128 v[104:107], v7 offset:19456
  v_add_f32 v38, v38, v46
  v_mfma_f32_16x16x32_bf16 v[28:31], a[228:231], v[128:131], v[28:31]
  v_add_f32 v39, v39, v47
  v_cvt_pk_bf16_f32 v40, v36, v37
  v_mfma_f32_16x16x32_bf16 v[32:35], a[232:235], v[128:131], v[32:35]
  v_cvt_pk_bf16_f32 v41, v38, v39
  s_waitcnt vmcnt(12)
  v_mfma_f32_16x16x32_bf16 v[16:19], a[236:239], v[132:135], v[16:19]
  buffer_load_dwordx4 v[60:63], v2, s[4:7], s62 offen offset:2048 sc1
  s_add_u32 s49, s52, 20480
  v_mfma_f32_16x16x32_bf16 v[20:23], a[240:243], v[132:135], v[20:23]
  buffer_store_dwordx2 v[40:41], v14, s[32:35], s49 offen
  v_mfma_f32_16x16x32_bf16 v[24:27], a[244:247], v[132:135], v[24:27]
  v_mfma_f32_16x16x32_bf16 v[28:31], a[248:251], v[132:135], v[28:31]
  v_mfma_f32_16x16x32_bf16 v[32:35], a[252:255], v[132:135], v[32:35]
  s_waitcnt vmcnt(12)
  s_waitcnt lgkmcnt(0)
  v_mfma_f32_16x16x32_bf16 v[16:19], v[88:91], v[64:67], v[16:19]
  buffer_load_dwordx4 v[120:123], v2, s[4:7], s62 offen offset:3072 sc1
  v_mfma_f32_16x16x32_bf16 v[20:23], v[92:95], v[64:67], v[20:23]
  v_mfma_f32_16x16x32_bf16 v[24:27], v[96:99], v[64:67], v[24:27]
  v_mfma_f32_16x16x32_bf16 v[28:31], v[100:103], v[64:67], v[28:31]
  v_mfma_f32_16x16x32_bf16 v[32:35], v[104:107], v[64:67], v[32:35]
  ds_read_b128 v[88:91], v7 offset:0
  s_waitcnt vmcnt(12)
  v_mfma_f32_16x16x32_bf16 v[36:39], a[96:99], v[68:71], 0
  buffer_load_dwordx4 v[124:127], v2, s[4:7], s54 offen offset:3072 sc1
  ds_read_b128 v[92:95], v7 offset:1024
  v_mfma_f32_16x16x32_bf16 v[40:43], a[100:103], v[68:71], 0
  ds_read_b128 v[96:99], v7 offset:2048
  ds_read_b128 v[100:103], v7 offset:3072
  v_mfma_f32_16x16x32_bf16 v[44:47], a[104:107], v[68:71], 0
  ds_read_b128 v[104:107], v7 offset:4096
  v_mfma_f32_16x16x32_bf16 v[48:51], a[108:111], v[68:71], 0
  ds_write_b128 v3, v[16:19] offset:0
  v_mfma_f32_16x16x32_bf16 v[52:55], a[112:115], v[68:71], 0
  s_waitcnt vmcnt(12)
  v_mfma_f32_16x16x32_bf16 v[36:39], a[116:119], v[72:75], v[36:39]
  ds_write_b128 v3, v[20:23] offset:1024
  v_mfma_f32_16x16x32_bf16 v[40:43], a[120:123], v[72:75], v[40:43]
  ds_write_b128 v3, v[24:27] offset:2048
  v_mfma_f32_16x16x32_bf16 v[44:47], a[124:127], v[72:75], v[44:47]
  ds_write_b128 v3, v[28:31] offset:3072
  v_mfma_f32_16x16x32_bf16 v[48:51], a[128:131], v[72:75], v[48:51]
  ds_write_b128 v15, v[32:35] offset:8192
  v_mfma_f32_16x16x32_bf16 v[52:55], a[132:135], v[72:75], v[52:55]
  s_waitcnt vmcnt(11)
  s_waitcnt lgkmcnt(5)
  v_mfma_f32_16x16x32_bf16 v[36:39], v[88:91], v[76:79], v[36:39]
  v_mfma_f32_16x16x32_bf16 v[40:43], v[92:95], v[76:79], v[40:43]
  v_mfma_f32_16x16x32_bf16 v[44:47], v[96:99], v[76:79], v[44:47]
  v_mfma_f32_16x16x32_bf16 v[48:51], v[100:103], v[76:79], v[48:51]
  v_mfma_f32_16x16x32_bf16 v[52:55], v[104:107], v[76:79], v[52:55]
  ds_read_b128 v[88:91], v7 offset:5120
  s_waitcnt vmcnt(10)
  v_mfma_f32_16x16x32_bf16 v[36:39], a[136:139], v[80:83], v[36:39]
  ds_read_b128 v[92:95], v7 offset:6144
  ds_read_b128 v[96:99], v7 offset:7168
  v_mfma_f32_16x16x32_bf16 v[40:43], a[140:143], v[80:83], v[40:43]
  ds_read_b128 v[100:103], v7 offset:8192
  ds_read_b128 v[104:107], v7 offset:9216
  v_mfma_f32_16x16x32_bf16 v[44:47], a[144:147], v[80:83], v[44:47]
  v_mfma_f32_16x16x32_bf16 v[48:51], a[148:151], v[80:83], v[48:51]
  v_mfma_f32_16x16x32_bf16 v[52:55], a[152:155], v[80:83], v[52:55]
  s_waitcnt lgkmcnt(5)
  s_barrier
  s_waitcnt vmcnt(9)
  v_mfma_f32_16x16x32_bf16 v[36:39], a[156:159], v[84:87], v[36:39]
  ds_read_b128 v[16:19], v13 offset:0
  ds_read_b128 v[20:23], v13 offset:4096
  v_mfma_f32_16x16x32_bf16 v[40:43], a[160:163], v[84:87], v[40:43]
  ds_read_b128 v[24:27], v13 offset:8192
  ds_read_b128 v[28:31], v13 offset:12288
  v_mfma_f32_16x16x32_bf16 v[44:47], a[164:167], v[84:87], v[44:47]
  s_waitcnt vmcnt(6)
  v_lshlrev_b32 v32, 16, v108
  v_mfma_f32_16x16x32_bf16 v[48:51], a[168:171], v[84:87], v[48:51]
  v_and_b32 v33, 0xffff0000, v108
  v_lshlrev_b32 v34, 16, v109
  v_mfma_f32_16x16x32_bf16 v[52:55], a[172:175], v[84:87], v[52:55]
  s_waitcnt vmcnt(8)
  s_waitcnt lgkmcnt(4)
  v_mfma_f32_16x16x32_bf16 v[36:39], v[88:91], v[8:11], v[36:39]
  v_and_b32 v35, 0xffff0000, v109
  v_mfma_f32_16x16x32_bf16 v[40:43], v[92:95], v[8:11], v[40:43]
  v_mfma_f32_16x16x32_bf16 v[44:47], v[96:99], v[8:11], v[44:47]
  v_mfma_f32_16x16x32_bf16 v[48:51], v[100:103], v[8:11], v[48:51]
  s_waitcnt lgkmcnt(0)
  v_add_f32 v16, v16, v20
  v_mfma_f32_16x16x32_bf16 v[52:55], v[104:107], v[8:11], v[52:55]
  ds_read_b128 v[88:91], v7 offset:10240
  s_waitcnt vmcnt(7)
  v_mfma_f32_16x16x32_bf16 v[36:39], a[176:179], v[112:115], v[36:39]
  ds_read_b128 v[92:95], v7 offset:11264
  ds_read_b128 v[96:99], v7 offset:12288
  v_mfma_f32_16x16x32_bf16 v[40:43], a[180:183], v[112:115], v[40:43]
  ds_read_b128 v[100:103], v7 offset:13312
  ds_read_b128 v[104:107], v7 offset:14336
  v_mfma_f32_16x16x32_bf16 v[44:47], a[184:187], v[112:115], v[44:47]
  v_add_f32 v17, v17, v21
  v_add_f32 v18, v18, v22
  v_mfma_f32_16x16x32_bf16 v[48:51], a[188:191], v[112:115], v[48:51]
  v_add_f32 v19, v19, v23
  v_add_f32 v24, v24, v28
  v_mfma_f32_16x16x32_bf16 v[52:55], a[192:195], v[112:115], v[52:55]
  v_add_f32 v25, v25, v29
  s_waitcnt vmcnt(5)
  v_mfma_f32_16x16x32_bf16 v[36:39], a[196:199], v[116:119], v[36:39]
  v_add_f32 v26, v26, v30
  v_add_f32 v27, v27, v31
  v_mfma_f32_16x16x32_bf16 v[40:43], a[200:203], v[116:119], v[40:43]
  v_add_f32 v16, v16, v32
  v_add_f32 v17, v17, v33
  v_mfma_f32_16x16x32_bf16 v[44:47], a[204:207], v[116:119], v[44:47]
  v_add_f32 v18, v18, v34
  v_add_f32 v19, v19, v35
  v_mfma_f32_16x16x32_bf16 v[48:51], a[208:211], v[116:119], v[48:51]
  v_add_f32 v16, v16, v24
  v_add_f32 v17, v17, v25
  v_mfma_f32_16x16x32_bf16 v[52:55], a[212:215], v[116:119], v[52:55]
  s_waitcnt vmcnt(4)
  s_waitcnt lgkmcnt(0)
  v_mfma_f32_16x16x32_bf16 v[36:39], v[88:91], v[56:59], v[36:39]
  s_add_u32 s55, s50, 61440
  buffer_load_dwordx2 v[110:111], v4, s[4:7], s55 offen sc1
  v_mfma_f32_16x16x32_bf16 v[40:43], v[92:95], v[56:59], v[40:43]
  s_add_u32 s55, s51, 0
  buffer_load_dwordx2 v[128:129], v4, s[4:7], s55 offen sc1
  v_mfma_f32_16x16x32_bf16 v[44:47], v[96:99], v[56:59], v[44:47]
  v_add_f32 v18, v18, v26
  v_add_f32 v19, v19, v27
  v_mfma_f32_16x16x32_bf16 v[48:51], v[100:103], v[56:59], v[48:51]
  v_cvt_pk_bf16_f32 v20, v16, v17
  v_cvt_pk_bf16_f32 v21, v18, v19
  v_mfma_f32_16x16x32_bf16 v[52:55], v[104:107], v[56:59], v[52:55]
  ds_read_b128 v[88:91], v7 offset:15360
  s_waitcnt vmcnt(5)
  v_mfma_f32_16x16x32_bf16 v[36:39], a[216:219], v[60:63], v[36:39]
  ds_read_b128 v[92:95], v7 offset:16384
  ds_read_b128 v[96:99], v7 offset:17408
  v_mfma_f32_16x16x32_bf16 v[40:43], a[220:223], v[60:63], v[40:43]
  ds_read_b128 v[100:103], v7 offset:18432
  ds_read_b128 v[104:107], v7 offset:19456
  v_mfma_f32_16x16x32_bf16 v[44:47], a[224:227], v[60:63], v[44:47]
  s_add_u32 s49, s52, 40960
  buffer_store_dwordx2 v[20:21], v14, s[32:35], s49 offen
  v_mfma_f32_16x16x32_bf16 v[48:51], a[228:231], v[60:63], v[48:51]
  v_mfma_f32_16x16x32_bf16 v[52:55], a[232:235], v[60:63], v[52:55]
  s_waitcnt vmcnt(4)
  v_mfma_f32_16x16x32_bf16 v[36:39], a[236:239], v[120:123], v[36:39]
  v_mfma_f32_16x16x32_bf16 v[40:43], a[240:243], v[120:123], v[40:43]
  v_mfma_f32_16x16x32_bf16 v[44:47], a[244:247], v[120:123], v[44:47]
  v_mfma_f32_16x16x32_bf16 v[48:51], a[248:251], v[120:123], v[48:51]
  v_mfma_f32_16x16x32_bf16 v[52:55], a[252:255], v[120:123], v[52:55]
  s_waitcnt vmcnt(3)
  s_waitcnt lgkmcnt(0)
  v_mfma_f32_16x16x32_bf16 v[36:39], v[88:91], v[124:127], v[36:39]
  v_mfma_f32_16x16x32_bf16 v[40:43], v[92:95], v[124:127], v[40:43]
  v_mfma_f32_16x16x32_bf16 v[44:47], v[96:99], v[124:127], v[44:47]
  v_mfma_f32_16x16x32_bf16 v[48:51], v[100:103], v[124:127], v[48:51]
  v_mfma_f32_16x16x32_bf16 v[52:55], v[104:107], v[124:127], v[52:55]
  s_nop 3
  ds_write_b128 v3, v[36:39] offset:16384
  ds_write_b128 v3, v[40:43] offset:17408
  ds_write_b128 v3, v[44:47] offset:18432
  ds_write_b128 v3, v[48:51] offset:19456
  ds_write_b128 v15, v[52:55] offset:12288
  s_waitcnt vmcnt(1)
  v_lshlrev_b32 v104, 16, v128
  v_and_b32 v105, 0xffff0000, v128
  v_lshlrev_b32 v106, 16, v129
  v_and_b32 v107, 0xffff0000, v129
  v_lshlrev_b32 v32, 16, v110
  v_and_b32 v33, 0xffff0000, v110
  v_lshlrev_b32 v34, 16, v111
  v_and_b32 v35, 0xffff0000, v111
  s_waitcnt lgkmcnt(0)
  s_barrier
  ds_read_b128 v[16:19], v13 offset:16384
  ds_read_b128 v[20:23], v13 offset:20480
  ds_read_b128 v[24:27], v13 offset:24576
  ds_read_b128 v[28:31], v13 offset:28672
  ds_read_b128 v[88:91], v5 offset:0
  ds_read_b128 v[92:95], v5 offset:1024
  ds_read_b128 v[96:99], v5 offset:2048
  ds_read_b128 v[100:103], v5 offset:3072
  s_waitcnt lgkmcnt(4)
  v_pk_add_f32 v[16:17], v[16:17], v[20:21]
  v_pk_add_f32 v[24:25], v[24:25], v[28:29]
  v_pk_add_f32 v[18:19], v[18:19], v[22:23]
  v_pk_add_f32 v[26:27], v[26:27], v[30:31]
  v_pk_add_f32 v[16:17], v[16:17], v[32:33]
  v_pk_add_f32 v[18:19], v[18:19], v[34:35]
  v_pk_add_f32 v[16:17], v[16:17], v[24:25]
  v_pk_add_f32 v[18:19], v[18:19], v[26:27]
  v_cvt_pk_bf16_f32 v20, v16, v17
  v_cvt_pk_bf16_f32 v21, v18, v19
  s_add_u32 s49, s52, 61440
  buffer_store_dwordx2 v[20:21], v14, s[32:35], s49 offen
  s_waitcnt lgkmcnt(0)
  v_pk_add_f32 v[88:89], v[88:89], v[92:93]
  v_pk_add_f32 v[96:97], v[96:97], v[100:101]
  v_pk_add_f32 v[90:91], v[90:91], v[94:95]
  v_pk_add_f32 v[98:99], v[98:99], v[102:103]
  v_pk_add_f32 v[88:89], v[88:89], v[104:105]
  v_pk_add_f32 v[90:91], v[90:91], v[106:107]
  v_pk_add_f32 v[88:89], v[88:89], v[96:97]
  v_pk_add_f32 v[90:91], v[90:91], v[98:99]
  v_cvt_pk_bf16_f32 v92, v88, v89
  v_cvt_pk_bf16_f32 v93, v90, v91
  s_add_u32 s49, s53, 0
  buffer_store_dwordx2 v[92:93], v14, s[32:35], s49 offen
L_fin_f:
  s_endpgm
L_slow_conv:
  buffer_wbl2 sc1
  s_waitcnt vmcnt(0)
  s_add_u32 s46, s64, 36864
  s_mov_b64 exec, 1
  buffer_store_dword v1, off, s[4:7], s46 sc1
  s_mov_b64 exec, -1
  s_add_u32 s46, s65, 36864
Lpoll_43:
  buffer_load_dwordx4 v[8:11], v95, s[4:7], s46 offen sc1
  s_waitcnt vmcnt(0)
  v_bitop3_b32 v8, v8, v9, v1 bitop3:0x7e
  v_bitop3_b32 v10, v10, v11, v1 bitop3:0x7e
  v_or_b32 v8, v8, v10
  v_cmp_ne_u32 vcc, 0, v8
  s_nop 3
  s_cbranch_vccnz Lpoll_43
  buffer_inv sc1
  s_waitcnt vmcnt(0)
  s_mov_b32 m0, s49
  s_nop 0
  buffer_load_dwordx4 v236, s[4:7], s52 offen sc1 lds
  s_add_u32 s49, s49, 1024
  s_mov_b32 m0, s49
  s_nop 0
  buffer_load_dwordx4 v237, s[4:7], s52 offen sc1 lds
  s_add_u32 s49, s49, 1024
  s_mov_b32 m0, s49
  s_nop 0
  buffer_load_dwordx4 v238, s[4:7], s52 offen sc1 lds
  s_add_u32 s49, s49, 1024
  s_mov_b32 m0, s49
  s_nop 0
  buffer_load_dwordx4 v239, s[4:7], s52 offen sc1 lds
  s_add_u32 s49, s49, 1024
  v_and_b32 v14, 7, v0
  v_lshrrev_b32 v15, 3, v0
  s_lshl_b32 s59, s42, 3
  v_add_u32 v15, s59, v15
  v_mul_u32_u24 v14, 1280, v14
  v_lshl_add_u32 v14, v15, 4, v14
  s_lshl_b32 s59, s40, 5
  s_add_u32 s59, s59, s41
  s_mul_i32 s59, s59, 10240
  s_add_u32 s60, s59, s66
  buffer_load_dwordx4 v[72:75], v14, s[8:11], s59 offen offset:0 nt
  buffer_load_dwordx4 v[76:79], v14, s[8:11], s59 offen offset:512 nt
  buffer_load_dwordx4 v[80:83], v14, s[8:11], s60 offen offset:1024 nt
  ds_read_b64 a[12:13], v232 offset:192
  ds_read_b64 a[14:15], v232 offset:200
  ds_read_b64 a[44:45], v232 offset:704
  ds_read_b64 a[46:47], v232 offset:712
  ds_read_b64 a[76:77], v232 offset:1216
  ds_read_b64 a[78:79], v232 offset:1224
  ds_read_b64 a[108:109], v232 offset:1728
  ds_read_b64 a[110:111], v232 offset:1736
  ds_read_b64 a[140:141], v232 offset:2240
  ds_read_b64 a[142:143], v232 offset:2248
  ds_read_b64 a[172:173], v232 offset:2752
  ds_read_b64 a[174:175], v232 offset:2760
  ds_read_b64 a[204:205], v232 offset:3264
  ds_read_b64 a[206:207], v232 offset:3272
  ds_read_b64 a[236:237], v232 offset:3776
  ds_read_b64 a[238:239], v232 offset:3784
  ds_read_b64 a[8:9], v232 offset:128
  ds_read_b64 a[10:11], v232 offset:136
  ds_read_b64 a[40:41], v232 offset:640
  ds_read_b64 a[42:43], v232 offset:648
  ds_read_b64 a[72:73], v232 offset:1152
  ds_read_b64 a[74:75], v232 offset:1160
  ds_read_b64 a[104:105], v232 offset:1664
  ds_read_b64 a[106:107], v232 offset:1672
  ds_read_b64 a[136:137], v232 offset:2176
  ds_read_b64 a[138:139], v232 offset:2184
  ds_read_b64 a[168:169], v232 offset:2688
  ds_read_b64 a[170:171], v232 offset:2696
  ds_read_b64 a[200:201], v232 offset:3200
  ds_read_b64 a[202:203], v232 offset:3208
  ds_read_b64 a[232:233], v232 offset:3712
  ds_read_b64 a[234:235], v232 offset:3720
  ds_read_b64 a[4:5], v232 offset:64
  ds_read_b64 a[6:7], v232 offset:72
  ds_read_b64 a[36:37], v232 offset:576
  ds_read_b64 a[38:39], v232 offset:584
  ds_read_b64 a[68:69], v232 offset:1088
  ds_read_b64 a[70:71], v232 offset:1096
  ds_read_b64 a[100:101], v232 offset:1600
  ds_read_b64 a[102:103], v232 offset:1608
  ds_read_b64 a[132:133], v232 offset:2112
  ds_read_b64 a[134:135], v232 offset:2120
  ds_read_b64 a[164:165], v232 offset:2624
  ds_read_b64 a[166:167], v232 offset:2632
  ds_read_b64 a[196:197], v232 offset:3136
  ds_read_b64 a[198:199], v232 offset:3144
  ds_read_b64 a[228:229], v232 offset:3648
  ds_read_b64 a[230:231], v232 offset:3656
  ds_read_b64 a[0:1], v232 offset:0
  ds_read_b64 a[2:3], v232 offset:8
  ds_read_b64 a[32:33], v232 offset:512
  ds_read_b64 a[34:35], v232 offset:520
  ds_read_b64 a[64:65], v232 offset:1024
  ds_read_b64 a[66:67], v232 offset:1032
  ds_read_b64 a[96:97], v232 offset:1536
  ds_read_b64 a[98:99], v232 offset:1544
  ds_read_b64 a[128:129], v232 offset:2048
  ds_read_b64 a[130:131], v232 offset:2056
  ds_read_b64 a[160:161], v232 offset:2560
  ds_read_b64 a[162:163], v232 offset:2568
  ds_read_b64 a[192:193], v232 offset:3072
  ds_read_b64 a[194:195], v232 offset:3080
  ds_read_b64 a[224:225], v232 offset:3584
  ds_read_b64 a[226:227], v232 offset:3592
  s_waitcnt vmcnt(5)
  ds_read_b128 v[48:51], v233 offset:0
  ds_read_b128 v[52:55], v233 offset:64
  ds_read_b128 v[56:59], v233 offset:128
  s_waitcnt lgkmcnt(2)
  v_mfma_f32_16x16x32_bf16 v[16:19], a[28:31], v[48:51], 0
  ds_read_b128 v[60:63], v233 offset:192
  s_waitcnt lgkmcnt(14)
  v_mfma_f32_16x16x32_bf16 v[20:23], a[60:63], v[48:51], 0
  s_waitcnt lgkmcnt(14)
  v_mfma_f32_16x16x32_bf16 v[24:27], a[92:95], v[48:51], 0
  s_waitcnt lgkmcnt(14)
  v_mfma_f32_16x16x32_bf16 v[28:31], a[124:127], v[48:51], 0
  s_waitcnt lgkmcnt(14)
  v_mfma_f32_16x16x32_bf16 v[32:35], a[156:159], v[48:51], 0
  s_waitcnt lgkmcnt(14)
  v_mfma_f32_16x16x32_bf16 v[36:39], a[188:191], v[48:51], 0
  s_waitcnt lgkmcnt(14)
  v_mfma_f32_16x16x32_bf16 v[40:43], a[220:223], v[48:51], 0
  s_waitcnt lgkmcnt(14)
  v_mfma_f32_16x16x32_bf16 v[44:47], a[252:255], v[48:51], 0
  s_waitcnt lgkmcnt(2)
  v_mfma_f32_16x16x32_bf16 v[16:19], a[24:27], v[52:55], v[16:19]
  ds_read_b128 v[48:51], v233 offset:256
  s_waitcnt lgkmcnt(14)
  v_mfma_f32_16x16x32_bf16 v[20:23], a[56:59], v[52:55], v[20:23]
  s_waitcnt lgkmcnt(14)
  v_mfma_f32_16x16x32_bf16 v[24:27], a[88:91], v[52:55], v[24:27]
  s_waitcnt lgkmcnt(14)
  v_mfma_f32_16x16x32_bf16 v[28:31], a[120:123], v[52:55], v[28:31]
  s_waitcnt lgkmcnt(14)
  v_mfma_f32_16x16x32_bf16 v[32:35], a[152:155], v[52:55], v[32:35]
  s_waitcnt lgkmcnt(14)
  v_mfma_f32_16x16x32_bf16 v[36:39], a[184:187], v[52:55], v[36:39]
  s_waitcnt lgkmcnt(14)
  v_mfma_f32_16x16x32_bf16 v[40:43], a[216:219], v[52:55], v[40:43]
  s_waitcnt lgkmcnt(14)
  v_mfma_f32_16x16x32_bf16 v[44:47], a[248:251], v[52:55], v[44:47]
  s_waitcnt lgkmcnt(2)
  v_mfma_f32_16x16x32_bf16 v[16:19], a[20:23], v[56:59], v[16:19]
  ds_read_b128 v[52:55], v233 offset:320
  s_waitcnt lgkmcnt(14)
  v_mfma_f32_16x16x32_bf16 v[20:23], a[52:55], v[56:59], v[20:23]
  s_waitcnt lgkmcnt(14)
  v_mfma_f32_16x16x32_bf16 v[24:27], a[84:87], v[56:59], v[24:27]
  s_waitcnt lgkmcnt(14)
  v_mfma_f32_16x16x32_bf16 v[28:31], a[116:119], v[56:59], v[28:31]
  s_add_u32 m0, s54, 0
  s_nop 0
  buffer_load_dwordx4 v104, s[24:27], s3 offen lds
  s_waitcnt lgkmcnt(14)
  v_mfma_f32_16x16x32_bf16 v[32:35], a[148:151], v[56:59], v[32:35]
  s_waitcnt lgkmcnt(14)
  v_mfma_f32_16x16x32_bf16 v[36:39], a[180:183], v[56:59], v[36:39]
  s_waitcnt lgkmcnt(14)
  v_mfma_f32_16x16x32_bf16 v[40:43], a[212:215], v[56:59], v[40:43]
  s_waitcnt lgkmcnt(14)
  v_mfma_f32_16x16x32_bf16 v[44:47], a[244:247], v[56:59], v[44:47]
  s_waitcnt lgkmcnt(2)
  v_mfma_f32_16x16x32_bf16 v[16:19], a[16:19], v[60:63], v[16:19]
  ds_read_b128 v[56:59], v233 offset:384
  s_waitcnt lgkmcnt(14)
  v_mfma_f32_16x16x32_bf16 v[20:23], a[48:51], v[60:63], v[20:23]
  s_waitcnt lgkmcnt(14)
  v_mfma_f32_16x16x32_bf16 v[24:27], a[80:83], v[60:63], v[24:27]
  s_waitcnt lgkmcnt(14)
  v_mfma_f32_16x16x32_bf16 v[28:31], a[112:115], v[60:63], v[28:31]
  s_waitcnt lgkmcnt(14)
  v_mfma_f32_16x16x32_bf16 v[32:35], a[144:147], v[60:63], v[32:35]
  s_waitcnt lgkmcnt(14)
  v_mfma_f32_16x16x32_bf16 v[36:39], a[176:179], v[60:63], v[36:39]
  s_add_u32 m0, s54, 1024
  s_nop 0
  buffer_load_dwordx4 v105, s[24:27], s3 offen lds
  s_waitcnt lgkmcnt(14)
  v_mfma_f32_16x16x32_bf16 v[40:43], a[208:211], v[60:63], v[40:43]
  s_waitcnt lgkmcnt(14)
  v_mfma_f32_16x16x32_bf16 v[44:47], a[240:243], v[60:63], v[44:47]
  s_waitcnt lgkmcnt(2)
  v_mfma_f32_16x16x32_bf16 v[16:19], a[12:15], v[48:51], v[16:19]
  ds_read_b128 v[60:63], v233 offset:448
  s_waitcnt lgkmcnt(14)
  v_mfma_f32_16x16x32_bf16 v[20:23], a[44:47], v[48:51], v[20:23]
  s_waitcnt lgkmcnt(14)
  v_mfma_f32_16x16x32_bf16 v[24:27], a[76:79], v[48:51], v[24:27]
  s_waitcnt lgkmcnt(14)
  v_mfma_f32_16x16x32_bf16 v[28:31], a[108:111], v[48:51], v[28:31]
  s_waitcnt lgkmcnt(14)
  v_mfma_f32_16x16x32_bf16 v[32:35], a[140:143], v[48:51], v[32:35]
  s_waitcnt lgkmcnt(14)
  v_mfma_f32_16x16x32_bf16 v[36:39], a[172:175], v[48:51], v[36:39]
  s_waitcnt lgkmcnt(14)
  v_mfma_f32_16x16x32_bf16 v[40:43], a[204:207], v[48:51], v[40:43]
  s_waitcnt lgkmcnt(14)
  v_mfma_f32_16x16x32_bf16 v[44:47], a[236:239], v[48:51], v[44:47]
  s_add_u32 m0, s54, 2048
  s_nop 0
  buffer_load_dwordx4 v106, s[24:27], s3 offen lds
  s_add_u32 s3, s3, 24576
  s_cmp_eq_u32 s3, 491520
  s_cselect_b32 s3, 0, s3
  s_waitcnt lgkmcnt(2)
  v_mfma_f32_16x16x32_bf16 v[16:19], a[8:11], v[52:55], v[16:19]
  ds_read_b128 v[48:51], v233 offset:512
  s_waitcnt lgkmcnt(14)
  v_mfma_f32_16x16x32_bf16 v[20:23], a[40:43], v[52:55], v[20:23]
  s_waitcnt lgkmcnt(14)
  v_mfma_f32_16x16x32_bf16 v[24:27], a[72:75], v[52:55], v[24:27]
  s_waitcnt lgkmcnt(14)
  v_mfma_f32_16x16x32_bf16 v[28:31], a[104:107], v[52:55], v[28:31]
  s_waitcnt lgkmcnt(14)
  v_mfma_f32_16x16x32_bf16 v[32:35], a[136:139], v[52:55], v[32:35]
  s_waitcnt lgkmcnt(14)
  v_mfma_f32_16x16x32_bf16 v[36:39], a[168:171], v[52:55], v[36:39]
  s_waitcnt lgkmcnt(14)
  v_mfma_f32_16x16x32_bf16 v[40:43], a[200:203], v[52:55], v[40:43]
  s_waitcnt lgkmcnt(14)
  v_mfma_f32_16x16x32_bf16 v[44:47], a[232:235], v[52:55], v[44:47]
  s_waitcnt lgkmcnt(2)
  v_mfma_f32_16x16x32_bf16 v[16:19], a[4:7], v[56:59], v[16:19]
  ds_read_b128 v[52:55], v233 offset:576
  s_waitcnt lgkmcnt(14)
  v_mfma_f32_16x16x32_bf16 v[20:23], a[36:39], v[56:59], v[20:23]
  s_add_u32 m0, s54, 12320
  s_nop 0
  buffer_load_dwordx4 v104, s[24:27], s3 offen lds
  s_waitcnt lgkmcnt(14)
  v_mfma_f32_16x16x32_bf16 v[24:27], a[68:71], v[56:59], v[24:27]
  s_waitcnt lgkmcnt(14)
  v_mfma_f32_16x16x32_bf16 v[28:31], a[100:103], v[56:59], v[28:31]
  s_waitcnt lgkmcnt(14)
  v_mfma_f32_16x16x32_bf16 v[32:35], a[132:135], v[56:59], v[32:35]
  s_waitcnt lgkmcnt(14)
  v_mfma_f32_16x16x32_bf16 v[36:39], a[164:167], v[56:59], v[36:39]
  s_waitcnt lgkmcnt(14)
  v_mfma_f32_16x16x32_bf16 v[40:43], a[196:199], v[56:59], v[40:43]
  s_waitcnt lgkmcnt(14)
  v_mfma_f32_16x16x32_bf16 v[44:47], a[228:231], v[56:59], v[44:47]
  s_waitcnt lgkmcnt(2)
  v_mfma_f32_16x16x32_bf16 v[16:19], a[0:3], v[60:63], v[16:19]
  v_mfma_f32_16x16x32_bf16 v[16:19], v[228:231], v[60:63], v[16:19]
  ds_read_b128 v[56:59], v233 offset:640
  s_waitcnt lgkmcnt(14)
  v_mfma_f32_16x16x32_bf16 v[20:23], a[32:35], v[60:63], v[20:23]
  s_waitcnt lgkmcnt(14)
  v_mfma_f32_16x16x32_bf16 v[24:27], a[64:67], v[60:63], v[24:27]
  s_waitcnt lgkmcnt(14)
  v_mfma_f32_16x16x32_bf16 v[28:31], a[96:99], v[60:63], v[28:31]
  s_add_u32 m0, s54, 13344
  s_nop 0
  buffer_load_dwordx4 v105, s[24:27], s3 offen lds
  s_waitcnt lgkmcnt(14)
  v_mfma_f32_16x16x32_bf16 v[32:35], a[128:131], v[60:63], v[32:35]
  v_cvt_pk_bf16_f32 v68, v16, v17
  v_cvt_pk_bf16_f32 v69, v18, v19
  s_add_u32 s53, s51, 0
  buffer_store_dwordx2 v[68:69], v234, s[4:7], s53 offen sc1
  s_waitcnt lgkmcnt(14)
  v_mfma_f32_16x16x32_bf16 v[36:39], a[160:163], v[60:63], v[36:39]
  s_waitcnt lgkmcnt(13)
  v_mfma_f32_16x16x32_bf16 v[40:43], a[192:195], v[60:63], v[40:43]
  s_waitcnt lgkmcnt(11)
  v_mfma_f32_16x16x32_bf16 v[44:47], a[224:227], v[60:63], v[44:47]
  s_waitcnt lgkmcnt(2)
  v_mfma_f32_16x16x32_bf16 v[20:23], a[28:31], v[48:51], v[20:23]
  ds_read_b128 v[60:63], v233 offset:704
  s_barrier
  v_mfma_f32_16x16x32_bf16 v[24:27], a[60:63], v[48:51], v[24:27]
  v_mfma_f32_16x16x32_bf16 v[28:31], a[92:95], v[48:51], v[28:31]
  v_mfma_f32_16x16x32_bf16 v[32:35], a[124:127], v[48:51], v[32:35]
  v_mfma_f32_16x16x32_bf16 v[36:39], a[156:159], v[48:51], v[36:39]
  v_mfma_f32_16x16x32_bf16 v[40:43], a[188:191], v[48:51], v[40:43]
  s_add_u32 m0, s54, 14368
  s_nop 0
  buffer_load_dwordx4 v106, s[24:27], s3 offen lds
  s_add_u32 s3, s3, 24576
  s_cmp_eq_u32 s3, 491520
  s_cselect_b32 s3, 0, s3
  v_mfma_f32_16x16x32_bf16 v[44:47], a[220:223], v[48:51], v[44:47]
  s_waitcnt lgkmcnt(2)
  v_mfma_f32_16x16x32_bf16 v[20:23], a[24:27], v[52:55], v[20:23]
  ds_read_b128 v[48:51], v233 offset:768
  v_mfma_f32_16x16x32_bf16 v[24:27], a[56:59], v[52:55], v[24:27]
  v_mfma_f32_16x16x32_bf16 v[28:31], a[88:91], v[52:55], v[28:31]
  v_mfma_f32_16x16x32_bf16 v[32:35], a[120:123], v[52:55], v[32:35]
  v_mfma_f32_16x16x32_bf16 v[36:39], a[152:155], v[52:55], v[36:39]
  v_mfma_f32_16x16x32_bf16 v[40:43], a[184:187], v[52:55], v[40:43]
  v_mfma_f32_16x16x32_bf16 v[44:47], a[216:219], v[52:55], v[44:47]
  s_waitcnt lgkmcnt(2)
  v_mfma_f32_16x16x32_bf16 v[20:23], a[20:23], v[56:59], v[20:23]
  ds_read_b128 v[52:55], v233 offset:832
  v_mfma_f32_16x16x32_bf16 v[24:27], a[52:55], v[56:59], v[24:27]
  s_add_u32 m0, s54, 24640
  s_nop 0
  buffer_load_dwordx4 v104, s[24:27], s3 offen lds
  v_mfma_f32_16x16x32_bf16 v[28:31], a[84:87], v[56:59], v[28:31]
  v_mfma_f32_16x16x32_bf16 v[32:35], a[116:119], v[56:59], v[32:35]
  v_mfma_f32_16x16x32_bf16 v[36:39], a[148:151], v[56:59], v[36:39]
  v_mfma_f32_16x16x32_bf16 v[40:43], a[180:183], v[56:59], v[40:43]
  v_mfma_f32_16x16x32_bf16 v[44:47], a[212:215], v[56:59], v[44:47]
  s_waitcnt lgkmcnt(2)
  v_mfma_f32_16x16x32_bf16 v[20:23], a[16:19], v[60:63], v[20:23]
  ds_read_b128 v[56:59], v233 offset:896
  v_mfma_f32_16x16x32_bf16 v[24:27], a[48:51], v[60:63], v[24:27]
  v_mfma_f32_16x16x32_bf16 v[28:31], a[80:83], v[60:63], v[28:31]
  v_mfma_f32_16x16x32_bf16 v[32:35], a[112:115], v[60:63], v[32:35]
  v_mfma_f32_16x16x32_bf16 v[36:39], a[144:147], v[60:63], v[36:39]
  s_add_u32 m0, s54, 25664
  s_nop 0
  buffer_load_dwordx4 v105, s[24:27], s3 offen lds
  v_mfma_f32_16x16x32_bf16 v[40:43], a[176:179], v[60:63], v[40:43]
  v_mfma_f32_16x16x32_bf16 v[44:47], a[208:211], v[60:63], v[44:47]
  s_waitcnt lgkmcnt(2)
  v_mfma_f32_16x16x32_bf16 v[20:23], a[12:15], v[48:51], v[20:23]
  ds_read_b128 v[60:63], v233 offset:960
  v_mfma_f32_16x16x32_bf16 v[24:27], a[44:47], v[48:51], v[24:27]
  v_mfma_f32_16x16x32_bf16 v[28:31], a[76:79], v[48:51], v[28:31]
  v_mfma_f32_16x16x32_bf16 v[32:35], a[108:111], v[48:51], v[32:35]
  v_mfma_f32_16x16x32_bf16 v[36:39], a[140:143], v[48:51], v[36:39]
  v_mfma_f32_16x16x32_bf16 v[40:43], a[172:175], v[48:51], v[40:43]
  v_mfma_f32_16x16x32_bf16 v[44:47], a[204:207], v[48:51], v[44:47]
  s_waitcnt lgkmcnt(2)
  v_mfma_f32_16x16x32_bf16 v[20:23], a[8:11], v[52:55], v[20:23]
  s_waitcnt vmcnt(13)
  ds_read_b128 v[48:51], v233 offset:1024
  s_add_u32 m0, s54, 26688
  s_nop 0
  buffer_load_dwordx4 v106, s[24:27], s3 offen lds
  s_add_u32 s3, s3, 24576
  s_cmp_eq_u32 s3, 491520
  s_cselect_b32 s3, 0, s3
  v_mfma_f32_16x16x32_bf16 v[24:27], a[40:43], v[52:55], v[24:27]
  v_mfma_f32_16x16x32_bf16 v[28:31], a[72:75], v[52:55], v[28:31]
  v_mfma_f32_16x16x32_bf16 v[32:35], a[104:107], v[52:55], v[32:35]
  v_mfma_f32_16x16x32_bf16 v[36:39], a[136:139], v[52:55], v[36:39]
  v_mfma_f32_16x16x32_bf16 v[40:43], a[168:171], v[52:55], v[40:43]
  v_mfma_f32_16x16x32_bf16 v[44:47], a[200:203], v[52:55], v[44:47]
  s_waitcnt lgkmcnt(2)
  v_mfma_f32_16x16x32_bf16 v[20:23], a[4:7], v[56:59], v[20:23]
  ds_read_b128 v[52:55], v233 offset:1088
  v_mfma_f32_16x16x32_bf16 v[24:27], a[36:39], v[56:59], v[24:27]
  v_mfma_f32_16x16x32_bf16 v[28:31], a[68:71], v[56:59], v[28:31]
  v_mfma_f32_16x16x32_bf16 v[32:35], a[100:103], v[56:59], v[32:35]
  s_add_u32 m0, s54, 36960
  s_nop 0
  buffer_load_dwordx4 v104, s[24:27], s3 offen lds
  v_mfma_f32_16x16x32_bf16 v[36:39], a[132:135], v[56:59], v[36:39]
  v_mfma_f32_16x16x32_bf16 v[40:43], a[164:167], v[56:59], v[40:43]
  v_mfma_f32_16x16x32_bf16 v[44:47], a[196:199], v[56:59], v[44:47]
  s_waitcnt lgkmcnt(2)
  v_mfma_f32_16x16x32_bf16 v[20:23], a[0:3], v[60:63], v[20:23]
  v_mfma_f32_16x16x32_bf16 v[20:23], v[228:231], v[60:63], v[20:23]
  ds_read_b128 v[56:59], v233 offset:1152
  v_mfma_f32_16x16x32_bf16 v[24:27], a[32:35], v[60:63], v[24:27]
  v_mfma_f32_16x16x32_bf16 v[28:31], a[64:67], v[60:63], v[28:31]
  v_mfma_f32_16x16x32_bf16 v[32:35], a[96:99], v[60:63], v[32:35]
  v_mfma_f32_16x16x32_bf16 v[36:39], a[128:131], v[60:63], v[36:39]
  s_nop 2
  v_cvt_pk_bf16_f32 v70, v20, v21
  v_cvt_pk_bf16_f32 v71, v22, v23
  s_add_u32 s53, s51, 327680
  buffer_store_dwordx2 v[70:71], v234, s[4:7], s53 offen sc1
  v_mfma_f32_16x16x32_bf16 v[40:43], a[160:163], v[60:63], v[40:43]
  v_mfma_f32_16x16x32_bf16 v[44:47], a[192:195], v[60:63], v[44:47]
  s_add_u32 m0, s54, 37984
  s_nop 0
  buffer_load_dwordx4 v105, s[24:27], s3 offen lds
  s_waitcnt lgkmcnt(2)
  v_mfma_f32_16x16x32_bf16 v[24:27], a[28:31], v[48:51], v[24:27]
  ds_read_b128 v[60:63], v233 offset:1216
  v_mfma_f32_16x16x32_bf16 v[28:31], a[60:63], v[48:51], v[28:31]
  v_mfma_f32_16x16x32_bf16 v[32:35], a[92:95], v[48:51], v[32:35]
  v_mfma_f32_16x16x32_bf16 v[36:39], a[124:127], v[48:51], v[36:39]
  v_mfma_f32_16x16x32_bf16 v[40:43], a[156:159], v[48:51], v[40:43]
  v_mfma_f32_16x16x32_bf16 v[44:47], a[188:191], v[48:51], v[44:47]
  s_waitcnt lgkmcnt(2)
  v_mfma_f32_16x16x32_bf16 v[24:27], a[24:27], v[52:55], v[24:27]
  ds_read_b128 v[48:51], v233 offset:1280
  v_mfma_f32_16x16x32_bf16 v[28:31], a[56:59], v[52:55], v[28:31]
  v_mfma_f32_16x16x32_bf16 v[32:35], a[88:91], v[52:55], v[32:35]
  v_mfma_f32_16x16x32_bf16 v[36:39], a[120:123], v[52:55], v[36:39]
  s_add_u32 m0, s54, 39008
  s_nop 0
  buffer_load_dwordx4 v106, s[24:27], s3 offen lds
  s_add_u32 s3, s3, 24576
  s_cmp_eq_u32 s3, 491520
  s_cselect_b32 s3, 0, s3
  v_mfma_f32_16x16x32_bf16 v[40:43], a[152:155], v[52:55], v[40:43]
  v_mfma_f32_16x16x32_bf16 v[44:47], a[184:187], v[52:55], v[44:47]
  s_waitcnt lgkmcnt(2)
  v_mfma_f32_16x16x32_bf16 v[24:27], a[20:23], v[56:59], v[24:27]
  ds_read_b128 v[52:55], v233 offset:1344
  v_mfma_f32_16x16x32_bf16 v[28:31], a[52:55], v[56:59], v[28:31]
  v_mfma_f32_16x16x32_bf16 v[32:35], a[84:87], v[56:59], v[32:35]
  v_mfma_f32_16x16x32_bf16 v[36:39], a[116:119], v[56:59], v[36:39]
  v_mfma_f32_16x16x32_bf16 v[40:43], a[148:151], v[56:59], v[40:43]
  v_mfma_f32_16x16x32_bf16 v[44:47], a[180:183], v[56:59], v[44:47]
  s_waitcnt lgkmcnt(2)
  v_mfma_f32_16x16x32_bf16 v[24:27], a[16:19], v[60:63], v[24:27]
  ds_read_b128 v[56:59], v233 offset:1408
  v_mfma_f32_16x16x32_bf16 v[28:31], a[48:51], v[60:63], v[28:31]
  s_add_u32 m0, s54, 49280
  s_nop 0
  buffer_load_dwordx4 v104, s[24:27], s3 offen lds
  v_mfma_f32_16x16x32_bf16 v[32:35], a[80:83], v[60:63], v[32:35]
  v_mfma_f32_16x16x32_bf16 v[36:39], a[112:115], v[60:63], v[36:39]
  v_mfma_f32_16x16x32_bf16 v[40:43], a[144:147], v[60:63], v[40:43]
  v_mfma_f32_16x16x32_bf16 v[44:47], a[176:179], v[60:63], v[44:47]
  s_waitcnt lgkmcnt(2)
  v_mfma_f32_16x16x32_bf16 v[24:27], a[12:15], v[48:51], v[24:27]
  ds_read_b128 v[60:63], v233 offset:1472
  v_mfma_f32_16x16x32_bf16 v[28:31], a[44:47], v[48:51], v[28:31]
  v_mfma_f32_16x16x32_bf16 v[32:35], a[76:79], v[48:51], v[32:35]
  v_mfma_f32_16x16x32_bf16 v[36:39], a[108:111], v[48:51], v[36:39]
  v_mfma_f32_16x16x32_bf16 v[40:43], a[140:143], v[48:51], v[40:43]
  v_mfma_f32_16x16x32_bf16 v[44:47], a[172:175], v[48:51], v[44:47]
  s_add_u32 m0, s54, 50304
  s_nop 0
  buffer_load_dwordx4 v105, s[24:27], s3 offen lds
  s_waitcnt lgkmcnt(2)
  v_mfma_f32_16x16x32_bf16 v[24:27], a[8:11], v[52:55], v[24:27]
  ds_read_b128 v[48:51], v233 offset:1536
  v_mfma_f32_16x16x32_bf16 v[28:31], a[40:43], v[52:55], v[28:31]
  v_mfma_f32_16x16x32_bf16 v[32:35], a[72:75], v[52:55], v[32:35]
  v_mfma_f32_16x16x32_bf16 v[36:39], a[104:107], v[52:55], v[36:39]
  v_mfma_f32_16x16x32_bf16 v[40:43], a[136:139], v[52:55], v[40:43]
  v_mfma_f32_16x16x32_bf16 v[44:47], a[168:171], v[52:55], v[44:47]
  s_waitcnt lgkmcnt(2)
  v_mfma_f32_16x16x32_bf16 v[24:27], a[4:7], v[56:59], v[24:27]
  ds_read_b128 v[52:55], v233 offset:1600
  v_mfma_f32_16x16x32_bf16 v[28:31], a[36:39], v[56:59], v[28:31]
  v_mfma_f32_16x16x32_bf16 v[32:35], a[68:71], v[56:59], v[32:35]
  v_mfma_f32_16x16x32_bf16 v[36:39], a[100:103], v[56:59], v[36:39]
  s_add_u32 m0, s54, 51328
  s_nop 0
  buffer_load_dwordx4 v106, s[24:27], s3 offen lds
  s_add_u32 s3, s3, 24576
  s_cmp_eq_u32 s3, 491520
  s_cselect_b32 s3, 0, s3
  v_mfma_f32_16x16x32_bf16 v[40:43], a[132:135], v[56:59], v[40:43]
  v_mfma_f32_16x16x32_bf16 v[44:47], a[164:167], v[56:59], v[44:47]
  s_waitcnt lgkmcnt(2)
  v_mfma_f32_16x16x32_bf16 v[24:27], a[0:3], v[60:63], v[24:27]
  v_mfma_f32_16x16x32_bf16 v[24:27], v[228:231], v[60:63], v[24:27]
  ds_read_b128 v[56:59], v233 offset:1664
  v_mfma_f32_16x16x32_bf16 v[28:31], a[32:35], v[60:63], v[28:31]
  v_mfma_f32_16x16x32_bf16 v[32:35], a[64:67], v[60:63], v[32:35]
  v_mfma_f32_16x16x32_bf16 v[36:39], a[96:99], v[60:63], v[36:39]
  v_mfma_f32_16x16x32_bf16 v[40:43], a[128:131], v[60:63], v[40:43]
  s_nop 2
  v_cvt_pk_bf16_f32 v68, v24, v25
  v_cvt_pk_bf16_f32 v69, v26, v27
  s_add_u32 s53, s51, 655360
  buffer_store_dwordx2 v[68:69], v234, s[4:7], s53 offen sc1
  v_mfma_f32_16x16x32_bf16 v[44:47], a[160:163], v[60:63], v[44:47]
  s_waitcnt lgkmcnt(2)
  v_mfma_f32_16x16x32_bf16 v[28:31], a[28:31], v[48:51], v[28:31]
  ds_read_b128 v[60:63], v233 offset:1728
  v_mfma_f32_16x16x32_bf16 v[32:35], a[60:63], v[48:51], v[32:35]
  s_add_u32 m0, s54, 81920
  s_nop 0
  buffer_load_dwordx4 v104, s[24:27], s3 offen lds
  v_mfma_f32_16x16x32_bf16 v[36:39], a[92:95], v[48:51], v[36:39]
  v_mfma_f32_16x16x32_bf16 v[40:43], a[124:127], v[48:51], v[40:43]
  v_mfma_f32_16x16x32_bf16 v[44:47], a[156:159], v[48:51], v[44:47]
  s_waitcnt lgkmcnt(2)
  v_mfma_f32_16x16x32_bf16 v[28:31], a[24:27], v[52:55], v[28:31]
  ds_read_b128 v[48:51], v233 offset:1792
  v_mfma_f32_16x16x32_bf16 v[32:35], a[56:59], v[52:55], v[32:35]
  v_mfma_f32_16x16x32_bf16 v[36:39], a[88:91], v[52:55], v[36:39]
  v_mfma_f32_16x16x32_bf16 v[40:43], a[120:123], v[52:55], v[40:43]
  v_mfma_f32_16x16x32_bf16 v[44:47], a[152:155], v[52:55], v[44:47]
  s_waitcnt lgkmcnt(2)
  v_mfma_f32_16x16x32_bf16 v[28:31], a[20:23], v[56:59], v[28:31]
  ds_read_b128 v[52:55], v233 offset:1856
  v_mfma_f32_16x16x32_bf16 v[32:35], a[52:55], v[56:59], v[32:35]
  s_add_u32 m0, s54, 82944
  s_nop 0
  buffer_load_dwordx4 v105, s[24:27], s3 offen lds
  v_mfma_f32_16x16x32_bf16 v[36:39], a[84:87], v[56:59], v[36:39]
  v_mfma_f32_16x16x32_bf16 v[40:43], a[116:119], v[56:59], v[40:43]
  v_mfma_f32_16x16x32_bf16 v[44:47], a[148:151], v[56:59], v[44:47]
  s_waitcnt lgkmcnt(2)
  v_mfma_f32_16x16x32_bf16 v[28:31], a[16:19], v[60:63], v[28:31]
  ds_read_b128 v[56:59], v233 offset:1920
  v_mfma_f32_16x16x32_bf16 v[32:35], a[48:51], v[60:63], v[32:35]
  v_mfma_f32_16x16x32_bf16 v[36:39], a[80:83], v[60:63], v[36:39]
  v_mfma_f32_16x16x32_bf16 v[40:43], a[112:115], v[60:63], v[40:43]
  v_mfma_f32_16x16x32_bf16 v[44:47], a[144:147], v[60:63], v[44:47]
  s_waitcnt lgkmcnt(2)
  v_mfma_f32_16x16x32_bf16 v[28:31], a[12:15], v[48:51], v[28:31]
  ds_read_b128 v[60:63], v233 offset:1984
  v_mfma_f32_16x16x32_bf16 v[32:35], a[44:47], v[48:51], v[32:35]
  s_add_u32 m0, s54, 83968
  s_nop 0
  buffer_load_dwordx4 v106, s[24:27], s3 offen lds
  s_add_u32 s3, s3, 24576
  s_cmp_eq_u32 s3, 491520
  s_cselect_b32 s3, 0, s3
  v_mfma_f32_16x16x32_bf16 v[36:39], a[76:79], v[48:51], v[36:39]
  v_mfma_f32_16x16x32_bf16 v[40:43], a[108:111], v[48:51], v[40:43]
  v_mfma_f32_16x16x32_bf16 v[44:47], a[140:143], v[48:51], v[44:47]
  s_waitcnt lgkmcnt(2)
  v_mfma_f32_16x16x32_bf16 v[28:31], a[8:11], v[52:55], v[28:31]
  s_waitcnt vmcnt(24)
  ds_read_b128 v[48:51], v233 offset:2048
  v_mfma_f32_16x16x32_bf16 v[32:35], a[40:43], v[52:55], v[32:35]
  v_mfma_f32_16x16x32_bf16 v[36:39], a[72:75], v[52:55], v[36:39]
  v_mfma_f32_16x16x32_bf16 v[40:43], a[104:107], v[52:55], v[40:43]
  v_mfma_f32_16x16x32_bf16 v[44:47], a[136:139], v[52:55], v[44:47]
  s_waitcnt lgkmcnt(2)
  v_mfma_f32_16x16x32_bf16 v[28:31], a[4:7], v[56:59], v[28:31]
  ds_read_b128 v[52:55], v233 offset:2112
  v_mfma_f32_16x16x32_bf16 v[32:35], a[36:39], v[56:59], v[32:35]
  s_add_u32 m0, s54, 94240
  s_nop 0
  buffer_load_dwordx4 v104, s[24:27], s3 offen lds
  v_mfma_f32_16x16x32_bf16 v[36:39], a[68:71], v[56:59], v[36:39]
  v_mfma_f32_16x16x32_bf16 v[40:43], a[100:103], v[56:59], v[40:43]
  v_mfma_f32_16x16x32_bf16 v[44:47], a[132:135], v[56:59], v[44:47]
  s_waitcnt lgkmcnt(2)
  v_mfma_f32_16x16x32_bf16 v[28:31], a[0:3], v[60:63], v[28:31]
  v_mfma_f32_16x16x32_bf16 v[28:31], v[228:231], v[60:63], v[28:31]
  ds_read_b128 v[56:59], v233 offset:2176
  v_mfma_f32_16x16x32_bf16 v[32:35], a[32:35], v[60:63], v[32:35]
  v_mfma_f32_16x16x32_bf16 v[36:39], a[64:67], v[60:63], v[36:39]
  v_mfma_f32_16x16x32_bf16 v[40:43], a[96:99], v[60:63], v[40:43]
  v_mfma_f32_16x16x32_bf16 v[44:47], a[128:131], v[60:63], v[44:47]
  s_nop 2
  v_cvt_pk_bf16_f32 v70, v28, v29
  v_cvt_pk_bf16_f32 v71, v30, v31
  s_add_u32 s53, s51, 983040
  buffer_store_dwordx2 v[70:71], v234, s[4:7], s53 offen sc1
  s_waitcnt lgkmcnt(2)
  v_mfma_f32_16x16x32_bf16 v[32:35], a[28:31], v[48:51], v[32:35]
  ds_read_b128 v[60:63], v233 offset:2240
  v_mfma_f32_16x16x32_bf16 v[36:39], a[60:63], v[48:51], v[36:39]
  s_add_u32 m0, s54, 95264
  s_nop 0
  buffer_load_dwordx4 v105, s[24:27], s3 offen lds
  v_mfma_f32_16x16x32_bf16 v[40:43], a[92:95], v[48:51], v[40:43]
  v_mfma_f32_16x16x32_bf16 v[44:47], a[124:127], v[48:51], v[44:47]
  s_waitcnt lgkmcnt(2)
  v_mfma_f32_16x16x32_bf16 v[32:35], a[24:27], v[52:55], v[32:35]
  ds_read_b128 v[48:51], v233 offset:2304
  v_mfma_f32_16x16x32_bf16 v[36:39], a[56:59], v[52:55], v[36:39]
  v_mfma_f32_16x16x32_bf16 v[40:43], a[88:91], v[52:55], v[40:43]
  v_mfma_f32_16x16x32_bf16 v[44:47], a[120:123], v[52:55], v[44:47]
  s_waitcnt lgkmcnt(2)
  v_mfma_f32_16x16x32_bf16 v[32:35], a[20:23], v[56:59], v[32:35]
  ds_read_b128 v[52:55], v233 offset:2368
  v_mfma_f32_16x16x32_bf16 v[36:39], a[52:55], v[56:59], v[36:39]
  v_mfma_f32_16x16x32_bf16 v[40:43], a[84:87], v[56:59], v[40:43]
  v_mfma_f32_16x16x32_bf16 v[44:47], a[116:119], v[56:59], v[44:47]
  s_add_u32 m0, s54, 96288
  s_nop 0
  buffer_load_dwordx4 v106, s[24:27], s3 offen lds
  s_add_u32 s3, s3, 24576
  s_cmp_eq_u32 s3, 491520
  s_cselect_b32 s3, 0, s3
  s_waitcnt lgkmcnt(2)
  v_mfma_f32_16x16x32_bf16 v[32:35], a[16:19], v[60:63], v[32:35]
  ds_read_b128 v[56:59], v233 offset:2432
  v_mfma_f32_16x16x32_bf16 v[36:39], a[48:51], v[60:63], v[36:39]
  v_mfma_f32_16x16x32_bf16 v[40:43], a[80:83], v[60:63], v[40:43]
  v_mfma_f32_16x16x32_bf16 v[44:47], a[112:115], v[60:63], v[44:47]
  s_waitcnt lgkmcnt(2)
  v_mfma_f32_16x16x32_bf16 v[32:35], a[12:15], v[48:51], v[32:35]
  ds_read_b128 v[60:63], v233 offset:2496
  v_mfma_f32_16x16x32_bf16 v[36:39], a[44:47], v[48:51], v[36:39]
  v_mfma_f32_16x16x32_bf16 v[40:43], a[76:79], v[48:51], v[40:43]
  v_mfma_f32_16x16x32_bf16 v[44:47], a[108:111], v[48:51], v[44:47]
  s_waitcnt lgkmcnt(2)
  v_mfma_f32_16x16x32_bf16 v[32:35], a[8:11], v[52:55], v[32:35]
  ds_read_b128 v[48:51], v233 offset:2560
  v_mfma_f32_16x16x32_bf16 v[36:39], a[40:43], v[52:55], v[36:39]
  s_add_u32 m0, s54, 106560
  s_nop 0
  buffer_load_dwordx4 v104, s[24:27], s3 offen lds
  v_mfma_f32_16x16x32_bf16 v[40:43], a[72:75], v[52:55], v[40:43]
  v_mfma_f32_16x16x32_bf16 v[44:47], a[104:107], v[52:55], v[44:47]
  s_waitcnt lgkmcnt(2)
  v_mfma_f32_16x16x32_bf16 v[32:35], a[4:7], v[56:59], v[32:35]
  ds_read_b128 v[52:55], v233 offset:2624
  v_mfma_f32_16x16x32_bf16 v[36:39], a[36:39], v[56:59], v[36:39]
  v_mfma_f32_16x16x32_bf16 v[40:43], a[68:71], v[56:59], v[40:43]
  v_mfma_f32_16x16x32_bf16 v[44:47], a[100:103], v[56:59], v[44:47]
  s_waitcnt lgkmcnt(2)
  v_mfma_f32_16x16x32_bf16 v[32:35], a[0:3], v[60:63], v[32:35]
  v_mfma_f32_16x16x32_bf16 v[32:35], v[228:231], v[60:63], v[32:35]
  ds_read_b128 v[56:59], v233 offset:2688
  v_mfma_f32_16x16x32_bf16 v[36:39], a[32:35], v[60:63], v[36:39]
  v_mfma_f32_16x16x32_bf16 v[40:43], a[64:67], v[60:63], v[40:43]
  v_mfma_f32_16x16x32_bf16 v[44:47], a[96:99], v[60:63], v[44:47]
  s_add_u32 m0, s54, 107584
  s_nop 0
  buffer_load_dwordx4 v105, s[24:27], s3 offen lds
  s_waitcnt lgkmcnt(2)
  v_mfma_f32_16x16x32_bf16 v[36:39], a[28:31], v[48:51], v[36:39]
  ds_read_b128 v[60:63], v233 offset:2752
  v_cvt_pk_bf16_f32 v68, v32, v33
  v_cvt_pk_bf16_f32 v69, v34, v35
  s_add_u32 s53, s51, 1310720
  buffer_store_dwordx2 v[68:69], v234, s[4:7], s53 offen sc1
  v_mfma_f32_16x16x32_bf16 v[40:43], a[60:63], v[48:51], v[40:43]
  v_mfma_f32_16x16x32_bf16 v[44:47], a[92:95], v[48:51], v[44:47]
  s_waitcnt lgkmcnt(2)
  v_mfma_f32_16x16x32_bf16 v[36:39], a[24:27], v[52:55], v[36:39]
  ds_read_b128 v[48:51], v233 offset:2816
  v_mfma_f32_16x16x32_bf16 v[40:43], a[56:59], v[52:55], v[40:43]
  v_mfma_f32_16x16x32_bf16 v[44:47], a[88:91], v[52:55], v[44:47]
  s_waitcnt lgkmcnt(2)
  v_mfma_f32_16x16x32_bf16 v[36:39], a[20:23], v[56:59], v[36:39]
  ds_read_b128 v[52:55], v233 offset:2880
  v_mfma_f32_16x16x32_bf16 v[40:43], a[52:55], v[56:59], v[40:43]
  v_mfma_f32_16x16x32_bf16 v[44:47], a[84:87], v[56:59], v[44:47]
  s_waitcnt lgkmcnt(2)
  v_mfma_f32_16x16x32_bf16 v[36:39], a[16:19], v[60:63], v[36:39]
  ds_read_b128 v[56:59], v233 offset:2944
  v_mfma_f32_16x16x32_bf16 v[40:43], a[48:51], v[60:63], v[40:43]
  v_mfma_f32_16x16x32_bf16 v[44:47], a[80:83], v[60:63], v[44:47]
  s_waitcnt lgkmcnt(2)
  v_mfma_f32_16x16x32_bf16 v[36:39], a[12:15], v[48:51], v[36:39]
  ds_read_b128 v[60:63], v233 offset:3008
  v_mfma_f32_16x16x32_bf16 v[40:43], a[44:47], v[48:51], v[40:43]
  v_mfma_f32_16x16x32_bf16 v[44:47], a[76:79], v[48:51], v[44:47]
  s_waitcnt lgkmcnt(2)
  v_mfma_f32_16x16x32_bf16 v[36:39], a[8:11], v[52:55], v[36:39]
  s_waitcnt vmcnt(30)
  ds_read_b128 v[48:51], v233 offset:3072
  v_mfma_f32_16x16x32_bf16 v[40:43], a[40:43], v[52:55], v[40:43]
  v_mfma_f32_16x16x32_bf16 v[44:47], a[72:75], v[52:55], v[44:47]
  s_waitcnt lgkmcnt(2)
  v_mfma_f32_16x16x32_bf16 v[36:39], a[4:7], v[56:59], v[36:39]
  ds_read_b128 v[52:55], v233 offset:3136
  v_mfma_f32_16x16x32_bf16 v[40:43], a[36:39], v[56:59], v[40:43]
  v_mfma_f32_16x16x32_bf16 v[44:47], a[68:71], v[56:59], v[44:47]
  s_waitcnt lgkmcnt(2)
  v_mfma_f32_16x16x32_bf16 v[36:39], a[0:3], v[60:63], v[36:39]
  v_mfma_f32_16x16x32_bf16 v[36:39], v[228:231], v[60:63], v[36:39]
  ds_read_b128 v[56:59], v233 offset:3200
  v_mfma_f32_16x16x32_bf16 v[40:43], a[32:35], v[60:63], v[40:43]
  v_mfma_f32_16x16x32_bf16 v[44:47], a[64:67], v[60:63], v[44:47]
  s_waitcnt lgkmcnt(2)
  v_mfma_f32_16x16x32_bf16 v[40:43], a[28:31], v[48:51], v[40:43]
  ds_read_b128 v[60:63], v233 offset:3264
  v_mfma_f32_16x16x32_bf16 v[44:47], a[60:63], v[48:51], v[44:47]
  s_nop 0
  v_cvt_pk_bf16_f32 v70, v36, v37
  v_cvt_pk_bf16_f32 v71, v38, v39
  s_add_u32 s53, s51, 1638400
  buffer_store_dwordx2 v[70:71], v234, s[4:7], s53 offen sc1
  s_waitcnt lgkmcnt(2)
  v_mfma_f32_16x16x32_bf16 v[40:43], a[24:27], v[52:55], v[40:43]
  ds_read_b128 v[48:51], v233 offset:3328
  v_mfma_f32_16x16x32_bf16 v[44:47], a[56:59], v[52:55], v[44:47]
  s_waitcnt lgkmcnt(2)
  v_mfma_f32_16x16x32_bf16 v[40:43], a[20:23], v[56:59], v[40:43]
  ds_read_b128 v[52:55], v233 offset:3392
  v_mfma_f32_16x16x32_bf16 v[44:47], a[52:55], v[56:59], v[44:47]
  s_waitcnt lgkmcnt(2)
  v_mfma_f32_16x16x32_bf16 v[40:43], a[16:19], v[60:63], v[40:43]
  ds_read_b128 v[56:59], v233 offset:3456
  v_mfma_f32_16x16x32_bf16 v[44:47], a[48:51], v[60:63], v[44:47]
  s_waitcnt lgkmcnt(2)
  v_mfma_f32_16x16x32_bf16 v[40:43], a[12:15], v[48:51], v[40:43]
  ds_read_b128 v[60:63], v233 offset:3520
  v_mfma_f32_16x16x32_bf16 v[44:47], a[44:47], v[48:51], v[44:47]
  s_waitcnt lgkmcnt(2)
  v_mfma_f32_16x16x32_bf16 v[40:43], a[8:11], v[52:55], v[40:43]
  ds_read_b128 v[48:51], v233 offset:3584
  v_mfma_f32_16x16x32_bf16 v[44:47], a[40:43], v[52:55], v[44:47]
  s_waitcnt lgkmcnt(2)
  v_mfma_f32_16x16x32_bf16 v[40:43], a[4:7], v[56:59], v[40:43]
  ds_read_b128 v[52:55], v233 offset:3648
  v_mfma_f32_16x16x32_bf16 v[44:47], a[36:39], v[56:59], v[44:47]
  s_waitcnt lgkmcnt(2)
  v_mfma_f32_16x16x32_bf16 v[40:43], a[0:3], v[60:63], v[40:43]
  v_mfma_f32_16x16x32_bf16 v[40:43], v[228:231], v[60:63], v[40:43]
  ds_read_b128 v[56:59], v233 offset:3712
  v_mfma_f32_16x16x32_bf16 v[44:47], a[32:35], v[60:63], v[44:47]
  s_waitcnt lgkmcnt(2)
  v_mfma_f32_16x16x32_bf16 v[44:47], a[28:31], v[48:51], v[44:47]
  ds_read_b128 v[60:63], v233 offset:3776
  s_waitcnt lgkmcnt(2)
  v_mfma_f32_16x16x32_bf16 v[44:47], a[24:27], v[52:55], v[44:47]
  ds_read_b128 v[48:51], v233 offset:3840
  s_waitcnt lgkmcnt(2)
  v_mfma_f32_16x16x32_bf16 v[44:47], a[20:23], v[56:59], v[44:47]
  ds_read_b128 v[52:55], v233 offset:3904
  v_cvt_pk_bf16_f32 v68, v40, v41
  v_cvt_pk_bf16_f32 v69, v42, v43
  s_add_u32 s53, s51, 1966080
  buffer_store_dwordx2 v[68:69], v234, s[4:7], s53 offen sc1
  s_waitcnt lgkmcnt(2)
  v_mfma_f32_16x16x32_bf16 v[44:47], a[16:19], v[60:63], v[44:47]
  ds_read_b128 v[56:59], v233 offset:3968
  s_waitcnt lgkmcnt(2)
  v_mfma_f32_16x16x32_bf16 v[44:47], a[12:15], v[48:51], v[44:47]
  ds_read_b128 v[60:63], v233 offset:4032
  s_waitcnt lgkmcnt(2)
  v_mfma_f32_16x16x32_bf16 v[44:47], a[8:11], v[52:55], v[44:47]
  s_waitcnt lgkmcnt(1)
  v_mfma_f32_16x16x32_bf16 v[44:47], a[4:7], v[56:59], v[44:47]
  s_waitcnt lgkmcnt(0)
  v_mfma_f32_16x16x32_bf16 v[44:47], a[0:3], v[60:63], v[44:47]
  v_mfma_f32_16x16x32_bf16 v[44:47], v[228:231], v[60:63], v[44:47]
  s_nop 7
  v_cvt_pk_bf16_f32 v70, v44, v45
  v_cvt_pk_bf16_f32 v71, v46, v47
  s_add_u32 s53, s51, 2293760
  buffer_store_dwordx2 v[70:71], v234, s[4:7], s53 offen sc1
  s_waitcnt vmcnt(0)
  s_add_u32 s46, s64, 4096
  s_mov_b64 exec, 1
  buffer_store_dword v1, off, s[4:7], s46 sc1
  s_mov_b64 exec, -1
  s_barrier
  ds_read_b64_tr_b16 v[112:113], v107 offset:0
  ds_read_b64_tr_b16 v[114:115], v107 offset:3072
  ds_read_b64_tr_b16 v[116:117], v107 offset:16
  ds_read_b64_tr_b16 v[118:119], v107 offset:3088
  ds_read_b64_tr_b16 v[120:121], v108 offset:0
  ds_read_b64_tr_b16 v[122:123], v108 offset:3072
  ds_read_b64_tr_b16 v[124:125], v107 offset:12320
  ds_read_b64_tr_b16 v[126:127], v107 offset:15392
  ds_read_b64_tr_b16 v[128:129], v107 offset:12336
  ds_read_b64_tr_b16 v[130:131], v107 offset:15408
  ds_read_b64_tr_b16 v[132:133], v108 offset:12320
  ds_read_b64_tr_b16 v[134:135], v108 offset:15392
  ds_read_b64_tr_b16 v[136:137], v107 offset:24640
  ds_read_b64_tr_b16 v[138:139], v107 offset:27712
  ds_read_b64_tr_b16 v[140:141], v107 offset:24656
  ds_read_b64_tr_b16 v[142:143], v107 offset:27728
  ds_read_b64_tr_b16 v[144:145], v108 offset:24640
  ds_read_b64_tr_b16 v[146:147], v108 offset:27712
  ds_read_b64_tr_b16 v[148:149], v107 offset:36960
  ds_read_b64_tr_b16 v[150:151], v107 offset:40032
  ds_read_b64_tr_b16 v[152:153], v107 offset:36976
  ds_read_b64_tr_b16 v[154:155], v107 offset:40048
  ds_read_b64_tr_b16 v[156:157], v108 offset:36960
  ds_read_b64_tr_b16 v[158:159], v108 offset:40032
  ds_read_b64_tr_b16 v[160:161], v107 offset:49280
  ds_read_b64_tr_b16 v[162:163], v107 offset:52352
  ds_read_b64_tr_b16 v[164:165], v107 offset:49296
  ds_read_b64_tr_b16 v[166:167], v107 offset:52368
  ds_read_b64_tr_b16 v[168:169], v108 offset:49280
  ds_read_b64_tr_b16 v[170:171], v108 offset:52352
  s_waitcnt vmcnt(0)
  s_add_u32 s46, s65, 4096
  buffer_load_dwordx4 v[8:11], v95, s[4:7], s46 offen sc1
  s_add_u32 m0, s54, 108608
  s_nop 0
  buffer_load_dwordx4 v106, s[24:27], s3 offen lds
  s_add_u32 s3, s3, 24576
  s_cmp_eq_u32 s3, 491520
  s_cselect_b32 s3, 0, s3
  s_add_u32 m0, s54, 118880
  s_nop 0
  buffer_load_dwordx4 v104, s[24:27], s3 offen lds
  s_add_u32 m0, s54, 119904
  s_nop 0
  buffer_load_dwordx4 v105, s[24:27], s3 offen lds
  s_add_u32 m0, s54, 120928
  s_nop 0
  buffer_load_dwordx4 v106, s[24:27], s3 offen lds
  s_add_u32 s3, s3, 24576
  s_cmp_eq_u32 s3, 491520
  s_cselect_b32 s3, 0, s3
  s_add_u32 m0, s54, 131200
  s_nop 0
  buffer_load_dwordx4 v104, s[24:27], s3 offen lds
  s_add_u32 m0, s54, 132224
  s_nop 0
  buffer_load_dwordx4 v105, s[24:27], s3 offen lds
  s_add_u32 m0, s54, 133248
  s_nop 0
  buffer_load_dwordx4 v106, s[24:27], s3 offen lds
  s_add_u32 s3, s3, 24576
  s_cmp_eq_u32 s3, 491520
  s_cselect_b32 s3, 0, s3
  s_add_u32 m0, s54, 143520
  s_nop 0
  buffer_load_dwordx4 v104, s[24:27], s3 offen lds
  s_add_u32 m0, s54, 144544
  s_nop 0
  buffer_load_dwordx4 v105, s[24:27], s3 offen lds
  s_add_u32 m0, s54, 145568
  s_nop 0
  buffer_load_dwordx4 v106, s[24:27], s3 offen lds
  s_add_u32 s3, s3, 24576
  s_cmp_eq_u32 s3, 491520
  s_cselect_b32 s3, 0, s3
  s_waitcnt lgkmcnt(0)
  s_barrier
  v_lshrrev_b32 v12, 3, v0
  v_lshlrev_b32 v12, 10, v12
  v_and_b32 v13, 7, v0
  v_lshl_add_u32 v12, v13, 4, v12
  s_lshl_b32 s48, s40, 7
  s_add_u32 s48, s48, 77824
  s_waitcnt vmcnt(10)
  v_bitop3_b32 v8, v8, v9, v1 bitop3:0x7e
  v_bitop3_b32 v10, v10, v11, v1 bitop3:0x7e
  v_or_b32 v8, v8, v10
  v_cmp_ne_u32 vcc, 0, v8
  s_nop 3
  s_cbranch_vccnz Lypass_44
  v_mov_b32 v8, v1
  v_mov_b32 v9, v1
  v_mov_b32 v10, v1
  v_mov_b32 v11, v1
  buffer_store_dwordx4 v[8:11], v12, s[4:7], s48 offen sc1
Lypass_44:
  s_add_u32 m0, s54, 0
  s_nop 0
  buffer_load_dwordx4 v104, s[24:27], s3 offen lds
  ds_read_b64_tr_b16 v[172:173], v110 offset:0
  ds_read_b64_tr_b16 v[174:175], v110 offset:3072
  ds_read_b64_tr_b16 v[176:177], v110 offset:16
  s_add_u32 m0, s54, 1024
  s_nop 0
  buffer_load_dwordx4 v105, s[24:27], s3 offen lds
  ds_read_b64_tr_b16 v[178:179], v110 offset:3088
  ds_read_b64_tr_b16 v[180:181], v111 offset:0
  ds_read_b64_tr_b16 v[182:183], v111 offset:3072
  s_add_u32 m0, s54, 2048
  s_nop 0
  buffer_load_dwordx4 v106, s[24:27], s3 offen lds
  s_add_u32 s3, s3, 24576
  s_cmp_eq_u32 s3, 491520
  s_cselect_b32 s3, 0, s3
  ds_read_b64_tr_b16 v[184:185], v110 offset:12320
  ds_read_b64_tr_b16 v[186:187], v110 offset:15392
  ds_read_b64_tr_b16 v[188:189], v110 offset:12336
  s_add_u32 m0, s54, 12320
  s_nop 0
  buffer_load_dwordx4 v104, s[24:27], s3 offen lds
  ds_read_b64_tr_b16 v[190:191], v110 offset:15408
  ds_read_b64_tr_b16 v[192:193], v111 offset:12320
  ds_read_b64_tr_b16 v[194:195], v111 offset:15392
  s_add_u32 m0, s54, 13344
  s_nop 0
  buffer_load_dwordx4 v105, s[24:27], s3 offen lds
  s_add_u32 m0, s54, 14368
  s_nop 0
  buffer_load_dwordx4 v106, s[24:27], s3 offen lds
  s_add_u32 s3, s3, 24576
  s_cmp_eq_u32 s3, 491520
  s_cselect_b32 s3, 0, s3
  s_add_u32 m0, s54, 24640
  s_nop 0
  buffer_load_dwordx4 v104, s[24:27], s3 offen lds
  s_add_u32 m0, s54, 25664
  s_nop 0
  buffer_load_dwordx4 v105, s[24:27], s3 offen lds
  s_add_u32 m0, s54, 26688
  s_nop 0
  buffer_load_dwordx4 v106, s[24:27], s3 offen lds
  s_add_u32 s3, s3, 24576
  s_cmp_eq_u32 s3, 491520
  s_cselect_b32 s3, 0, s3
  s_add_u32 m0, s54, 36960
  s_nop 0
  buffer_load_dwordx4 v104, s[24:27], s3 offen lds
  s_add_u32 m0, s54, 37984
  s_nop 0
  buffer_load_dwordx4 v105, s[24:27], s3 offen lds
  s_add_u32 m0, s54, 39008
  s_nop 0
  buffer_load_dwordx4 v106, s[24:27], s3 offen lds
  s_add_u32 s3, s3, 24576
  s_cmp_eq_u32 s3, 491520
  s_cselect_b32 s3, 0, s3
  s_add_u32 m0, s54, 49280
  s_nop 0
  buffer_load_dwordx4 v104, s[24:27], s3 offen lds
  s_add_u32 m0, s54, 50304
  s_nop 0
  buffer_load_dwordx4 v105, s[24:27], s3 offen lds
  s_add_u32 m0, s54, 51328
  s_nop 0
  buffer_load_dwordx4 v106, s[24:27], s3 offen lds
  s_add_u32 s3, s3, 24576
  s_cmp_eq_u32 s3, 491520
  s_cselect_b32 s3, 0, s3
  s_waitcnt vmcnt(15)
  s_barrier
  ds_read_b64_tr_b16 v[196:197], v110 offset:24640
  ds_read_b64_tr_b16 v[198:199], v110 offset:27712
  ds_read_b64_tr_b16 v[200:201], v110 offset:24656
  ds_read_b64_tr_b16 v[202:203], v110 offset:27728
  ds_read_b64_tr_b16 v[204:205], v111 offset:24640
  ds_read_b64_tr_b16 v[206:207], v111 offset:27712
  ds_read_b64_tr_b16 v[208:209], v110 offset:36960
  ds_read_b64_tr_b16 v[210:211], v110 offset:40032
  ds_read_b64_tr_b16 v[212:213], v110 offset:36976
  ds_read_b64_tr_b16 v[214:215], v110 offset:40048
  ds_read_b64_tr_b16 v[216:217], v111 offset:36960
  ds_read_b64_tr_b16 v[218:219], v111 offset:40032
  ds_read_b64_tr_b16 v[220:221], v110 offset:49280
  ds_read_b64_tr_b16 v[222:223], v110 offset:52352
  ds_read_b64_tr_b16 v[224:225], v110 offset:49296
  ds_read_b64_tr_b16 v[226:227], v110 offset:52368
  ds_read_b64_tr_b16 v[228:229], v111 offset:49280
  ds_read_b64_tr_b16 v[230:231], v111 offset:52352
  ds_read_b64_tr_b16 v[232:233], v110 offset:61600
  ds_read_b64_tr_b16 v[234:235], v110 offset:64672
  ds_read_b64_tr_b16 v[236:237], v110 offset:61616
  ds_read_b64_tr_b16 v[238:239], v110 offset:64688
  ds_read_b64_tr_b16 v[240:241], v111 offset:61600
  ds_read_b64_tr_b16 v[242:243], v111 offset:64672
  s_waitcnt lgkmcnt(0)
  s_barrier
  s_branch L_join_s
L_slow_nc:
  buffer_wbl2 sc1
  s_waitcnt vmcnt(0)
  s_add_u32 s46, s64, 36864
  s_mov_b64 exec, 1
  buffer_store_dword v1, off, s[4:7], s46 sc1
  s_mov_b64 exec, -1
  s_add_u32 s46, s64, 4096
  s_mov_b64 exec, 1
  buffer_store_dword v1, off, s[4:7], s46 sc1
  s_mov_b64 exec, -1
  s_add_u32 m0, s54, 106560
  s_nop 0
  buffer_load_dwordx4 v104, s[24:27], s3 offen lds
  s_add_u32 m0, s54, 107584
  s_nop 0
  buffer_load_dwordx4 v105, s[24:27], s3 offen lds
  s_add_u32 m0, s54, 108608
  s_nop 0
  buffer_load_dwordx4 v106, s[24:27], s3 offen lds
  s_add_u32 s3, s3, 24576
  s_cmp_eq_u32 s3, 491520
  s_cselect_b32 s3, 0, s3
  s_add_u32 m0, s54, 118880
  s_nop 0
  buffer_load_dwordx4 v104, s[24:27], s3 offen lds
  s_add_u32 m0, s54, 119904
  s_nop 0
  buffer_load_dwordx4 v105, s[24:27], s3 offen lds
  s_add_u32 m0, s54, 120928
  s_nop 0
  buffer_load_dwordx4 v106, s[24:27], s3 offen lds
  s_add_u32 s3, s3, 24576
  s_cmp_eq_u32 s3, 491520
  s_cselect_b32 s3, 0, s3
  s_waitcnt vmcnt(6)
  s_add_u32 s46, s65, 4096
  buffer_load_dwordx4 v[8:11], v95, s[4:7], s46 offen sc1
  s_add_u32 m0, s54, 131200
  s_nop 0
  buffer_load_dwordx4 v104, s[24:27], s3 offen lds
  s_add_u32 m0, s54, 132224
  s_nop 0
  buffer_load_dwordx4 v105, s[24:27], s3 offen lds
  s_add_u32 m0, s54, 133248
  s_nop 0
  buffer_load_dwordx4 v106, s[24:27], s3 offen lds
  s_add_u32 s3, s3, 24576
  s_cmp_eq_u32 s3, 491520
  s_cselect_b32 s3, 0, s3
  s_add_u32 m0, s54, 143520
  s_nop 0
  buffer_load_dwordx4 v104, s[24:27], s3 offen lds
  s_add_u32 m0, s54, 144544
  s_nop 0
  buffer_load_dwordx4 v105, s[24:27], s3 offen lds
  s_add_u32 m0, s54, 145568
  s_nop 0
  buffer_load_dwordx4 v106, s[24:27], s3 offen lds
  s_add_u32 s3, s3, 24576
  s_cmp_eq_u32 s3, 491520
  s_cselect_b32 s3, 0, s3
  s_nop 0
  v_and_b32 v14, 7, v0
  v_lshrrev_b32 v15, 3, v0
  s_lshl_b32 s59, s42, 3
  v_add_u32 v15, s59, v15
  v_mul_u32_u24 v14, 1280, v14
  v_lshl_add_u32 v14, v15, 4, v14
  s_lshl_b32 s59, s40, 5
  s_add_u32 s59, s59, s41
  s_mul_i32 s59, s59, 10240
  s_add_u32 s60, s59, s66
  buffer_load_dwordx4 v[72:75], v14, s[8:11], s59 offen offset:0 nt
  buffer_load_dwordx4 v[76:79], v14, s[8:11], s59 offen offset:512 nt
  buffer_load_dwordx4 v[80:83], v14, s[8:11], s60 offen offset:1024 nt
  v_lshrrev_b32 v12, 3, v0
  v_lshlrev_b32 v12, 10, v12
  v_and_b32 v13, 7, v0
  v_lshl_add_u32 v12, v13, 4, v12
  s_lshl_b32 s48, s40, 7
  s_add_u32 s48, s48, 77824
  s_waitcnt vmcnt(8)
  v_bitop3_b32 v8, v8, v9, v1 bitop3:0x7e
  v_bitop3_b32 v10, v10, v11, v1 bitop3:0x7e
  v_or_b32 v8, v8, v10
  v_cmp_ne_u32 vcc, 0, v8
  s_nop 3
  s_cbranch_vccnz Lypass_45
  v_mov_b32 v8, v1
  v_mov_b32 v9, v1
  v_mov_b32 v10, v1
  v_mov_b32 v11, v1
  buffer_store_dwordx4 v[8:11], v12, s[4:7], s48 offen sc1
Lypass_45:
  s_waitcnt vmcnt(8)
  s_barrier
  ds_read_b64_tr_b16 v[112:113], v107 offset:0
  ds_read_b64_tr_b16 v[114:115], v107 offset:3072
  ds_read_b64_tr_b16 v[116:117], v107 offset:16
  ds_read_b64_tr_b16 v[118:119], v107 offset:3088
  ds_read_b64_tr_b16 v[120:121], v108 offset:0
  ds_read_b64_tr_b16 v[122:123], v108 offset:3072
  ds_read_b64_tr_b16 v[124:125], v107 offset:12320
  ds_read_b64_tr_b16 v[126:127], v107 offset:15392
  ds_read_b64_tr_b16 v[128:129], v107 offset:12336
  ds_read_b64_tr_b16 v[130:131], v107 offset:15408
  ds_read_b64_tr_b16 v[132:133], v108 offset:12320
  ds_read_b64_tr_b16 v[134:135], v108 offset:15392
  ds_read_b64_tr_b16 v[136:137], v107 offset:24640
  ds_read_b64_tr_b16 v[138:139], v107 offset:27712
  ds_read_b64_tr_b16 v[140:141], v107 offset:24656
  ds_read_b64_tr_b16 v[142:143], v107 offset:27728
  ds_read_b64_tr_b16 v[144:145], v108 offset:24640
  ds_read_b64_tr_b16 v[146:147], v108 offset:27712
  ds_read_b64_tr_b16 v[148:149], v107 offset:36960
  ds_read_b64_tr_b16 v[150:151], v107 offset:40032
  ds_read_b64_tr_b16 v[152:153], v107 offset:36976
  ds_read_b64_tr_b16 v[154:155], v107 offset:40048
  ds_read_b64_tr_b16 v[156:157], v108 offset:36960
  ds_read_b64_tr_b16 v[158:159], v108 offset:40032
  ds_read_b64_tr_b16 v[160:161], v107 offset:49280
  ds_read_b64_tr_b16 v[162:163], v107 offset:52352
  ds_read_b64_tr_b16 v[164:165], v107 offset:49296
  ds_read_b64_tr_b16 v[166:167], v107 offset:52368
  ds_read_b64_tr_b16 v[168:169], v108 offset:49280
  ds_read_b64_tr_b16 v[170:171], v108 offset:52352
  s_waitcnt lgkmcnt(0)
  s_barrier
  s_add_u32 m0, s54, 0
  s_nop 0
  buffer_load_dwordx4 v104, s[24:27], s3 offen lds
  s_add_u32 m0, s54, 1024
  s_nop 0
  buffer_load_dwordx4 v105, s[24:27], s3 offen lds
  s_add_u32 m0, s54, 2048
  s_nop 0
  buffer_load_dwordx4 v106, s[24:27], s3 offen lds
  s_add_u32 s3, s3, 24576
  s_cmp_eq_u32 s3, 491520
  s_cselect_b32 s3, 0, s3
  s_add_u32 m0, s54, 12320
  s_nop 0
  buffer_load_dwordx4 v104, s[24:27], s3 offen lds
  s_add_u32 m0, s54, 13344
  s_nop 0
  buffer_load_dwordx4 v105, s[24:27], s3 offen lds
  s_add_u32 m0, s54, 14368
  s_nop 0
  buffer_load_dwordx4 v106, s[24:27], s3 offen lds
  s_add_u32 s3, s3, 24576
  s_cmp_eq_u32 s3, 491520
  s_cselect_b32 s3, 0, s3
  s_add_u32 m0, s54, 24640
  s_nop 0
  buffer_load_dwordx4 v104, s[24:27], s3 offen lds
  s_add_u32 m0, s54, 25664
  s_nop 0
  buffer_load_dwordx4 v105, s[24:27], s3 offen lds
  s_add_u32 m0, s54, 26688
  s_nop 0
  buffer_load_dwordx4 v106, s[24:27], s3 offen lds
  s_add_u32 s3, s3, 24576
  s_cmp_eq_u32 s3, 491520
  s_cselect_b32 s3, 0, s3
  s_add_u32 m0, s54, 36960
  s_nop 0
  buffer_load_dwordx4 v104, s[24:27], s3 offen lds
  s_add_u32 m0, s54, 37984
  s_nop 0
  buffer_load_dwordx4 v105, s[24:27], s3 offen lds
  s_add_u32 m0, s54, 39008
  s_nop 0
  buffer_load_dwordx4 v106, s[24:27], s3 offen lds
  s_add_u32 s3, s3, 24576
  s_cmp_eq_u32 s3, 491520
  s_cselect_b32 s3, 0, s3
  s_add_u32 m0, s54, 49280
  s_nop 0
  buffer_load_dwordx4 v104, s[24:27], s3 offen lds
  s_add_u32 m0, s54, 50304
  s_nop 0
  buffer_load_dwordx4 v105, s[24:27], s3 offen lds
  s_add_u32 m0, s54, 51328
  s_nop 0
  buffer_load_dwordx4 v106, s[24:27], s3 offen lds
  s_add_u32 s3, s3, 24576
  s_cmp_eq_u32 s3, 491520
  s_cselect_b32 s3, 0, s3
  s_waitcnt vmcnt(15)
  s_barrier
  ds_read_b64_tr_b16 v[172:173], v110 offset:0
  ds_read_b64_tr_b16 v[174:175], v110 offset:3072
  ds_read_b64_tr_b16 v[176:177], v110 offset:16
  ds_read_b64_tr_b16 v[178:179], v110 offset:3088
  ds_read_b64_tr_b16 v[180:181], v111 offset:0
  ds_read_b64_tr_b16 v[182:183], v111 offset:3072
  ds_read_b64_tr_b16 v[184:185], v110 offset:12320
  ds_read_b64_tr_b16 v[186:187], v110 offset:15392
  ds_read_b64_tr_b16 v[188:189], v110 offset:12336
  ds_read_b64_tr_b16 v[190:191], v110 offset:15408
  ds_read_b64_tr_b16 v[192:193], v111 offset:12320
  ds_read_b64_tr_b16 v[194:195], v111 offset:15392
  ds_read_b64_tr_b16 v[196:197], v110 offset:24640
  ds_read_b64_tr_b16 v[198:199], v110 offset:27712
  ds_read_b64_tr_b16 v[200:201], v110 offset:24656
  ds_read_b64_tr_b16 v[202:203], v110 offset:27728
  ds_read_b64_tr_b16 v[204:205], v111 offset:24640
  ds_read_b64_tr_b16 v[206:207], v111 offset:27712
  ds_read_b64_tr_b16 v[208:209], v110 offset:36960
  ds_read_b64_tr_b16 v[210:211], v110 offset:40032
  ds_read_b64_tr_b16 v[212:213], v110 offset:36976
  ds_read_b64_tr_b16 v[214:215], v110 offset:40048
  ds_read_b64_tr_b16 v[216:217], v111 offset:36960
  ds_read_b64_tr_b16 v[218:219], v111 offset:40032
  ds_read_b64_tr_b16 v[220:221], v110 offset:49280
  ds_read_b64_tr_b16 v[222:223], v110 offset:52352
  ds_read_b64_tr_b16 v[224:225], v110 offset:49296
  ds_read_b64_tr_b16 v[226:227], v110 offset:52368
  ds_read_b64_tr_b16 v[228:229], v111 offset:49280
  ds_read_b64_tr_b16 v[230:231], v111 offset:52352
  ds_read_b64_tr_b16 v[232:233], v110 offset:61600
  ds_read_b64_tr_b16 v[234:235], v110 offset:64672
  ds_read_b64_tr_b16 v[236:237], v110 offset:61616
  ds_read_b64_tr_b16 v[238:239], v110 offset:64688
  ds_read_b64_tr_b16 v[240:241], v111 offset:61600
  ds_read_b64_tr_b16 v[242:243], v111 offset:64672
  s_waitcnt lgkmcnt(0)
  s_barrier
L_join_s:
  s_getpc_b64 s[12:13]
Lpc_46:
  s_add_u32 s12, s12, L_r1_s-Lpc_46
  s_addc_u32 s13, s13, 0
  s_lshl_b32 s14, s42, 3
  s_add_u32 s14, s14, s41
  s_and_b32 s14, s14, 31
  v_min_u32 v92, (L_r2_s-L_r1_s)/4096, v0
  v_lshl_add_u32 v92, v92, 5, s14
  v_lshlrev_b32 v92, 7, v92
  v_mov_b32 v93, s13
  v_add_co_u32 v92, vcc, s12, v92
  s_nop 1
  v_addc_co_u32 v93, vcc, 0, v93, vcc
  global_load_dword v94, v[92:93], off
  s_lshl_b32 s48, s40, 5
  s_add_u32 s48, s48, s41
  s_lshl_b32 s48, s48, 7
  s_add_u32 s48, s48, 98304
  v_and_b32 v91, 1, v0
  v_lshlrev_b32 v91, 15, v91
  buffer_load_dword v91, v91, s[4:7], s48 offen sc1
  s_add_u32 m0, s54, 81920
  s_nop 0
  buffer_load_dwordx4 v104, s[24:27], s3 offen lds
  s_add_u32 m0, s54, 82944
  s_nop 0
  buffer_load_dwordx4 v105, s[24:27], s3 offen lds
  v_mov_b32 v8, 0x3f803f80
  v_accvgpr_write_b32 a252, v8
  v_accvgpr_write_b32 a253, v8
  v_accvgpr_write_b32 a254, v8
  v_accvgpr_write_b32 a255, v8
  s_add_u32 m0, s54, 83968
  s_nop 0
  buffer_load_dwordx4 v106, s[24:27], s3 offen lds
  s_add_u32 s3, s3, 24576
  s_cmp_eq_u32 s3, 491520
  s_cselect_b32 s3, 0, s3
  v_mfma_f32_16x16x32_bf16 a[240:243], v[112:115], a[252:255], 0
  v_mfma_f32_16x16x32_bf16 a[244:247], v[116:119], a[252:255], 0
  v_mfma_f32_16x16x32_bf16 a[248:251], v[120:123], a[252:255], 0
  v_mfma_f32_16x16x32_bf16 a[240:243], v[124:127], a[252:255], a[240:243]
  v_mfma_f32_16x16x32_bf16 a[244:247], v[128:131], a[252:255], a[244:247]
  s_add_u32 m0, s54, 94240
  s_nop 0
  buffer_load_dwordx4 v104, s[24:27], s3 offen lds
  v_mfma_f32_16x16x32_bf16 a[248:251], v[132:135], a[252:255], a[248:251]
  v_mfma_f32_16x16x32_bf16 a[240:243], v[136:139], a[252:255], a[240:243]
  v_mfma_f32_16x16x32_bf16 a[244:247], v[140:143], a[252:255], a[244:247]
  v_mfma_f32_16x16x32_bf16 a[248:251], v[144:147], a[252:255], a[248:251]
  v_mfma_f32_16x16x32_bf16 a[240:243], v[148:151], a[252:255], a[240:243]
  s_add_u32 m0, s54, 95264
  s_nop 0
  buffer_load_dwordx4 v105, s[24:27], s3 offen lds
  v_mfma_f32_16x16x32_bf16 a[244:247], v[152:155], a[252:255], a[244:247]
  v_mfma_f32_16x16x32_bf16 a[248:251], v[156:159], a[252:255], a[248:251]
  v_mfma_f32_16x16x32_bf16 a[240:243], v[160:163], a[252:255], a[240:243]
  v_mfma_f32_16x16x32_bf16 a[244:247], v[164:167], a[252:255], a[244:247]
  v_mfma_f32_16x16x32_bf16 a[248:251], v[168:171], a[252:255], a[248:251]
  s_add_u32 m0, s54, 96288
  s_nop 0
  buffer_load_dwordx4 v106, s[24:27], s3 offen lds
  s_add_u32 s3, s3, 24576
  s_cmp_eq_u32 s3, 491520
  s_cselect_b32 s3, 0, s3
  v_mfma_f32_16x16x32_bf16 a[240:243], v[172:175], a[252:255], a[240:243]
  v_mfma_f32_16x16x32_bf16 a[244:247], v[176:179], a[252:255], a[244:247]
  v_mfma_f32_16x16x32_bf16 a[248:251], v[180:183], a[252:255], a[248:251]
  v_mfma_f32_16x16x32_bf16 a[240:243], v[184:187], a[252:255], a[240:243]
  v_mfma_f32_16x16x32_bf16 a[244:247], v[188:191], a[252:255], a[244:247]
  s_add_u32 m0, s54, 106560
  s_nop 0
  buffer_load_dwordx4 v104, s[24:27], s3 offen lds
  v_mfma_f32_16x16x32_bf16 a[248:251], v[192:195], a[252:255], a[248:251]
  v_mfma_f32_16x16x32_bf16 a[240:243], v[196:199], a[252:255], a[240:243]
  v_mfma_f32_16x16x32_bf16 a[244:247], v[200:203], a[252:255], a[244:247]
  v_mfma_f32_16x16x32_bf16 a[248:251], v[204:207], a[252:255], a[248:251]
  v_mfma_f32_16x16x32_bf16 a[240:243], v[208:211], a[252:255], a[240:243]
  s_add_u32 m0, s54, 107584
  s_nop 0
  buffer_load_dwordx4 v105, s[24:27], s3 offen lds
  v_mfma_f32_16x16x32_bf16 a[244:247], v[212:215], a[252:255], a[244:247]
  v_mfma_f32_16x16x32_bf16 a[248:251], v[216:219], a[252:255], a[248:251]
  v_mfma_f32_16x16x32_bf16 a[240:243], v[220:223], a[252:255], a[240:243]
  v_mfma_f32_16x16x32_bf16 a[244:247], v[224:227], a[252:255], a[244:247]
  v_mfma_f32_16x16x32_bf16 a[248:251], v[228:231], a[252:255], a[248:251]
  s_add_u32 m0, s54, 108608
  s_nop 0
  buffer_load_dwordx4 v106, s[24:27], s3 offen lds
  s_add_u32 s3, s3, 24576
  s_cmp_eq_u32 s3, 491520
  s_cselect_b32 s3, 0, s3
  v_mfma_f32_16x16x32_bf16 a[240:243], v[232:235], a[252:255], a[240:243]
  v_mfma_f32_16x16x32_bf16 a[244:247], v[236:239], a[252:255], a[244:247]
  v_mfma_f32_16x16x32_bf16 a[248:251], v[240:243], a[252:255], a[248:251]
  s_lshl_b32 s48, s42, 12
  v_lshlrev_b32 v5, 6, v0
  v_add_u32 v5, s48, v5
  s_add_u32 m0, s54, 118880
  s_nop 0
  buffer_load_dwordx4 v104, s[24:27], s3 offen lds
  s_mul_i32 s58, s42, 3072
  s_add_u32 s58, s58, 69632
  s_lshl_b32 s48, s40, 3
  s_lshr_b32 s61, s41, 2
  s_add_u32 s61, s61, s48
  s_mul_i32 s61, s61, 40960
  s_and_b32 s48, s41, 3
  s_lshl_b32 s48, s48, 4
  s_add_u32 s61, s61, s48
  s_add_u32 s61, s61, 7340032
  v_and_b32 v24, 7, v0
  v_lshrrev_b32 v25, 3, v0
  s_lshl_b32 s48, s42, 3
  v_add_u32 v25, s48, v25
  v_lshlrev_b32 v3, 4, v24
  s_lshl_b32 s48, s67, 2
  v_subrev_u32 v26, s48, v25
  s_add_u32 m0, s54, 119904
  s_nop 0
  buffer_load_dwordx4 v105, s[24:27], s3 offen lds
  v_add_u32 v27, 0, v25
  v_mul_u32_u24 v26, 205, v27
  v_lshrrev_b32 v26, 12, v26
  v_mul_u32_u24 v98, 20, v26
  v_sub_u32 v27, v27, v98
  s_add_u32 m0, s54, 120928
  s_nop 0
  buffer_load_dwordx4 v106, s[24:27], s3 offen lds
  s_add_u32 s3, s3, 24576
  s_cmp_eq_u32 s3, 491520
  s_cselect_b32 s3, 0, s3
  v_subrev_u32 v27, s67, v27
  v_add_u32 v98, 20, v27
  v_min_u32 v27, v27, v98
  v_lshl_add_u32 v27, v27, 2, v26
  v_lshl_add_u32 v99, v27, 8, v3
  v_add_u32 v27, 32, v25
  v_mul_u32_u24 v26, 205, v27
  v_lshrrev_b32 v26, 12, v26
  v_mul_u32_u24 v98, 20, v26
  v_sub_u32 v27, v27, v98
  v_subrev_u32 v27, s67, v27
  v_add_u32 v98, 20, v27
  v_min_u32 v27, v27, v98
  v_lshl_add_u32 v27, v27, 2, v26
  v_lshl_add_u32 v100, v27, 8, v3
  v_add_u32 v27, 64, v25
  v_mul_u32_u24 v26, 205, v27
  v_lshrrev_b32 v26, 12, v26
  v_mul_u32_u24 v98, 20, v26
  v_sub_u32 v27, v27, v98
  v_subrev_u32 v27, s67, v27
  v_add_u32 v98, 20, v27
  v_min_u32 v27, v27, v98
  v_lshl_add_u32 v27, v27, 2, v26
  v_lshl_add_u32 v101, v27, 8, v3
  v_lshrrev_b32 v25, 4, v0
  v_lshlrev_b32 v6, 8, v25
  v_bfe_u32 v26, v0, 1, 1
  v_lshl_add_u32 v6, v26, 7, v6
  v_bfe_u32 v26, v0, 2, 2
  v_lshl_add_u32 v6, v26, 4, v6
  v_and_b32 v26, 1, v0
  v_lshl_add_u32 v6, v26, 3, v6
  v_add_u32 v6, s58, v6
  v_lshlrev_b32 v90, 5, v24
  v_add_u32 v90, 61760, v90
  v_and_b32 v25, 1, v25
  v_lshl_add_u32 v7, v25, 4, v90
  s_lshl_b32 s48, s42, 2
  v_add_u32 v7, s48, v7
  s_lshl_b32 s48, s40, 5
  s_add_u32 s48, s48, s41
  s_lshl_b32 s59, s48, 7
  s_add_u32 s59, s59, 98304
  s_cmp_eq_u32 s42, 0
  s_cselect_b32 s59, s59, 0x80000000
  s_lshr_b32 s49, s48, 1
  s_mul_i32 s60, s49, 20480
  s_and_b32 s49, s41, 1
  s_lshl_b32 s49, s49, 7
  s_add_u32 s60, s60, s49
  s_add_u32 s60, s60, 1048576
  s_and_b32 s57, s41, 7
  s_lshl_b32 s57, s57, 2
  s_add_u32 s57, s57, s42
  s_mul_i32 s57, s57, 61440
  s_add_u32 s57, s57, 4194304
  s_mul_i32 s56, s42, 20480
  s_add_u32 s56, s56, 81920
  v_lshlrev_b32 v32, 16, v72
  v_and_b32 v33, 0xffff0000, v72
  v_lshlrev_b32 v34, 16, v73
  v_and_b32 v35, 0xffff0000, v73
  v_lshlrev_b32 v36, 16, v74
  v_and_b32 v37, 0xffff0000, v74
  v_lshlrev_b32 v38, 16, v75
  v_and_b32 v39, 0xffff0000, v75
  v_lshlrev_b32 v40, 16, v76
  v_and_b32 v41, 0xffff0000, v76
  v_lshlrev_b32 v42, 16, v77
  v_and_b32 v43, 0xffff0000, v77
  v_lshlrev_b32 v44, 16, v78
  v_and_b32 v45, 0xffff0000, v78
  v_lshlrev_b32 v46, 16, v79
  v_and_b32 v47, 0xffff0000, v79
  v_lshlrev_b32 v48, 16, v80
  v_and_b32 v49, 0xffff0000, v80
  v_lshlrev_b32 v50, 16, v81
  v_and_b32 v51, 0xffff0000, v81
  v_lshlrev_b32 v52, 16, v82
  v_and_b32 v53, 0xffff0000, v82
  v_lshlrev_b32 v54, 16, v83
  v_and_b32 v55, 0xffff0000, v83
  v_pk_add_f32 v[80:81], v[32:33], v[34:35]
  v_pk_mul_f32 v[82:83], v[32:33], v[32:33]
  v_pk_add_f32 v[84:85], v[36:37], v[38:39]
  v_pk_mul_f32 v[86:87], v[34:35], v[34:35]
  v_pk_fma_f32 v[82:83], v[36:37], v[36:37], v[82:83]
  v_pk_fma_f32 v[86:87], v[38:39], v[38:39], v[86:87]
  v_pk_add_f32 v[80:81], v[80:81], v[40:41]
  v_pk_fma_f32 v[82:83], v[40:41], v[40:41], v[82:83]
  v_pk_add_f32 v[84:85], v[84:85], v[42:43]
  v_pk_fma_f32 v[86:87], v[42:43], v[42:43], v[86:87]
  v_pk_add_f32 v[80:81], v[80:81], v[44:45]
  v_pk_fma_f32 v[82:83], v[44:45], v[44:45], v[82:83]
  v_pk_add_f32 v[84:85], v[84:85], v[46:47]
  v_pk_fma_f32 v[86:87], v[46:47], v[46:47], v[86:87]
  v_pk_add_f32 v[80:81], v[80:81], v[48:49]
  v_pk_fma_f32 v[82:83], v[48:49], v[48:49], v[82:83]
  v_pk_add_f32 v[84:85], v[84:85], v[50:51]
  v_pk_fma_f32 v[86:87], v[50:51], v[50:51], v[86:87]
  v_pk_add_f32 v[80:81], v[80:81], v[52:53]
  v_pk_fma_f32 v[82:83], v[52:53], v[52:53], v[82:83]
  v_pk_add_f32 v[84:85], v[84:85], v[54:55]
  v_pk_fma_f32 v[86:87], v[54:55], v[54:55], v[86:87]
  v_pk_add_f32 v[80:81], v[80:81], v[84:85]
  v_pk_add_f32 v[82:83], v[82:83], v[86:87]
  v_add_f32 v80, v80, v81
  v_add_f32 v82, v82, v83
  s_nop 0
  v_add_f32_dpp v80, v80, v80 row_ror:8 row_mask:0xf bank_mask:0xf
  v_add_f32_dpp v82, v82, v82 row_ror:8 row_mask:0xf bank_mask:0xf
  s_nop 1
  v_permlane16_swap_b32 v80, v82
  v_add_f32 v80, v80, v82
  v_mov_b32 v82, v80
  s_nop 1
  v_permlane32_swap_b32 v80, v82
  v_add_f32 v80, v80, v82
  s_mov_b64 exec, 0x00ff00ff
  ds_write_b32 v7, v80 offset:0
  s_mov_b64 exec, -1
  s_waitcnt lgkmcnt(0)
  s_barrier
  ds_read_b128 v[80:83], v90 offset:0
  ds_read_b128 v[84:87], v90 offset:16
  s_waitcnt lgkmcnt(0)
  v_pk_add_f32 v[80:81], v[80:81], v[82:83]
  v_pk_add_f32 v[84:85], v[84:85], v[86:87]
  v_add_f32 v80, v80, v81
  v_add_f32 v84, v84, v85
  v_mul_f32 v80, 0.0015625, v80
  v_mul_f32 v84, 0.0015625, v84
  v_fma_f32 v84, -v80, v80, v84
  v_max_f32 v84, 0, v84
  v_cvt_pk_bf16_f32 v84, v84, v80
  v_and_b32 v80, 0xffff0000, v84
  v_lshlrev_b32 v84, 16, v84
  v_add_f32 v84, 0x3727c5ac, v84
  v_cvt_pk_bf16_f32 v84, v84, v84
  v_lshlrev_b32 v84, 16, v84
  v_sqrt_f32 v84, v84
  s_nop 0
  v_cvt_pk_bf16_f32 v84, v84, v84
  v_lshlrev_b32 v84, 16, v84
  v_rcp_f32 v88, v84
  s_nop 0
  v_mul_f32 v89, v80, v88
  v_sub_f32 v89, 0, v89
  s_cmp_lg_u32 s42, 0
  s_cbranch_scc1 Lxdone_49
  s_cmp_lg_u32 s41, 31
  s_cbranch_scc1 Lnoagg_47
  v_and_b32 v80, 31, v0
  v_lshlrev_b32 v80, 4, v80
  s_add_u32 s46, s65, 4096
Lpoll_51:
  buffer_load_dwordx4 v[84:87], v80, s[4:7], s46 offen sc1
  s_waitcnt vmcnt(0)
  v_bitop3_b32 v84, v84, v85, v1 bitop3:0x7e
  v_bitop3_b32 v86, v86, v87, v1 bitop3:0x7e
  v_or_b32 v84, v84, v86
  v_cmp_ne_u32 vcc, 0, v84
  s_nop 3
  s_cbranch_vccnz Lpoll_51
  buffer_inv sc1
  s_waitcnt vmcnt(0)
  v_lshrrev_b32 v80, 3, v0
  v_lshlrev_b32 v80, 10, v80
  v_and_b32 v81, 7, v0
  v_lshl_add_u32 v80, v81, 4, v80
  v_mov_b32 v84, v1
  v_mov_b32 v85, v1
  v_mov_b32 v86, v1
  v_mov_b32 v87, v1
  s_lshl_b32 s48, s40, 7
  s_add_u32 s48, s48, 77824
  buffer_store_dwordx4 v[84:87], v80, s[4:7], s48 offen sc1
Lnoagg_47:
  v_and_b32 v80, 7, v0
  v_lshlrev_b32 v80, 7, v80
  s_lshl_b32 s48, s40, 10
  s_add_u32 s48, s48, 77824
Lxpoll_48:
  buffer_load_dword v81, v80, s[4:7], s48 offen sc1
  s_waitcnt vmcnt(0)
  v_cmp_ne_u32 vcc, v81, v1
  s_nop 3
  s_cbranch_vccnz Lxpoll_48
  s_cmp_lg_u32 s2, 0
  s_cbranch_scc1 Lxpoll_48e
  s_mov_b64 exec, 1
  buffer_store_dword v1, off, s[4:7], 0 offset:0 sc1
  s_mov_b64 exec, -1
Lxpoll_48e:
  s_barrier
  s_branch Lnoe_50
Lxdone_49:
  s_waitcnt vmcnt(0)
  s_barrier
Lnoe_50:
  buffer_inv sc1
  s_waitcnt vmcnt(0)
L_r1_s:
  s_add_u32 m0, s58, 0
  s_add_u32 s48, s61, 0
  buffer_load_dwordx4 v5, s[4:7], s48 offen sc1 lds
  s_add_u32 m0, s58, 1024
  s_add_u32 s48, s61, 16384
  buffer_load_dwordx4 v5, s[4:7], s48 offen sc1 lds
  s_add_u32 m0, s58, 2048
  s_add_u32 s48, s61, 32768
  s_add_u32 s48, s48, s66
  buffer_load_dwordx4 v5, s[4:7], s48 offen sc1 lds
  s_add_u32 s54, s57, 0
  buffer_load_dwordx4 a[96:99], v2, s[4:7], s54 offen offset:0 sc1
  buffer_load_dwordx4 a[100:103], v2, s[4:7], s54 offen offset:1024 sc1
  buffer_load_dwordx4 a[104:107], v2, s[4:7], s54 offen offset:2048 sc1
  buffer_load_dwordx4 a[108:111], v2, s[4:7], s54 offen offset:3072 sc1
  s_waitcnt vmcnt(4)
  ds_read_b64_tr_b16 v[20:21], v6 offset:0
  ds_read_b64_tr_b16 v[22:23], v6 offset:64
  ds_read_b64_tr_b16 v[24:25], v6 offset:1024
  ds_read_b64_tr_b16 v[26:27], v6 offset:1088
  ds_read_b64_tr_b16 v[28:29], v6 offset:2048
  ds_read_b64_tr_b16 v[30:31], v6 offset:2112
  s_waitcnt lgkmcnt(0)
  v_lshlrev_b32 v56, 16, v20
  v_and_b32 v57, 0xffff0000, v20
  v_lshlrev_b32 v58, 16, v21
  v_and_b32 v59, 0xffff0000, v21
  v_lshlrev_b32 v60, 16, v22
  v_and_b32 v61, 0xffff0000, v22
  v_lshlrev_b32 v62, 16, v23
  v_and_b32 v63, 0xffff0000, v23
  v_lshlrev_b32 v64, 16, v24
  v_and_b32 v65, 0xffff0000, v24
  v_lshlrev_b32 v66, 16, v25
  v_and_b32 v67, 0xffff0000, v25
  v_lshlrev_b32 v68, 16, v26
  v_and_b32 v69, 0xffff0000, v26
  v_lshlrev_b32 v70, 16, v27
  v_and_b32 v71, 0xffff0000, v27
  v_lshlrev_b32 v72, 16, v28
  v_and_b32 v73, 0xffff0000, v28
  v_lshlrev_b32 v74, 16, v29
  v_and_b32 v75, 0xffff0000, v29
  v_lshlrev_b32 v76, 16, v30
  v_and_b32 v77, 0xffff0000, v30
  v_lshlrev_b32 v78, 16, v31
  v_and_b32 v79, 0xffff0000, v31
  s_add_u32 s49, s60, s66
  v_pk_fma_f32 v[92:93], v[32:33], v[88:89], v[88:89] op_sel:[0,0,1] op_sel_hi:[1,0,1]
  v_pk_fma_f32 v[32:33], v[92:93], v[56:57], v[32:33]
  v_cvt_pk_bf16_f32 v20, v32, v33
  v_pk_fma_f32 v[94:95], v[34:35], v[88:89], v[88:89] op_sel:[0,0,1] op_sel_hi:[1,0,1]
  v_pk_fma_f32 v[34:35], v[94:95], v[58:59], v[34:35]
  v_cvt_pk_bf16_f32 v21, v34, v35
  v_pk_fma_f32 v[92:93], v[36:37], v[88:89], v[88:89] op_sel:[0,0,1] op_sel_hi:[1,0,1]
  v_pk_fma_f32 v[36:37], v[92:93], v[60:61], v[36:37]
  v_cvt_pk_bf16_f32 v22, v36, v37
  v_pk_fma_f32 v[94:95], v[38:39], v[88:89], v[88:89] op_sel:[0,0,1] op_sel_hi:[1,0,1]
  v_pk_fma_f32 v[38:39], v[94:95], v[62:63], v[38:39]
  v_cvt_pk_bf16_f32 v23, v38, v39
  buffer_store_dwordx4 v[20:23], v99, s[4:7], s60 offen sc1
  v_pk_fma_f32 v[92:93], v[40:41], v[88:89], v[88:89] op_sel:[0,0,1] op_sel_hi:[1,0,1]
  v_pk_fma_f32 v[40:41], v[92:93], v[64:65], v[40:41]
  v_cvt_pk_bf16_f32 v24, v40, v41
  v_pk_fma_f32 v[94:95], v[42:43], v[88:89], v[88:89] op_sel:[0,0,1] op_sel_hi:[1,0,1]
  v_pk_fma_f32 v[42:43], v[94:95], v[66:67], v[42:43]
  v_cvt_pk_bf16_f32 v25, v42, v43
  v_pk_fma_f32 v[92:93], v[44:45], v[88:89], v[88:89] op_sel:[0,0,1] op_sel_hi:[1,0,1]
  v_pk_fma_f32 v[44:45], v[92:93], v[68:69], v[44:45]
  v_cvt_pk_bf16_f32 v26, v44, v45
  v_pk_fma_f32 v[94:95], v[46:47], v[88:89], v[88:89] op_sel:[0,0,1] op_sel_hi:[1,0,1]
  v_pk_fma_f32 v[46:47], v[94:95], v[70:71], v[46:47]
  v_cvt_pk_bf16_f32 v27, v46, v47
  buffer_store_dwordx4 v[24:27], v100, s[4:7], s60 offen sc1
  v_pk_fma_f32 v[92:93], v[48:49], v[88:89], v[88:89] op_sel:[0,0,1] op_sel_hi:[1,0,1]
  v_pk_fma_f32 v[48:49], v[92:93], v[72:73], v[48:49]
  v_cvt_pk_bf16_f32 v28, v48, v49
  v_pk_fma_f32 v[94:95], v[50:51], v[88:89], v[88:89] op_sel:[0,0,1] op_sel_hi:[1,0,1]
  v_pk_fma_f32 v[50:51], v[94:95], v[74:75], v[50:51]
  v_cvt_pk_bf16_f32 v29, v50, v51
  v_pk_fma_f32 v[92:93], v[52:53], v[88:89], v[88:89] op_sel:[0,0,1] op_sel_hi:[1,0,1]
  v_pk_fma_f32 v[52:53], v[92:93], v[76:77], v[52:53]
  v_cvt_pk_bf16_f32 v30, v52, v53
  v_pk_fma_f32 v[94:95], v[54:55], v[88:89], v[88:89] op_sel:[0,0,1] op_sel_hi:[1,0,1]
  v_pk_fma_f32 v[54:55], v[94:95], v[78:79], v[54:55]
  v_cvt_pk_bf16_f32 v31, v54, v55
  buffer_store_dwordx4 v[28:31], v101, s[4:7], s49 offen sc1
  v_mov_b32 v93, v3
  s_mov_b32 s58, s59
  v_mov_b32 v84, 0x3f803f80
  v_dot2_f32_bf16 v80, v20, v84, 0
  v_dot2_f32_bf16 v82, v20, v20, 0
  v_dot2_f32_bf16 v81, v21, v84, 0
  v_dot2_f32_bf16 v83, v21, v21, 0
  v_dot2_f32_bf16 v80, v22, v84, v80
  v_dot2_f32_bf16 v82, v22, v22, v82
  v_dot2_f32_bf16 v81, v23, v84, v81
  v_dot2_f32_bf16 v83, v23, v23, v83
  v_dot2_f32_bf16 v80, v24, v84, v80
  v_dot2_f32_bf16 v82, v24, v24, v82
  v_dot2_f32_bf16 v81, v25, v84, v81
  v_dot2_f32_bf16 v83, v25, v25, v83
  v_dot2_f32_bf16 v80, v26, v84, v80
  v_dot2_f32_bf16 v82, v26, v26, v82
  v_dot2_f32_bf16 v81, v27, v84, v81
  v_dot2_f32_bf16 v83, v27, v27, v83
  v_dot2_f32_bf16 v80, v28, v84, v80
  v_dot2_f32_bf16 v82, v28, v28, v82
  v_dot2_f32_bf16 v81, v29, v84, v81
  v_dot2_f32_bf16 v83, v29, v29, v83
  v_dot2_f32_bf16 v80, v30, v84, v80
  v_dot2_f32_bf16 v82, v30, v30, v82
  v_dot2_f32_bf16 v81, v31, v84, v81
  v_dot2_f32_bf16 v83, v31, v31, v83
  s_nop 1
  v_add_f32 v80, v80, v81
  v_add_f32 v82, v82, v83
  s_nop 0
  v_add_f32_dpp v80, v80, v80 row_ror:8 row_mask:0xf bank_mask:0xf
  v_add_f32_dpp v82, v82, v82 row_ror:8 row_mask:0xf bank_mask:0xf
  s_nop 1
  v_permlane16_swap_b32 v80, v82
  v_add_f32 v80, v80, v82
  v_mov_b32 v82, v80
  s_nop 1
  v_permlane32_swap_b32 v80, v82
  v_add_f32 v80, v80, v82
  s_mov_b64 exec, 0x00ff00ff
  ds_write_b32 v7, v80 offset:256
  s_mov_b64 exec, -1
  ds_read_b64_tr_b16 v[244:245], v107 offset:0
  ds_read_b64_tr_b16 v[246:247], v107 offset:3072
  ds_read_b64_tr_b16 v[248:249], v107 offset:16
  ds_read_b64_tr_b16 v[250:251], v107 offset:3088
  ds_read_b64_tr_b16 v[252:253], v108 offset:0
  ds_read_b64_tr_b16 v[254:255], v108 offset:3072
  ds_read_b64_tr_b16 a[0:1], v107 offset:12320
  ds_read_b64_tr_b16 a[2:3], v107 offset:15392
  ds_read_b64_tr_b16 a[4:5], v107 offset:12336
  ds_read_b64_tr_b16 a[6:7], v107 offset:15408
  ds_read_b64_tr_b16 a[8:9], v108 offset:12320
  ds_read_b64_tr_b16 a[10:11], v108 offset:15392
  s_waitcnt vmcnt(0)
  s_add_u32 s46, s64, 8192
  s_mov_b64 exec, 1
  buffer_store_dword v1, off, s[4:7], s46 sc1
  s_mov_b64 exec, -1
  ds_read_b64_tr_b16 a[12:13], v107 offset:24640
  ds_read_b64_tr_b16 a[14:15], v107 offset:27712
  ds_read_b64_tr_b16 a[16:17], v107 offset:24656
  ds_read_b64_tr_b16 a[18:19], v107 offset:27728
  ds_read_b64_tr_b16 a[20:21], v108 offset:24640
  ds_read_b64_tr_b16 a[22:23], v108 offset:27712
  ds_read_b64_tr_b16 a[24:25], v107 offset:36960
  ds_read_b64_tr_b16 a[26:27], v107 offset:40032
  ds_read_b64_tr_b16 a[28:29], v107 offset:36976
  ds_read_b64_tr_b16 a[30:31], v107 offset:40048
  ds_read_b64_tr_b16 a[32:33], v108 offset:36960
  ds_read_b64_tr_b16 a[34:35], v108 offset:40032
  ds_read_b64_tr_b16 a[36:37], v107 offset:49280
  ds_read_b64_tr_b16 a[38:39], v107 offset:52352
  ds_read_b64_tr_b16 a[40:41], v107 offset:49296
  ds_read_b64_tr_b16 a[42:43], v107 offset:52368
  ds_read_b64_tr_b16 a[44:45], v108 offset:49280
  ds_read_b64_tr_b16 a[46:47], v108 offset:52352
  ds_read_b64_tr_b16 a[48:49], v110 offset:0
  ds_read_b64_tr_b16 a[50:51], v110 offset:3072
  ds_read_b64_tr_b16 a[52:53], v110 offset:16
  ds_read_b64_tr_b16 a[54:55], v110 offset:3088
  ds_read_b64_tr_b16 a[56:57], v111 offset:0
  ds_read_b64_tr_b16 a[58:59], v111 offset:3072
  ds_read_b64_tr_b16 a[60:61], v110 offset:12320
  ds_read_b64_tr_b16 a[62:63], v110 offset:15392
  ds_read_b64_tr_b16 a[64:65], v110 offset:12336
  ds_read_b64_tr_b16 a[66:67], v110 offset:15408
  ds_read_b64_tr_b16 a[68:69], v111 offset:12320
  ds_read_b64_tr_b16 a[70:71], v111 offset:15392
  ds_read_b64_tr_b16 a[72:73], v110 offset:24640
  ds_read_b64_tr_b16 a[74:75], v110 offset:27712
  ds_read_b64_tr_b16 a[76:77], v110 offset:24656
  ds_read_b64_tr_b16 a[78:79], v110 offset:27728
  ds_read_b64_tr_b16 a[80:81], v111 offset:24640
  ds_read_b64_tr_b16 a[82:83], v111 offset:27712
  ds_read_b64_tr_b16 a[84:85], v110 offset:36960
  ds_read_b64_tr_b16 a[86:87], v110 offset:40032
  ds_read_b64_tr_b16 a[88:89], v110 offset:36976
  ds_read_b64_tr_b16 a[90:91], v110 offset:40048
  ds_read_b64_tr_b16 a[92:93], v111 offset:36960
  ds_read_b64_tr_b16 a[94:95], v111 offset:40032
  s_add_u32 s54, s57, 4096
  buffer_load_dwordx4 a[112:115], v2, s[4:7], s54 offen offset:0 sc1
  buffer_load_dwordx4 a[116:119], v2, s[4:7], s54 offen offset:1024 sc1
  buffer_load_dwordx4 a[120:123], v2, s[4:7], s54 offen offset:2048 sc1
  buffer_load_dwordx4 a[124:127], v2, s[4:7], s54 offen offset:3072 sc1
  s_add_u32 s54, s57, 8192
  buffer_load_dwordx4 a[128:131], v2, s[4:7], s54 offen offset:0 sc1
  buffer_load_dwordx4 a[132:135], v2, s[4:7], s54 offen offset:1024 sc1
  buffer_load_dwordx4 a[136:139], v2, s[4:7], s54 offen offset:2048 sc1
  buffer_load_dwordx4 a[140:143], v2, s[4:7], s54 offen offset:3072 sc1
  s_add_u32 s54, s57, 12288
  buffer_load_dwordx4 a[144:147], v2, s[4:7], s54 offen offset:0 sc1
  buffer_load_dwordx4 a[148:151], v2, s[4:7], s54 offen offset:1024 sc1
  buffer_load_dwordx4 a[152:155], v2, s[4:7], s54 offen offset:2048 sc1
  buffer_load_dwordx4 a[156:159], v2, s[4:7], s54 offen offset:3072 sc1
  s_add_u32 s54, s57, 16384
  buffer_load_dwordx4 a[160:163], v2, s[4:7], s54 offen offset:0 sc1
  buffer_load_dwordx4 a[164:167], v2, s[4:7], s54 offen offset:1024 sc1
  v_and_b32 v5, 15, v0
  v_lshlrev_b32 v5, 4, v5
  v_bfe_u32 v6, v0, 4, 1
  v_lshl_add_u32 v7, v6, 8, v5
  s_lshl_b32 s48, s42, 8
  v_add_u32 v5, s48, v5
  v_mul_u32_u24 v6, 49152, v6
  v_add_u32 v5, v5, v6
  v_lshrrev_b32 v6, 5, v0
  v_lshl_add_u32 v3, v6, 10, v5
  v_lshl_add_u32 v4, v6, 3, v5
  v_add_u32 v4, 2048, v4
  v_mul_u32_u24 v13, 96, v6
  s_mul_i32 s48, s42, 192
  s_add_u32 s48, s48, 36864
  v_add_u32 v13, s48, v13
  v_add_u32 v5, 40960, v2
  s_lshr_b32 s49, s41, 4
  s_lshl_b32 s50, s40, 1
  s_add_u32 s50, s50, s49
  s_lshl_b32 s50, s50, 3
  s_and_b32 s48, s42, 1
  s_mul_i32 s48, s48, 20480
  s_lshr_b32 s53, s42, 1
  s_lshl_b32 s53, s53, 10
  s_add_u32 s53, s53, s48
  s_mul_i32 s51, s50, 20480
  s_add_u32 s51, s51, s53
  s_add_u32 s51, s51, 1048576
  s_lshl_b32 s48, s36, 10
  s_add_u32 s51, s51, s48
  s_cmp_eq_u32 s36, 0
  s_cselect_b32 s48, 0, 20480
  s_sub_u32 s61, s51, s48
  s_and_b32 s48, s41, 15
  s_mul_i32 s48, s48, 3072
  s_mul_i32 s52, s50, 49152
  s_add_u32 s52, s52, s48
  s_add_u32 s52, s52, 10485760
  s_lshl_b32 s62, s50, 8
  s_add_u32 s62, s62, 98304
  s_lshr_b32 s48, s41, 3
  s_lshl_b32 s59, s40, 2
  s_add_u32 s59, s59, s48
  s_mul_i32 s59, s59, 196608
  s_mul_i32 s48, s42, 12288
  s_add_u32 s59, s59, s48
  s_add_u32 s59, s59, 10485760
  s_mul_i32 s60, s42, 9216
  s_lshl_b32 s49, s49, 4
  v_and_b32 v6, 15, v0
  v_add_u32 v6, s49, v6
  v_lshlrev_b32 v6, 4, v6
  s_waitcnt lgkmcnt(0)
  s_barrier
  s_add_u32 s46, s65, 8192
Lpoll_52:
  buffer_load_dwordx4 v[8:11], v6, s[4:7], s46 offen sc1
  s_waitcnt vmcnt(0)
  v_bitop3_b32 v8, v8, v9, v1 bitop3:0x7e
  v_bitop3_b32 v10, v10, v11, v1 bitop3:0x7e
  v_or_b32 v8, v8, v10
  v_cmp_ne_u32 vcc, 0, v8
  s_nop 3
  s_cbranch_vccnz Lpoll_52
  buffer_inv sc1
  s_waitcnt vmcnt(0)
  s_add_u32 m0, s53, 0
  s_add_u32 s48, s51, 0
  buffer_load_dwordx4 v2, s[4:7], s48 offen offset:0 sc1 lds
  buffer_load_dwordx4 v2, s[4:7], s48 offen offset:2048 sc1 lds
  s_add_u32 m0, s53, 4096
  s_add_u32 s48, s51, 4096
  buffer_load_dwordx4 v2, s[4:7], s48 offen offset:0 sc1 lds
  buffer_load_dwordx4 v2, s[4:7], s48 offen offset:2048 sc1 lds
  s_lshl_b32 s55, s42, 2
  s_add_u32 s49, s49, s55
  v_and_b32 v6, 3, v0
  v_add_u32 v6, s49, v6
  v_lshlrev_b32 v6, 4, v6
  s_waitcnt lgkmcnt(0)
  s_barrier
  ds_read_b128 v[80:83], v90 offset:256
  ds_read_b128 v[84:87], v90 offset:272
  s_waitcnt lgkmcnt(0)
  v_pk_add_f32 v[80:81], v[80:81], v[82:83]
  v_pk_add_f32 v[84:85], v[84:85], v[86:87]
  v_add_f32 v80, v80, v81
  v_add_f32 v84, v84, v85
  v_mul_f32 v80, 0.0015625, v80
  v_mul_f32 v84, 0.0015625, v84
  v_fma_f32 v84, -v80, v80, v84
  v_max_f32 v84, 0, v84
  v_cvt_pk_bf16_f32 v84, v84, v80
  v_and_b32 v80, 0xffff0000, v84
  v_lshlrev_b32 v84, 16, v84
  v_add_f32 v84, 0x3727c5ac, v84
  v_cvt_pk_bf16_f32 v84, v84, v84
  v_lshlrev_b32 v84, 16, v84
  v_sqrt_f32 v84, v84
  s_nop 0
  v_cvt_pk_bf16_f32 v84, v84, v84
  v_lshlrev_b32 v84, 16, v84
  v_rcp_f32 v88, v84
  s_nop 0
  v_mul_f32 v89, v88, v88
  v_sub_f32 v88, 0, v80
  v_mov_b32 v90, v1
  v_mov_b32 v91, v1
  s_mov_b64 exec, 0xff
  buffer_store_dwordx4 v[88:91], v93, s[4:7], s58 offen sc1
  s_mov_b64 exec, -1
  s_waitcnt lgkmcnt(0)
  v_mfma_f32_16x16x32_bf16 a[240:243], v[244:247], a[252:255], a[240:243]
  v_mfma_f32_16x16x32_bf16 a[244:247], v[248:251], a[252:255], a[244:247]
  v_mfma_f32_16x16x32_bf16 a[248:251], v[252:255], a[252:255], a[248:251]
  v_mfma_f32_16x16x32_bf16 a[240:243], a[0:3], a[252:255], a[240:243]
  v_mfma_f32_16x16x32_bf16 a[244:247], a[4:7], a[252:255], a[244:247]
  v_mfma_f32_16x16x32_bf16 a[248:251], a[8:11], a[252:255], a[248:251]
  v_mfma_f32_16x16x32_bf16 a[240:243], a[12:15], a[252:255], a[240:243]
  v_mfma_f32_16x16x32_bf16 a[244:247], a[16:19], a[252:255], a[244:247]
  v_mfma_f32_16x16x32_bf16 a[248:251], a[20:23], a[252:255], a[248:251]
  v_mfma_f32_16x16x32_bf16 a[240:243], a[24:27], a[252:255], a[240:243]
  v_mfma_f32_16x16x32_bf16 a[244:247], a[28:31], a[252:255], a[244:247]
  v_mfma_f32_16x16x32_bf16 a[248:251], a[32:35], a[252:255], a[248:251]
  v_mfma_f32_16x16x32_bf16 a[240:243], a[36:39], a[252:255], a[240:243]
  v_mfma_f32_16x16x32_bf16 a[244:247], a[40:43], a[252:255], a[244:247]
  v_mfma_f32_16x16x32_bf16 a[248:251], a[44:47], a[252:255], a[248:251]
  v_mfma_f32_16x16x32_bf16 a[240:243], a[48:51], a[252:255], a[240:243]
  v_mfma_f32_16x16x32_bf16 a[244:247], a[52:55], a[252:255], a[244:247]
  v_mfma_f32_16x16x32_bf16 a[248:251], a[56:59], a[252:255], a[248:251]
  v_mfma_f32_16x16x32_bf16 a[240:243], a[60:63], a[252:255], a[240:243]
  v_mfma_f32_16x16x32_bf16 a[244:247], a[64:67], a[252:255], a[244:247]
  v_mfma_f32_16x16x32_bf16 a[248:251], a[68:71], a[252:255], a[248:251]
  v_mfma_f32_16x16x32_bf16 a[240:243], a[72:75], a[252:255], a[240:243]
  v_mfma_f32_16x16x32_bf16 a[244:247], a[76:79], a[252:255], a[244:247]
  v_mfma_f32_16x16x32_bf16 a[248:251], a[80:83], a[252:255], a[248:251]
  v_mfma_f32_16x16x32_bf16 a[240:243], a[84:87], a[252:255], a[240:243]
  v_mfma_f32_16x16x32_bf16 a[244:247], a[88:91], a[252:255], a[244:247]
  v_mfma_f32_16x16x32_bf16 a[248:251], a[92:95], a[252:255], a[248:251]
  s_waitcnt vmcnt(2)
  s_barrier
  ds_read_b128 v[64:67], v2 offset:0
  ds_read_b128 v[68:71], v2 offset:20480
  ds_read_b128 v[72:75], v2 offset:1024
  ds_read_b128 v[76:79], v2 offset:21504
  s_waitcnt lgkmcnt(2)
  v_mfma_f32_16x16x32_bf16 v[16:19], v[112:115], v[64:67], 0
  ds_read_b128 v[80:83], v2 offset:2048
  s_add_u32 m0, s53, 8192
  v_mfma_f32_16x16x32_bf16 v[28:31], v[112:115], v[68:71], 0
  ds_read_b128 v[84:87], v2 offset:22528
  s_add_u32 s48, s61, 8192
  v_mfma_f32_16x16x32_bf16 v[20:23], v[116:119], v[64:67], 0
  buffer_load_dwordx4 v2, s[4:7], s48 offen offset:0 sc1 lds
  buffer_load_dwordx4 v2, s[4:7], s48 offen offset:2048 sc1 lds
  v_mfma_f32_16x16x32_bf16 v[32:35], v[116:119], v[68:71], 0
  v_accvgpr_read_b32 v88, a240
  v_accvgpr_read_b32 v100, a240
  v_mfma_f32_16x16x32_bf16 v[24:27], v[120:123], v[64:67], 0
  v_accvgpr_read_b32 v89, a241
  v_accvgpr_read_b32 v101, a241
  v_mfma_f32_16x16x32_bf16 v[36:39], v[120:123], v[68:71], 0
  v_accvgpr_read_b32 v90, a242
  s_waitcnt lgkmcnt(2)
  v_mfma_f32_16x16x32_bf16 v[16:19], v[124:127], v[72:75], v[16:19]
  ds_read_b128 v[64:67], v2 offset:3072
  s_add_u32 m0, s53, 12288
  v_mfma_f32_16x16x32_bf16 v[28:31], v[124:127], v[76:79], v[28:31]
  ds_read_b128 v[68:71], v2 offset:23552
  s_add_u32 s48, s61, 12288
  v_mfma_f32_16x16x32_bf16 v[20:23], v[128:131], v[72:75], v[20:23]
  buffer_load_dwordx4 v2, s[4:7], s48 offen offset:0 sc1 lds
  buffer_load_dwordx4 v2, s[4:7], s48 offen offset:2048 sc1 lds
  v_mfma_f32_16x16x32_bf16 v[32:35], v[128:131], v[76:79], v[32:35]
  v_accvgpr_read_b32 v102, a242
  v_accvgpr_read_b32 v91, a243
  v_mfma_f32_16x16x32_bf16 v[24:27], v[132:135], v[72:75], v[24:27]
  v_accvgpr_read_b32 v103, a243
  v_accvgpr_read_b32 v92, a244
  v_mfma_f32_16x16x32_bf16 v[36:39], v[132:135], v[76:79], v[36:39]
  v_accvgpr_read_b32 v104, a244
  s_waitcnt lgkmcnt(2)
  v_mfma_f32_16x16x32_bf16 v[16:19], v[136:139], v[80:83], v[16:19]
  s_waitcnt vmcnt(4)
  s_barrier
  ds_read_b128 v[72:75], v2 offset:4096
  v_mfma_f32_16x16x32_bf16 v[28:31], v[136:139], v[84:87], v[28:31]
  ds_read_b128 v[76:79], v2 offset:24576
  s_add_u32 m0, s53, 16384
  v_mfma_f32_16x16x32_bf16 v[20:23], v[140:143], v[80:83], v[20:23]
  s_add_u32 s48, s61, 16384
  buffer_load_dwordx4 v2, s[4:7], s48 offen offset:0 sc1 lds
  v_mfma_f32_16x16x32_bf16 v[32:35], v[140:143], v[84:87], v[32:35]
  buffer_load_dwordx4 v2, s[4:7], s48 offen offset:2048 sc1 lds
  v_accvgpr_read_b32 v93, a245
  v_mfma_f32_16x16x32_bf16 v[24:27], v[144:147], v[80:83], v[24:27]
  v_accvgpr_read_b32 v105, a245
  v_accvgpr_read_b32 v94, a246
  v_mfma_f32_16x16x32_bf16 v[36:39], v[144:147], v[84:87], v[36:39]
  v_accvgpr_read_b32 v106, a246
  s_waitcnt lgkmcnt(2)
  v_mfma_f32_16x16x32_bf16 v[16:19], v[148:151], v[64:67], v[16:19]
  ds_read_b128 v[80:83], v2 offset:5120
  s_add_u32 m0, s53, 40960
  v_mfma_f32_16x16x32_bf16 v[28:31], v[148:151], v[68:71], v[28:31]
  ds_read_b128 v[84:87], v2 offset:25600
  s_add_u32 s48, s51, 81920
  v_mfma_f32_16x16x32_bf16 v[20:23], v[152:155], v[64:67], v[20:23]
  buffer_load_dwordx4 v2, s[4:7], s48 offen offset:0 sc1 lds
  buffer_load_dwordx4 v2, s[4:7], s48 offen offset:2048 sc1 lds
  v_mfma_f32_16x16x32_bf16 v[32:35], v[152:155], v[68:71], v[32:35]
  v_accvgpr_read_b32 v95, a247
  v_accvgpr_read_b32 v107, a247
  v_mfma_f32_16x16x32_bf16 v[24:27], v[156:159], v[64:67], v[24:27]
  v_accvgpr_read_b32 v96, a248
  v_accvgpr_read_b32 v108, a248
  v_mfma_f32_16x16x32_bf16 v[36:39], v[156:159], v[68:71], v[36:39]
  v_accvgpr_read_b32 v97, a249
  s_waitcnt lgkmcnt(2)
  v_mfma_f32_16x16x32_bf16 v[16:19], v[160:163], v[72:75], v[16:19]
  ds_read_b128 v[64:67], v2 offset:6144
  s_add_u32 m0, s53, 45056
  v_mfma_f32_16x16x32_bf16 v[28:31], v[160:163], v[76:79], v[28:31]
  ds_read_b128 v[68:71], v2 offset:26624
  s_add_u32 s48, s51, 86016
  v_mfma_f32_16x16x32_bf16 v[20:23], v[164:167], v[72:75], v[20:23]
  buffer_load_dwordx4 v2, s[4:7], s48 offen offset:0 sc1 lds
  v_accvgpr_read_b32 v109, a249
  v_mfma_f32_16x16x32_bf16 v[32:35], v[164:167], v[76:79], v[32:35]
  v_accvgpr_read_b32 v98, a250
  v_accvgpr_read_b32 v110, a250
  v_mfma_f32_16x16x32_bf16 v[24:27], v[168:171], v[72:75], v[24:27]
  v_accvgpr_read_b32 v99, a251
  v_accvgpr_read_b32 v111, a251
  v_mfma_f32_16x16x32_bf16 v[36:39], v[168:171], v[76:79], v[36:39]
  s_waitcnt lgkmcnt(2)
  v_mfma_f32_16x16x32_bf16 v[16:19], v[172:175], v[80:83], v[16:19]
  ds_read_b128 v[72:75], v2 offset:7168
  buffer_load_dwordx4 v2, s[4:7], s48 offen offset:2048 sc1 lds
  v_mfma_f32_16x16x32_bf16 v[28:31], v[172:175], v[84:87], v[28:31]
  ds_read_b128 v[76:79], v2 offset:27648
  v_mfma_f32_16x16x32_bf16 v[20:23], v[176:179], v[80:83], v[20:23]
  v_permlane16_swap_b32 v88, v100
  v_mfma_f32_16x16x32_bf16 v[32:35], v[176:179], v[84:87], v[32:35]
  v_permlane16_swap_b32 v89, v101
  v_mfma_f32_16x16x32_bf16 v[24:27], v[180:183], v[80:83], v[24:27]
  v_permlane16_swap_b32 v90, v102
  v_mfma_f32_16x16x32_bf16 v[36:39], v[180:183], v[84:87], v[36:39]
  s_waitcnt lgkmcnt(2)
  v_mfma_f32_16x16x32_bf16 v[16:19], v[184:187], v[64:67], v[16:19]
  s_waitcnt vmcnt(7)
  s_barrier
  ds_read_b128 v[80:83], v2 offset:8192
  v_mfma_f32_16x16x32_bf16 v[28:31], v[184:187], v[68:71], v[28:31]
  ds_read_b128 v[84:87], v2 offset:28672
  s_add_u32 m0, s53, 49152
  v_mfma_f32_16x16x32_bf16 v[20:23], v[188:191], v[64:67], v[20:23]
  s_add_u32 s48, s61, 90112
  buffer_load_dwordx4 v2, s[4:7], s48 offen offset:0 sc1 lds
  v_mfma_f32_16x16x32_bf16 v[32:35], v[188:191], v[68:71], v[32:35]
  v_permlane16_swap_b32 v91, v103
  v_mfma_f32_16x16x32_bf16 v[24:27], v[192:195], v[64:67], v[24:27]
  v_permlane16_swap_b32 v92, v104
  v_mfma_f32_16x16x32_bf16 v[36:39], v[192:195], v[68:71], v[36:39]
  s_waitcnt lgkmcnt(2)
  v_mfma_f32_16x16x32_bf16 v[16:19], v[196:199], v[72:75], v[16:19]
  ds_read_b128 v[64:67], v2 offset:9216
  buffer_load_dwordx4 v2, s[4:7], s48 offen offset:2048 sc1 lds
  v_mfma_f32_16x16x32_bf16 v[28:31], v[196:199], v[76:79], v[28:31]
  ds_read_b128 v[68:71], v2 offset:29696
  v_mfma_f32_16x16x32_bf16 v[20:23], v[200:203], v[72:75], v[20:23]
  v_permlane16_swap_b32 v93, v105
  v_mfma_f32_16x16x32_bf16 v[32:35], v[200:203], v[76:79], v[32:35]
  v_permlane16_swap_b32 v94, v106
  v_mfma_f32_16x16x32_bf16 v[24:27], v[204:207], v[72:75], v[24:27]
  v_permlane16_swap_b32 v95, v107
  v_mfma_f32_16x16x32_bf16 v[36:39], v[204:207], v[76:79], v[36:39]
  s_waitcnt lgkmcnt(2)
  v_mfma_f32_16x16x32_bf16 v[16:19], v[208:211], v[80:83], v[16:19]
  ds_read_b128 v[72:75], v2 offset:10240
  s_add_u32 m0, s53, 53248
  v_mfma_f32_16x16x32_bf16 v[28:31], v[208:211], v[84:87], v[28:31]
  ds_read_b128 v[76:79], v2 offset:30720
  s_add_u32 s48, s61, 94208
  v_mfma_f32_16x16x32_bf16 v[20:23], v[212:215], v[80:83], v[20:23]
  buffer_load_dwordx4 v2, s[4:7], s48 offen offset:0 sc1 lds
  v_mfma_f32_16x16x32_bf16 v[32:35], v[212:215], v[84:87], v[32:35]
  v_permlane16_swap_b32 v96, v108
  v_mfma_f32_16x16x32_bf16 v[24:27], v[216:219], v[80:83], v[24:27]
  v_permlane16_swap_b32 v97, v109
  v_mfma_f32_16x16x32_bf16 v[36:39], v[216:219], v[84:87], v[36:39]
  s_waitcnt lgkmcnt(2)
  v_mfma_f32_16x16x32_bf16 v[16:19], v[220:223], v[64:67], v[16:19]
  ds_read_b128 v[80:83], v2 offset:11264
  buffer_load_dwordx4 v2, s[4:7], s48 offen offset:2048 sc1 lds
  v_mfma_f32_16x16x32_bf16 v[28:31], v[220:223], v[68:71], v[28:31]
  ds_read_b128 v[84:87], v2 offset:31744
  v_mfma_f32_16x16x32_bf16 v[20:23], v[224:227], v[64:67], v[20:23]
  v_permlane16_swap_b32 v98, v110
  v_mfma_f32_16x16x32_bf16 v[32:35], v[224:227], v[68:71], v[32:35]
  v_permlane16_swap_b32 v99, v111
  v_mfma_f32_16x16x32_bf16 v[24:27], v[228:231], v[64:67], v[24:27]
  v_mfma_f32_16x16x32_bf16 v[36:39], v[228:231], v[68:71], v[36:39]
  s_waitcnt lgkmcnt(2)
  v_mfma_f32_16x16x32_bf16 v[16:19], v[232:235], v[72:75], v[16:19]
  ds_read_b128 v[64:67], v2 offset:12288
  s_add_u32 m0, s53, 57344
  v_mfma_f32_16x16x32_bf16 v[28:31], v[232:235], v[76:79], v[28:31]
  ds_read_b128 v[68:71], v2 offset:32768
  s_add_u32 s48, s61, 98304
  v_mfma_f32_16x16x32_bf16 v[20:23], v[236:239], v[72:75], v[20:23]
  buffer_load_dwordx4 v2, s[4:7], s48 offen offset:0 sc1 lds
  v_mfma_f32_16x16x32_bf16 v[32:35], v[236:239], v[76:79], v[32:35]
  v_mfma_f32_16x16x32_bf16 v[24:27], v[240:243], v[72:75], v[24:27]
  v_mfma_f32_16x16x32_bf16 v[36:39], v[240:243], v[76:79], v[36:39]
  s_waitcnt lgkmcnt(2)
  v_mfma_f32_16x16x32_bf16 v[16:19], v[244:247], v[80:83], v[16:19]
  ds_read_b128 v[72:75], v2 offset:13312
  buffer_load_dwordx4 v2, s[4:7], s48 offen offset:2048 sc1 lds
  v_mfma_f32_16x16x32_bf16 v[28:31], v[244:247], v[84:87], v[28:31]
  ds_read_b128 v[76:79], v2 offset:33792
  v_mfma_f32_16x16x32_bf16 v[20:23], v[248:251], v[80:83], v[20:23]
  v_mfma_f32_16x16x32_bf16 v[32:35], v[248:251], v[84:87], v[32:35]
  v_mfma_f32_16x16x32_bf16 v[24:27], v[252:255], v[80:83], v[24:27]
  v_mfma_f32_16x16x32_bf16 v[36:39], v[252:255], v[84:87], v[36:39]
  s_waitcnt lgkmcnt(2)
  v_mfma_f32_16x16x32_bf16 v[16:19], a[0:3], v[64:67], v[16:19]
  s_waitcnt vmcnt(10)
  s_barrier
  ds_read_b128 v[80:83], v2 offset:14336
  v_mfma_f32_16x16x32_bf16 v[28:31], a[0:3], v[68:71], v[28:31]
  ds_read_b128 v[84:87], v2 offset:34816
  s_add_u32 s55, s62, 0
  v_mfma_f32_16x16x32_bf16 v[20:23], a[4:7], v[64:67], v[20:23]
  buffer_load_dwordx4 v[8:11], v7, s[4:7], s55 offen sc1
  buffer_load_dwordx4 a[168:171], v2, s[4:7], s54 offen offset:2048 sc1
  v_mfma_f32_16x16x32_bf16 v[32:35], a[4:7], v[68:71], v[32:35]
  buffer_load_dwordx4 a[172:175], v2, s[4:7], s54 offen offset:3072 sc1
  v_mfma_f32_16x16x32_bf16 v[24:27], a[8:11], v[64:67], v[24:27]
  v_mfma_f32_16x16x32_bf16 v[36:39], a[8:11], v[68:71], v[36:39]
  s_waitcnt lgkmcnt(2)
  v_mfma_f32_16x16x32_bf16 v[16:19], a[12:15], v[72:75], v[16:19]
  ds_read_b128 v[64:67], v2 offset:15360
  s_add_u32 s54, s57, 20480
  v_mfma_f32_16x16x32_bf16 v[28:31], a[12:15], v[76:79], v[28:31]
  ds_read_b128 v[68:71], v2 offset:35840
  buffer_load_dwordx4 a[176:179], v2, s[4:7], s54 offen offset:0 sc1
  v_mfma_f32_16x16x32_bf16 v[20:23], a[16:19], v[72:75], v[20:23]
  v_mfma_f32_16x16x32_bf16 v[32:35], a[16:19], v[76:79], v[32:35]
  v_mfma_f32_16x16x32_bf16 v[24:27], a[20:23], v[72:75], v[24:27]
  v_mfma_f32_16x16x32_bf16 v[36:39], a[20:23], v[76:79], v[36:39]
  s_waitcnt lgkmcnt(2)
  v_mfma_f32_16x16x32_bf16 v[16:19], a[24:27], v[80:83], v[16:19]
  ds_read_b128 v[72:75], v2 offset:16384
  buffer_load_dwordx4 a[180:183], v2, s[4:7], s54 offen offset:1024 sc1
  v_mfma_f32_16x16x32_bf16 v[28:31], a[24:27], v[84:87], v[28:31]
  ds_read_b128 v[76:79], v2 offset:36864
  buffer_load_dwordx4 a[184:187], v2, s[4:7], s54 offen offset:2048 sc1
  v_mfma_f32_16x16x32_bf16 v[20:23], a[28:31], v[80:83], v[20:23]
  v_mfma_f32_16x16x32_bf16 v[32:35], a[28:31], v[84:87], v[32:35]
  v_mfma_f32_16x16x32_bf16 v[24:27], a[32:35], v[80:83], v[24:27]
  v_mfma_f32_16x16x32_bf16 v[36:39], a[32:35], v[84:87], v[36:39]
  s_waitcnt lgkmcnt(2)
  v_mfma_f32_16x16x32_bf16 v[16:19], a[36:39], v[64:67], v[16:19]
  ds_read_b128 v[80:83], v2 offset:17408
  buffer_load_dwordx4 a[188:191], v2, s[4:7], s54 offen offset:3072 sc1
  v_mfma_f32_16x16x32_bf16 v[28:31], a[36:39], v[68:71], v[28:31]
  ds_read_b128 v[84:87], v2 offset:37888
  v_mfma_f32_16x16x32_bf16 v[20:23], a[40:43], v[64:67], v[20:23]
  v_mfma_f32_16x16x32_bf16 v[32:35], a[40:43], v[68:71], v[32:35]
  v_mfma_f32_16x16x32_bf16 v[24:27], a[44:47], v[64:67], v[24:27]
  v_mfma_f32_16x16x32_bf16 v[36:39], a[44:47], v[68:71], v[36:39]
  s_waitcnt lgkmcnt(2)
  v_mfma_f32_16x16x32_bf16 v[16:19], a[48:51], v[72:75], v[16:19]
  ds_read_b128 v[64:67], v2 offset:18432
  s_add_u32 s54, s57, 24576
  v_mfma_f32_16x16x32_bf16 v[28:31], a[48:51], v[76:79], v[28:31]
  ds_read_b128 v[68:71], v2 offset:38912
  buffer_load_dwordx4 a[192:195], v2, s[4:7], s54 offen offset:0 sc1
  v_mfma_f32_16x16x32_bf16 v[20:23], a[52:55], v[72:75], v[20:23]
  buffer_load_dwordx4 a[196:199], v2, s[4:7], s54 offen offset:1024 sc1
  v_mfma_f32_16x16x32_bf16 v[32:35], a[52:55], v[76:79], v[32:35]
  v_mfma_f32_16x16x32_bf16 v[24:27], a[56:59], v[72:75], v[24:27]
  v_mfma_f32_16x16x32_bf16 v[36:39], a[56:59], v[76:79], v[36:39]
  s_waitcnt lgkmcnt(2)
  v_mfma_f32_16x16x32_bf16 v[16:19], a[60:63], v[80:83], v[16:19]
  ds_read_b128 v[72:75], v2 offset:19456
  buffer_load_dwordx4 a[200:203], v2, s[4:7], s54 offen offset:2048 sc1
  v_mfma_f32_16x16x32_bf16 v[28:31], a[60:63], v[84:87], v[28:31]
  ds_read_b128 v[76:79], v2 offset:39936
  v_mfma_f32_16x16x32_bf16 v[20:23], a[64:67], v[80:83], v[20:23]
  v_mfma_f32_16x16x32_bf16 v[32:35], a[64:67], v[84:87], v[32:35]
  v_mfma_f32_16x16x32_bf16 v[24:27], a[68:71], v[80:83], v[24:27]
  v_mfma_f32_16x16x32_bf16 v[36:39], a[68:71], v[84:87], v[36:39]
  s_waitcnt lgkmcnt(2)
  v_mfma_f32_16x16x32_bf16 v[16:19], a[72:75], v[64:67], v[16:19]
  s_waitcnt vmcnt(10) lgkmcnt(0)
  s_barrier
  ds_read_b128 v[80:83], v5 offset:0
  v_mfma_f32_16x16x32_bf16 v[28:31], a[72:75], v[68:71], v[28:31]
  ds_read_b128 v[84:87], v5 offset:20480
  buffer_load_dwordx4 a[204:207], v2, s[4:7], s54 offen offset:3072 sc1
  v_mfma_f32_16x16x32_bf16 v[20:23], a[76:79], v[64:67], v[20:23]
  s_add_u32 s54, s57, 28672
  buffer_load_dwordx4 a[208:211], v2, s[4:7], s54 offen offset:0 sc1
  v_mfma_f32_16x16x32_bf16 v[32:35], a[76:79], v[68:71], v[32:35]
  v_mfma_f32_16x16x32_bf16 v[24:27], a[80:83], v[64:67], v[24:27]
  v_mfma_f32_16x16x32_bf16 v[36:39], a[80:83], v[68:71], v[36:39]
  s_waitcnt lgkmcnt(2)
  v_mfma_f32_16x16x32_bf16 v[16:19], a[84:87], v[72:75], v[16:19]
  ds_read_b128 v[64:67], v5 offset:1024
  buffer_load_dwordx4 a[212:215], v2, s[4:7], s54 offen offset:1024 sc1
  v_mfma_f32_16x16x32_bf16 v[28:31], a[84:87], v[76:79], v[28:31]
  ds_read_b128 v[68:71], v5 offset:21504
  v_mfma_f32_16x16x32_bf16 v[20:23], a[88:91], v[72:75], v[20:23]
  v_mfma_f32_16x16x32_bf16 v[32:35], a[88:91], v[76:79], v[32:35]
  v_mfma_f32_16x16x32_bf16 v[24:27], a[92:95], v[72:75], v[24:27]
  v_mfma_f32_16x16x32_bf16 v[36:39], a[92:95], v[76:79], v[36:39]
  s_waitcnt lgkmcnt(2)
  v_mfma_f32_16x16x32_bf16 v[40:43], v[112:115], v[80:83], 0
  ds_read_b128 v[72:75], v5 offset:2048
  buffer_load_dwordx4 a[216:219], v2, s[4:7], s54 offen offset:2048 sc1
  v_mfma_f32_16x16x32_bf16 v[52:55], v[112:115], v[84:87], 0
  ds_read_b128 v[76:79], v5 offset:22528
  buffer_load_dwordx4 a[220:223], v2, s[4:7], s54 offen offset:3072 sc1
  v_mfma_f32_16x16x32_bf16 v[44:47], v[116:119], v[80:83], 0
  v_mfma_f32_16x16x32_bf16 v[56:59], v[116:119], v[84:87], 0
  v_mfma_f32_16x16x32_bf16 v[48:51], v[120:123], v[80:83], 0
  v_mfma_f32_16x16x32_bf16 v[60:63], v[120:123], v[84:87], 0
  s_waitcnt lgkmcnt(2)
  v_mfma_f32_16x16x32_bf16 v[40:43], v[124:127], v[64:67], v[40:43]
  ds_read_b128 v[80:83], v5 offset:3072
  s_add_u32 s54, s57, 32768
  v_mfma_f32_16x16x32_bf16 v[52:55], v[124:127], v[68:71], v[52:55]
  ds_read_b128 v[84:87], v5 offset:23552
  buffer_load_dwordx4 a[224:227], v2, s[4:7], s54 offen offset:0 sc1
  v_mfma_f32_16x16x32_bf16 v[44:47], v[128:131], v[64:67], v[44:47]
  v_permlane16_swap_b32 v16, v28
  v_mfma_f32_16x16x32_bf16 v[56:59], v[128:131], v[68:71], v[56:59]
  v_permlane16_swap_b32 v17, v29
  v_mfma_f32_16x16x32_bf16 v[48:51], v[132:135], v[64:67], v[48:51]
  v_permlane16_swap_b32 v18, v30
  v_mfma_f32_16x16x32_bf16 v[60:63], v[132:135], v[68:71], v[60:63]
  s_waitcnt lgkmcnt(2)
  v_mfma_f32_16x16x32_bf16 v[40:43], v[136:139], v[72:75], v[40:43]
  ds_read_b128 v[64:67], v5 offset:4096
  s_add_u32 m0, s53, 0
  v_mfma_f32_16x16x32_bf16 v[52:55], v[136:139], v[76:79], v[52:55]
  ds_read_b128 v[68:71], v5 offset:24576
  s_add_u32 s48, s51, 40960
  v_mfma_f32_16x16x32_bf16 v[44:47], v[140:143], v[72:75], v[44:47]
  buffer_load_dwordx4 v2, s[4:7], s48 offen offset:0 sc1 lds
  v_mfma_f32_16x16x32_bf16 v[56:59], v[140:143], v[76:79], v[56:59]
  v_permlane16_swap_b32 v19, v31
  v_mfma_f32_16x16x32_bf16 v[48:51], v[144:147], v[72:75], v[48:51]
  v_permlane16_swap_b32 v20, v32
  v_mfma_f32_16x16x32_bf16 v[60:63], v[144:147], v[76:79], v[60:63]
  s_waitcnt lgkmcnt(2)
  v_mfma_f32_16x16x32_bf16 v[40:43], v[148:151], v[80:83], v[40:43]
  ds_read_b128 v[72:75], v5 offset:5120
  buffer_load_dwordx4 v2, s[4:7], s48 offen offset:2048 sc1 lds
  v_mfma_f32_16x16x32_bf16 v[52:55], v[148:151], v[84:87], v[52:55]
  ds_read_b128 v[76:79], v5 offset:25600
  v_mfma_f32_16x16x32_bf16 v[44:47], v[152:155], v[80:83], v[44:47]
  v_permlane16_swap_b32 v21, v33
  v_mfma_f32_16x16x32_bf16 v[56:59], v[152:155], v[84:87], v[56:59]
  v_permlane16_swap_b32 v22, v34
  v_mfma_f32_16x16x32_bf16 v[48:51], v[156:159], v[80:83], v[48:51]
  v_permlane16_swap_b32 v23, v35
  v_mfma_f32_16x16x32_bf16 v[60:63], v[156:159], v[84:87], v[60:63]
  s_waitcnt vmcnt(17)
  s_waitcnt lgkmcnt(2)
  v_mfma_f32_16x16x32_bf16 v[40:43], v[160:163], v[64:67], v[40:43]
  ds_read_b128 v[80:83], v5 offset:6144
  s_add_u32 m0, s53, 4096
  v_mfma_f32_16x16x32_bf16 v[52:55], v[160:163], v[68:71], v[52:55]
  ds_read_b128 v[84:87], v5 offset:26624
  s_add_u32 s48, s51, 45056
  v_mfma_f32_16x16x32_bf16 v[44:47], v[164:167], v[64:67], v[44:47]
  buffer_load_dwordx4 v2, s[4:7], s48 offen offset:0 sc1 lds
  v_bitop3_b32 v10, v10, v11, v1 bitop3:0x7e
  v_mfma_f32_16x16x32_bf16 v[56:59], v[164:167], v[68:71], v[56:59]
  v_cmp_ne_u32 vcc, 0, v10
  v_mfma_f32_16x16x32_bf16 v[48:51], v[168:171], v[64:67], v[48:51]
  v_permlane16_swap_b32 v24, v36
  v_mfma_f32_16x16x32_bf16 v[60:63], v[168:171], v[68:71], v[60:63]
  s_waitcnt lgkmcnt(2)
  v_mfma_f32_16x16x32_bf16 v[40:43], v[172:175], v[72:75], v[40:43]
  ds_read_b128 v[64:67], v5 offset:7168
  buffer_load_dwordx4 v2, s[4:7], s48 offen offset:2048 sc1 lds
  v_mfma_f32_16x16x32_bf16 v[52:55], v[172:175], v[76:79], v[52:55]
  ds_read_b128 v[68:71], v5 offset:27648
  v_mfma_f32_16x16x32_bf16 v[44:47], v[176:179], v[72:75], v[44:47]
  v_permlane16_swap_b32 v25, v37
  v_mfma_f32_16x16x32_bf16 v[56:59], v[176:179], v[76:79], v[56:59]
  v_permlane16_swap_b32 v26, v38
  v_mfma_f32_16x16x32_bf16 v[48:51], v[180:183], v[72:75], v[48:51]
  v_permlane16_swap_b32 v27, v39
  v_mfma_f32_16x16x32_bf16 v[60:63], v[180:183], v[76:79], v[60:63]
  s_cbranch_vccz Lsckd_54
Lsck_53:
  s_add_u32 s55, s62, 0
  buffer_load_dwordx4 v[8:11], v7, s[4:7], s55 offen sc1
  s_waitcnt vmcnt(0)
  v_bitop3_b32 v10, v10, v11, v1 bitop3:0x7e
  v_cmp_ne_u32 vcc, 0, v10
  s_nop 1
  s_nop 1
  s_cbranch_vccnz Lsck_53
Lsckd_54:
  buffer_inv sc1
  s_waitcnt vmcnt(0)
  s_waitcnt lgkmcnt(2)
  v_mfma_f32_16x16x32_bf16 v[40:43], v[184:187], v[80:83], v[40:43]
  ds_read_b128 v[72:75], v5 offset:8192
  s_add_u32 m0, s53, 8192
  v_mfma_f32_16x16x32_bf16 v[52:55], v[184:187], v[84:87], v[52:55]
  ds_read_b128 v[76:79], v5 offset:28672
  s_add_u32 s48, s61, 49152
  v_mfma_f32_16x16x32_bf16 v[44:47], v[188:191], v[80:83], v[44:47]
  buffer_load_dwordx4 v2, s[4:7], s48 offen offset:0 sc1 lds
  v_fmac_f32 v16, v8, v88
  v_mfma_f32_16x16x32_bf16 v[56:59], v[188:191], v[84:87], v[56:59]
  v_fmac_f32 v17, v8, v89
  v_fmac_f32 v18, v8, v90
  v_mfma_f32_16x16x32_bf16 v[48:51], v[192:195], v[80:83], v[48:51]
  v_fmac_f32 v19, v8, v91
  v_fmac_f32 v20, v8, v92
  v_mfma_f32_16x16x32_bf16 v[60:63], v[192:195], v[84:87], v[60:63]
  v_fmac_f32 v21, v8, v93
  s_waitcnt lgkmcnt(2)
  v_mfma_f32_16x16x32_bf16 v[40:43], v[196:199], v[64:67], v[40:43]
  ds_read_b128 v[80:83], v5 offset:9216
  buffer_load_dwordx4 v2, s[4:7], s48 offen offset:2048 sc1 lds
  v_mfma_f32_16x16x32_bf16 v[52:55], v[196:199], v[68:71], v[52:55]
  ds_read_b128 v[84:87], v5 offset:29696
  v_fmac_f32 v22, v8, v94
  v_mfma_f32_16x16x32_bf16 v[44:47], v[200:203], v[64:67], v[44:47]
  v_fmac_f32 v23, v8, v95
  v_fmac_f32 v24, v8, v96
  v_mfma_f32_16x16x32_bf16 v[56:59], v[200:203], v[68:71], v[56:59]
  v_fmac_f32 v25, v8, v97
  v_fmac_f32 v26, v8, v98
  v_mfma_f32_16x16x32_bf16 v[48:51], v[204:207], v[64:67], v[48:51]
  v_fmac_f32 v27, v8, v99
  v_fmac_f32 v28, v8, v100
  v_mfma_f32_16x16x32_bf16 v[60:63], v[204:207], v[68:71], v[60:63]
  v_fmac_f32 v29, v8, v101
  s_waitcnt lgkmcnt(2)
  v_mfma_f32_16x16x32_bf16 v[40:43], v[208:211], v[72:75], v[40:43]
  ds_read_b128 v[64:67], v5 offset:10240
  s_add_u32 m0, s53, 12288
  v_mfma_f32_16x16x32_bf16 v[52:55], v[208:211], v[76:79], v[52:55]
  ds_read_b128 v[68:71], v5 offset:30720
  s_add_u32 s48, s61, 53248
  v_mfma_f32_16x16x32_bf16 v[44:47], v[212:215], v[72:75], v[44:47]
  buffer_load_dwordx4 v2, s[4:7], s48 offen offset:0 sc1 lds
  v_fmac_f32 v30, v8, v102
  v_mfma_f32_16x16x32_bf16 v[56:59], v[212:215], v[76:79], v[56:59]
  v_fmac_f32 v31, v8, v103
  v_fmac_f32 v32, v8, v104
  v_mfma_f32_16x16x32_bf16 v[48:51], v[216:219], v[72:75], v[48:51]
  v_fmac_f32 v33, v8, v105
  v_fmac_f32 v34, v8, v106
  v_mfma_f32_16x16x32_bf16 v[60:63], v[216:219], v[76:79], v[60:63]
  v_fmac_f32 v35, v8, v107
  s_waitcnt lgkmcnt(2)
  v_mfma_f32_16x16x32_bf16 v[40:43], v[220:223], v[80:83], v[40:43]
  ds_read_b128 v[72:75], v5 offset:11264
  buffer_load_dwordx4 v2, s[4:7], s48 offen offset:2048 sc1 lds
  v_mfma_f32_16x16x32_bf16 v[52:55], v[220:223], v[84:87], v[52:55]
  ds_read_b128 v[76:79], v5 offset:31744
  v_fmac_f32 v36, v8, v108
  v_mfma_f32_16x16x32_bf16 v[44:47], v[224:227], v[80:83], v[44:47]
  v_fmac_f32 v37, v8, v109
  v_fmac_f32 v38, v8, v110
  v_mfma_f32_16x16x32_bf16 v[56:59], v[224:227], v[84:87], v[56:59]
  v_fmac_f32 v39, v8, v111
  v_max_f32 v16, 0, v16
  v_mfma_f32_16x16x32_bf16 v[48:51], v[228:231], v[80:83], v[48:51]
  v_mul_f32 v28, v9, v28
  v_max_f32 v17, 0, v17
  v_mfma_f32_16x16x32_bf16 v[60:63], v[228:231], v[84:87], v[60:63]
  v_mul_f32 v29, v9, v29
  s_waitcnt lgkmcnt(2)
  v_mfma_f32_16x16x32_bf16 v[40:43], v[232:235], v[64:67], v[40:43]
  ds_read_b128 v[80:83], v5 offset:12288
  s_add_u32 m0, s53, 16384
  v_mfma_f32_16x16x32_bf16 v[52:55], v[232:235], v[68:71], v[52:55]
  ds_read_b128 v[84:87], v5 offset:32768
  s_add_u32 s48, s61, 57344
  v_mfma_f32_16x16x32_bf16 v[44:47], v[236:239], v[64:67], v[44:47]
  buffer_load_dwordx4 v2, s[4:7], s48 offen offset:0 sc1 lds
  v_max_f32 v18, 0, v18
  v_mfma_f32_16x16x32_bf16 v[56:59], v[236:239], v[68:71], v[56:59]
  v_mul_f32 v30, v9, v30
  v_max_f32 v19, 0, v19
  v_mfma_f32_16x16x32_bf16 v[48:51], v[240:243], v[64:67], v[48:51]
  v_mul_f32 v31, v9, v31
  v_max_f32 v20, 0, v20
  v_mfma_f32_16x16x32_bf16 v[60:63], v[240:243], v[68:71], v[60:63]
  v_mul_f32 v32, v9, v32
  s_waitcnt lgkmcnt(2)
  v_mfma_f32_16x16x32_bf16 v[40:43], v[244:247], v[72:75], v[40:43]
  ds_read_b128 v[64:67], v5 offset:13312
  buffer_load_dwordx4 v2, s[4:7], s48 offen offset:2048 sc1 lds
  v_mfma_f32_16x16x32_bf16 v[52:55], v[244:247], v[76:79], v[52:55]
  ds_read_b128 v[68:71], v5 offset:33792
  v_max_f32 v21, 0, v21
  v_mfma_f32_16x16x32_bf16 v[44:47], v[248:251], v[72:75], v[44:47]
  v_mul_f32 v33, v9, v33
  v_max_f32 v22, 0, v22
  v_mfma_f32_16x16x32_bf16 v[56:59], v[248:251], v[76:79], v[56:59]
  v_mul_f32 v34, v9, v34
  v_max_f32 v23, 0, v23
  v_mfma_f32_16x16x32_bf16 v[48:51], v[252:255], v[72:75], v[48:51]
  v_mul_f32 v35, v9, v35
  v_max_f32 v24, 0, v24
  v_mfma_f32_16x16x32_bf16 v[60:63], v[252:255], v[76:79], v[60:63]
  v_mul_f32 v36, v9, v36
  s_waitcnt lgkmcnt(2)
  v_mfma_f32_16x16x32_bf16 v[40:43], a[0:3], v[80:83], v[40:43]
  ds_read_b128 v[72:75], v5 offset:14336
  s_add_u32 s55, s62, 1024
  v_mfma_f32_16x16x32_bf16 v[52:55], a[0:3], v[84:87], v[52:55]
  ds_read_b128 v[76:79], v5 offset:34816
  buffer_load_dwordx4 v[12:15], v7, s[4:7], s55 offen sc1
  v_mfma_f32_16x16x32_bf16 v[44:47], a[4:7], v[80:83], v[44:47]
  s_add_u32 m0, s56, 0
  s_add_u32 s63, s57, 40960
  v_mfma_f32_16x16x32_bf16 v[56:59], a[4:7], v[84:87], v[56:59]
  buffer_load_dwordx4 v2, s[4:7], s63 offen offset:0 sc1 lds
  v_max_f32 v25, 0, v25
  v_mfma_f32_16x16x32_bf16 v[48:51], a[8:11], v[80:83], v[48:51]
  v_mul_f32 v37, v9, v37
  v_max_f32 v26, 0, v26
  v_mfma_f32_16x16x32_bf16 v[60:63], a[8:11], v[84:87], v[60:63]
  v_mul_f32 v38, v9, v38
  s_waitcnt lgkmcnt(2)
  v_mfma_f32_16x16x32_bf16 v[40:43], a[12:15], v[64:67], v[40:43]
  ds_read_b128 v[80:83], v5 offset:15360
  buffer_load_dwordx4 v2, s[4:7], s63 offen offset:1024 sc1 lds
  v_mfma_f32_16x16x32_bf16 v[52:55], a[12:15], v[68:71], v[52:55]
  ds_read_b128 v[84:87], v5 offset:35840
  buffer_load_dwordx4 v2, s[4:7], s63 offen offset:2048 sc1 lds
  v_mfma_f32_16x16x32_bf16 v[44:47], a[16:19], v[64:67], v[44:47]
  v_max_f32 v27, 0, v27
  v_mul_f32 v39, v9, v39
  v_mfma_f32_16x16x32_bf16 v[56:59], a[16:19], v[68:71], v[56:59]
  v_mul_f32 v16, v16, v28
  v_mul_f32 v17, v17, v29
  v_mfma_f32_16x16x32_bf16 v[48:51], a[20:23], v[64:67], v[48:51]
  v_mul_f32 v18, v18, v30
  v_mul_f32 v19, v19, v31
  v_mfma_f32_16x16x32_bf16 v[60:63], a[20:23], v[68:71], v[60:63]
  v_mul_f32 v20, v20, v32
  s_waitcnt lgkmcnt(2)
  v_mfma_f32_16x16x32_bf16 v[40:43], a[24:27], v[72:75], v[40:43]
  ds_read_b128 v[64:67], v5 offset:16384
  buffer_load_dwordx4 v2, s[4:7], s63 offen offset:3072 sc1 lds
  v_mfma_f32_16x16x32_bf16 v[52:55], a[24:27], v[76:79], v[52:55]
  ds_read_b128 v[68:71], v5 offset:36864
  v_mul_f32 v21, v21, v33
  v_mfma_f32_16x16x32_bf16 v[44:47], a[28:31], v[72:75], v[44:47]
  v_mul_f32 v22, v22, v34
  v_mul_f32 v23, v23, v35
  v_mfma_f32_16x16x32_bf16 v[56:59], a[28:31], v[76:79], v[56:59]
  v_mul_f32 v24, v24, v36
  v_mul_f32 v25, v25, v37
  v_mfma_f32_16x16x32_bf16 v[48:51], a[32:35], v[72:75], v[48:51]
  v_mul_f32 v26, v26, v38
  v_mul_f32 v27, v27, v39
  v_mfma_f32_16x16x32_bf16 v[60:63], a[32:35], v[76:79], v[60:63]
  v_cvt_pk_bf16_f32 v28, v16, v17
  s_waitcnt lgkmcnt(2)
  v_mfma_f32_16x16x32_bf16 v[40:43], a[36:39], v[80:83], v[40:43]
  ds_read_b128 v[72:75], v5 offset:17408
  s_add_u32 m0, s56, 4096
  v_mfma_f32_16x16x32_bf16 v[52:55], a[36:39], v[84:87], v[52:55]
  ds_read_b128 v[76:79], v5 offset:37888
  s_add_u32 s63, s57, 45056
  v_mfma_f32_16x16x32_bf16 v[44:47], a[40:43], v[80:83], v[44:47]
  buffer_load_dwordx4 v2, s[4:7], s63 offen offset:0 sc1 lds
  v_cvt_pk_bf16_f32 v29, v18, v19
  v_mfma_f32_16x16x32_bf16 v[56:59], a[40:43], v[84:87], v[56:59]
  v_cvt_pk_bf16_f32 v30, v20, v21
  v_cvt_pk_bf16_f32 v31, v22, v23
  v_mfma_f32_16x16x32_bf16 v[48:51], a[44:47], v[80:83], v[48:51]
  v_cvt_pk_bf16_f32 v32, v24, v25
  v_cvt_pk_bf16_f32 v33, v26, v27
  v_mfma_f32_16x16x32_bf16 v[60:63], a[44:47], v[84:87], v[60:63]
  s_add_u32 s49, s52, 0
  s_waitcnt lgkmcnt(2)
  v_mfma_f32_16x16x32_bf16 v[40:43], a[48:51], v[64:67], v[40:43]
  ds_read_b128 v[80:83], v5 offset:18432
  buffer_load_dwordx4 v2, s[4:7], s63 offen offset:1024 sc1 lds
  v_mfma_f32_16x16x32_bf16 v[52:55], a[48:51], v[68:71], v[52:55]
  ds_read_b128 v[84:87], v5 offset:38912
  buffer_store_dwordx4 v[28:31], v3, s[4:7], s49 offen sc1
  v_mfma_f32_16x16x32_bf16 v[44:47], a[52:55], v[64:67], v[44:47]
  buffer_store_dwordx2 v[32:33], v4, s[4:7], s49 offen sc1
  v_mfma_f32_16x16x32_bf16 v[56:59], a[52:55], v[68:71], v[56:59]
  v_mfma_f32_16x16x32_bf16 v[48:51], a[56:59], v[64:67], v[48:51]
  v_mfma_f32_16x16x32_bf16 v[60:63], a[56:59], v[68:71], v[60:63]
  s_waitcnt lgkmcnt(2)
  v_mfma_f32_16x16x32_bf16 v[40:43], a[60:63], v[72:75], v[40:43]
  ds_read_b128 v[64:67], v5 offset:19456
  buffer_load_dwordx4 v2, s[4:7], s63 offen offset:2048 sc1 lds
  v_mfma_f32_16x16x32_bf16 v[52:55], a[60:63], v[76:79], v[52:55]
  ds_read_b128 v[68:71], v5 offset:39936
  buffer_load_dwordx4 v2, s[4:7], s63 offen offset:3072 sc1 lds
  v_mfma_f32_16x16x32_bf16 v[44:47], a[64:67], v[72:75], v[44:47]
  v_mfma_f32_16x16x32_bf16 v[56:59], a[64:67], v[76:79], v[56:59]
  v_mfma_f32_16x16x32_bf16 v[48:51], a[68:71], v[72:75], v[48:51]
  v_mfma_f32_16x16x32_bf16 v[60:63], a[68:71], v[76:79], v[60:63]
  s_waitcnt lgkmcnt(2)
  v_mfma_f32_16x16x32_bf16 v[40:43], a[72:75], v[80:83], v[40:43]
  s_waitcnt vmcnt(11) lgkmcnt(0)
  s_barrier
  ds_read_b128 v[72:75], v2 offset:0
  v_mfma_f32_16x16x32_bf16 v[52:55], a[72:75], v[84:87], v[52:55]
  ds_read_b128 v[76:79], v2 offset:20480
  s_add_u32 m0, s56, 8192
  v_mfma_f32_16x16x32_bf16 v[44:47], a[76:79], v[80:83], v[44:47]
  s_add_u32 s63, s57, 49152
  buffer_load_dwordx4 v2, s[4:7], s63 offen offset:0 sc1 lds
  v_mfma_f32_16x16x32_bf16 v[56:59], a[76:79], v[84:87], v[56:59]
  v_mfma_f32_16x16x32_bf16 v[48:51], a[80:83], v[80:83], v[48:51]
  v_mfma_f32_16x16x32_bf16 v[60:63], a[80:83], v[84:87], v[60:63]
  s_waitcnt lgkmcnt(2)
  v_mfma_f32_16x16x32_bf16 v[40:43], a[84:87], v[64:67], v[40:43]
  ds_read_b128 v[80:83], v2 offset:1024
  buffer_load_dwordx4 v2, s[4:7], s63 offen offset:1024 sc1 lds
  v_mfma_f32_16x16x32_bf16 v[52:55], a[84:87], v[68:71], v[52:55]
  ds_read_b128 v[84:87], v2 offset:21504
  v_mfma_f32_16x16x32_bf16 v[44:47], a[88:91], v[64:67], v[44:47]
  v_mfma_f32_16x16x32_bf16 v[56:59], a[88:91], v[68:71], v[56:59]
  v_mfma_f32_16x16x32_bf16 v[48:51], a[92:95], v[64:67], v[48:51]
  v_mfma_f32_16x16x32_bf16 v[60:63], a[92:95], v[68:71], v[60:63]
  s_waitcnt lgkmcnt(2)
  v_mfma_f32_16x16x32_bf16 v[16:19], v[112:115], v[72:75], 0
  ds_read_b128 v[64:67], v2 offset:2048
  buffer_load_dwordx4 v2, s[4:7], s63 offen offset:2048 sc1 lds
  v_mfma_f32_16x16x32_bf16 v[28:31], v[112:115], v[76:79], 0
  ds_read_b128 v[68:71], v2 offset:22528
  v_mfma_f32_16x16x32_bf16 v[20:23], v[116:119], v[72:75], 0
  v_mfma_f32_16x16x32_bf16 v[32:35], v[116:119], v[76:79], 0
  v_mfma_f32_16x16x32_bf16 v[24:27], v[120:123], v[72:75], 0
  v_mfma_f32_16x16x32_bf16 v[36:39], v[120:123], v[76:79], 0
  s_waitcnt lgkmcnt(2)
  v_mfma_f32_16x16x32_bf16 v[16:19], v[124:127], v[80:83], v[16:19]
  ds_read_b128 v[72:75], v2 offset:3072
  buffer_load_dwordx4 v2, s[4:7], s63 offen offset:3072 sc1 lds
  v_mfma_f32_16x16x32_bf16 v[28:31], v[124:127], v[84:87], v[28:31]
  ds_read_b128 v[76:79], v2 offset:23552
  v_mfma_f32_16x16x32_bf16 v[20:23], v[128:131], v[80:83], v[20:23]
  v_permlane16_swap_b32 v40, v52
  v_mfma_f32_16x16x32_bf16 v[32:35], v[128:131], v[84:87], v[32:35]
  v_permlane16_swap_b32 v41, v53
  v_mfma_f32_16x16x32_bf16 v[24:27], v[132:135], v[80:83], v[24:27]
  v_permlane16_swap_b32 v42, v54
  v_mfma_f32_16x16x32_bf16 v[36:39], v[132:135], v[84:87], v[36:39]
  s_waitcnt lgkmcnt(2)
  v_mfma_f32_16x16x32_bf16 v[16:19], v[136:139], v[64:67], v[16:19]
  ds_read_b128 v[80:83], v2 offset:4096
  v_mfma_f32_16x16x32_bf16 v[28:31], v[136:139], v[68:71], v[28:31]
  ds_read_b128 v[84:87], v2 offset:24576
  v_mfma_f32_16x16x32_bf16 v[20:23], v[140:143], v[64:67], v[20:23]
  v_permlane16_swap_b32 v43, v55
  v_mfma_f32_16x16x32_bf16 v[32:35], v[140:143], v[68:71], v[32:35]
  v_permlane16_swap_b32 v44, v56
  v_mfma_f32_16x16x32_bf16 v[24:27], v[144:147], v[64:67], v[24:27]
  v_permlane16_swap_b32 v45, v57
  v_mfma_f32_16x16x32_bf16 v[36:39], v[144:147], v[68:71], v[36:39]
  s_waitcnt lgkmcnt(2)
  v_mfma_f32_16x16x32_bf16 v[16:19], v[148:151], v[72:75], v[16:19]
  ds_read_b128 v[64:67], v2 offset:5120
  v_mfma_f32_16x16x32_bf16 v[28:31], v[148:151], v[76:79], v[28:31]
  ds_read_b128 v[68:71], v2 offset:25600
  v_mfma_f32_16x16x32_bf16 v[20:23], v[152:155], v[72:75], v[20:23]
  v_permlane16_swap_b32 v46, v58
  v_mfma_f32_16x16x32_bf16 v[32:35], v[152:155], v[76:79], v[32:35]
  v_permlane16_swap_b32 v47, v59
  v_mfma_f32_16x16x32_bf16 v[24:27], v[156:159], v[72:75], v[24:27]
  s_waitcnt vmcnt(14)
  v_bitop3_b32 v14, v14, v15, v1 bitop3:0x7e
  v_mfma_f32_16x16x32_bf16 v[36:39], v[156:159], v[76:79], v[36:39]
  v_cmp_ne_u32 vcc, 0, v14
  s_waitcnt lgkmcnt(2)
  v_mfma_f32_16x16x32_bf16 v[16:19], v[160:163], v[80:83], v[16:19]
  ds_read_b128 v[72:75], v2 offset:6144
  v_mfma_f32_16x16x32_bf16 v[28:31], v[160:163], v[84:87], v[28:31]
  ds_read_b128 v[76:79], v2 offset:26624
  v_mfma_f32_16x16x32_bf16 v[20:23], v[164:167], v[80:83], v[20:23]
  v_permlane16_swap_b32 v48, v60
  v_mfma_f32_16x16x32_bf16 v[32:35], v[164:167], v[84:87], v[32:35]
  v_permlane16_swap_b32 v49, v61
  v_mfma_f32_16x16x32_bf16 v[24:27], v[168:171], v[80:83], v[24:27]
  v_permlane16_swap_b32 v50, v62
  v_mfma_f32_16x16x32_bf16 v[36:39], v[168:171], v[84:87], v[36:39]
  s_waitcnt lgkmcnt(2)
  v_mfma_f32_16x16x32_bf16 v[16:19], v[172:175], v[64:67], v[16:19]
  ds_read_b128 v[80:83], v2 offset:7168
  v_mfma_f32_16x16x32_bf16 v[28:31], v[172:175], v[68:71], v[28:31]
  ds_read_b128 v[84:87], v2 offset:27648
  v_mfma_f32_16x16x32_bf16 v[20:23], v[176:179], v[64:67], v[20:23]
  v_permlane16_swap_b32 v51, v63
  v_mfma_f32_16x16x32_bf16 v[32:35], v[176:179], v[68:71], v[32:35]
  s_cbranch_vccz Lsckd_56
Lsck_55:
  s_add_u32 s55, s62, 1024
  buffer_load_dwordx4 v[12:15], v7, s[4:7], s55 offen sc1
  s_waitcnt vmcnt(0)
  v_bitop3_b32 v14, v14, v15, v1 bitop3:0x7e
  v_cmp_ne_u32 vcc, 0, v14
  s_nop 1
  s_nop 1
  s_cbranch_vccnz Lsck_55
Lsckd_56:
  buffer_inv sc1
  s_waitcnt vmcnt(0)
  v_fmac_f32 v40, v12, v88
  v_mfma_f32_16x16x32_bf16 v[24:27], v[180:183], v[64:67], v[24:27]
  v_fmac_f32 v41, v12, v89
  v_fmac_f32 v42, v12, v90
  v_mfma_f32_16x16x32_bf16 v[36:39], v[180:183], v[68:71], v[36:39]
  v_fmac_f32 v43, v12, v91
  s_waitcnt lgkmcnt(2)
  v_mfma_f32_16x16x32_bf16 v[16:19], v[184:187], v[72:75], v[16:19]
  ds_read_b128 v[64:67], v2 offset:8192
  s_add_u32 m0, s53, 40960
  v_mfma_f32_16x16x32_bf16 v[28:31], v[184:187], v[76:79], v[28:31]
  ds_read_b128 v[68:71], v2 offset:28672
  s_add_u32 s48, s51, 122880
  v_mfma_f32_16x16x32_bf16 v[20:23], v[188:191], v[72:75], v[20:23]
  buffer_load_dwordx4 v2, s[4:7], s48 offen offset:0 sc1 lds
  buffer_load_dwordx4 v2, s[4:7], s48 offen offset:2048 sc1 lds
  v_mfma_f32_16x16x32_bf16 v[32:35], v[188:191], v[76:79], v[32:35]
  v_fmac_f32 v44, v12, v92
  v_fmac_f32 v45, v12, v93
  v_mfma_f32_16x16x32_bf16 v[24:27], v[192:195], v[72:75], v[24:27]
  v_fmac_f32 v46, v12, v94
  v_fmac_f32 v47, v12, v95
  v_mfma_f32_16x16x32_bf16 v[36:39], v[192:195], v[76:79], v[36:39]
  v_fmac_f32 v48, v12, v96
  s_waitcnt lgkmcnt(2)
  v_mfma_f32_16x16x32_bf16 v[16:19], v[196:199], v[80:83], v[16:19]
  ds_read_b128 v[72:75], v2 offset:9216
  s_add_u32 m0, s53, 45056
  v_mfma_f32_16x16x32_bf16 v[28:31], v[196:199], v[84:87], v[28:31]
  ds_read_b128 v[76:79], v2 offset:29696
  s_add_u32 s48, s51, 126976
  v_mfma_f32_16x16x32_bf16 v[20:23], v[200:203], v[80:83], v[20:23]
  buffer_load_dwordx4 v2, s[4:7], s48 offen offset:0 sc1 lds
  v_fmac_f32 v49, v12, v97
  v_mfma_f32_16x16x32_bf16 v[32:35], v[200:203], v[84:87], v[32:35]
  v_fmac_f32 v50, v12, v98
  v_fmac_f32 v51, v12, v99
  v_mfma_f32_16x16x32_bf16 v[24:27], v[204:207], v[80:83], v[24:27]
  v_fmac_f32 v52, v12, v100
  v_fmac_f32 v53, v12, v101
  v_mfma_f32_16x16x32_bf16 v[36:39], v[204:207], v[84:87], v[36:39]
  v_fmac_f32 v54, v12, v102
  s_waitcnt lgkmcnt(2)
  v_mfma_f32_16x16x32_bf16 v[16:19], v[208:211], v[64:67], v[16:19]
  ds_read_b128 v[80:83], v2 offset:10240
  buffer_load_dwordx4 v2, s[4:7], s48 offen offset:2048 sc1 lds
  v_mfma_f32_16x16x32_bf16 v[28:31], v[208:211], v[68:71], v[28:31]
  ds_read_b128 v[84:87], v2 offset:30720
  v_fmac_f32 v55, v12, v103
  v_mfma_f32_16x16x32_bf16 v[20:23], v[212:215], v[64:67], v[20:23]
  v_fmac_f32 v56, v12, v104
  v_fmac_f32 v57, v12, v105
  v_mfma_f32_16x16x32_bf16 v[32:35], v[212:215], v[68:71], v[32:35]
  v_fmac_f32 v58, v12, v106
  v_fmac_f32 v59, v12, v107
  v_mfma_f32_16x16x32_bf16 v[24:27], v[216:219], v[64:67], v[24:27]
  v_fmac_f32 v60, v12, v108
  v_fmac_f32 v61, v12, v109
  v_mfma_f32_16x16x32_bf16 v[36:39], v[216:219], v[68:71], v[36:39]
  v_fmac_f32 v62, v12, v110
  s_waitcnt lgkmcnt(2)
  v_mfma_f32_16x16x32_bf16 v[16:19], v[220:223], v[72:75], v[16:19]
  ds_read_b128 v[64:67], v2 offset:11264
  s_add_u32 m0, s53, 49152
  v_mfma_f32_16x16x32_bf16 v[28:31], v[220:223], v[76:79], v[28:31]
  ds_read_b128 v[68:71], v2 offset:31744
  s_add_u32 s48, s61, 131072
  v_mfma_f32_16x16x32_bf16 v[20:23], v[224:227], v[72:75], v[20:23]
  buffer_load_dwordx4 v2, s[4:7], s48 offen offset:0 sc1 lds
  v_fmac_f32 v63, v12, v111
  v_mfma_f32_16x16x32_bf16 v[32:35], v[224:227], v[76:79], v[32:35]
  v_max_f32 v40, 0, v40
  v_mul_f32 v52, v13, v52
  v_mfma_f32_16x16x32_bf16 v[24:27], v[228:231], v[72:75], v[24:27]
  v_max_f32 v41, 0, v41
  v_mul_f32 v53, v13, v53
  v_mfma_f32_16x16x32_bf16 v[36:39], v[228:231], v[76:79], v[36:39]
  v_max_f32 v42, 0, v42
  s_waitcnt lgkmcnt(2)
  v_mfma_f32_16x16x32_bf16 v[16:19], v[232:235], v[80:83], v[16:19]
  ds_read_b128 v[72:75], v2 offset:12288
  buffer_load_dwordx4 v2, s[4:7], s48 offen offset:2048 sc1 lds
  v_mfma_f32_16x16x32_bf16 v[28:31], v[232:235], v[84:87], v[28:31]
  ds_read_b128 v[76:79], v2 offset:32768
  v_mul_f32 v54, v13, v54
  v_mfma_f32_16x16x32_bf16 v[20:23], v[236:239], v[80:83], v[20:23]
  v_max_f32 v43, 0, v43
  v_mul_f32 v55, v13, v55
  v_mfma_f32_16x16x32_bf16 v[32:35], v[236:239], v[84:87], v[32:35]
  v_max_f32 v44, 0, v44
  v_mul_f32 v56, v13, v56
  v_mfma_f32_16x16x32_bf16 v[24:27], v[240:243], v[80:83], v[24:27]
  v_max_f32 v45, 0, v45
  v_mul_f32 v57, v13, v57
  v_mfma_f32_16x16x32_bf16 v[36:39], v[240:243], v[84:87], v[36:39]
  v_max_f32 v46, 0, v46
  s_waitcnt lgkmcnt(2)
  v_mfma_f32_16x16x32_bf16 v[16:19], v[244:247], v[64:67], v[16:19]
  ds_read_b128 v[80:83], v2 offset:13312
  s_add_u32 m0, s53, 53248
  v_mfma_f32_16x16x32_bf16 v[28:31], v[244:247], v[68:71], v[28:31]
  ds_read_b128 v[84:87], v2 offset:33792
  s_add_u32 s48, s61, 135168
  v_mfma_f32_16x16x32_bf16 v[20:23], v[248:251], v[64:67], v[20:23]
  buffer_load_dwordx4 v2, s[4:7], s48 offen offset:0 sc1 lds
  v_mul_f32 v58, v13, v58
  v_mfma_f32_16x16x32_bf16 v[32:35], v[248:251], v[68:71], v[32:35]
  v_max_f32 v47, 0, v47
  v_mul_f32 v59, v13, v59
  v_mfma_f32_16x16x32_bf16 v[24:27], v[252:255], v[64:67], v[24:27]
  v_max_f32 v48, 0, v48
  v_mul_f32 v60, v13, v60
  v_mfma_f32_16x16x32_bf16 v[36:39], v[252:255], v[68:71], v[36:39]
  v_max_f32 v49, 0, v49
  s_waitcnt lgkmcnt(2)
  v_mfma_f32_16x16x32_bf16 v[16:19], a[0:3], v[72:75], v[16:19]
  ds_read_b128 v[64:67], v2 offset:14336
  buffer_load_dwordx4 v2, s[4:7], s48 offen offset:2048 sc1 lds
  v_mfma_f32_16x16x32_bf16 v[28:31], a[0:3], v[76:79], v[28:31]
  ds_read_b128 v[68:71], v2 offset:34816
  v_mul_f32 v61, v13, v61
  v_mfma_f32_16x16x32_bf16 v[20:23], a[4:7], v[72:75], v[20:23]
  v_max_f32 v50, 0, v50
  v_mul_f32 v62, v13, v62
  v_mfma_f32_16x16x32_bf16 v[32:35], a[4:7], v[76:79], v[32:35]
  v_max_f32 v51, 0, v51
  v_mul_f32 v63, v13, v63
  v_mfma_f32_16x16x32_bf16 v[24:27], a[8:11], v[72:75], v[24:27]
  v_mul_f32 v40, v40, v52
  v_mul_f32 v41, v41, v53
  v_mfma_f32_16x16x32_bf16 v[36:39], a[8:11], v[76:79], v[36:39]
  v_mul_f32 v42, v42, v54
  s_waitcnt lgkmcnt(2)
  v_mfma_f32_16x16x32_bf16 v[16:19], a[12:15], v[80:83], v[16:19]
  ds_read_b128 v[72:75], v2 offset:15360
  s_add_u32 m0, s53, 57344
  v_mfma_f32_16x16x32_bf16 v[28:31], a[12:15], v[84:87], v[28:31]
  ds_read_b128 v[76:79], v2 offset:35840
  s_add_u32 s48, s61, 139264
  v_mfma_f32_16x16x32_bf16 v[20:23], a[16:19], v[80:83], v[20:23]
  buffer_load_dwordx4 v2, s[4:7], s48 offen offset:0 sc1 lds
  v_mul_f32 v43, v43, v55
  v_mfma_f32_16x16x32_bf16 v[32:35], a[16:19], v[84:87], v[32:35]
  v_mul_f32 v44, v44, v56
  v_mul_f32 v45, v45, v57
  v_mfma_f32_16x16x32_bf16 v[24:27], a[20:23], v[80:83], v[24:27]
  v_mul_f32 v46, v46, v58
  v_mul_f32 v47, v47, v59
  v_mfma_f32_16x16x32_bf16 v[36:39], a[20:23], v[84:87], v[36:39]
  v_mul_f32 v48, v48, v60
  s_waitcnt lgkmcnt(2)
  v_mfma_f32_16x16x32_bf16 v[16:19], a[24:27], v[64:67], v[16:19]
  ds_read_b128 v[80:83], v2 offset:16384
  buffer_load_dwordx4 v2, s[4:7], s48 offen offset:2048 sc1 lds
  v_mfma_f32_16x16x32_bf16 v[28:31], a[24:27], v[68:71], v[28:31]
  ds_read_b128 v[84:87], v2 offset:36864
  v_mul_f32 v49, v49, v61
  v_mfma_f32_16x16x32_bf16 v[20:23], a[28:31], v[64:67], v[20:23]
  v_mul_f32 v50, v50, v62
  v_mul_f32 v51, v51, v63
  v_mfma_f32_16x16x32_bf16 v[32:35], a[28:31], v[68:71], v[32:35]
  v_cvt_pk_bf16_f32 v52, v40, v41
  v_cvt_pk_bf16_f32 v53, v42, v43
  v_mfma_f32_16x16x32_bf16 v[24:27], a[32:35], v[64:67], v[24:27]
  v_cvt_pk_bf16_f32 v54, v44, v45
  v_cvt_pk_bf16_f32 v55, v46, v47
  v_mfma_f32_16x16x32_bf16 v[36:39], a[32:35], v[68:71], v[36:39]
  v_cvt_pk_bf16_f32 v56, v48, v49
  s_waitcnt lgkmcnt(2)
  v_mfma_f32_16x16x32_bf16 v[16:19], a[36:39], v[72:75], v[16:19]
  ds_read_b128 v[64:67], v2 offset:17408
  s_add_u32 s55, s62, 512
  v_mfma_f32_16x16x32_bf16 v[28:31], a[36:39], v[76:79], v[28:31]
  ds_read_b128 v[68:71], v2 offset:37888
  buffer_load_dwordx4 v[8:11], v7, s[4:7], s55 offen sc1
  v_mfma_f32_16x16x32_bf16 v[20:23], a[40:43], v[72:75], v[20:23]
  v_cvt_pk_bf16_f32 v57, v50, v51
  s_add_u32 s49, s52, 196608
  v_mfma_f32_16x16x32_bf16 v[32:35], a[40:43], v[76:79], v[32:35]
  buffer_store_dwordx4 v[52:55], v3, s[4:7], s49 offen sc1
  buffer_store_dwordx2 v[56:57], v4, s[4:7], s49 offen sc1
  v_mfma_f32_16x16x32_bf16 v[24:27], a[44:47], v[72:75], v[24:27]
  v_mfma_f32_16x16x32_bf16 v[36:39], a[44:47], v[76:79], v[36:39]
  s_waitcnt lgkmcnt(2)
  v_mfma_f32_16x16x32_bf16 v[16:19], a[48:51], v[80:83], v[16:19]
  ds_read_b128 v[72:75], v2 offset:18432
  s_add_u32 m0, s56, 12288
  v_mfma_f32_16x16x32_bf16 v[28:31], a[48:51], v[84:87], v[28:31]
  ds_read_b128 v[76:79], v2 offset:38912
  s_add_u32 s63, s57, 53248
  v_mfma_f32_16x16x32_bf16 v[20:23], a[52:55], v[80:83], v[20:23]
  buffer_load_dwordx4 v2, s[4:7], s63 offen offset:0 sc1 lds
  v_mfma_f32_16x16x32_bf16 v[32:35], a[52:55], v[84:87], v[32:35]
  v_mfma_f32_16x16x32_bf16 v[24:27], a[56:59], v[80:83], v[24:27]
  v_mfma_f32_16x16x32_bf16 v[36:39], a[56:59], v[84:87], v[36:39]
  s_waitcnt lgkmcnt(2)
  v_mfma_f32_16x16x32_bf16 v[16:19], a[60:63], v[64:67], v[16:19]
  ds_read_b128 v[80:83], v2 offset:19456
  buffer_load_dwordx4 v2, s[4:7], s63 offen offset:1024 sc1 lds
  v_mfma_f32_16x16x32_bf16 v[28:31], a[60:63], v[68:71], v[28:31]
  ds_read_b128 v[84:87], v2 offset:39936
  v_mfma_f32_16x16x32_bf16 v[20:23], a[64:67], v[64:67], v[20:23]
  v_mfma_f32_16x16x32_bf16 v[32:35], a[64:67], v[68:71], v[32:35]
  v_mfma_f32_16x16x32_bf16 v[24:27], a[68:71], v[64:67], v[24:27]
  v_mfma_f32_16x16x32_bf16 v[36:39], a[68:71], v[68:71], v[36:39]
  s_waitcnt lgkmcnt(2)
  v_mfma_f32_16x16x32_bf16 v[16:19], a[72:75], v[72:75], v[16:19]
  s_waitcnt vmcnt(5) lgkmcnt(0)
  s_barrier
  ds_read_b128 v[64:67], v5 offset:0
  v_mfma_f32_16x16x32_bf16 v[28:31], a[72:75], v[76:79], v[28:31]
  ds_read_b128 v[68:71], v5 offset:20480
  buffer_load_dwordx4 v2, s[4:7], s63 offen offset:2048 sc1 lds
  v_mfma_f32_16x16x32_bf16 v[20:23], a[76:79], v[72:75], v[20:23]
  v_mfma_f32_16x16x32_bf16 v[32:35], a[76:79], v[76:79], v[32:35]
  v_mfma_f32_16x16x32_bf16 v[24:27], a[80:83], v[72:75], v[24:27]
  v_mfma_f32_16x16x32_bf16 v[36:39], a[80:83], v[76:79], v[36:39]
  s_waitcnt lgkmcnt(2)
  v_mfma_f32_16x16x32_bf16 v[16:19], a[84:87], v[80:83], v[16:19]
  ds_read_b128 v[72:75], v5 offset:1024
  buffer_load_dwordx4 v2, s[4:7], s63 offen offset:3072 sc1 lds
  v_mfma_f32_16x16x32_bf16 v[28:31], a[84:87], v[84:87], v[28:31]
  ds_read_b128 v[76:79], v5 offset:21504
  v_mfma_f32_16x16x32_bf16 v[20:23], a[88:91], v[80:83], v[20:23]
  v_mfma_f32_16x16x32_bf16 v[32:35], a[88:91], v[84:87], v[32:35]
  v_mfma_f32_16x16x32_bf16 v[24:27], a[92:95], v[80:83], v[24:27]
  v_mfma_f32_16x16x32_bf16 v[36:39], a[92:95], v[84:87], v[36:39]
  s_waitcnt lgkmcnt(2)
  v_mfma_f32_16x16x32_bf16 v[40:43], v[112:115], v[64:67], 0
  ds_read_b128 v[80:83], v5 offset:2048
  s_add_u32 m0, s56, 16384
  v_mfma_f32_16x16x32_bf16 v[52:55], v[112:115], v[68:71], 0
  ds_read_b128 v[84:87], v5 offset:22528
  s_add_u32 s63, s57, 57344
  v_mfma_f32_16x16x32_bf16 v[44:47], v[116:119], v[64:67], 0
  buffer_load_dwordx4 v2, s[4:7], s63 offen offset:0 sc1 lds
  s_getpc_b64 s[12:13]
Lpc_57:
  v_mfma_f32_16x16x32_bf16 v[56:59], v[116:119], v[68:71], 0
  s_add_u32 s12, s12, L_r2_s-Lpc_57
  s_addc_u32 s13, s13, 0
  v_mfma_f32_16x16x32_bf16 v[48:51], v[120:123], v[64:67], 0
  s_lshl_b32 s14, s42, 3
  s_add_u32 s14, s14, s41
  v_mfma_f32_16x16x32_bf16 v[60:63], v[120:123], v[68:71], 0
  s_and_b32 s14, s14, 31
  s_waitcnt lgkmcnt(2)
  v_mfma_f32_16x16x32_bf16 v[40:43], v[124:127], v[72:75], v[40:43]
  ds_read_b128 v[64:67], v5 offset:3072
  v_min_u32 v12, (L_fin_s-L_r2_s)/4096, v0
  v_mfma_f32_16x16x32_bf16 v[52:55], v[124:127], v[76:79], v[52:55]
  ds_read_b128 v[68:71], v5 offset:23552
  v_lshl_add_u32 v12, v12, 5, s14
  v_mfma_f32_16x16x32_bf16 v[44:47], v[128:131], v[72:75], v[44:47]
  v_lshlrev_b32 v12, 7, v12
  v_mov_b32 v13, s13
  v_mfma_f32_16x16x32_bf16 v[56:59], v[128:131], v[76:79], v[56:59]
  v_add_co_u32 v12, vcc, s12, v12
  s_nop 1
  v_addc_co_u32 v13, vcc, 0, v13, vcc
  v_mfma_f32_16x16x32_bf16 v[48:51], v[132:135], v[72:75], v[48:51]
  global_load_dword v14, v[12:13], off
  buffer_load_dwordx4 v2, s[4:7], s63 offen offset:1024 sc1 lds
  v_mfma_f32_16x16x32_bf16 v[60:63], v[132:135], v[76:79], v[60:63]
  s_waitcnt lgkmcnt(2)
  v_mfma_f32_16x16x32_bf16 v[40:43], v[136:139], v[80:83], v[40:43]
  ds_read_b128 v[72:75], v5 offset:4096
  buffer_load_dwordx4 v2, s[4:7], s63 offen offset:2048 sc1 lds
  v_mfma_f32_16x16x32_bf16 v[52:55], v[136:139], v[84:87], v[52:55]
  ds_read_b128 v[76:79], v5 offset:24576
  v_mfma_f32_16x16x32_bf16 v[44:47], v[140:143], v[80:83], v[44:47]
  s_waitcnt vmcnt(8)
  s_add_u32 s46, s64, 28672
  s_mov_b64 exec, 1
  buffer_store_dword v1, off, s[4:7], s46 sc1
  s_mov_b64 exec, -1
  v_mfma_f32_16x16x32_bf16 v[56:59], v[140:143], v[84:87], v[56:59]
  v_permlane16_swap_b32 v16, v28
  v_mfma_f32_16x16x32_bf16 v[48:51], v[144:147], v[80:83], v[48:51]
  v_permlane16_swap_b32 v17, v29
  v_mfma_f32_16x16x32_bf16 v[60:63], v[144:147], v[84:87], v[60:63]
  s_waitcnt lgkmcnt(2)
  v_mfma_f32_16x16x32_bf16 v[40:43], v[148:151], v[64:67], v[40:43]
  ds_read_b128 v[80:83], v5 offset:5120
  buffer_load_dwordx4 v2, s[4:7], s63 offen offset:3072 sc1 lds
  v_mfma_f32_16x16x32_bf16 v[52:55], v[148:151], v[68:71], v[52:55]
  ds_read_b128 v[84:87], v5 offset:25600
  v_mfma_f32_16x16x32_bf16 v[44:47], v[152:155], v[64:67], v[44:47]
  v_permlane16_swap_b32 v18, v30
  v_mfma_f32_16x16x32_bf16 v[56:59], v[152:155], v[68:71], v[56:59]
  v_permlane16_swap_b32 v19, v31
  v_mfma_f32_16x16x32_bf16 v[48:51], v[156:159], v[64:67], v[48:51]
  v_permlane16_swap_b32 v20, v32
  v_mfma_f32_16x16x32_bf16 v[60:63], v[156:159], v[68:71], v[60:63]
  s_waitcnt lgkmcnt(2)
  v_mfma_f32_16x16x32_bf16 v[40:43], v[160:163], v[72:75], v[40:43]
  ds_read_b128 v[64:67], v5 offset:6144
  buffer_load_dwordx4 a[228:231], v2, s[4:7], s54 offen offset:1024 sc1
  v_mfma_f32_16x16x32_bf16 v[52:55], v[160:163], v[76:79], v[52:55]
  ds_read_b128 v[68:71], v5 offset:26624
  v_mfma_f32_16x16x32_bf16 v[44:47], v[164:167], v[72:75], v[44:47]
  v_permlane16_swap_b32 v21, v33
  v_mfma_f32_16x16x32_bf16 v[56:59], v[164:167], v[76:79], v[56:59]
  v_permlane16_swap_b32 v22, v34
  v_mfma_f32_16x16x32_bf16 v[48:51], v[168:171], v[72:75], v[48:51]
  v_permlane16_swap_b32 v23, v35
  v_mfma_f32_16x16x32_bf16 v[60:63], v[168:171], v[76:79], v[60:63]
  s_waitcnt vmcnt(13)
  s_waitcnt lgkmcnt(2)
  v_mfma_f32_16x16x32_bf16 v[40:43], v[172:175], v[80:83], v[40:43]
  ds_read_b128 v[72:75], v5 offset:7168
  s_add_u32 s55, s65, 28672
  buffer_load_dwordx4 v[12:15], v6, s[4:7], s55 offen sc1
  v_mfma_f32_16x16x32_bf16 v[52:55], v[172:175], v[84:87], v[52:55]
  ds_read_b128 v[76:79], v5 offset:27648
  buffer_load_dwordx4 a[232:235], v2, s[4:7], s54 offen offset:2048 sc1
  v_mfma_f32_16x16x32_bf16 v[44:47], v[176:179], v[80:83], v[44:47]
  v_bitop3_b32 v10, v10, v11, v1 bitop3:0x7e
  v_cmp_ne_u32 vcc, 0, v10
  v_mfma_f32_16x16x32_bf16 v[56:59], v[176:179], v[84:87], v[56:59]
  v_permlane16_swap_b32 v24, v36
  v_mfma_f32_16x16x32_bf16 v[48:51], v[180:183], v[80:83], v[48:51]
  v_permlane16_swap_b32 v25, v37
  v_mfma_f32_16x16x32_bf16 v[60:63], v[180:183], v[84:87], v[60:63]
  s_waitcnt lgkmcnt(2)
  v_mfma_f32_16x16x32_bf16 v[40:43], v[184:187], v[64:67], v[40:43]
  ds_read_b128 v[80:83], v5 offset:8192
  buffer_load_dwordx4 a[236:239], v2, s[4:7], s54 offen offset:3072 sc1
  v_mfma_f32_16x16x32_bf16 v[52:55], v[184:187], v[68:71], v[52:55]
  ds_read_b128 v[84:87], v5 offset:28672
  v_mfma_f32_16x16x32_bf16 v[44:47], v[188:191], v[64:67], v[44:47]
  v_permlane16_swap_b32 v26, v38
  v_mfma_f32_16x16x32_bf16 v[56:59], v[188:191], v[68:71], v[56:59]
  v_permlane16_swap_b32 v27, v39
  v_mfma_f32_16x16x32_bf16 v[48:51], v[192:195], v[64:67], v[48:51]
  s_cbranch_vccz Lsckd_59
Lsck_58:
  s_add_u32 s55, s62, 512
  buffer_load_dwordx4 v[8:11], v7, s[4:7], s55 offen sc1
  s_waitcnt vmcnt(0)
  v_bitop3_b32 v10, v10, v11, v1 bitop3:0x7e
  v_cmp_ne_u32 vcc, 0, v10
  s_nop 1
  s_nop 1
  s_cbranch_vccnz Lsck_58
Lsckd_59:
  buffer_inv sc1
  s_waitcnt vmcnt(0)
  v_fmac_f32 v16, v8, v88
  v_mfma_f32_16x16x32_bf16 v[60:63], v[192:195], v[68:71], v[60:63]
  v_fmac_f32 v17, v8, v89
  s_waitcnt lgkmcnt(2)
  v_mfma_f32_16x16x32_bf16 v[40:43], v[196:199], v[72:75], v[40:43]
  ds_read_b128 v[64:67], v5 offset:9216
  s_add_u32 s54, s57, 36864
  v_mfma_f32_16x16x32_bf16 v[52:55], v[196:199], v[76:79], v[52:55]
  ds_read_b128 v[68:71], v5 offset:29696
  buffer_load_dwordx4 a[240:243], v2, s[4:7], s54 offen offset:0 sc1
  v_mfma_f32_16x16x32_bf16 v[44:47], v[200:203], v[72:75], v[44:47]
  v_fmac_f32 v18, v8, v90
  v_fmac_f32 v19, v8, v91
  v_mfma_f32_16x16x32_bf16 v[56:59], v[200:203], v[76:79], v[56:59]
  v_fmac_f32 v20, v8, v92
  v_fmac_f32 v21, v8, v93
  v_mfma_f32_16x16x32_bf16 v[48:51], v[204:207], v[72:75], v[48:51]
  v_fmac_f32 v22, v8, v94
  v_fmac_f32 v23, v8, v95
  v_mfma_f32_16x16x32_bf16 v[60:63], v[204:207], v[76:79], v[60:63]
  v_fmac_f32 v24, v8, v96
  s_waitcnt lgkmcnt(2)
  v_mfma_f32_16x16x32_bf16 v[40:43], v[208:211], v[80:83], v[40:43]
  ds_read_b128 v[72:75], v5 offset:10240
  buffer_load_dwordx4 a[244:247], v2, s[4:7], s54 offen offset:1024 sc1
  v_mfma_f32_16x16x32_bf16 v[52:55], v[208:211], v[84:87], v[52:55]
  ds_read_b128 v[76:79], v5 offset:30720
  v_fmac_f32 v25, v8, v97
  v_mfma_f32_16x16x32_bf16 v[44:47], v[212:215], v[80:83], v[44:47]
  s_waitcnt vmcnt(4)
  v_bitop3_b32 v12, v12, v13, v1 bitop3:0x7e
  v_mfma_f32_16x16x32_bf16 v[56:59], v[212:215], v[84:87], v[56:59]
  v_bitop3_b32 v14, v14, v15, v1 bitop3:0x7e
  v_or_b32 v12, v12, v14
  v_mfma_f32_16x16x32_bf16 v[48:51], v[216:219], v[80:83], v[48:51]
  v_cmp_ne_u32 vcc, 0, v12
  v_fmac_f32 v26, v8, v98
  v_mfma_f32_16x16x32_bf16 v[60:63], v[216:219], v[84:87], v[60:63]
  v_fmac_f32 v27, v8, v99
  s_waitcnt lgkmcnt(2)
  v_mfma_f32_16x16x32_bf16 v[40:43], v[220:223], v[64:67], v[40:43]
  ds_read_b128 v[80:83], v5 offset:11264
  buffer_load_dwordx4 a[248:251], v2, s[4:7], s54 offen offset:2048 sc1
  v_mfma_f32_16x16x32_bf16 v[52:55], v[220:223], v[68:71], v[52:55]
  ds_read_b128 v[84:87], v5 offset:31744
  s_cbranch_vccz Lsckd_61
Lsck_60:
  s_add_u32 s55, s65, 28672
  buffer_load_dwordx4 v[12:15], v6, s[4:7], s55 offen sc1
  s_waitcnt vmcnt(0)
  v_bitop3_b32 v12, v12, v13, v1 bitop3:0x7e
  v_bitop3_b32 v14, v14, v15, v1 bitop3:0x7e
  v_or_b32 v12, v12, v14
  v_cmp_ne_u32 vcc, 0, v12
  s_nop 1
  s_nop 1
  s_cbranch_vccnz Lsck_60
Lsckd_61:
  buffer_inv sc1
  s_waitcnt vmcnt(0)
  v_mfma_f32_16x16x32_bf16 v[44:47], v[224:227], v[64:67], v[44:47]
  v_fmac_f32 v28, v8, v100
  v_mfma_f32_16x16x32_bf16 v[56:59], v[224:227], v[68:71], v[56:59]
  v_fmac_f32 v29, v8, v101
  v_fmac_f32 v30, v8, v102
  v_mfma_f32_16x16x32_bf16 v[48:51], v[228:231], v[64:67], v[48:51]
  v_fmac_f32 v31, v8, v103
  v_fmac_f32 v32, v8, v104
  v_mfma_f32_16x16x32_bf16 v[60:63], v[228:231], v[68:71], v[60:63]
  v_fmac_f32 v33, v8, v105
  s_waitcnt lgkmcnt(2)
  v_mfma_f32_16x16x32_bf16 v[40:43], v[232:235], v[72:75], v[40:43]
  ds_read_b128 v[64:67], v5 offset:12288
  s_add_u32 s55, s62, 1536
  buffer_load_dwordx4 v[12:15], v7, s[4:7], s55 offen sc1
  v_mfma_f32_16x16x32_bf16 v[52:55], v[232:235], v[76:79], v[52:55]
  ds_read_b128 v[68:71], v5 offset:32768
  s_add_u32 m0, s60, 0
  s_add_u32 s48, s59, 0
  v_mfma_f32_16x16x32_bf16 v[44:47], v[236:239], v[72:75], v[44:47]
  buffer_load_dwordx4 v2, s[4:7], s48 offen offset:0 sc1 lds
  buffer_load_dwordx4 v2, s[4:7], s48 offen offset:1024 sc1 lds
  buffer_load_dwordx4 a[252:255], v2, s[4:7], s54 offen offset:3072 sc1
  v_mfma_f32_16x16x32_bf16 v[56:59], v[236:239], v[76:79], v[56:59]
  v_fmac_f32 v34, v8, v106
  v_fmac_f32 v35, v8, v107
  v_mfma_f32_16x16x32_bf16 v[48:51], v[240:243], v[72:75], v[48:51]
  v_fmac_f32 v36, v8, v108
  v_fmac_f32 v37, v8, v109
  v_mfma_f32_16x16x32_bf16 v[60:63], v[240:243], v[76:79], v[60:63]
  v_fmac_f32 v38, v8, v110
  s_waitcnt lgkmcnt(2)
  v_mfma_f32_16x16x32_bf16 v[40:43], v[244:247], v[80:83], v[40:43]
  ds_read_b128 v[72:75], v5 offset:13312
  buffer_load_dwordx4 v2, s[4:7], s48 offen offset:2048 sc1 lds
  buffer_load_dwordx4 v2, s[4:7], s48 offen offset:3072 sc1 lds
  v_mfma_f32_16x16x32_bf16 v[52:55], v[244:247], v[84:87], v[52:55]
  ds_read_b128 v[76:79], v5 offset:33792
  v_fmac_f32 v39, v8, v111
  v_mfma_f32_16x16x32_bf16 v[44:47], v[248:251], v[80:83], v[44:47]
  v_max_f32 v16, 0, v16
  v_mul_f32 v28, v9, v28
  v_mfma_f32_16x16x32_bf16 v[56:59], v[248:251], v[84:87], v[56:59]
  v_max_f32 v17, 0, v17
  v_mul_f32 v29, v9, v29
  v_mfma_f32_16x16x32_bf16 v[48:51], v[252:255], v[80:83], v[48:51]
  v_max_f32 v18, 0, v18
  v_mul_f32 v30, v9, v30
  v_mfma_f32_16x16x32_bf16 v[60:63], v[252:255], v[84:87], v[60:63]
  v_max_f32 v19, 0, v19
  s_waitcnt lgkmcnt(2)
  v_mfma_f32_16x16x32_bf16 v[40:43], a[0:3], v[64:67], v[40:43]
  ds_read_b128 v[80:83], v5 offset:14336
  s_add_u32 m0, s60, 4096
  v_mfma_f32_16x16x32_bf16 v[52:55], a[0:3], v[68:71], v[52:55]
  ds_read_b128 v[84:87], v5 offset:34816
  s_add_u32 s48, s59, 8192
  v_mfma_f32_16x16x32_bf16 v[44:47], a[4:7], v[64:67], v[44:47]
  buffer_load_dwordx4 v2, s[4:7], s48 offen offset:0 sc1 lds
  v_mul_f32 v31, v9, v31
  v_mfma_f32_16x16x32_bf16 v[56:59], a[4:7], v[68:71], v[56:59]
  v_max_f32 v20, 0, v20
  v_mul_f32 v32, v9, v32
  v_mfma_f32_16x16x32_bf16 v[48:51], a[8:11], v[64:67], v[48:51]
  v_max_f32 v21, 0, v21
  v_mul_f32 v33, v9, v33
  v_mfma_f32_16x16x32_bf16 v[60:63], a[8:11], v[68:71], v[60:63]
  v_max_f32 v22, 0, v22
  s_waitcnt lgkmcnt(2)
  v_mfma_f32_16x16x32_bf16 v[40:43], a[12:15], v[72:75], v[40:43]
  ds_read_b128 v[64:67], v5 offset:15360
  buffer_load_dwordx4 v2, s[4:7], s48 offen offset:1024 sc1 lds
  v_mfma_f32_16x16x32_bf16 v[52:55], a[12:15], v[76:79], v[52:55]
  ds_read_b128 v[68:71], v5 offset:35840
  v_mul_f32 v34, v9, v34
  v_mfma_f32_16x16x32_bf16 v[44:47], a[16:19], v[72:75], v[44:47]
  v_max_f32 v23, 0, v23
  v_mul_f32 v35, v9, v35
  v_mfma_f32_16x16x32_bf16 v[56:59], a[16:19], v[76:79], v[56:59]
  v_max_f32 v24, 0, v24
  v_mul_f32 v36, v9, v36
  v_mfma_f32_16x16x32_bf16 v[48:51], a[20:23], v[72:75], v[48:51]
  v_max_f32 v25, 0, v25
  v_mul_f32 v37, v9, v37
  v_mfma_f32_16x16x32_bf16 v[60:63], a[20:23], v[76:79], v[60:63]
  v_max_f32 v26, 0, v26
  s_waitcnt lgkmcnt(2)
  v_mfma_f32_16x16x32_bf16 v[40:43], a[24:27], v[80:83], v[40:43]
  ds_read_b128 v[72:75], v5 offset:16384
  buffer_load_dwordx4 v2, s[4:7], s48 offen offset:2048 sc1 lds
  v_mfma_f32_16x16x32_bf16 v[52:55], a[24:27], v[84:87], v[52:55]
  ds_read_b128 v[76:79], v5 offset:36864
  v_mul_f32 v38, v9, v38
  v_mfma_f32_16x16x32_bf16 v[44:47], a[28:31], v[80:83], v[44:47]
  v_max_f32 v27, 0, v27
  v_mul_f32 v39, v9, v39
  v_mfma_f32_16x16x32_bf16 v[56:59], a[28:31], v[84:87], v[56:59]
  v_mul_f32 v16, v16, v28
  v_mul_f32 v17, v17, v29
  v_mfma_f32_16x16x32_bf16 v[48:51], a[32:35], v[80:83], v[48:51]
  v_mul_f32 v18, v18, v30
  v_mul_f32 v19, v19, v31
  v_mfma_f32_16x16x32_bf16 v[60:63], a[32:35], v[84:87], v[60:63]
  v_mul_f32 v20, v20, v32
  s_waitcnt lgkmcnt(2)
  v_mfma_f32_16x16x32_bf16 v[40:43], a[36:39], v[64:67], v[40:43]
  ds_read_b128 v[80:83], v5 offset:17408
  s_add_u32 m0, s60, 7168
  v_mfma_f32_16x16x32_bf16 v[52:55], a[36:39], v[68:71], v[52:55]
  ds_read_b128 v[84:87], v5 offset:37888
  s_add_u32 s48, s59, 4096
  v_mfma_f32_16x16x32_bf16 v[44:47], a[40:43], v[64:67], v[44:47]
  buffer_load_dwordx4 v2, s[4:7], s48 offen offset:0 sc1 lds
  v_mul_f32 v21, v21, v33
  v_mfma_f32_16x16x32_bf16 v[56:59], a[40:43], v[68:71], v[56:59]
  v_mul_f32 v22, v22, v34
  v_mul_f32 v23, v23, v35
  v_mfma_f32_16x16x32_bf16 v[48:51], a[44:47], v[64:67], v[48:51]
  v_mul_f32 v24, v24, v36
  v_mul_f32 v25, v25, v37
  v_mfma_f32_16x16x32_bf16 v[60:63], a[44:47], v[68:71], v[60:63]
  v_mul_f32 v26, v26, v38
  s_waitcnt lgkmcnt(2)
  v_mfma_f32_16x16x32_bf16 v[40:43], a[48:51], v[72:75], v[40:43]
  ds_read_b128 v[64:67], v5 offset:18432
  buffer_load_dwordx4 v2, s[4:7], s48 offen offset:1024 sc1 lds
  v_mfma_f32_16x16x32_bf16 v[52:55], a[48:51], v[76:79], v[52:55]
  ds_read_b128 v[68:71], v5 offset:38912
  v_mul_f32 v27, v27, v39
  v_mfma_f32_16x16x32_bf16 v[44:47], a[52:55], v[72:75], v[44:47]
  v_cvt_pk_bf16_f32 v28, v16, v17
  v_cvt_pk_bf16_f32 v29, v18, v19
  v_mfma_f32_16x16x32_bf16 v[56:59], a[52:55], v[76:79], v[56:59]
  v_cvt_pk_bf16_f32 v30, v20, v21
  v_cvt_pk_bf16_f32 v31, v22, v23
  v_mfma_f32_16x16x32_bf16 v[48:51], a[56:59], v[72:75], v[48:51]
  v_cvt_pk_bf16_f32 v32, v24, v25
  v_cvt_pk_bf16_f32 v33, v26, v27
  v_mfma_f32_16x16x32_bf16 v[60:63], a[56:59], v[76:79], v[60:63]
  s_add_u32 s49, s52, 98304
  s_waitcnt lgkmcnt(2)
  v_mfma_f32_16x16x32_bf16 v[40:43], a[60:63], v[80:83], v[40:43]
  ds_read_b128 v[72:75], v5 offset:19456
  buffer_store_dwordx4 v[28:31], v3, s[4:7], s49 offen sc1
  v_mfma_f32_16x16x32_bf16 v[52:55], a[60:63], v[84:87], v[52:55]
  ds_read_b128 v[76:79], v5 offset:39936
  buffer_store_dwordx2 v[32:33], v4, s[4:7], s49 offen sc1
  v_mfma_f32_16x16x32_bf16 v[44:47], a[64:67], v[80:83], v[44:47]
  v_mfma_f32_16x16x32_bf16 v[56:59], a[64:67], v[84:87], v[56:59]
  v_mfma_f32_16x16x32_bf16 v[48:51], a[68:71], v[80:83], v[48:51]
  v_mfma_f32_16x16x32_bf16 v[60:63], a[68:71], v[84:87], v[60:63]
  s_waitcnt lgkmcnt(2)
  v_mfma_f32_16x16x32_bf16 v[40:43], a[72:75], v[64:67], v[40:43]
  s_waitcnt vmcnt(12)
  v_bitop3_b32 v14, v14, v15, v1 bitop3:0x7e
  v_mfma_f32_16x16x32_bf16 v[52:55], a[72:75], v[68:71], v[52:55]
  v_cmp_ne_u32 vcc, 0, v14
  v_add_u32 v8, s60, v2
  v_mfma_f32_16x16x32_bf16 v[44:47], a[76:79], v[64:67], v[44:47]
  s_nop 0
  s_nop 0
  s_cbranch_vccz Lsckd_63
Lsck_62:
  s_add_u32 s55, s62, 1536
  buffer_load_dwordx4 v[12:15], v7, s[4:7], s55 offen sc1
  s_waitcnt vmcnt(0)
  v_bitop3_b32 v14, v14, v15, v1 bitop3:0x7e
  v_cmp_ne_u32 vcc, 0, v14
  s_nop 1
  s_nop 1
  s_cbranch_vccnz Lsck_62
Lsckd_63:
  buffer_inv sc1
  s_waitcnt vmcnt(0)
  v_mfma_f32_16x16x32_bf16 v[56:59], a[76:79], v[68:71], v[56:59]
  v_add_u32 v7, s56, v2
  v_mfma_f32_16x16x32_bf16 v[48:51], a[80:83], v[64:67], v[48:51]
  v_mfma_f32_16x16x32_bf16 v[60:63], a[80:83], v[68:71], v[60:63]
  s_waitcnt lgkmcnt(0)
  v_mfma_f32_16x16x32_bf16 v[40:43], a[84:87], v[72:75], v[40:43]
  v_mfma_f32_16x16x32_bf16 v[52:55], a[84:87], v[76:79], v[52:55]
  v_mfma_f32_16x16x32_bf16 v[44:47], a[88:91], v[72:75], v[44:47]
  v_mfma_f32_16x16x32_bf16 v[56:59], a[88:91], v[76:79], v[56:59]
  v_mfma_f32_16x16x32_bf16 v[48:51], a[92:95], v[72:75], v[48:51]
  v_mfma_f32_16x16x32_bf16 v[60:63], a[92:95], v[76:79], v[60:63]
  s_waitcnt vmcnt(10)
  ds_read_b128 v[64:67], v8 offset:0
  ds_read_b128 v[68:71], v8 offset:1024
  s_nop 0
  v_permlane16_swap_b32 v40, v52
  v_permlane16_swap_b32 v41, v53
  v_permlane16_swap_b32 v42, v54
  v_permlane16_swap_b32 v43, v55
  v_permlane16_swap_b32 v44, v56
  v_permlane16_swap_b32 v45, v57
  v_permlane16_swap_b32 v46, v58
  v_permlane16_swap_b32 v47, v59
  v_permlane16_swap_b32 v48, v60
  v_permlane16_swap_b32 v49, v61
  v_permlane16_swap_b32 v50, v62
  v_permlane16_swap_b32 v51, v63
  v_pk_fma_f32 v[40:41], v[88:89], v[12:13], v[40:41] op_sel_hi:[1,0,1]
  v_pk_fma_f32 v[42:43], v[90:91], v[12:13], v[42:43] op_sel_hi:[1,0,1]
  v_pk_fma_f32 v[44:45], v[92:93], v[12:13], v[44:45] op_sel_hi:[1,0,1]
  v_pk_fma_f32 v[46:47], v[94:95], v[12:13], v[46:47] op_sel_hi:[1,0,1]
  v_pk_fma_f32 v[48:49], v[96:97], v[12:13], v[48:49] op_sel_hi:[1,0,1]
  v_pk_fma_f32 v[50:51], v[98:99], v[12:13], v[50:51] op_sel_hi:[1,0,1]
  v_pk_fma_f32 v[52:53], v[100:101], v[12:13], v[52:53] op_sel_hi:[1,0,1]
  v_pk_fma_f32 v[54:55], v[102:103], v[12:13], v[54:55] op_sel_hi:[1,0,1]
  v_pk_fma_f32 v[56:57], v[104:105], v[12:13], v[56:57] op_sel_hi:[1,0,1]
  v_pk_fma_f32 v[58:59], v[106:107], v[12:13], v[58:59] op_sel_hi:[1,0,1]
  v_pk_fma_f32 v[60:61], v[108:109], v[12:13], v[60:61] op_sel_hi:[1,0,1]
  v_pk_fma_f32 v[62:63], v[110:111], v[12:13], v[62:63] op_sel_hi:[1,0,1]
  v_max_f32 v40, 0, v40
  v_max_f32 v41, 0, v41
  v_max_f32 v42, 0, v42
  v_max_f32 v43, 0, v43
  v_max_f32 v44, 0, v44
  v_max_f32 v45, 0, v45
  v_max_f32 v46, 0, v46
  v_max_f32 v47, 0, v47
  v_max_f32 v48, 0, v48
  v_max_f32 v49, 0, v49
  v_max_f32 v50, 0, v50
  v_max_f32 v51, 0, v51
  v_pk_mul_f32 v[52:53], v[52:53], v[12:13] op_sel:[0,1] op_sel_hi:[1,1]
  v_pk_mul_f32 v[54:55], v[54:55], v[12:13] op_sel:[0,1] op_sel_hi:[1,1]
  v_pk_mul_f32 v[56:57], v[56:57], v[12:13] op_sel:[0,1] op_sel_hi:[1,1]
  v_pk_mul_f32 v[58:59], v[58:59], v[12:13] op_sel:[0,1] op_sel_hi:[1,1]
  v_pk_mul_f32 v[60:61], v[60:61], v[12:13] op_sel:[0,1] op_sel_hi:[1,1]
  v_pk_mul_f32 v[62:63], v[62:63], v[12:13] op_sel:[0,1] op_sel_hi:[1,1]
  v_pk_mul_f32 v[40:41], v[40:41], v[52:53]
  v_pk_mul_f32 v[42:43], v[42:43], v[54:55]
  v_pk_mul_f32 v[44:45], v[44:45], v[56:57]
  v_pk_mul_f32 v[46:47], v[46:47], v[58:59]
  v_pk_mul_f32 v[48:49], v[48:49], v[60:61]
  v_pk_mul_f32 v[50:51], v[50:51], v[62:63]
  v_cvt_pk_bf16_f32 v52, v40, v41
  v_cvt_pk_bf16_f32 v53, v42, v43
  v_cvt_pk_bf16_f32 v54, v44, v45
  v_cvt_pk_bf16_f32 v55, v46, v47
  v_cvt_pk_bf16_f32 v56, v48, v49
  v_cvt_pk_bf16_f32 v57, v50, v51
  s_add_u32 s49, s52, 294912
  buffer_store_dwordx4 v[52:55], v3, s[4:7], s49 offen sc1
  buffer_store_dwordx2 v[56:57], v4, s[4:7], s49 offen sc1
  v_lshrrev_b32 v10, 5, v0
  v_mul_u32_u24 v10, 96, v10
  s_mul_i32 s48, s42, 192
  s_add_u32 s48, s48, 36864
  v_add_u32 v10, s48, v10
  ds_write_b128 v10, v[88:91] offset:0
  ds_write_b128 v10, v[92:95] offset:16
  ds_write_b128 v10, v[96:99] offset:32
  ds_write_b128 v10, v[100:103] offset:48
  ds_write_b128 v10, v[104:107] offset:64
  ds_write_b128 v10, v[108:111] offset:80
  s_add_u32 s62, s59, 4096
  buffer_load_dwordx4 v[76:79], v2, s[4:7], s62 offen offset:2048 sc1
  buffer_load_dwordx4 v[80:83], v2, s[4:7], s62 offen offset:3072 sc1
  s_add_u32 s54, s59, 8192
  buffer_load_dwordx4 v[84:87], v2, s[4:7], s54 offen offset:3072 sc1
  s_waitcnt lgkmcnt(7)
  v_mfma_f32_16x16x32_bf16 v[16:19], a[96:99], v[64:67], 0
  s_waitcnt vmcnt(11)
  ds_read_b128 v[72:75], v8 offset:4096
  ds_read_b128 v[88:91], v7 offset:0
  v_mfma_f32_16x16x32_bf16 v[20:23], a[100:103], v[64:67], 0
  ds_read_b128 v[92:95], v7 offset:1024
  ds_read_b128 v[96:99], v7 offset:2048
  ds_read_b128 v[100:103], v7 offset:3072
  v_mfma_f32_16x16x32_bf16 v[24:27], a[104:107], v[64:67], 0
  ds_read_b128 v[104:107], v7 offset:4096
  s_lshl_b32 s48, s42, 12
  v_add_u32 v3, s48, v5
  v_mfma_f32_16x16x32_bf16 v[28:31], a[108:111], v[64:67], 0
  s_lshl_b32 s48, s42, 10
  v_add_u32 v13, s48, v5
  v_and_b32 v4, 15, v0
  v_mfma_f32_16x16x32_bf16 v[32:35], a[112:115], v[64:67], 0
  v_lshrrev_b32 v15, 4, v0
  v_lshlrev_b32 v4, 4, v4
  s_waitcnt lgkmcnt(12)
  v_mfma_f32_16x16x32_bf16 v[16:19], a[116:119], v[68:71], v[16:19]
  s_waitcnt vmcnt(13)
  ds_read_b128 v[64:67], v8 offset:2048
  v_and_b32 v15, 1, v15
  v_mfma_f32_16x16x32_bf16 v[20:23], a[120:123], v[68:71], v[20:23]
  v_lshl_add_u32 v4, v15, 3, v4
  v_lshrrev_b32 v15, 5, v0
  v_lshl_add_u32 v4, v15, 10, v4
  v_mfma_f32_16x16x32_bf16 v[24:27], a[124:127], v[68:71], v[24:27]
  s_and_b32 s63, s41, 7
  s_mul_i32 s48, s63, 10
  s_lshl_b32 s49, s42, 1
  v_mfma_f32_16x16x32_bf16 v[28:31], a[128:131], v[68:71], v[28:31]
  s_add_u32 s50, s48, s49
  s_add_u32 s51, s48, 8
  v_mfma_f32_16x16x32_bf16 v[32:35], a[132:135], v[68:71], v[32:35]
  s_waitcnt lgkmcnt(6)
  s_waitcnt lgkmcnt(1)
  v_mfma_f32_16x16x32_bf16 v[16:19], v[88:91], v[72:75], v[16:19]
  s_waitcnt vmcnt(12)
  ds_read_b128 v[68:71], v8 offset:3072
  s_add_u32 s60, s59, 49152
  v_mfma_f32_16x16x32_bf16 v[20:23], v[92:95], v[72:75], v[20:23]
  buffer_load_dwordx4 v[56:59], v2, s[4:7], s60 offen offset:0 sc1
  s_mul_i32 s48, s50, 205
  s_lshr_b32 s48, s48, 12
  v_mfma_f32_16x16x32_bf16 v[24:27], v[96:99], v[72:75], v[24:27]
  s_mul_i32 s49, s48, 20
  s_sub_u32 s50, s50, s49
  v_mfma_f32_16x16x32_bf16 v[28:31], v[100:103], v[72:75], v[28:31]
  s_sub_u32 s50, s50, s67
  s_add_u32 s49, s50, 20
  v_mfma_f32_16x16x32_bf16 v[32:35], v[104:107], v[72:75], v[32:35]
  ds_read_b128 v[88:91], v7 offset:5120
  ds_read_b128 v[92:95], v7 offset:6144
  s_waitcnt lgkmcnt(3)
  v_mfma_f32_16x16x32_bf16 v[16:19], a[136:139], v[64:67], v[16:19]
  s_waitcnt vmcnt(11)
  ds_read_b128 v[72:75], v8 offset:5120
  buffer_load_dwordx4 v[60:63], v2, s[4:7], s60 offen offset:1024 sc1
  v_mfma_f32_16x16x32_bf16 v[20:23], a[140:143], v[64:67], v[20:23]
  ds_read_b128 v[96:99], v7 offset:7168
  ds_read_b128 v[100:103], v7 offset:8192
  ds_read_b128 v[104:107], v7 offset:9216
  v_mfma_f32_16x16x32_bf16 v[24:27], a[144:147], v[64:67], v[24:27]
  s_min_u32 s50, s50, s49
  s_lshl_b32 s50, s50, 2
  s_add_u32 s50, s50, s48
  v_mfma_f32_16x16x32_bf16 v[28:31], a[148:151], v[64:67], v[28:31]
  s_mul_i32 s48, s51, 205
  s_lshr_b32 s48, s48, 12
  v_mfma_f32_16x16x32_bf16 v[32:35], a[152:155], v[64:67], v[32:35]
  s_mul_i32 s49, s48, 20
  s_waitcnt lgkmcnt(6)
  v_mfma_f32_16x16x32_bf16 v[16:19], a[156:159], v[68:71], v[16:19]
  s_waitcnt vmcnt(10)
  ds_read_b128 v[64:67], v8 offset:7168
  v_mfma_f32_16x16x32_bf16 v[20:23], a[160:163], v[68:71], v[20:23]
  s_sub_u32 s51, s51, s49
  s_sub_u32 s51, s51, s67
  v_mfma_f32_16x16x32_bf16 v[24:27], a[164:167], v[68:71], v[24:27]
  s_add_u32 s49, s51, 20
  s_min_u32 s51, s51, s49
  v_mfma_f32_16x16x32_bf16 v[28:31], a[168:171], v[68:71], v[28:31]
  s_lshl_b32 s51, s51, 2
  s_add_u32 s51, s51, s48
  v_mfma_f32_16x16x32_bf16 v[32:35], a[172:175], v[68:71], v[32:35]
  s_waitcnt lgkmcnt(4)
  s_waitcnt lgkmcnt(1)
  v_mfma_f32_16x16x32_bf16 v[16:19], v[88:91], v[72:75], v[16:19]
  s_waitcnt vmcnt(9)
  ds_read_b128 v[68:71], v8 offset:8192
  v_mfma_f32_16x16x32_bf16 v[20:23], v[92:95], v[72:75], v[20:23]
  s_lshl_b32 s50, s50, 8
  s_lshl_b32 s51, s51, 8
  v_mfma_f32_16x16x32_bf16 v[24:27], v[96:99], v[72:75], v[24:27]
  s_lshr_b32 s48, s41, 3
  s_lshl_b32 s49, s40, 2
  v_mfma_f32_16x16x32_bf16 v[28:31], v[100:103], v[72:75], v[28:31]
  s_add_u32 s48, s48, s49
  s_mul_i32 s48, s48, 81920
  v_mfma_f32_16x16x32_bf16 v[32:35], v[104:107], v[72:75], v[32:35]
  ds_read_b128 v[88:91], v7 offset:10240
  s_waitcnt lgkmcnt(2)
  v_mfma_f32_16x16x32_bf16 v[16:19], a[176:179], v[64:67], v[16:19]
  s_waitcnt vmcnt(11)
  ds_read_b128 v[72:75], v8 offset:6144
  ds_read_b128 v[92:95], v7 offset:11264
  v_mfma_f32_16x16x32_bf16 v[20:23], a[180:183], v[64:67], v[20:23]
  ds_read_b128 v[96:99], v7 offset:12288
  ds_read_b128 v[100:103], v7 offset:13312
  ds_read_b128 v[104:107], v7 offset:14336
  v_mfma_f32_16x16x32_bf16 v[24:27], a[184:187], v[64:67], v[24:27]
  s_add_u32 s49, s48, 1048576
  s_add_u32 s50, s50, s49
  v_mfma_f32_16x16x32_bf16 v[28:31], a[188:191], v[64:67], v[28:31]
  s_add_u32 s51, s51, s49
  s_lshl_b32 s48, s42, 12
  v_mfma_f32_16x16x32_bf16 v[32:35], a[192:195], v[64:67], v[32:35]
  v_lshlrev_b32 v14, 6, v0
  s_waitcnt lgkmcnt(6)
  v_mfma_f32_16x16x32_bf16 v[16:19], a[196:199], v[68:71], v[16:19]
  s_add_u32 s54, s59, 57344
  buffer_load_dwordx4 v[64:67], v2, s[4:7], s54 offen offset:0 sc1
  v_mfma_f32_16x16x32_bf16 v[20:23], a[200:203], v[68:71], v[20:23]
  v_add_u32 v14, s48, v14
  s_mul_i32 s58, s42, 3072
  v_mfma_f32_16x16x32_bf16 v[24:27], a[204:207], v[68:71], v[24:27]
  s_add_u32 s58, s58, 0
  s_lshl_b32 s48, s40, 3
  v_mfma_f32_16x16x32_bf16 v[28:31], a[208:211], v[68:71], v[28:31]
  s_lshr_b32 s61, s41, 2
  s_add_u32 s61, s61, s48
  v_mfma_f32_16x16x32_bf16 v[32:35], a[212:215], v[68:71], v[32:35]
  s_waitcnt vmcnt(6)
  s_add_u32 s46, s64, 12288
  s_mov_b64 exec, 1
  buffer_store_dword v1, off, s[4:7], s46 sc1
  s_mov_b64 exec, -1
  s_waitcnt lgkmcnt(4)
  s_waitcnt lgkmcnt(0)
  v_mfma_f32_16x16x32_bf16 v[16:19], v[88:91], v[72:75], v[16:19]
  buffer_load_dwordx4 v[68:71], v2, s[4:7], s60 offen offset:2048 sc1
  s_mul_i32 s61, s61, 40960
  v_mfma_f32_16x16x32_bf16 v[20:23], v[92:95], v[72:75], v[20:23]
  s_and_b32 s48, s41, 3
  s_lshl_b32 s48, s48, 4
  v_mfma_f32_16x16x32_bf16 v[24:27], v[96:99], v[72:75], v[24:27]
  s_add_u32 s61, s61, s48
  s_add_u32 s61, s61, 7340032
  v_mfma_f32_16x16x32_bf16 v[28:31], v[100:103], v[72:75], v[28:31]
  s_mul_i32 s48, s42, 20480
  s_add_u32 s51, s51, s48
  v_mfma_f32_16x16x32_bf16 v[32:35], v[104:107], v[72:75], v[32:35]
  ds_read_b128 v[88:91], v7 offset:15360
  s_waitcnt vmcnt(7)
  v_mfma_f32_16x16x32_bf16 v[16:19], a[216:219], v[76:79], v[16:19]
  buffer_load_dwordx4 v[72:75], v2, s[4:7], s60 offen offset:3072 sc1
  ds_read_b128 v[92:95], v7 offset:16384
  v_mfma_f32_16x16x32_bf16 v[20:23], a[220:223], v[76:79], v[20:23]
  ds_read_b128 v[96:99], v7 offset:17408
  ds_read_b128 v[100:103], v7 offset:18432
  v_mfma_f32_16x16x32_bf16 v[24:27], a[224:227], v[76:79], v[24:27]
  ds_read_b128 v[104:107], v7 offset:19456
  s_lshl_b32 s49, s42, 10
  v_mfma_f32_16x16x32_bf16 v[28:31], a[228:231], v[76:79], v[28:31]
  s_add_u32 s49, s49, 16384
  v_add_u32 v15, s49, v2
  v_mfma_f32_16x16x32_bf16 v[32:35], a[232:235], v[76:79], v[32:35]
  s_mul_i32 s49, s42, 3072
  s_waitcnt vmcnt(7)
  v_mfma_f32_16x16x32_bf16 v[16:19], a[236:239], v[80:83], v[16:19]
  s_add_u32 s55, s50, 0
  buffer_load_dwordx2 v[108:109], v4, s[4:7], s55 offen sc1
  v_mfma_f32_16x16x32_bf16 v[20:23], a[240:243], v[80:83], v[20:23]
  buffer_load_dwordx4 v[76:79], v2, s[4:7], s54 offen offset:1024 sc1
  v_add_u32 v5, s49, v15
  v_mfma_f32_16x16x32_bf16 v[24:27], a[244:247], v[80:83], v[24:27]
  v_mfma_f32_16x16x32_bf16 v[28:31], a[248:251], v[80:83], v[28:31]
  v_mfma_f32_16x16x32_bf16 v[32:35], a[252:255], v[80:83], v[32:35]
  s_barrier
  s_waitcnt vmcnt(8)
  s_waitcnt lgkmcnt(0)
  v_mfma_f32_16x16x32_bf16 v[16:19], v[88:91], v[84:87], v[16:19]
  s_add_u32 s55, s65, 12288
  buffer_load_dwordx4 v[8:11], v6, s[4:7], s55 offen sc1
  v_mfma_f32_16x16x32_bf16 v[20:23], v[92:95], v[84:87], v[20:23]
  s_add_u32 s62, s59, 53248
  buffer_load_dwordx4 v[80:83], v2, s[4:7], s62 offen offset:0 sc1
  v_mfma_f32_16x16x32_bf16 v[24:27], v[96:99], v[84:87], v[24:27]
  v_mfma_f32_16x16x32_bf16 v[28:31], v[100:103], v[84:87], v[28:31]
  v_mfma_f32_16x16x32_bf16 v[32:35], v[104:107], v[84:87], v[32:35]
  ds_read_b128 v[88:91], v7 offset:0
  ds_read_b128 v[92:95], v7 offset:1024
  s_waitcnt vmcnt(9)
  v_mfma_f32_16x16x32_bf16 v[36:39], a[96:99], v[56:59], 0
  buffer_load_dwordx4 v[84:87], v2, s[4:7], s62 offen offset:1024 sc1
  ds_read_b128 v[96:99], v7 offset:2048
  v_mfma_f32_16x16x32_bf16 v[40:43], a[100:103], v[56:59], 0
  ds_read_b128 v[100:103], v7 offset:3072
  ds_read_b128 v[104:107], v7 offset:4096
  v_mfma_f32_16x16x32_bf16 v[44:47], a[104:107], v[56:59], 0
  ds_write_b128 v3, v[16:19] offset:0
  v_mfma_f32_16x16x32_bf16 v[48:51], a[108:111], v[56:59], 0
  ds_write_b128 v3, v[20:23] offset:1024
  v_mfma_f32_16x16x32_bf16 v[52:55], a[112:115], v[56:59], 0
  s_waitcnt vmcnt(9)
  v_mfma_f32_16x16x32_bf16 v[36:39], a[116:119], v[60:63], v[36:39]
  buffer_load_dwordx4 v[56:59], v2, s[4:7], s54 offen offset:2048 sc1
  v_mfma_f32_16x16x32_bf16 v[40:43], a[120:123], v[60:63], v[40:43]
  ds_write_b128 v3, v[24:27] offset:2048
  v_mfma_f32_16x16x32_bf16 v[44:47], a[124:127], v[60:63], v[44:47]
  ds_write_b128 v3, v[28:31] offset:3072
  v_mfma_f32_16x16x32_bf16 v[48:51], a[128:131], v[60:63], v[48:51]
  ds_write_b128 v15, v[32:35] offset:0
  v_mfma_f32_16x16x32_bf16 v[52:55], a[132:135], v[60:63], v[52:55]
  s_waitcnt vmcnt(9)
  s_waitcnt lgkmcnt(5)
  v_mfma_f32_16x16x32_bf16 v[36:39], v[88:91], v[64:67], v[36:39]
  buffer_load_dwordx4 v[60:63], v2, s[4:7], s62 offen offset:2048 sc1
  v_mfma_f32_16x16x32_bf16 v[40:43], v[92:95], v[64:67], v[40:43]
  v_mfma_f32_16x16x32_bf16 v[44:47], v[96:99], v[64:67], v[44:47]
  v_mfma_f32_16x16x32_bf16 v[48:51], v[100:103], v[64:67], v[48:51]
  v_mfma_f32_16x16x32_bf16 v[52:55], v[104:107], v[64:67], v[52:55]
  ds_read_b128 v[88:91], v7 offset:5120
  s_waitcnt vmcnt(8)
  v_mfma_f32_16x16x32_bf16 v[36:39], a[136:139], v[68:71], v[36:39]
  buffer_load_dwordx4 v[64:67], v2, s[4:7], s62 offen offset:3072 sc1
  ds_read_b128 v[92:95], v7 offset:6144
  v_mfma_f32_16x16x32_bf16 v[40:43], a[140:143], v[68:71], v[40:43]
  ds_read_b128 v[96:99], v7 offset:7168
  ds_read_b128 v[100:103], v7 offset:8192
  v_mfma_f32_16x16x32_bf16 v[44:47], a[144:147], v[68:71], v[44:47]
  ds_read_b128 v[104:107], v7 offset:9216
  v_mfma_f32_16x16x32_bf16 v[48:51], a[148:151], v[68:71], v[48:51]
  v_mfma_f32_16x16x32_bf16 v[52:55], a[152:155], v[68:71], v[52:55]
  s_waitcnt lgkmcnt(5)
  s_barrier
  s_waitcnt vmcnt(8)
  v_mfma_f32_16x16x32_bf16 v[36:39], a[156:159], v[72:75], v[36:39]
  buffer_load_dwordx4 v[68:71], v2, s[4:7], s54 offen offset:3072 sc1
  ds_read_b128 v[16:19], v13 offset:0
  v_mfma_f32_16x16x32_bf16 v[40:43], a[160:163], v[72:75], v[40:43]
  ds_read_b128 v[20:23], v13 offset:4096
  ds_read_b128 v[24:27], v13 offset:8192
  v_mfma_f32_16x16x32_bf16 v[44:47], a[164:167], v[72:75], v[44:47]
  ds_read_b128 v[28:31], v13 offset:12288
  s_waitcnt vmcnt(8)
  v_mfma_f32_16x16x32_bf16 v[48:51], a[168:171], v[72:75], v[48:51]
  v_lshlrev_b32 v32, 16, v108
  v_and_b32 v33, 0xffff0000, v108
  v_mfma_f32_16x16x32_bf16 v[52:55], a[172:175], v[72:75], v[52:55]
  s_waitcnt vmcnt(7)
  s_waitcnt lgkmcnt(4)
  v_mfma_f32_16x16x32_bf16 v[36:39], v[88:91], v[76:79], v[36:39]
  s_waitcnt vmcnt(6)
  v_bitop3_b32 v8, v8, v9, v1 bitop3:0x7e
  v_mfma_f32_16x16x32_bf16 v[40:43], v[92:95], v[76:79], v[40:43]
  v_bitop3_b32 v10, v10, v11, v1 bitop3:0x7e
  v_or_b32 v8, v8, v10
  v_mfma_f32_16x16x32_bf16 v[44:47], v[96:99], v[76:79], v[44:47]
  v_cmp_ne_u32 vcc, 0, v8
  s_nop 0
  v_mfma_f32_16x16x32_bf16 v[48:51], v[100:103], v[76:79], v[48:51]
  s_nop 1
  s_cbranch_vccz Lsckd_65
Lsck_64:
  s_add_u32 s55, s65, 12288
  buffer_load_dwordx4 v[8:11], v6, s[4:7], s55 offen sc1
  s_waitcnt vmcnt(0)
  v_bitop3_b32 v8, v8, v9, v1 bitop3:0x7e
  v_bitop3_b32 v10, v10, v11, v1 bitop3:0x7e
  v_or_b32 v8, v8, v10
  v_cmp_ne_u32 vcc, 0, v8
  s_nop 1
  s_nop 1
  s_cbranch_vccnz Lsck_64
Lsckd_65:
  buffer_inv sc1
  s_waitcnt vmcnt(0)
  v_mfma_f32_16x16x32_bf16 v[52:55], v[104:107], v[76:79], v[52:55]
  ds_read_b128 v[88:91], v7 offset:10240
  s_waitcnt vmcnt(5)
  v_mfma_f32_16x16x32_bf16 v[36:39], a[176:179], v[80:83], v[36:39]
  s_add_u32 s60, s59, 98304
  buffer_load_dwordx4 v[72:75], v2, s[4:7], s60 offen offset:0 sc1
  v_mfma_f32_16x16x32_bf16 v[40:43], a[180:183], v[80:83], v[40:43]
  buffer_load_dwordx4 v[76:79], v2, s[4:7], s60 offen offset:1024 sc1
  ds_read_b128 v[92:95], v7 offset:11264
  v_mfma_f32_16x16x32_bf16 v[44:47], a[184:187], v[80:83], v[44:47]
  ds_read_b128 v[96:99], v7 offset:12288
  ds_read_b128 v[100:103], v7 offset:13312
  v_mfma_f32_16x16x32_bf16 v[48:51], a[188:191], v[80:83], v[48:51]
  ds_read_b128 v[104:107], v7 offset:14336
  v_lshlrev_b32 v34, 16, v109
  v_mfma_f32_16x16x32_bf16 v[52:55], a[192:195], v[80:83], v[52:55]
  v_and_b32 v35, 0xffff0000, v109
  s_waitcnt vmcnt(6)
  v_mfma_f32_16x16x32_bf16 v[36:39], a[196:199], v[84:87], v[36:39]
  s_add_u32 s54, s59, 106496
  buffer_load_dwordx4 v[8:11], v2, s[4:7], s54 offen offset:0 sc1
  v_mfma_f32_16x16x32_bf16 v[40:43], a[200:203], v[84:87], v[40:43]
  buffer_load_dwordx4 v[80:83], v2, s[4:7], s60 offen offset:2048 sc1
  s_waitcnt lgkmcnt(5)
  v_mfma_f32_16x16x32_bf16 v[44:47], a[204:207], v[84:87], v[44:47]
  v_add_f32 v16, v16, v20
  v_add_f32 v17, v17, v21
  v_mfma_f32_16x16x32_bf16 v[48:51], a[208:211], v[84:87], v[48:51]
  v_add_f32 v18, v18, v22
  v_add_f32 v19, v19, v23
  v_mfma_f32_16x16x32_bf16 v[52:55], a[212:215], v[84:87], v[52:55]
  s_waitcnt vmcnt(7)
  s_waitcnt lgkmcnt(0)
  v_mfma_f32_16x16x32_bf16 v[36:39], v[88:91], v[56:59], v[36:39]
  s_add_u32 s55, s50, 20480
  buffer_load_dwordx2 v[110:111], v4, s[4:7], s55 offen sc1
  v_mfma_f32_16x16x32_bf16 v[40:43], v[92:95], v[56:59], v[40:43]
  buffer_load_dwordx4 v[84:87], v2, s[4:7], s60 offen offset:3072 sc1
  v_add_f32 v24, v24, v28
  v_mfma_f32_16x16x32_bf16 v[44:47], v[96:99], v[56:59], v[44:47]
  v_add_f32 v25, v25, v29
  v_add_f32 v26, v26, v30
  v_mfma_f32_16x16x32_bf16 v[48:51], v[100:103], v[56:59], v[48:51]
  v_add_f32 v27, v27, v31
  v_add_f32 v16, v16, v32
  v_mfma_f32_16x16x32_bf16 v[52:55], v[104:107], v[56:59], v[52:55]
  ds_read_b128 v[88:91], v7 offset:15360
  s_waitcnt vmcnt(8)
  v_mfma_f32_16x16x32_bf16 v[36:39], a[216:219], v[60:63], v[36:39]
  buffer_load_dwordx4 v[56:59], v2, s[4:7], s54 offen offset:1024 sc1
  ds_read_b128 v[92:95], v7 offset:16384
  v_mfma_f32_16x16x32_bf16 v[40:43], a[220:223], v[60:63], v[40:43]
  ds_read_b128 v[96:99], v7 offset:17408
  ds_read_b128 v[100:103], v7 offset:18432
  v_mfma_f32_16x16x32_bf16 v[44:47], a[224:227], v[60:63], v[44:47]
  ds_read_b128 v[104:107], v7 offset:19456
  v_add_f32 v17, v17, v33
  v_mfma_f32_16x16x32_bf16 v[48:51], a[228:231], v[60:63], v[48:51]
  v_add_f32 v18, v18, v34
  v_add_f32 v19, v19, v35
  v_mfma_f32_16x16x32_bf16 v[52:55], a[232:235], v[60:63], v[52:55]
  v_add_f32 v16, v16, v24
  s_waitcnt vmcnt(8)
  v_mfma_f32_16x16x32_bf16 v[36:39], a[236:239], v[64:67], v[36:39]
  s_add_u32 m0, s58, 0
  s_add_u32 s48, s61, 0
  v_mfma_f32_16x16x32_bf16 v[40:43], a[240:243], v[64:67], v[40:43]
  buffer_load_dwordx4 v14, s[4:7], s48 offen sc1 lds
  s_add_u32 s62, s59, 102400
  v_mfma_f32_16x16x32_bf16 v[44:47], a[244:247], v[64:67], v[44:47]
  buffer_load_dwordx4 v[60:63], v2, s[4:7], s62 offen offset:0 sc1
  v_add_f32 v17, v17, v25
  v_mfma_f32_16x16x32_bf16 v[48:51], a[248:251], v[64:67], v[48:51]
  v_add_f32 v18, v18, v26
  v_add_f32 v19, v19, v27
  v_mfma_f32_16x16x32_bf16 v[52:55], a[252:255], v[64:67], v[52:55]
  s_waitcnt vmcnt(9)
  s_waitcnt lgkmcnt(0)
  v_mfma_f32_16x16x32_bf16 v[36:39], v[88:91], v[68:71], v[36:39]
  s_add_u32 m0, s58, 1024
  s_add_u32 s48, s61, 16384
  v_mfma_f32_16x16x32_bf16 v[40:43], v[92:95], v[68:71], v[40:43]
  buffer_load_dwordx4 v14, s[4:7], s48 offen sc1 lds
  buffer_load_dwordx4 v[64:67], v2, s[4:7], s62 offen offset:1024 sc1
  v_mfma_f32_16x16x32_bf16 v[44:47], v[96:99], v[68:71], v[44:47]
  v_cvt_pk_bf16_f32 v20, v16, v17
  v_cvt_pk_bf16_f32 v21, v18, v19
  v_mfma_f32_16x16x32_bf16 v[48:51], v[100:103], v[68:71], v[48:51]
  s_add_u32 s49, s50, 0
  buffer_store_dwordx2 v[20:21], v4, s[4:7], s49 offen sc1
  v_mfma_f32_16x16x32_bf16 v[52:55], v[104:107], v[68:71], v[52:55]
  ds_read_b128 v[88:91], v7 offset:0
  s_waitcnt vmcnt(11)
  v_mfma_f32_16x16x32_bf16 v[16:19], a[96:99], v[72:75], 0
  buffer_load_dwordx4 v[68:71], v2, s[4:7], s54 offen offset:2048 sc1
  ds_read_b128 v[92:95], v7 offset:1024
  v_mfma_f32_16x16x32_bf16 v[20:23], a[100:103], v[72:75], 0
  ds_read_b128 v[96:99], v7 offset:2048
  ds_read_b128 v[100:103], v7 offset:3072
  v_mfma_f32_16x16x32_bf16 v[24:27], a[104:107], v[72:75], 0
  ds_read_b128 v[104:107], v7 offset:4096
  v_mfma_f32_16x16x32_bf16 v[28:31], a[108:111], v[72:75], 0
  ds_write_b128 v3, v[36:39] offset:16384
  v_mfma_f32_16x16x32_bf16 v[32:35], a[112:115], v[72:75], 0
  s_waitcnt vmcnt(11)
  v_mfma_f32_16x16x32_bf16 v[16:19], a[116:119], v[76:79], v[16:19]
  buffer_load_dwordx4 v[72:75], v2, s[4:7], s62 offen offset:2048 sc1
  v_mfma_f32_16x16x32_bf16 v[20:23], a[120:123], v[76:79], v[20:23]
  ds_write_b128 v3, v[40:43] offset:17408
  v_mfma_f32_16x16x32_bf16 v[24:27], a[124:127], v[76:79], v[24:27]
  ds_write_b128 v3, v[44:47] offset:18432
  v_mfma_f32_16x16x32_bf16 v[28:31], a[128:131], v[76:79], v[28:31]
  ds_write_b128 v3, v[48:51] offset:19456
  v_mfma_f32_16x16x32_bf16 v[32:35], a[132:135], v[76:79], v[32:35]
  s_waitcnt vmcnt(11)
  s_waitcnt lgkmcnt(4)
  v_mfma_f32_16x16x32_bf16 v[16:19], v[88:91], v[8:11], v[16:19]
  buffer_load_dwordx4 v[76:79], v2, s[4:7], s62 offen offset:3072 sc1
  v_mfma_f32_16x16x32_bf16 v[20:23], v[92:95], v[8:11], v[20:23]
  ds_write_b128 v15, v[52:55] offset:4096
  v_mfma_f32_16x16x32_bf16 v[24:27], v[96:99], v[8:11], v[24:27]
  v_mfma_f32_16x16x32_bf16 v[28:31], v[100:103], v[8:11], v[28:31]
  v_mfma_f32_16x16x32_bf16 v[32:35], v[104:107], v[8:11], v[32:35]
  ds_read_b128 v[88:91], v7 offset:5120
  s_waitcnt vmcnt(11)
  v_mfma_f32_16x16x32_bf16 v[16:19], a[136:139], v[80:83], v[16:19]
  buffer_load_dwordx4 v[8:11], v2, s[4:7], s54 offen offset:3072 sc1
  ds_read_b128 v[92:95], v7 offset:6144
  v_mfma_f32_16x16x32_bf16 v[20:23], a[140:143], v[80:83], v[20:23]
  ds_read_b128 v[96:99], v7 offset:7168
  ds_read_b128 v[100:103], v7 offset:8192
  v_mfma_f32_16x16x32_bf16 v[24:27], a[144:147], v[80:83], v[24:27]
  ds_read_b128 v[104:107], v7 offset:9216
  v_mfma_f32_16x16x32_bf16 v[28:31], a[148:151], v[80:83], v[28:31]
  v_mfma_f32_16x16x32_bf16 v[32:35], a[152:155], v[80:83], v[32:35]
  s_waitcnt lgkmcnt(5)
  s_barrier
  s_waitcnt vmcnt(10)
  v_mfma_f32_16x16x32_bf16 v[16:19], a[156:159], v[84:87], v[16:19]
  s_add_u32 s60, s59, 147456
  buffer_load_dwordx4 v[80:83], v2, s[4:7], s60 offen offset:0 sc1
  v_mfma_f32_16x16x32_bf16 v[20:23], a[160:163], v[84:87], v[20:23]
  ds_read_b128 v[36:39], v13 offset:16384
  ds_read_b128 v[40:43], v13 offset:20480
  v_mfma_f32_16x16x32_bf16 v[24:27], a[164:167], v[84:87], v[24:27]
  ds_read_b128 v[44:47], v13 offset:24576
  ds_read_b128 v[48:51], v13 offset:28672
  v_mfma_f32_16x16x32_bf16 v[28:31], a[168:171], v[84:87], v[28:31]
  s_waitcnt vmcnt(12)
  v_lshlrev_b32 v52, 16, v110
  v_mfma_f32_16x16x32_bf16 v[32:35], a[172:175], v[84:87], v[32:35]
  s_waitcnt vmcnt(10)
  s_waitcnt lgkmcnt(4)
  v_mfma_f32_16x16x32_bf16 v[16:19], v[88:91], v[56:59], v[16:19]
  buffer_load_dwordx4 v[84:87], v2, s[4:7], s60 offen offset:1024 sc1
  v_and_b32 v53, 0xffff0000, v110
  v_mfma_f32_16x16x32_bf16 v[20:23], v[92:95], v[56:59], v[20:23]
  v_lshlrev_b32 v54, 16, v111
  v_and_b32 v55, 0xffff0000, v111
  v_mfma_f32_16x16x32_bf16 v[24:27], v[96:99], v[56:59], v[24:27]
  v_mfma_f32_16x16x32_bf16 v[28:31], v[100:103], v[56:59], v[28:31]
  v_mfma_f32_16x16x32_bf16 v[32:35], v[104:107], v[56:59], v[32:35]
  ds_read_b128 v[88:91], v7 offset:10240
  s_waitcnt vmcnt(9)
  v_mfma_f32_16x16x32_bf16 v[16:19], a[176:179], v[60:63], v[16:19]
  s_add_u32 s54, s59, 155648
  buffer_load_dwordx4 v[56:59], v2, s[4:7], s54 offen offset:0 sc1
  v_mfma_f32_16x16x32_bf16 v[20:23], a[180:183], v[60:63], v[20:23]
  ds_read_b128 v[92:95], v7 offset:11264
  ds_read_b128 v[96:99], v7 offset:12288
  v_mfma_f32_16x16x32_bf16 v[24:27], a[184:187], v[60:63], v[24:27]
  ds_read_b128 v[100:103], v7 offset:13312
  ds_read_b128 v[104:107], v7 offset:14336
  v_mfma_f32_16x16x32_bf16 v[28:31], a[188:191], v[60:63], v[28:31]
  s_waitcnt lgkmcnt(5)
  v_add_f32 v36, v36, v40
  v_mfma_f32_16x16x32_bf16 v[32:35], a[192:195], v[60:63], v[32:35]
  v_add_f32 v37, v37, v41
  s_waitcnt vmcnt(8)
  v_mfma_f32_16x16x32_bf16 v[16:19], a[196:199], v[64:67], v[16:19]
  buffer_load_dwordx4 v[60:63], v2, s[4:7], s60 offen offset:2048 sc1
  v_add_f32 v38, v38, v42
  v_mfma_f32_16x16x32_bf16 v[20:23], a[200:203], v[64:67], v[20:23]
  v_add_f32 v39, v39, v43
  v_add_f32 v44, v44, v48
  v_mfma_f32_16x16x32_bf16 v[24:27], a[204:207], v[64:67], v[24:27]
  v_add_f32 v45, v45, v49
  v_add_f32 v46, v46, v50
  v_mfma_f32_16x16x32_bf16 v[28:31], a[208:211], v[64:67], v[28:31]
  v_add_f32 v47, v47, v51
  v_add_f32 v36, v36, v52
  v_mfma_f32_16x16x32_bf16 v[32:35], a[212:215], v[64:67], v[32:35]
  s_waitcnt vmcnt(7)
  s_waitcnt lgkmcnt(0)
  v_mfma_f32_16x16x32_bf16 v[16:19], v[88:91], v[68:71], v[16:19]
  s_add_u32 s55, s50, 40960
  buffer_load_dwordx2 v[108:109], v4, s[4:7], s55 offen sc1
  v_mfma_f32_16x16x32_bf16 v[20:23], v[92:95], v[68:71], v[20:23]
  buffer_load_dwordx4 v[64:67], v2, s[4:7], s60 offen offset:3072 sc1
  v_add_f32 v37, v37, v53
  v_mfma_f32_16x16x32_bf16 v[24:27], v[96:99], v[68:71], v[24:27]
  v_add_f32 v38, v38, v54
  v_add_f32 v39, v39, v55
  v_mfma_f32_16x16x32_bf16 v[28:31], v[100:103], v[68:71], v[28:31]
  v_add_f32 v36, v36, v44
  v_add_f32 v37, v37, v45
  v_mfma_f32_16x16x32_bf16 v[32:35], v[104:107], v[68:71], v[32:35]
  ds_read_b128 v[88:91], v7 offset:15360
  s_waitcnt vmcnt(8)
  v_mfma_f32_16x16x32_bf16 v[16:19], a[216:219], v[72:75], v[16:19]
  buffer_load_dwordx4 v[68:71], v2, s[4:7], s54 offen offset:1024 sc1
  ds_read_b128 v[92:95], v7 offset:16384
  v_mfma_f32_16x16x32_bf16 v[20:23], a[220:223], v[72:75], v[20:23]
  ds_read_b128 v[96:99], v7 offset:17408
  ds_read_b128 v[100:103], v7 offset:18432
  v_mfma_f32_16x16x32_bf16 v[24:27], a[224:227], v[72:75], v[24:27]
  ds_read_b128 v[104:107], v7 offset:19456
  v_add_f32 v38, v38, v46
  v_mfma_f32_16x16x32_bf16 v[28:31], a[228:231], v[72:75], v[28:31]
  v_add_f32 v39, v39, v47
  v_cvt_pk_bf16_f32 v40, v36, v37
  v_mfma_f32_16x16x32_bf16 v[32:35], a[232:235], v[72:75], v[32:35]
  v_cvt_pk_bf16_f32 v41, v38, v39
  s_waitcnt vmcnt(8)
  v_mfma_f32_16x16x32_bf16 v[16:19], a[236:239], v[76:79], v[16:19]
  s_add_u32 s62, s59, 151552
  buffer_load_dwordx4 v[72:75], v2, s[4:7], s62 offen offset:0 sc1
  v_mfma_f32_16x16x32_bf16 v[20:23], a[240:243], v[76:79], v[20:23]
  s_add_u32 s49, s50, 20480
  buffer_store_dwordx2 v[40:41], v4, s[4:7], s49 offen sc1
  v_mfma_f32_16x16x32_bf16 v[24:27], a[244:247], v[76:79], v[24:27]
  v_mfma_f32_16x16x32_bf16 v[28:31], a[248:251], v[76:79], v[28:31]
  v_mfma_f32_16x16x32_bf16 v[32:35], a[252:255], v[76:79], v[32:35]
  s_waitcnt vmcnt(9)
  s_waitcnt lgkmcnt(0)
  v_mfma_f32_16x16x32_bf16 v[16:19], v[88:91], v[8:11], v[16:19]
  s_add_u32 m0, s58, 2048
  s_add_u32 s48, s61, 32768
  v_mfma_f32_16x16x32_bf16 v[20:23], v[92:95], v[8:11], v[20:23]
  s_add_u32 s48, s48, s66
  buffer_load_dwordx4 v14, s[4:7], s48 offen sc1 lds
  v_mfma_f32_16x16x32_bf16 v[24:27], v[96:99], v[8:11], v[24:27]
  buffer_load_dwordx4 v[76:79], v2, s[4:7], s62 offen offset:1024 sc1
  v_mfma_f32_16x16x32_bf16 v[28:31], v[100:103], v[8:11], v[28:31]
  v_mfma_f32_16x16x32_bf16 v[32:35], v[104:107], v[8:11], v[32:35]
  ds_read_b128 v[88:91], v7 offset:0
  s_waitcnt vmcnt(9)
  v_mfma_f32_16x16x32_bf16 v[36:39], a[96:99], v[80:83], 0
  buffer_load_dwordx4 v[8:11], v2, s[4:7], s54 offen offset:2048 sc1
  ds_read_b128 v[92:95], v7 offset:1024
  v_mfma_f32_16x16x32_bf16 v[40:43], a[100:103], v[80:83], 0
  ds_read_b128 v[96:99], v7 offset:2048
  ds_read_b128 v[100:103], v7 offset:3072
  v_mfma_f32_16x16x32_bf16 v[44:47], a[104:107], v[80:83], 0
  ds_read_b128 v[104:107], v7 offset:4096
  v_mfma_f32_16x16x32_bf16 v[48:51], a[108:111], v[80:83], 0
  ds_write_b128 v3, v[16:19] offset:0
  v_mfma_f32_16x16x32_bf16 v[52:55], a[112:115], v[80:83], 0
  s_waitcnt vmcnt(9)
  v_mfma_f32_16x16x32_bf16 v[36:39], a[116:119], v[84:87], v[36:39]
  buffer_load_dwordx4 v[80:83], v2, s[4:7], s62 offen offset:2048 sc1
  v_mfma_f32_16x16x32_bf16 v[40:43], a[120:123], v[84:87], v[40:43]
  ds_write_b128 v3, v[20:23] offset:1024
  v_mfma_f32_16x16x32_bf16 v[44:47], a[124:127], v[84:87], v[44:47]
  ds_write_b128 v3, v[24:27] offset:2048
  v_mfma_f32_16x16x32_bf16 v[48:51], a[128:131], v[84:87], v[48:51]
  ds_write_b128 v3, v[28:31] offset:3072
  v_mfma_f32_16x16x32_bf16 v[52:55], a[132:135], v[84:87], v[52:55]
  s_waitcnt vmcnt(9)
  s_waitcnt lgkmcnt(4)
  v_mfma_f32_16x16x32_bf16 v[36:39], v[88:91], v[56:59], v[36:39]
  buffer_load_dwordx4 v[84:87], v2, s[4:7], s62 offen offset:3072 sc1
  v_mfma_f32_16x16x32_bf16 v[40:43], v[92:95], v[56:59], v[40:43]
  ds_write_b128 v15, v[32:35] offset:8192
  v_mfma_f32_16x16x32_bf16 v[44:47], v[96:99], v[56:59], v[44:47]
  v_mfma_f32_16x16x32_bf16 v[48:51], v[100:103], v[56:59], v[48:51]
  v_mfma_f32_16x16x32_bf16 v[52:55], v[104:107], v[56:59], v[52:55]
  ds_read_b128 v[88:91], v7 offset:5120
  s_waitcnt vmcnt(9)
  v_mfma_f32_16x16x32_bf16 v[36:39], a[136:139], v[60:63], v[36:39]
  buffer_load_dwordx4 v[56:59], v2, s[4:7], s54 offen offset:3072 sc1
  ds_read_b128 v[92:95], v7 offset:6144
  v_mfma_f32_16x16x32_bf16 v[40:43], a[140:143], v[60:63], v[40:43]
  ds_read_b128 v[96:99], v7 offset:7168
  ds_read_b128 v[100:103], v7 offset:8192
  v_mfma_f32_16x16x32_bf16 v[44:47], a[144:147], v[60:63], v[44:47]
  ds_read_b128 v[104:107], v7 offset:9216
  v_mfma_f32_16x16x32_bf16 v[48:51], a[148:151], v[60:63], v[48:51]
  v_mfma_f32_16x16x32_bf16 v[52:55], a[152:155], v[60:63], v[52:55]
  s_waitcnt lgkmcnt(5)
  s_barrier
  s_waitcnt vmcnt(8)
  v_mfma_f32_16x16x32_bf16 v[36:39], a[156:159], v[64:67], v[36:39]
  ds_read_b128 v[16:19], v13 offset:0
  ds_read_b128 v[20:23], v13 offset:4096
  v_mfma_f32_16x16x32_bf16 v[40:43], a[160:163], v[64:67], v[40:43]
  ds_read_b128 v[24:27], v13 offset:8192
  ds_read_b128 v[28:31], v13 offset:12288
  v_mfma_f32_16x16x32_bf16 v[44:47], a[164:167], v[64:67], v[44:47]
  s_waitcnt vmcnt(9)
  v_lshlrev_b32 v32, 16, v108
  v_mfma_f32_16x16x32_bf16 v[48:51], a[168:171], v[64:67], v[48:51]
  v_and_b32 v33, 0xffff0000, v108
  v_lshlrev_b32 v34, 16, v109
  v_mfma_f32_16x16x32_bf16 v[52:55], a[172:175], v[64:67], v[52:55]
  s_waitcnt vmcnt(7)
  s_waitcnt lgkmcnt(4)
  v_mfma_f32_16x16x32_bf16 v[36:39], v[88:91], v[68:71], v[36:39]
  v_and_b32 v35, 0xffff0000, v109
  v_mfma_f32_16x16x32_bf16 v[40:43], v[92:95], v[68:71], v[40:43]
  v_mfma_f32_16x16x32_bf16 v[44:47], v[96:99], v[68:71], v[44:47]
  v_mfma_f32_16x16x32_bf16 v[48:51], v[100:103], v[68:71], v[48:51]
  s_waitcnt lgkmcnt(0)
  v_add_f32 v16, v16, v20
  v_mfma_f32_16x16x32_bf16 v[52:55], v[104:107], v[68:71], v[52:55]
  ds_read_b128 v[88:91], v7 offset:10240
  s_waitcnt vmcnt(6)
  v_mfma_f32_16x16x32_bf16 v[36:39], a[176:179], v[72:75], v[36:39]
  ds_read_b128 v[92:95], v7 offset:11264
  ds_read_b128 v[96:99], v7 offset:12288
  v_mfma_f32_16x16x32_bf16 v[40:43], a[180:183], v[72:75], v[40:43]
  ds_read_b128 v[100:103], v7 offset:13312
  ds_read_b128 v[104:107], v7 offset:14336
  v_mfma_f32_16x16x32_bf16 v[44:47], a[184:187], v[72:75], v[44:47]
  v_add_f32 v17, v17, v21
  v_add_f32 v18, v18, v22
  v_mfma_f32_16x16x32_bf16 v[48:51], a[188:191], v[72:75], v[48:51]
  v_add_f32 v19, v19, v23
  v_add_f32 v24, v24, v28
  v_mfma_f32_16x16x32_bf16 v[52:55], a[192:195], v[72:75], v[52:55]
  v_add_f32 v25, v25, v29
  s_waitcnt vmcnt(4)
  v_mfma_f32_16x16x32_bf16 v[36:39], a[196:199], v[76:79], v[36:39]
  v_add_f32 v26, v26, v30
  v_add_f32 v27, v27, v31
  v_mfma_f32_16x16x32_bf16 v[40:43], a[200:203], v[76:79], v[40:43]
  v_add_f32 v16, v16, v32
  v_add_f32 v17, v17, v33
  v_mfma_f32_16x16x32_bf16 v[44:47], a[204:207], v[76:79], v[44:47]
  v_add_f32 v18, v18, v34
  v_add_f32 v19, v19, v35
  v_mfma_f32_16x16x32_bf16 v[48:51], a[208:211], v[76:79], v[48:51]
  v_add_f32 v16, v16, v24
  v_add_f32 v17, v17, v25
  v_mfma_f32_16x16x32_bf16 v[52:55], a[212:215], v[76:79], v[52:55]
  s_waitcnt vmcnt(3)
  s_waitcnt lgkmcnt(0)
  v_mfma_f32_16x16x32_bf16 v[36:39], v[88:91], v[8:11], v[36:39]
  s_add_u32 s55, s50, 61440
  buffer_load_dwordx2 v[110:111], v4, s[4:7], s55 offen sc1
  v_mfma_f32_16x16x32_bf16 v[40:43], v[92:95], v[8:11], v[40:43]
  s_add_u32 s55, s51, 0
  buffer_load_dwordx2 v[60:61], v4, s[4:7], s55 offen sc1
  v_mfma_f32_16x16x32_bf16 v[44:47], v[96:99], v[8:11], v[44:47]
  v_add_f32 v18, v18, v26
  v_add_f32 v19, v19, v27
  v_mfma_f32_16x16x32_bf16 v[48:51], v[100:103], v[8:11], v[48:51]
  v_cvt_pk_bf16_f32 v20, v16, v17
  v_cvt_pk_bf16_f32 v21, v18, v19
  v_mfma_f32_16x16x32_bf16 v[52:55], v[104:107], v[8:11], v[52:55]
  ds_read_b128 v[88:91], v7 offset:15360
  s_waitcnt vmcnt(4)
  v_mfma_f32_16x16x32_bf16 v[36:39], a[216:219], v[80:83], v[36:39]
  ds_read_b128 v[92:95], v7 offset:16384
  ds_read_b128 v[96:99], v7 offset:17408
  v_mfma_f32_16x16x32_bf16 v[40:43], a[220:223], v[80:83], v[40:43]
  ds_read_b128 v[100:103], v7 offset:18432
  ds_read_b128 v[104:107], v7 offset:19456
  v_mfma_f32_16x16x32_bf16 v[44:47], a[224:227], v[80:83], v[44:47]
  s_add_u32 s49, s50, 40960
  buffer_store_dwordx2 v[20:21], v4, s[4:7], s49 offen sc1
  v_mfma_f32_16x16x32_bf16 v[48:51], a[228:231], v[80:83], v[48:51]
  v_mfma_f32_16x16x32_bf16 v[52:55], a[232:235], v[80:83], v[52:55]
  s_waitcnt vmcnt(4)
  v_mfma_f32_16x16x32_bf16 v[36:39], a[236:239], v[84:87], v[36:39]
  v_mfma_f32_16x16x32_bf16 v[40:43], a[240:243], v[84:87], v[40:43]
  v_mfma_f32_16x16x32_bf16 v[44:47], a[244:247], v[84:87], v[44:47]
  v_mfma_f32_16x16x32_bf16 v[48:51], a[248:251], v[84:87], v[48:51]
  v_mfma_f32_16x16x32_bf16 v[52:55], a[252:255], v[84:87], v[52:55]
  s_waitcnt vmcnt(3)
  s_waitcnt lgkmcnt(0)
  v_mfma_f32_16x16x32_bf16 v[36:39], v[88:91], v[56:59], v[36:39]
  v_mfma_f32_16x16x32_bf16 v[40:43], v[92:95], v[56:59], v[40:43]
  v_mfma_f32_16x16x32_bf16 v[44:47], v[96:99], v[56:59], v[44:47]
  v_mfma_f32_16x16x32_bf16 v[48:51], v[100:103], v[56:59], v[48:51]
  v_mfma_f32_16x16x32_bf16 v[52:55], v[104:107], v[56:59], v[52:55]
  s_nop 3
  ds_write_b128 v3, v[36:39] offset:16384
  ds_write_b128 v3, v[40:43] offset:17408
  ds_write_b128 v3, v[44:47] offset:18432
  ds_write_b128 v3, v[48:51] offset:19456
  ds_write_b128 v15, v[52:55] offset:12288
  s_waitcnt vmcnt(1)
  v_lshlrev_b32 v104, 16, v60
  v_and_b32 v105, 0xffff0000, v60
  v_lshlrev_b32 v106, 16, v61
  v_and_b32 v107, 0xffff0000, v61
  v_lshlrev_b32 v32, 16, v110
  v_and_b32 v33, 0xffff0000, v110
  v_lshlrev_b32 v34, 16, v111
  v_and_b32 v35, 0xffff0000, v111
  s_waitcnt lgkmcnt(0)
  s_barrier
  ds_read_b128 v[16:19], v13 offset:16384
  ds_read_b128 v[20:23], v13 offset:20480
  ds_read_b128 v[24:27], v13 offset:24576
  ds_read_b128 v[28:31], v13 offset:28672
  ds_read_b128 v[88:91], v5 offset:0
  ds_read_b128 v[92:95], v5 offset:1024
  ds_read_b128 v[96:99], v5 offset:2048
  ds_read_b128 v[100:103], v5 offset:3072
  s_waitcnt lgkmcnt(4)
  v_pk_add_f32 v[16:17], v[16:17], v[20:21]
  v_pk_add_f32 v[24:25], v[24:25], v[28:29]
  v_pk_add_f32 v[18:19], v[18:19], v[22:23]
  v_pk_add_f32 v[26:27], v[26:27], v[30:31]
  v_pk_add_f32 v[16:17], v[16:17], v[32:33]
  v_pk_add_f32 v[18:19], v[18:19], v[34:35]
  v_pk_add_f32 v[16:17], v[16:17], v[24:25]
  v_pk_add_f32 v[18:19], v[18:19], v[26:27]
  v_cvt_pk_bf16_f32 v20, v16, v17
  v_cvt_pk_bf16_f32 v21, v18, v19
  s_add_u32 s49, s50, 61440
  buffer_store_dwordx2 v[20:21], v4, s[4:7], s49 offen sc1
  s_waitcnt lgkmcnt(0)
  v_pk_add_f32 v[88:89], v[88:89], v[92:93]
  v_pk_add_f32 v[96:97], v[96:97], v[100:101]
  v_pk_add_f32 v[90:91], v[90:91], v[94:95]
  v_pk_add_f32 v[98:99], v[98:99], v[102:103]
  v_pk_add_f32 v[88:89], v[88:89], v[104:105]
  v_pk_add_f32 v[90:91], v[90:91], v[106:107]
  v_pk_add_f32 v[88:89], v[88:89], v[96:97]
  v_pk_add_f32 v[90:91], v[90:91], v[98:99]
  v_cvt_pk_bf16_f32 v92, v88, v89
  v_cvt_pk_bf16_f32 v93, v90, v91
  s_add_u32 s49, s51, 0
  buffer_store_dwordx2 v[92:93], v4, s[4:7], s49 offen sc1
  v_and_b32 v24, 7, v0
  v_lshrrev_b32 v25, 3, v0
  s_lshl_b32 s48, s42, 3
  v_add_u32 v25, s48, v25
  v_lshlrev_b32 v3, 4, v24
  s_lshl_b32 s48, s67, 2
  v_subrev_u32 v26, s48, v25
  v_add_u32 v27, 0, v25
  v_mul_u32_u24 v26, 205, v27
  v_lshrrev_b32 v26, 12, v26
  v_mul_u32_u24 v98, 20, v26
  v_sub_u32 v27, v27, v98
  v_subrev_u32 v27, s67, v27
  v_add_u32 v98, 20, v27
  v_min_u32 v27, v27, v98
  v_lshl_add_u32 v27, v27, 2, v26
  v_lshl_add_u32 v99, v27, 8, v3
  v_add_u32 v27, 32, v25
  v_mul_u32_u24 v26, 205, v27
  v_lshrrev_b32 v26, 12, v26
  v_mul_u32_u24 v98, 20, v26
  v_sub_u32 v27, v27, v98
  v_subrev_u32 v27, s67, v27
  v_add_u32 v98, 20, v27
  v_min_u32 v27, v27, v98
  v_lshl_add_u32 v27, v27, 2, v26
  v_lshl_add_u32 v100, v27, 8, v3
  v_add_u32 v27, 64, v25
  v_mul_u32_u24 v26, 205, v27
  v_lshrrev_b32 v26, 12, v26
  v_mul_u32_u24 v98, 20, v26
  v_sub_u32 v27, v27, v98
  v_subrev_u32 v27, s67, v27
  v_add_u32 v98, 20, v27
  v_min_u32 v27, v27, v98
  v_lshl_add_u32 v27, v27, 2, v26
  v_lshl_add_u32 v101, v27, 8, v3
  v_lshrrev_b32 v25, 4, v0
  v_lshlrev_b32 v6, 8, v25
  v_bfe_u32 v26, v0, 1, 1
  v_lshl_add_u32 v6, v26, 7, v6
  v_bfe_u32 v26, v0, 2, 2
  v_lshl_add_u32 v6, v26, 4, v6
  v_and_b32 v26, 1, v0
  v_lshl_add_u32 v6, v26, 3, v6
  v_add_u32 v6, s58, v6
  v_lshlrev_b32 v90, 5, v24
  v_add_u32 v90, 12288, v90
  v_and_b32 v25, 1, v25
  v_lshl_add_u32 v7, v25, 4, v90
  s_lshl_b32 s48, s42, 2
  v_add_u32 v7, s48, v7
  s_lshl_b32 s48, s40, 5
  s_add_u32 s48, s48, s41
  s_lshl_b32 s59, s48, 7
  s_add_u32 s59, s59, 131072
  s_cmp_eq_u32 s42, 0
  s_cselect_b32 s59, s59, 0x80000000
  s_lshr_b32 s49, s48, 1
  s_mul_i32 s60, s49, 20480
  s_and_b32 s49, s41, 1
  s_lshl_b32 s49, s49, 7
  s_add_u32 s60, s60, s49
  s_add_u32 s60, s60, 1048576
  s_waitcnt vmcnt(0)
  s_add_u32 s46, s64, 16384
  s_mov_b64 exec, 1
  buffer_store_dword v1, off, s[4:7], s46 sc1
  s_mov_b64 exec, -1
L_r2_s:
  s_and_b32 s49, s41, 24
  v_and_b32 v88, 7, v0
  v_add_u32 v88, s49, v88
  v_lshlrev_b32 v88, 4, v88
  s_waitcnt vmcnt(11)
  ds_read_b64_tr_b16 v[20:21], v6 offset:0
  ds_read_b64_tr_b16 v[22:23], v6 offset:64
  ds_read_b64_tr_b16 v[24:25], v6 offset:1024
  ds_read_b64_tr_b16 v[26:27], v6 offset:1088
  ds_read_b64_tr_b16 v[28:29], v6 offset:2048
  ds_read_b64_tr_b16 v[30:31], v6 offset:2112
  s_waitcnt lgkmcnt(0)
  s_add_u32 s55, s65, 16384
  buffer_load_dwordx4 v[8:11], v88, s[4:7], s55 offen sc1
  v_lshlrev_b32 v56, 16, v20
  v_and_b32 v57, 0xffff0000, v20
  v_lshlrev_b32 v58, 16, v21
  v_and_b32 v59, 0xffff0000, v21
  v_lshlrev_b32 v60, 16, v22
  v_and_b32 v61, 0xffff0000, v22
  v_lshlrev_b32 v62, 16, v23
  v_and_b32 v63, 0xffff0000, v23
  v_lshlrev_b32 v64, 16, v24
  v_and_b32 v65, 0xffff0000, v24
  v_lshlrev_b32 v66, 16, v25
  v_and_b32 v67, 0xffff0000, v25
  v_lshlrev_b32 v68, 16, v26
  v_and_b32 v69, 0xffff0000, v26
  v_lshlrev_b32 v70, 16, v27
  v_and_b32 v71, 0xffff0000, v27
  v_lshlrev_b32 v72, 16, v28
  v_and_b32 v73, 0xffff0000, v28
  v_lshlrev_b32 v74, 16, v29
  v_and_b32 v75, 0xffff0000, v29
  v_lshlrev_b32 v76, 16, v30
  v_and_b32 v77, 0xffff0000, v30
  v_lshlrev_b32 v78, 16, v31
  v_and_b32 v79, 0xffff0000, v31
  s_waitcnt vmcnt(0)
Lchk_66:
  v_bitop3_b32 v8, v8, v9, v1 bitop3:0x7e
  v_bitop3_b32 v10, v10, v11, v1 bitop3:0x7e
  v_or_b32 v8, v8, v10
  v_cmp_ne_u32 vcc, 0, v8
  s_nop 3
  s_cbranch_vccz Lchkd_67
  s_add_u32 s55, s65, 16384
  buffer_load_dwordx4 v[8:11], v88, s[4:7], s55 offen sc1
  s_waitcnt vmcnt(0)
  s_branch Lchk_66
Lchkd_67:
  buffer_inv sc1
  s_waitcnt vmcnt(0)
  s_add_u32 s49, s60, s66
  buffer_load_dwordx4 v[8:11], v99, s[4:7], s60 offen sc1
  buffer_load_dwordx4 v[12:15], v100, s[4:7], s60 offen sc1
  buffer_load_dwordx4 v[16:19], v101, s[4:7], s49 offen sc1
  v_mov_b32 v84, 0x3f803f80
  s_waitcnt vmcnt(1)
  v_dot2_f32_bf16 v80, v8, v84, 0
  v_dot2_f32_bf16 v82, v8, v8, 0
  v_dot2_f32_bf16 v81, v9, v84, 0
  v_dot2_f32_bf16 v83, v9, v9, 0
  v_dot2_f32_bf16 v80, v10, v84, v80
  v_dot2_f32_bf16 v82, v10, v10, v82
  v_dot2_f32_bf16 v81, v11, v84, v81
  v_dot2_f32_bf16 v83, v11, v11, v83
  s_waitcnt vmcnt(0)
  v_dot2_f32_bf16 v80, v12, v84, v80
  v_dot2_f32_bf16 v82, v12, v12, v82
  v_dot2_f32_bf16 v81, v13, v84, v81
  v_dot2_f32_bf16 v83, v13, v13, v83
  v_dot2_f32_bf16 v80, v14, v84, v80
  v_dot2_f32_bf16 v82, v14, v14, v82
  v_dot2_f32_bf16 v81, v15, v84, v81
  v_dot2_f32_bf16 v83, v15, v15, v83
  s_waitcnt vmcnt(0)
  v_dot2_f32_bf16 v80, v16, v84, v80
  v_dot2_f32_bf16 v82, v16, v16, v82
  v_dot2_f32_bf16 v81, v17, v84, v81
  v_dot2_f32_bf16 v83, v17, v17, v83
  v_dot2_f32_bf16 v80, v18, v84, v80
  v_dot2_f32_bf16 v82, v18, v18, v82
  v_dot2_f32_bf16 v81, v19, v84, v81
  v_dot2_f32_bf16 v83, v19, v19, v83
  s_nop 1
  v_add_f32 v80, v80, v81
  v_add_f32 v82, v82, v83
  s_nop 0
  v_add_f32_dpp v80, v80, v80 row_ror:8 row_mask:0xf bank_mask:0xf
  v_add_f32_dpp v82, v82, v82 row_ror:8 row_mask:0xf bank_mask:0xf
  s_nop 1
  v_permlane16_swap_b32 v80, v82
  v_add_f32 v80, v80, v82
  v_mov_b32 v82, v80
  s_nop 1
  v_permlane32_swap_b32 v80, v82
  v_add_f32 v80, v80, v82
  s_mov_b64 exec, 0x00ff00ff
  ds_write_b32 v7, v80 offset:0
  s_mov_b64 exec, -1
  v_lshlrev_b32 v32, 16, v8
  v_and_b32 v33, 0xffff0000, v8
  v_lshlrev_b32 v34, 16, v9
  v_and_b32 v35, 0xffff0000, v9
  v_lshlrev_b32 v36, 16, v10
  v_and_b32 v37, 0xffff0000, v10
  v_lshlrev_b32 v38, 16, v11
  v_and_b32 v39, 0xffff0000, v11
  v_lshlrev_b32 v40, 16, v12
  v_and_b32 v41, 0xffff0000, v12
  v_lshlrev_b32 v42, 16, v13
  v_and_b32 v43, 0xffff0000, v13
  v_lshlrev_b32 v44, 16, v14
  v_and_b32 v45, 0xffff0000, v14
  v_lshlrev_b32 v46, 16, v15
  v_and_b32 v47, 0xffff0000, v15
  v_lshlrev_b32 v48, 16, v16
  v_and_b32 v49, 0xffff0000, v16
  v_lshlrev_b32 v50, 16, v17
  v_and_b32 v51, 0xffff0000, v17
  v_lshlrev_b32 v52, 16, v18
  v_and_b32 v53, 0xffff0000, v18
  v_lshlrev_b32 v54, 16, v19
  v_and_b32 v55, 0xffff0000, v19
  s_waitcnt lgkmcnt(0)
  s_barrier
  ds_read_b128 v[80:83], v90 offset:0
  ds_read_b128 v[84:87], v90 offset:16
  s_waitcnt lgkmcnt(0)
  v_pk_add_f32 v[80:81], v[80:81], v[82:83]
  v_pk_add_f32 v[84:85], v[84:85], v[86:87]
  v_add_f32 v80, v80, v81
  v_add_f32 v84, v84, v85
  v_mul_f32 v80, 0.0015625, v80
  v_mul_f32 v84, 0.0015625, v84
  v_fma_f32 v84, -v80, v80, v84
  v_max_f32 v84, 0, v84
  v_cvt_pk_bf16_f32 v84, v84, v80
  v_and_b32 v80, 0xffff0000, v84
  v_lshlrev_b32 v84, 16, v84
  v_add_f32 v84, 0x3727c5ac, v84
  v_cvt_pk_bf16_f32 v84, v84, v84
  v_lshlrev_b32 v84, 16, v84
  v_sqrt_f32 v84, v84
  s_nop 0
  v_cvt_pk_bf16_f32 v84, v84, v84
  v_lshlrev_b32 v84, 16, v84
  v_rcp_f32 v88, v84
  s_nop 0
  v_mul_f32 v89, v80, v88
  v_sub_f32 v89, 0, v89
  s_add_u32 s49, s60, s66
  v_pk_fma_f32 v[92:93], v[32:33], v[88:89], v[88:89] op_sel:[0,0,1] op_sel_hi:[1,0,1]
  v_pk_fma_f32 v[32:33], v[92:93], v[56:57], v[32:33]
  v_cvt_pk_bf16_f32 v20, v32, v33
  v_pk_fma_f32 v[94:95], v[34:35], v[88:89], v[88:89] op_sel:[0,0,1] op_sel_hi:[1,0,1]
  v_pk_fma_f32 v[34:35], v[94:95], v[58:59], v[34:35]
  v_cvt_pk_bf16_f32 v21, v34, v35
  v_pk_fma_f32 v[92:93], v[36:37], v[88:89], v[88:89] op_sel:[0,0,1] op_sel_hi:[1,0,1]
  v_pk_fma_f32 v[36:37], v[92:93], v[60:61], v[36:37]
  v_cvt_pk_bf16_f32 v22, v36, v37
  v_pk_fma_f32 v[94:95], v[38:39], v[88:89], v[88:89] op_sel:[0,0,1] op_sel_hi:[1,0,1]
  v_pk_fma_f32 v[38:39], v[94:95], v[62:63], v[38:39]
  v_cvt_pk_bf16_f32 v23, v38, v39
  buffer_store_dwordx4 v[20:23], v99, s[4:7], s60 offen sc1
  v_pk_fma_f32 v[92:93], v[40:41], v[88:89], v[88:89] op_sel:[0,0,1] op_sel_hi:[1,0,1]
  v_pk_fma_f32 v[40:41], v[92:93], v[64:65], v[40:41]
  v_cvt_pk_bf16_f32 v24, v40, v41
  v_pk_fma_f32 v[94:95], v[42:43], v[88:89], v[88:89] op_sel:[0,0,1] op_sel_hi:[1,0,1]
  v_pk_fma_f32 v[42:43], v[94:95], v[66:67], v[42:43]
  v_cvt_pk_bf16_f32 v25, v42, v43
  v_pk_fma_f32 v[92:93], v[44:45], v[88:89], v[88:89] op_sel:[0,0,1] op_sel_hi:[1,0,1]
  v_pk_fma_f32 v[44:45], v[92:93], v[68:69], v[44:45]
  v_cvt_pk_bf16_f32 v26, v44, v45
  v_pk_fma_f32 v[94:95], v[46:47], v[88:89], v[88:89] op_sel:[0,0,1] op_sel_hi:[1,0,1]
  v_pk_fma_f32 v[46:47], v[94:95], v[70:71], v[46:47]
  v_cvt_pk_bf16_f32 v27, v46, v47
  buffer_store_dwordx4 v[24:27], v100, s[4:7], s60 offen sc1
  v_pk_fma_f32 v[92:93], v[48:49], v[88:89], v[88:89] op_sel:[0,0,1] op_sel_hi:[1,0,1]
  v_pk_fma_f32 v[48:49], v[92:93], v[72:73], v[48:49]
  v_cvt_pk_bf16_f32 v28, v48, v49
  v_pk_fma_f32 v[94:95], v[50:51], v[88:89], v[88:89] op_sel:[0,0,1] op_sel_hi:[1,0,1]
  v_pk_fma_f32 v[50:51], v[94:95], v[74:75], v[50:51]
  v_cvt_pk_bf16_f32 v29, v50, v51
  v_pk_fma_f32 v[92:93], v[52:53], v[88:89], v[88:89] op_sel:[0,0,1] op_sel_hi:[1,0,1]
  v_pk_fma_f32 v[52:53], v[92:93], v[76:77], v[52:53]
  v_cvt_pk_bf16_f32 v30, v52, v53
  v_pk_fma_f32 v[94:95], v[54:55], v[88:89], v[88:89] op_sel:[0,0,1] op_sel_hi:[1,0,1]
  v_pk_fma_f32 v[54:55], v[94:95], v[78:79], v[54:55]
  v_cvt_pk_bf16_f32 v31, v54, v55
  buffer_store_dwordx4 v[28:31], v101, s[4:7], s49 offen sc1
  v_mov_b32 v93, v3
  s_mov_b32 s58, s59
  v_mov_b32 v84, 0x3f803f80
  v_dot2_f32_bf16 v80, v20, v84, 0
  v_dot2_f32_bf16 v82, v20, v20, 0
  v_dot2_f32_bf16 v81, v21, v84, 0
  v_dot2_f32_bf16 v83, v21, v21, 0
  v_dot2_f32_bf16 v80, v22, v84, v80
  v_dot2_f32_bf16 v82, v22, v22, v82
  v_dot2_f32_bf16 v81, v23, v84, v81
  v_dot2_f32_bf16 v83, v23, v23, v83
  v_dot2_f32_bf16 v80, v24, v84, v80
  v_dot2_f32_bf16 v82, v24, v24, v82
  v_dot2_f32_bf16 v81, v25, v84, v81
  v_dot2_f32_bf16 v83, v25, v25, v83
  v_dot2_f32_bf16 v80, v26, v84, v80
  v_dot2_f32_bf16 v82, v26, v26, v82
  v_dot2_f32_bf16 v81, v27, v84, v81
  v_dot2_f32_bf16 v83, v27, v27, v83
  v_dot2_f32_bf16 v80, v28, v84, v80
  v_dot2_f32_bf16 v82, v28, v28, v82
  v_dot2_f32_bf16 v81, v29, v84, v81
  v_dot2_f32_bf16 v83, v29, v29, v83
  v_dot2_f32_bf16 v80, v30, v84, v80
  v_dot2_f32_bf16 v82, v30, v30, v82
  v_dot2_f32_bf16 v81, v31, v84, v81
  v_dot2_f32_bf16 v83, v31, v31, v83
  s_nop 1
  v_add_f32 v80, v80, v81
  v_add_f32 v82, v82, v83
  s_nop 0
  v_add_f32_dpp v80, v80, v80 row_ror:8 row_mask:0xf bank_mask:0xf
  v_add_f32_dpp v82, v82, v82 row_ror:8 row_mask:0xf bank_mask:0xf
  s_nop 1
  v_permlane16_swap_b32 v80, v82
  v_add_f32 v80, v80, v82
  v_mov_b32 v82, v80
  s_nop 1
  v_permlane32_swap_b32 v80, v82
  v_add_f32 v80, v80, v82
  s_mov_b64 exec, 0x00ff00ff
  ds_write_b32 v7, v80 offset:256
  s_mov_b64 exec, -1
  s_waitcnt vmcnt(0)
  s_add_u32 s46, s64, 20480
  s_mov_b64 exec, 1
  buffer_store_dword v1, off, s[4:7], s46 sc1
  s_mov_b64 exec, -1
  v_and_b32 v5, 15, v0
  v_lshlrev_b32 v5, 4, v5
  v_bfe_u32 v6, v0, 4, 1
  v_lshl_add_u32 v7, v6, 8, v5
  s_lshl_b32 s48, s42, 8
  v_add_u32 v5, s48, v5
  v_mul_u32_u24 v6, 49152, v6
  v_add_u32 v5, v5, v6
  v_lshrrev_b32 v6, 5, v0
  v_lshl_add_u32 v3, v6, 10, v5
  v_lshl_add_u32 v4, v6, 3, v5
  v_add_u32 v4, 2048, v4
  v_mul_u32_u24 v13, 96, v6
  s_mul_i32 s48, s42, 192
  s_add_u32 s48, s48, 36864
  v_add_u32 v13, s48, v13
  v_add_u32 v5, 40960, v2
  s_lshr_b32 s49, s41, 4
  s_lshl_b32 s50, s40, 1
  s_add_u32 s50, s50, s49
  s_lshl_b32 s50, s50, 3
  s_and_b32 s48, s42, 1
  s_mul_i32 s48, s48, 20480
  s_lshr_b32 s53, s42, 1
  s_lshl_b32 s53, s53, 10
  s_add_u32 s53, s53, s48
  s_mul_i32 s51, s50, 20480
  s_add_u32 s51, s51, s53
  s_add_u32 s51, s51, 1048576
  s_lshl_b32 s48, s36, 10
  s_add_u32 s51, s51, s48
  s_cmp_eq_u32 s36, 0
  s_cselect_b32 s48, 0, 20480
  s_sub_u32 s61, s51, s48
  s_and_b32 s48, s41, 15
  s_mul_i32 s48, s48, 3072
  s_mul_i32 s52, s50, 49152
  s_add_u32 s52, s52, s48
  s_add_u32 s52, s52, 10485760
  s_lshl_b32 s62, s50, 8
  s_add_u32 s62, s62, 131072
  s_lshr_b32 s48, s41, 3
  s_lshl_b32 s59, s40, 2
  s_add_u32 s59, s59, s48
  s_mul_i32 s59, s59, 196608
  s_mul_i32 s48, s42, 12288
  s_add_u32 s59, s59, s48
  s_add_u32 s59, s59, 10485760
  s_mul_i32 s60, s42, 9216
  s_lshl_b32 s49, s49, 4
  v_and_b32 v6, 15, v0
  v_add_u32 v6, s49, v6
  v_lshlrev_b32 v6, 4, v6
  s_add_u32 s46, s65, 20480
Lpoll_68:
  buffer_load_dwordx4 v[8:11], v6, s[4:7], s46 offen sc1
  s_waitcnt vmcnt(0)
  v_bitop3_b32 v8, v8, v9, v1 bitop3:0x7e
  v_bitop3_b32 v10, v10, v11, v1 bitop3:0x7e
  v_or_b32 v8, v8, v10
  v_cmp_ne_u32 vcc, 0, v8
  s_nop 3
  s_cbranch_vccnz Lpoll_68
  buffer_inv sc1
  s_waitcnt vmcnt(0)
  s_add_u32 m0, s53, 0
  s_add_u32 s48, s51, 0
  buffer_load_dwordx4 v2, s[4:7], s48 offen offset:0 sc1 lds
  buffer_load_dwordx4 v2, s[4:7], s48 offen offset:2048 sc1 lds
  s_add_u32 m0, s53, 4096
  s_add_u32 s48, s51, 4096
  buffer_load_dwordx4 v2, s[4:7], s48 offen offset:0 sc1 lds
  buffer_load_dwordx4 v2, s[4:7], s48 offen offset:2048 sc1 lds
  s_lshl_b32 s55, s42, 2
  s_add_u32 s49, s49, s55
  v_and_b32 v6, 3, v0
  v_add_u32 v6, s49, v6
  v_lshlrev_b32 v6, 4, v6
  s_waitcnt lgkmcnt(0)
  s_barrier
  ds_read_b128 v[80:83], v90 offset:256
  ds_read_b128 v[84:87], v90 offset:272
  s_waitcnt lgkmcnt(0)
  v_pk_add_f32 v[80:81], v[80:81], v[82:83]
  v_pk_add_f32 v[84:85], v[84:85], v[86:87]
  v_add_f32 v80, v80, v81
  v_add_f32 v84, v84, v85
  v_mul_f32 v80, 0.0015625, v80
  v_mul_f32 v84, 0.0015625, v84
  v_fma_f32 v84, -v80, v80, v84
  v_max_f32 v84, 0, v84
  v_cvt_pk_bf16_f32 v84, v84, v80
  v_and_b32 v80, 0xffff0000, v84
  v_lshlrev_b32 v84, 16, v84
  v_add_f32 v84, 0x3727c5ac, v84
  v_cvt_pk_bf16_f32 v84, v84, v84
  v_lshlrev_b32 v84, 16, v84
  v_sqrt_f32 v84, v84
  s_nop 0
  v_cvt_pk_bf16_f32 v84, v84, v84
  v_lshlrev_b32 v84, 16, v84
  v_rcp_f32 v88, v84
  s_nop 0
  v_mul_f32 v89, v88, v88
  v_sub_f32 v88, 0, v80
  v_mov_b32 v90, v1
  v_mov_b32 v91, v1
  s_mov_b64 exec, 0xff
  buffer_store_dwordx4 v[88:91], v93, s[4:7], s58 offen sc1
  s_mov_b64 exec, -1
  ds_read_b128 v[88:91], v13 offset:0
  ds_read_b128 v[92:95], v13 offset:16
  ds_read_b128 v[96:99], v13 offset:32
  ds_read_b128 v[100:103], v13 offset:48
  ds_read_b128 v[104:107], v13 offset:64
  ds_read_b128 v[108:111], v13 offset:80
  s_waitcnt lgkmcnt(0)
  s_waitcnt vmcnt(2)
  s_barrier
  ds_read_b128 v[64:67], v2 offset:0
  ds_read_b128 v[68:71], v2 offset:20480
  ds_read_b128 v[72:75], v2 offset:1024
  ds_read_b128 v[76:79], v2 offset:21504
  s_waitcnt lgkmcnt(2)
  v_mfma_f32_16x16x32_bf16 v[16:19], v[112:115], v[64:67], 0
  ds_read_b128 v[80:83], v2 offset:2048
  s_add_u32 m0, s53, 8192
  v_mfma_f32_16x16x32_bf16 v[28:31], v[112:115], v[68:71], 0
  ds_read_b128 v[84:87], v2 offset:22528
  s_add_u32 s48, s61, 8192
  v_mfma_f32_16x16x32_bf16 v[20:23], v[116:119], v[64:67], 0
  buffer_load_dwordx4 v2, s[4:7], s48 offen offset:0 sc1 lds
  buffer_load_dwordx4 v2, s[4:7], s48 offen offset:2048 sc1 lds
  v_mfma_f32_16x16x32_bf16 v[32:35], v[116:119], v[68:71], 0
  v_mfma_f32_16x16x32_bf16 v[24:27], v[120:123], v[64:67], 0
  v_mfma_f32_16x16x32_bf16 v[36:39], v[120:123], v[68:71], 0
  s_waitcnt lgkmcnt(2)
  v_mfma_f32_16x16x32_bf16 v[16:19], v[124:127], v[72:75], v[16:19]
  ds_read_b128 v[64:67], v2 offset:3072
  s_add_u32 m0, s53, 12288
  v_mfma_f32_16x16x32_bf16 v[28:31], v[124:127], v[76:79], v[28:31]
  ds_read_b128 v[68:71], v2 offset:23552
  s_add_u32 s48, s61, 12288
  v_mfma_f32_16x16x32_bf16 v[20:23], v[128:131], v[72:75], v[20:23]
  buffer_load_dwordx4 v2, s[4:7], s48 offen offset:0 sc1 lds
  buffer_load_dwordx4 v2, s[4:7], s48 offen offset:2048 sc1 lds
  v_mfma_f32_16x16x32_bf16 v[32:35], v[128:131], v[76:79], v[32:35]
  v_mfma_f32_16x16x32_bf16 v[24:27], v[132:135], v[72:75], v[24:27]
  v_mfma_f32_16x16x32_bf16 v[36:39], v[132:135], v[76:79], v[36:39]
  s_waitcnt lgkmcnt(2)
  v_mfma_f32_16x16x32_bf16 v[16:19], v[136:139], v[80:83], v[16:19]
  s_waitcnt vmcnt(4)
  s_barrier
  ds_read_b128 v[72:75], v2 offset:4096
  v_mfma_f32_16x16x32_bf16 v[28:31], v[136:139], v[84:87], v[28:31]
  ds_read_b128 v[76:79], v2 offset:24576
  s_add_u32 m0, s53, 16384
  v_mfma_f32_16x16x32_bf16 v[20:23], v[140:143], v[80:83], v[20:23]
  s_add_u32 s48, s61, 16384
  buffer_load_dwordx4 v2, s[4:7], s48 offen offset:0 sc1 lds
  v_mfma_f32_16x16x32_bf16 v[32:35], v[140:143], v[84:87], v[32:35]
  buffer_load_dwordx4 v2, s[4:7], s48 offen offset:2048 sc1 lds
  v_mfma_f32_16x16x32_bf16 v[24:27], v[144:147], v[80:83], v[24:27]
  v_mfma_f32_16x16x32_bf16 v[36:39], v[144:147], v[84:87], v[36:39]
  s_waitcnt lgkmcnt(2)
  v_mfma_f32_16x16x32_bf16 v[16:19], v[148:151], v[64:67], v[16:19]
  ds_read_b128 v[80:83], v2 offset:5120
  s_add_u32 m0, s53, 40960
  v_mfma_f32_16x16x32_bf16 v[28:31], v[148:151], v[68:71], v[28:31]
  ds_read_b128 v[84:87], v2 offset:25600
  s_add_u32 s48, s51, 81920
  v_mfma_f32_16x16x32_bf16 v[20:23], v[152:155], v[64:67], v[20:23]
  buffer_load_dwordx4 v2, s[4:7], s48 offen offset:0 sc1 lds
  buffer_load_dwordx4 v2, s[4:7], s48 offen offset:2048 sc1 lds
  v_mfma_f32_16x16x32_bf16 v[32:35], v[152:155], v[68:71], v[32:35]
  v_mfma_f32_16x16x32_bf16 v[24:27], v[156:159], v[64:67], v[24:27]
  v_mfma_f32_16x16x32_bf16 v[36:39], v[156:159], v[68:71], v[36:39]
  s_waitcnt lgkmcnt(2)
  v_mfma_f32_16x16x32_bf16 v[16:19], v[160:163], v[72:75], v[16:19]
  ds_read_b128 v[64:67], v2 offset:6144
  s_add_u32 m0, s53, 45056
  v_mfma_f32_16x16x32_bf16 v[28:31], v[160:163], v[76:79], v[28:31]
  ds_read_b128 v[68:71], v2 offset:26624
  s_add_u32 s48, s51, 86016
  v_mfma_f32_16x16x32_bf16 v[20:23], v[164:167], v[72:75], v[20:23]
  buffer_load_dwordx4 v2, s[4:7], s48 offen offset:0 sc1 lds
  v_mfma_f32_16x16x32_bf16 v[32:35], v[164:167], v[76:79], v[32:35]
  v_mfma_f32_16x16x32_bf16 v[24:27], v[168:171], v[72:75], v[24:27]
  v_mfma_f32_16x16x32_bf16 v[36:39], v[168:171], v[76:79], v[36:39]
  s_waitcnt lgkmcnt(2)
  v_mfma_f32_16x16x32_bf16 v[16:19], v[172:175], v[80:83], v[16:19]
  ds_read_b128 v[72:75], v2 offset:7168
  buffer_load_dwordx4 v2, s[4:7], s48 offen offset:2048 sc1 lds
  v_mfma_f32_16x16x32_bf16 v[28:31], v[172:175], v[84:87], v[28:31]
  ds_read_b128 v[76:79], v2 offset:27648
  v_mfma_f32_16x16x32_bf16 v[20:23], v[176:179], v[80:83], v[20:23]
  v_mfma_f32_16x16x32_bf16 v[32:35], v[176:179], v[84:87], v[32:35]
  v_mfma_f32_16x16x32_bf16 v[24:27], v[180:183], v[80:83], v[24:27]
  v_mfma_f32_16x16x32_bf16 v[36:39], v[180:183], v[84:87], v[36:39]
  s_waitcnt lgkmcnt(2)
  v_mfma_f32_16x16x32_bf16 v[16:19], v[184:187], v[64:67], v[16:19]
  s_waitcnt vmcnt(7)
  s_barrier
  ds_read_b128 v[80:83], v2 offset:8192
  v_mfma_f32_16x16x32_bf16 v[28:31], v[184:187], v[68:71], v[28:31]
  ds_read_b128 v[84:87], v2 offset:28672
  s_add_u32 m0, s53, 49152
  v_mfma_f32_16x16x32_bf16 v[20:23], v[188:191], v[64:67], v[20:23]
  s_add_u32 s48, s61, 90112
  buffer_load_dwordx4 v2, s[4:7], s48 offen offset:0 sc1 lds
  v_mfma_f32_16x16x32_bf16 v[32:35], v[188:191], v[68:71], v[32:35]
  v_mfma_f32_16x16x32_bf16 v[24:27], v[192:195], v[64:67], v[24:27]
  v_mfma_f32_16x16x32_bf16 v[36:39], v[192:195], v[68:71], v[36:39]
  s_waitcnt lgkmcnt(2)
  v_mfma_f32_16x16x32_bf16 v[16:19], v[196:199], v[72:75], v[16:19]
  ds_read_b128 v[64:67], v2 offset:9216
  buffer_load_dwordx4 v2, s[4:7], s48 offen offset:2048 sc1 lds
  v_mfma_f32_16x16x32_bf16 v[28:31], v[196:199], v[76:79], v[28:31]
  ds_read_b128 v[68:71], v2 offset:29696
  v_mfma_f32_16x16x32_bf16 v[20:23], v[200:203], v[72:75], v[20:23]
  v_mfma_f32_16x16x32_bf16 v[32:35], v[200:203], v[76:79], v[32:35]
  v_mfma_f32_16x16x32_bf16 v[24:27], v[204:207], v[72:75], v[24:27]
  v_mfma_f32_16x16x32_bf16 v[36:39], v[204:207], v[76:79], v[36:39]
  s_waitcnt lgkmcnt(2)
  v_mfma_f32_16x16x32_bf16 v[16:19], v[208:211], v[80:83], v[16:19]
  ds_read_b128 v[72:75], v2 offset:10240
  s_add_u32 m0, s53, 53248
  v_mfma_f32_16x16x32_bf16 v[28:31], v[208:211], v[84:87], v[28:31]
  ds_read_b128 v[76:79], v2 offset:30720
  s_add_u32 s48, s61, 94208
  v_mfma_f32_16x16x32_bf16 v[20:23], v[212:215], v[80:83], v[20:23]
  buffer_load_dwordx4 v2, s[4:7], s48 offen offset:0 sc1 lds
  v_mfma_f32_16x16x32_bf16 v[32:35], v[212:215], v[84:87], v[32:35]
  v_mfma_f32_16x16x32_bf16 v[24:27], v[216:219], v[80:83], v[24:27]
  v_mfma_f32_16x16x32_bf16 v[36:39], v[216:219], v[84:87], v[36:39]
  s_waitcnt lgkmcnt(2)
  v_mfma_f32_16x16x32_bf16 v[16:19], v[220:223], v[64:67], v[16:19]
  ds_read_b128 v[80:83], v2 offset:11264
  buffer_load_dwordx4 v2, s[4:7], s48 offen offset:2048 sc1 lds
  v_mfma_f32_16x16x32_bf16 v[28:31], v[220:223], v[68:71], v[28:31]
  ds_read_b128 v[84:87], v2 offset:31744
  v_mfma_f32_16x16x32_bf16 v[20:23], v[224:227], v[64:67], v[20:23]
  v_mfma_f32_16x16x32_bf16 v[32:35], v[224:227], v[68:71], v[32:35]
  v_mfma_f32_16x16x32_bf16 v[24:27], v[228:231], v[64:67], v[24:27]
  v_mfma_f32_16x16x32_bf16 v[36:39], v[228:231], v[68:71], v[36:39]
  s_waitcnt lgkmcnt(2)
  v_mfma_f32_16x16x32_bf16 v[16:19], v[232:235], v[72:75], v[16:19]
  ds_read_b128 v[64:67], v2 offset:12288
  s_add_u32 m0, s53, 57344
  v_mfma_f32_16x16x32_bf16 v[28:31], v[232:235], v[76:79], v[28:31]
  ds_read_b128 v[68:71], v2 offset:32768
  s_add_u32 s48, s61, 98304
  v_mfma_f32_16x16x32_bf16 v[20:23], v[236:239], v[72:75], v[20:23]
  buffer_load_dwordx4 v2, s[4:7], s48 offen offset:0 sc1 lds
  v_mfma_f32_16x16x32_bf16 v[32:35], v[236:239], v[76:79], v[32:35]
  v_mfma_f32_16x16x32_bf16 v[24:27], v[240:243], v[72:75], v[24:27]
  v_mfma_f32_16x16x32_bf16 v[36:39], v[240:243], v[76:79], v[36:39]
  s_waitcnt lgkmcnt(2)
  v_mfma_f32_16x16x32_bf16 v[16:19], v[244:247], v[80:83], v[16:19]
  ds_read_b128 v[72:75], v2 offset:13312
  buffer_load_dwordx4 v2, s[4:7], s48 offen offset:2048 sc1 lds
  v_mfma_f32_16x16x32_bf16 v[28:31], v[244:247], v[84:87], v[28:31]
  ds_read_b128 v[76:79], v2 offset:33792
  v_mfma_f32_16x16x32_bf16 v[20:23], v[248:251], v[80:83], v[20:23]
  v_mfma_f32_16x16x32_bf16 v[32:35], v[248:251], v[84:87], v[32:35]
  v_mfma_f32_16x16x32_bf16 v[24:27], v[252:255], v[80:83], v[24:27]
  v_mfma_f32_16x16x32_bf16 v[36:39], v[252:255], v[84:87], v[36:39]
  s_waitcnt lgkmcnt(2)
  v_mfma_f32_16x16x32_bf16 v[16:19], a[0:3], v[64:67], v[16:19]
  s_waitcnt vmcnt(10)
  s_barrier
  ds_read_b128 v[80:83], v2 offset:14336
  v_mfma_f32_16x16x32_bf16 v[28:31], a[0:3], v[68:71], v[28:31]
  ds_read_b128 v[84:87], v2 offset:34816
  s_add_u32 s55, s62, 0
  v_mfma_f32_16x16x32_bf16 v[20:23], a[4:7], v[64:67], v[20:23]
  buffer_load_dwordx4 v[8:11], v7, s[4:7], s55 offen sc1
  v_mfma_f32_16x16x32_bf16 v[32:35], a[4:7], v[68:71], v[32:35]
  v_mfma_f32_16x16x32_bf16 v[24:27], a[8:11], v[64:67], v[24:27]
  v_mfma_f32_16x16x32_bf16 v[36:39], a[8:11], v[68:71], v[36:39]
  s_waitcnt lgkmcnt(2)
  v_mfma_f32_16x16x32_bf16 v[16:19], a[12:15], v[72:75], v[16:19]
  ds_read_b128 v[64:67], v2 offset:15360
  v_mfma_f32_16x16x32_bf16 v[28:31], a[12:15], v[76:79], v[28:31]
  ds_read_b128 v[68:71], v2 offset:35840
  v_mfma_f32_16x16x32_bf16 v[20:23], a[16:19], v[72:75], v[20:23]
  v_mfma_f32_16x16x32_bf16 v[32:35], a[16:19], v[76:79], v[32:35]
  v_mfma_f32_16x16x32_bf16 v[24:27], a[20:23], v[72:75], v[24:27]
  v_mfma_f32_16x16x32_bf16 v[36:39], a[20:23], v[76:79], v[36:39]
  s_waitcnt lgkmcnt(2)
  v_mfma_f32_16x16x32_bf16 v[16:19], a[24:27], v[80:83], v[16:19]
  ds_read_b128 v[72:75], v2 offset:16384
  v_mfma_f32_16x16x32_bf16 v[28:31], a[24:27], v[84:87], v[28:31]
  ds_read_b128 v[76:79], v2 offset:36864
  v_mfma_f32_16x16x32_bf16 v[20:23], a[28:31], v[80:83], v[20:23]
  v_mfma_f32_16x16x32_bf16 v[32:35], a[28:31], v[84:87], v[32:35]
  v_mfma_f32_16x16x32_bf16 v[24:27], a[32:35], v[80:83], v[24:27]
  v_mfma_f32_16x16x32_bf16 v[36:39], a[32:35], v[84:87], v[36:39]
  s_waitcnt lgkmcnt(2)
  v_mfma_f32_16x16x32_bf16 v[16:19], a[36:39], v[64:67], v[16:19]
  ds_read_b128 v[80:83], v2 offset:17408
  v_mfma_f32_16x16x32_bf16 v[28:31], a[36:39], v[68:71], v[28:31]
  ds_read_b128 v[84:87], v2 offset:37888
  v_mfma_f32_16x16x32_bf16 v[20:23], a[40:43], v[64:67], v[20:23]
  v_mfma_f32_16x16x32_bf16 v[32:35], a[40:43], v[68:71], v[32:35]
  v_mfma_f32_16x16x32_bf16 v[24:27], a[44:47], v[64:67], v[24:27]
  v_mfma_f32_16x16x32_bf16 v[36:39], a[44:47], v[68:71], v[36:39]
  s_waitcnt lgkmcnt(2)
  v_mfma_f32_16x16x32_bf16 v[16:19], a[48:51], v[72:75], v[16:19]
  ds_read_b128 v[64:67], v2 offset:18432
  v_mfma_f32_16x16x32_bf16 v[28:31], a[48:51], v[76:79], v[28:31]
  ds_read_b128 v[68:71], v2 offset:38912
  v_mfma_f32_16x16x32_bf16 v[20:23], a[52:55], v[72:75], v[20:23]
  v_mfma_f32_16x16x32_bf16 v[32:35], a[52:55], v[76:79], v[32:35]
  v_mfma_f32_16x16x32_bf16 v[24:27], a[56:59], v[72:75], v[24:27]
  v_mfma_f32_16x16x32_bf16 v[36:39], a[56:59], v[76:79], v[36:39]
  s_waitcnt lgkmcnt(2)
  v_mfma_f32_16x16x32_bf16 v[16:19], a[60:63], v[80:83], v[16:19]
  ds_read_b128 v[72:75], v2 offset:19456
  v_mfma_f32_16x16x32_bf16 v[28:31], a[60:63], v[84:87], v[28:31]
  ds_read_b128 v[76:79], v2 offset:39936
  v_mfma_f32_16x16x32_bf16 v[20:23], a[64:67], v[80:83], v[20:23]
  v_mfma_f32_16x16x32_bf16 v[32:35], a[64:67], v[84:87], v[32:35]
  v_mfma_f32_16x16x32_bf16 v[24:27], a[68:71], v[80:83], v[24:27]
  v_mfma_f32_16x16x32_bf16 v[36:39], a[68:71], v[84:87], v[36:39]
  s_waitcnt lgkmcnt(2)
  v_mfma_f32_16x16x32_bf16 v[16:19], a[72:75], v[64:67], v[16:19]
  s_waitcnt vmcnt(1) lgkmcnt(0)
  s_barrier
  ds_read_b128 v[80:83], v5 offset:0
  v_mfma_f32_16x16x32_bf16 v[28:31], a[72:75], v[68:71], v[28:31]
  ds_read_b128 v[84:87], v5 offset:20480
  v_mfma_f32_16x16x32_bf16 v[20:23], a[76:79], v[64:67], v[20:23]
  v_mfma_f32_16x16x32_bf16 v[32:35], a[76:79], v[68:71], v[32:35]
  v_mfma_f32_16x16x32_bf16 v[24:27], a[80:83], v[64:67], v[24:27]
  v_mfma_f32_16x16x32_bf16 v[36:39], a[80:83], v[68:71], v[36:39]
  s_waitcnt lgkmcnt(2)
  v_mfma_f32_16x16x32_bf16 v[16:19], a[84:87], v[72:75], v[16:19]
  ds_read_b128 v[64:67], v5 offset:1024
  v_mfma_f32_16x16x32_bf16 v[28:31], a[84:87], v[76:79], v[28:31]
  ds_read_b128 v[68:71], v5 offset:21504
  v_mfma_f32_16x16x32_bf16 v[20:23], a[88:91], v[72:75], v[20:23]
  v_mfma_f32_16x16x32_bf16 v[32:35], a[88:91], v[76:79], v[32:35]
  v_mfma_f32_16x16x32_bf16 v[24:27], a[92:95], v[72:75], v[24:27]
  v_mfma_f32_16x16x32_bf16 v[36:39], a[92:95], v[76:79], v[36:39]
  s_waitcnt lgkmcnt(2)
  v_mfma_f32_16x16x32_bf16 v[40:43], v[112:115], v[80:83], 0
  ds_read_b128 v[72:75], v5 offset:2048
  s_add_u32 m0, s53, 0
  v_mfma_f32_16x16x32_bf16 v[52:55], v[112:115], v[84:87], 0
  ds_read_b128 v[76:79], v5 offset:22528
  s_add_u32 s48, s51, 40960
  v_mfma_f32_16x16x32_bf16 v[44:47], v[116:119], v[80:83], 0
  buffer_load_dwordx4 v2, s[4:7], s48 offen offset:0 sc1 lds
  v_mfma_f32_16x16x32_bf16 v[56:59], v[116:119], v[84:87], 0
  v_mfma_f32_16x16x32_bf16 v[48:51], v[120:123], v[80:83], 0
  v_mfma_f32_16x16x32_bf16 v[60:63], v[120:123], v[84:87], 0
  s_waitcnt lgkmcnt(2)
  v_mfma_f32_16x16x32_bf16 v[40:43], v[124:127], v[64:67], v[40:43]
  ds_read_b128 v[80:83], v5 offset:3072
  buffer_load_dwordx4 v2, s[4:7], s48 offen offset:2048 sc1 lds
  v_mfma_f32_16x16x32_bf16 v[52:55], v[124:127], v[68:71], v[52:55]
  ds_read_b128 v[84:87], v5 offset:23552
  v_mfma_f32_16x16x32_bf16 v[44:47], v[128:131], v[64:67], v[44:47]
  v_permlane16_swap_b32 v16, v28
  v_mfma_f32_16x16x32_bf16 v[56:59], v[128:131], v[68:71], v[56:59]
  v_permlane16_swap_b32 v17, v29
  v_mfma_f32_16x16x32_bf16 v[48:51], v[132:135], v[64:67], v[48:51]
  v_permlane16_swap_b32 v18, v30
  v_mfma_f32_16x16x32_bf16 v[60:63], v[132:135], v[68:71], v[60:63]
  s_waitcnt lgkmcnt(2)
  v_mfma_f32_16x16x32_bf16 v[40:43], v[136:139], v[72:75], v[40:43]
  ds_read_b128 v[64:67], v5 offset:4096
  s_add_u32 m0, s53, 4096
  v_mfma_f32_16x16x32_bf16 v[52:55], v[136:139], v[76:79], v[52:55]
  ds_read_b128 v[68:71], v5 offset:24576
  s_add_u32 s48, s51, 45056
  v_mfma_f32_16x16x32_bf16 v[44:47], v[140:143], v[72:75], v[44:47]
  buffer_load_dwordx4 v2, s[4:7], s48 offen offset:0 sc1 lds
  v_mfma_f32_16x16x32_bf16 v[56:59], v[140:143], v[76:79], v[56:59]
  v_permlane16_swap_b32 v19, v31
  v_mfma_f32_16x16x32_bf16 v[48:51], v[144:147], v[72:75], v[48:51]
  v_permlane16_swap_b32 v20, v32
  v_mfma_f32_16x16x32_bf16 v[60:63], v[144:147], v[76:79], v[60:63]
  s_waitcnt lgkmcnt(2)
  v_mfma_f32_16x16x32_bf16 v[40:43], v[148:151], v[80:83], v[40:43]
  ds_read_b128 v[72:75], v5 offset:5120
  buffer_load_dwordx4 v2, s[4:7], s48 offen offset:2048 sc1 lds
  v_mfma_f32_16x16x32_bf16 v[52:55], v[148:151], v[84:87], v[52:55]
  ds_read_b128 v[76:79], v5 offset:25600
  v_mfma_f32_16x16x32_bf16 v[44:47], v[152:155], v[80:83], v[44:47]
  v_permlane16_swap_b32 v21, v33
  v_mfma_f32_16x16x32_bf16 v[56:59], v[152:155], v[84:87], v[56:59]
  v_permlane16_swap_b32 v22, v34
  v_mfma_f32_16x16x32_bf16 v[48:51], v[156:159], v[80:83], v[48:51]
  v_permlane16_swap_b32 v23, v35
  v_mfma_f32_16x16x32_bf16 v[60:63], v[156:159], v[84:87], v[60:63]
  s_waitcnt vmcnt(4)
  s_waitcnt lgkmcnt(2)
  v_mfma_f32_16x16x32_bf16 v[40:43], v[160:163], v[64:67], v[40:43]
  ds_read_b128 v[80:83], v5 offset:6144
  s_add_u32 m0, s53, 8192
  v_mfma_f32_16x16x32_bf16 v[52:55], v[160:163], v[68:71], v[52:55]
  ds_read_b128 v[84:87], v5 offset:26624
  s_add_u32 s48, s61, 49152
  v_mfma_f32_16x16x32_bf16 v[44:47], v[164:167], v[64:67], v[44:47]
  buffer_load_dwordx4 v2, s[4:7], s48 offen offset:0 sc1 lds
  v_bitop3_b32 v10, v10, v11, v1 bitop3:0x7e
  v_mfma_f32_16x16x32_bf16 v[56:59], v[164:167], v[68:71], v[56:59]
  v_cmp_ne_u32 vcc, 0, v10
  v_mfma_f32_16x16x32_bf16 v[48:51], v[168:171], v[64:67], v[48:51]
  v_permlane16_swap_b32 v24, v36
  v_mfma_f32_16x16x32_bf16 v[60:63], v[168:171], v[68:71], v[60:63]
  s_waitcnt lgkmcnt(2)
  v_mfma_f32_16x16x32_bf16 v[40:43], v[172:175], v[72:75], v[40:43]
  ds_read_b128 v[64:67], v5 offset:7168
  buffer_load_dwordx4 v2, s[4:7], s48 offen offset:2048 sc1 lds
  v_mfma_f32_16x16x32_bf16 v[52:55], v[172:175], v[76:79], v[52:55]
  ds_read_b128 v[68:71], v5 offset:27648
  v_mfma_f32_16x16x32_bf16 v[44:47], v[176:179], v[72:75], v[44:47]
  v_permlane16_swap_b32 v25, v37
  v_mfma_f32_16x16x32_bf16 v[56:59], v[176:179], v[76:79], v[56:59]
  v_permlane16_swap_b32 v26, v38
  v_mfma_f32_16x16x32_bf16 v[48:51], v[180:183], v[72:75], v[48:51]
  v_permlane16_swap_b32 v27, v39
  v_mfma_f32_16x16x32_bf16 v[60:63], v[180:183], v[76:79], v[60:63]
  s_cbranch_vccz Lsckd_70
Lsck_69:
  s_add_u32 s55, s62, 0
  buffer_load_dwordx4 v[8:11], v7, s[4:7], s55 offen sc1
  s_waitcnt vmcnt(0)
  v_bitop3_b32 v10, v10, v11, v1 bitop3:0x7e
  v_cmp_ne_u32 vcc, 0, v10
  s_nop 1
  s_nop 1
  s_cbranch_vccnz Lsck_69
Lsckd_70:
  buffer_inv sc1
  s_waitcnt vmcnt(0)
  s_waitcnt lgkmcnt(2)
  v_mfma_f32_16x16x32_bf16 v[40:43], v[184:187], v[80:83], v[40:43]
  ds_read_b128 v[72:75], v5 offset:8192
  s_add_u32 m0, s53, 12288
  v_mfma_f32_16x16x32_bf16 v[52:55], v[184:187], v[84:87], v[52:55]
  ds_read_b128 v[76:79], v5 offset:28672
  s_add_u32 s48, s61, 53248
  v_mfma_f32_16x16x32_bf16 v[44:47], v[188:191], v[80:83], v[44:47]
  buffer_load_dwordx4 v2, s[4:7], s48 offen offset:0 sc1 lds
  v_fmac_f32 v16, v8, v88
  v_mfma_f32_16x16x32_bf16 v[56:59], v[188:191], v[84:87], v[56:59]
  v_fmac_f32 v17, v8, v89
  v_fmac_f32 v18, v8, v90
  v_mfma_f32_16x16x32_bf16 v[48:51], v[192:195], v[80:83], v[48:51]
  v_fmac_f32 v19, v8, v91
  v_fmac_f32 v20, v8, v92
  v_mfma_f32_16x16x32_bf16 v[60:63], v[192:195], v[84:87], v[60:63]
  v_fmac_f32 v21, v8, v93
  s_waitcnt lgkmcnt(2)
  v_mfma_f32_16x16x32_bf16 v[40:43], v[196:199], v[64:67], v[40:43]
  ds_read_b128 v[80:83], v5 offset:9216
  buffer_load_dwordx4 v2, s[4:7], s48 offen offset:2048 sc1 lds
  v_mfma_f32_16x16x32_bf16 v[52:55], v[196:199], v[68:71], v[52:55]
  ds_read_b128 v[84:87], v5 offset:29696
  v_fmac_f32 v22, v8, v94
  v_mfma_f32_16x16x32_bf16 v[44:47], v[200:203], v[64:67], v[44:47]
  v_fmac_f32 v23, v8, v95
  v_fmac_f32 v24, v8, v96
  v_mfma_f32_16x16x32_bf16 v[56:59], v[200:203], v[68:71], v[56:59]
  v_fmac_f32 v25, v8, v97
  v_fmac_f32 v26, v8, v98
  v_mfma_f32_16x16x32_bf16 v[48:51], v[204:207], v[64:67], v[48:51]
  v_fmac_f32 v27, v8, v99
  v_fmac_f32 v28, v8, v100
  v_mfma_f32_16x16x32_bf16 v[60:63], v[204:207], v[68:71], v[60:63]
  v_fmac_f32 v29, v8, v101
  s_waitcnt lgkmcnt(2)
  v_mfma_f32_16x16x32_bf16 v[40:43], v[208:211], v[72:75], v[40:43]
  ds_read_b128 v[64:67], v5 offset:10240
  s_add_u32 m0, s53, 16384
  v_mfma_f32_16x16x32_bf16 v[52:55], v[208:211], v[76:79], v[52:55]
  ds_read_b128 v[68:71], v5 offset:30720
  s_add_u32 s48, s61, 57344
  v_mfma_f32_16x16x32_bf16 v[44:47], v[212:215], v[72:75], v[44:47]
  buffer_load_dwordx4 v2, s[4:7], s48 offen offset:0 sc1 lds
  v_fmac_f32 v30, v8, v102
  v_mfma_f32_16x16x32_bf16 v[56:59], v[212:215], v[76:79], v[56:59]
  v_fmac_f32 v31, v8, v103
  v_fmac_f32 v32, v8, v104
  v_mfma_f32_16x16x32_bf16 v[48:51], v[216:219], v[72:75], v[48:51]
  v_fmac_f32 v33, v8, v105
  v_fmac_f32 v34, v8, v106
  v_mfma_f32_16x16x32_bf16 v[60:63], v[216:219], v[76:79], v[60:63]
  v_fmac_f32 v35, v8, v107
  s_waitcnt lgkmcnt(2)
  v_mfma_f32_16x16x32_bf16 v[40:43], v[220:223], v[80:83], v[40:43]
  ds_read_b128 v[72:75], v5 offset:11264
  buffer_load_dwordx4 v2, s[4:7], s48 offen offset:2048 sc1 lds
  v_mfma_f32_16x16x32_bf16 v[52:55], v[220:223], v[84:87], v[52:55]
  ds_read_b128 v[76:79], v5 offset:31744
  v_fmac_f32 v36, v8, v108
  v_mfma_f32_16x16x32_bf16 v[44:47], v[224:227], v[80:83], v[44:47]
  v_fmac_f32 v37, v8, v109
  v_fmac_f32 v38, v8, v110
  v_mfma_f32_16x16x32_bf16 v[56:59], v[224:227], v[84:87], v[56:59]
  v_fmac_f32 v39, v8, v111
  v_max_f32 v16, 0, v16
  v_mfma_f32_16x16x32_bf16 v[48:51], v[228:231], v[80:83], v[48:51]
  v_mul_f32 v28, v9, v28
  v_max_f32 v17, 0, v17
  v_mfma_f32_16x16x32_bf16 v[60:63], v[228:231], v[84:87], v[60:63]
  v_mul_f32 v29, v9, v29
  s_waitcnt lgkmcnt(2)
  v_mfma_f32_16x16x32_bf16 v[40:43], v[232:235], v[64:67], v[40:43]
  ds_read_b128 v[80:83], v5 offset:12288
  v_max_f32 v18, 0, v18
  v_mfma_f32_16x16x32_bf16 v[52:55], v[232:235], v[68:71], v[52:55]
  ds_read_b128 v[84:87], v5 offset:32768
  v_mul_f32 v30, v9, v30
  v_mfma_f32_16x16x32_bf16 v[44:47], v[236:239], v[64:67], v[44:47]
  v_max_f32 v19, 0, v19
  v_mul_f32 v31, v9, v31
  v_mfma_f32_16x16x32_bf16 v[56:59], v[236:239], v[68:71], v[56:59]
  v_max_f32 v20, 0, v20
  v_mul_f32 v32, v9, v32
  v_mfma_f32_16x16x32_bf16 v[48:51], v[240:243], v[64:67], v[48:51]
  v_max_f32 v21, 0, v21
  v_mul_f32 v33, v9, v33
  v_mfma_f32_16x16x32_bf16 v[60:63], v[240:243], v[68:71], v[60:63]
  v_max_f32 v22, 0, v22
  s_waitcnt lgkmcnt(2)
  v_mfma_f32_16x16x32_bf16 v[40:43], v[244:247], v[72:75], v[40:43]
  ds_read_b128 v[64:67], v5 offset:13312
  v_mul_f32 v34, v9, v34
  v_mfma_f32_16x16x32_bf16 v[52:55], v[244:247], v[76:79], v[52:55]
  ds_read_b128 v[68:71], v5 offset:33792
  v_max_f32 v23, 0, v23
  v_mfma_f32_16x16x32_bf16 v[44:47], v[248:251], v[72:75], v[44:47]
  v_mul_f32 v35, v9, v35
  v_max_f32 v24, 0, v24
  v_mfma_f32_16x16x32_bf16 v[56:59], v[248:251], v[76:79], v[56:59]
  v_mul_f32 v36, v9, v36
  v_max_f32 v25, 0, v25
  v_mfma_f32_16x16x32_bf16 v[48:51], v[252:255], v[72:75], v[48:51]
  v_mul_f32 v37, v9, v37
  v_max_f32 v26, 0, v26
  v_mfma_f32_16x16x32_bf16 v[60:63], v[252:255], v[76:79], v[60:63]
  v_mul_f32 v38, v9, v38
  s_waitcnt lgkmcnt(2)
  v_mfma_f32_16x16x32_bf16 v[40:43], a[0:3], v[80:83], v[40:43]
  ds_read_b128 v[72:75], v5 offset:14336
  s_add_u32 s55, s62, 1024
  v_mfma_f32_16x16x32_bf16 v[52:55], a[0:3], v[84:87], v[52:55]
  ds_read_b128 v[76:79], v5 offset:34816
  buffer_load_dwordx4 v[12:15], v7, s[4:7], s55 offen sc1
  v_mfma_f32_16x16x32_bf16 v[44:47], a[4:7], v[80:83], v[44:47]
  v_max_f32 v27, 0, v27
  v_mul_f32 v39, v9, v39
  v_mfma_f32_16x16x32_bf16 v[56:59], a[4:7], v[84:87], v[56:59]
  v_mul_f32 v16, v16, v28
  v_mul_f32 v17, v17, v29
  v_mfma_f32_16x16x32_bf16 v[48:51], a[8:11], v[80:83], v[48:51]
  v_mul_f32 v18, v18, v30
  v_mul_f32 v19, v19, v31
  v_mfma_f32_16x16x32_bf16 v[60:63], a[8:11], v[84:87], v[60:63]
  v_mul_f32 v20, v20, v32
  s_waitcnt lgkmcnt(2)
  v_mfma_f32_16x16x32_bf16 v[40:43], a[12:15], v[64:67], v[40:43]
  ds_read_b128 v[80:83], v5 offset:15360
  v_mul_f32 v21, v21, v33
  v_mfma_f32_16x16x32_bf16 v[52:55], a[12:15], v[68:71], v[52:55]
  ds_read_b128 v[84:87], v5 offset:35840
  v_mul_f32 v22, v22, v34
  v_mfma_f32_16x16x32_bf16 v[44:47], a[16:19], v[64:67], v[44:47]
  v_mul_f32 v23, v23, v35
  v_mul_f32 v24, v24, v36
  v_mfma_f32_16x16x32_bf16 v[56:59], a[16:19], v[68:71], v[56:59]
  v_mul_f32 v25, v25, v37
  v_mul_f32 v26, v26, v38
  v_mfma_f32_16x16x32_bf16 v[48:51], a[20:23], v[64:67], v[48:51]
  v_mul_f32 v27, v27, v39
  v_cvt_pk_bf16_f32 v28, v16, v17
  v_mfma_f32_16x16x32_bf16 v[60:63], a[20:23], v[68:71], v[60:63]
  v_cvt_pk_bf16_f32 v29, v18, v19
  s_waitcnt lgkmcnt(2)
  v_mfma_f32_16x16x32_bf16 v[40:43], a[24:27], v[72:75], v[40:43]
  ds_read_b128 v[64:67], v5 offset:16384
  v_cvt_pk_bf16_f32 v30, v20, v21
  v_mfma_f32_16x16x32_bf16 v[52:55], a[24:27], v[76:79], v[52:55]
  ds_read_b128 v[68:71], v5 offset:36864
  v_cvt_pk_bf16_f32 v31, v22, v23
  v_mfma_f32_16x16x32_bf16 v[44:47], a[28:31], v[72:75], v[44:47]
  v_cvt_pk_bf16_f32 v32, v24, v25
  v_cvt_pk_bf16_f32 v33, v26, v27
  v_mfma_f32_16x16x32_bf16 v[56:59], a[28:31], v[76:79], v[56:59]
  s_add_u32 s49, s52, 0
  buffer_store_dwordx4 v[28:31], v3, s[4:7], s49 offen sc1
  v_mfma_f32_16x16x32_bf16 v[48:51], a[32:35], v[72:75], v[48:51]
  buffer_store_dwordx2 v[32:33], v4, s[4:7], s49 offen sc1
  v_mfma_f32_16x16x32_bf16 v[60:63], a[32:35], v[76:79], v[60:63]
  s_waitcnt lgkmcnt(2)
  v_mfma_f32_16x16x32_bf16 v[40:43], a[36:39], v[80:83], v[40:43]
  ds_read_b128 v[72:75], v5 offset:17408
  v_mfma_f32_16x16x32_bf16 v[52:55], a[36:39], v[84:87], v[52:55]
  ds_read_b128 v[76:79], v5 offset:37888
  v_mfma_f32_16x16x32_bf16 v[44:47], a[40:43], v[80:83], v[44:47]
  v_mfma_f32_16x16x32_bf16 v[56:59], a[40:43], v[84:87], v[56:59]
  v_mfma_f32_16x16x32_bf16 v[48:51], a[44:47], v[80:83], v[48:51]
  v_mfma_f32_16x16x32_bf16 v[60:63], a[44:47], v[84:87], v[60:63]
  s_waitcnt lgkmcnt(2)
  v_mfma_f32_16x16x32_bf16 v[40:43], a[48:51], v[64:67], v[40:43]
  ds_read_b128 v[80:83], v5 offset:18432
  v_mfma_f32_16x16x32_bf16 v[52:55], a[48:51], v[68:71], v[52:55]
  ds_read_b128 v[84:87], v5 offset:38912
  v_mfma_f32_16x16x32_bf16 v[44:47], a[52:55], v[64:67], v[44:47]
  v_mfma_f32_16x16x32_bf16 v[56:59], a[52:55], v[68:71], v[56:59]
  v_mfma_f32_16x16x32_bf16 v[48:51], a[56:59], v[64:67], v[48:51]
  v_mfma_f32_16x16x32_bf16 v[60:63], a[56:59], v[68:71], v[60:63]
  s_waitcnt lgkmcnt(2)
  v_mfma_f32_16x16x32_bf16 v[40:43], a[60:63], v[72:75], v[40:43]
  ds_read_b128 v[64:67], v5 offset:19456
  v_mfma_f32_16x16x32_bf16 v[52:55], a[60:63], v[76:79], v[52:55]
  ds_read_b128 v[68:71], v5 offset:39936
  v_mfma_f32_16x16x32_bf16 v[44:47], a[64:67], v[72:75], v[44:47]
  v_mfma_f32_16x16x32_bf16 v[56:59], a[64:67], v[76:79], v[56:59]
  v_mfma_f32_16x16x32_bf16 v[48:51], a[68:71], v[72:75], v[48:51]
  v_mfma_f32_16x16x32_bf16 v[60:63], a[68:71], v[76:79], v[60:63]
  s_waitcnt lgkmcnt(2)
  v_mfma_f32_16x16x32_bf16 v[40:43], a[72:75], v[80:83], v[40:43]
  s_waitcnt vmcnt(3) lgkmcnt(0)
  s_barrier
  ds_read_b128 v[72:75], v2 offset:0
  v_mfma_f32_16x16x32_bf16 v[52:55], a[72:75], v[84:87], v[52:55]
  ds_read_b128 v[76:79], v2 offset:20480
  v_mfma_f32_16x16x32_bf16 v[44:47], a[76:79], v[80:83], v[44:47]
  v_mfma_f32_16x16x32_bf16 v[56:59], a[76:79], v[84:87], v[56:59]
  v_mfma_f32_16x16x32_bf16 v[48:51], a[80:83], v[80:83], v[48:51]
  v_mfma_f32_16x16x32_bf16 v[60:63], a[80:83], v[84:87], v[60:63]
  s_waitcnt lgkmcnt(2)
  v_mfma_f32_16x16x32_bf16 v[40:43], a[84:87], v[64:67], v[40:43]
  ds_read_b128 v[80:83], v2 offset:1024
  v_mfma_f32_16x16x32_bf16 v[52:55], a[84:87], v[68:71], v[52:55]
  ds_read_b128 v[84:87], v2 offset:21504
  v_mfma_f32_16x16x32_bf16 v[44:47], a[88:91], v[64:67], v[44:47]
  v_mfma_f32_16x16x32_bf16 v[56:59], a[88:91], v[68:71], v[56:59]
  v_mfma_f32_16x16x32_bf16 v[48:51], a[92:95], v[64:67], v[48:51]
  v_mfma_f32_16x16x32_bf16 v[60:63], a[92:95], v[68:71], v[60:63]
  s_waitcnt lgkmcnt(2)
  v_mfma_f32_16x16x32_bf16 v[16:19], v[112:115], v[72:75], 0
  ds_read_b128 v[64:67], v2 offset:2048
  v_mfma_f32_16x16x32_bf16 v[28:31], v[112:115], v[76:79], 0
  ds_read_b128 v[68:71], v2 offset:22528
  v_mfma_f32_16x16x32_bf16 v[20:23], v[116:119], v[72:75], 0
  v_mfma_f32_16x16x32_bf16 v[32:35], v[116:119], v[76:79], 0
  v_mfma_f32_16x16x32_bf16 v[24:27], v[120:123], v[72:75], 0
  v_mfma_f32_16x16x32_bf16 v[36:39], v[120:123], v[76:79], 0
  s_waitcnt lgkmcnt(2)
  v_mfma_f32_16x16x32_bf16 v[16:19], v[124:127], v[80:83], v[16:19]
  ds_read_b128 v[72:75], v2 offset:3072
  v_mfma_f32_16x16x32_bf16 v[28:31], v[124:127], v[84:87], v[28:31]
  ds_read_b128 v[76:79], v2 offset:23552
  v_mfma_f32_16x16x32_bf16 v[20:23], v[128:131], v[80:83], v[20:23]
  v_permlane16_swap_b32 v40, v52
  v_mfma_f32_16x16x32_bf16 v[32:35], v[128:131], v[84:87], v[32:35]
  v_permlane16_swap_b32 v41, v53
  v_mfma_f32_16x16x32_bf16 v[24:27], v[132:135], v[80:83], v[24:27]
  v_permlane16_swap_b32 v42, v54
  v_mfma_f32_16x16x32_bf16 v[36:39], v[132:135], v[84:87], v[36:39]
  s_waitcnt lgkmcnt(2)
  v_mfma_f32_16x16x32_bf16 v[16:19], v[136:139], v[64:67], v[16:19]
  ds_read_b128 v[80:83], v2 offset:4096
  v_mfma_f32_16x16x32_bf16 v[28:31], v[136:139], v[68:71], v[28:31]
  ds_read_b128 v[84:87], v2 offset:24576
  v_mfma_f32_16x16x32_bf16 v[20:23], v[140:143], v[64:67], v[20:23]
  v_permlane16_swap_b32 v43, v55
  v_mfma_f32_16x16x32_bf16 v[32:35], v[140:143], v[68:71], v[32:35]
  v_permlane16_swap_b32 v44, v56
  v_mfma_f32_16x16x32_bf16 v[24:27], v[144:147], v[64:67], v[24:27]
  v_permlane16_swap_b32 v45, v57
  v_mfma_f32_16x16x32_bf16 v[36:39], v[144:147], v[68:71], v[36:39]
  s_waitcnt lgkmcnt(2)
  v_mfma_f32_16x16x32_bf16 v[16:19], v[148:151], v[72:75], v[16:19]
  ds_read_b128 v[64:67], v2 offset:5120
  v_mfma_f32_16x16x32_bf16 v[28:31], v[148:151], v[76:79], v[28:31]
  ds_read_b128 v[68:71], v2 offset:25600
  v_mfma_f32_16x16x32_bf16 v[20:23], v[152:155], v[72:75], v[20:23]
  v_permlane16_swap_b32 v46, v58
  v_mfma_f32_16x16x32_bf16 v[32:35], v[152:155], v[76:79], v[32:35]
  v_permlane16_swap_b32 v47, v59
  v_mfma_f32_16x16x32_bf16 v[24:27], v[156:159], v[72:75], v[24:27]
  s_waitcnt vmcnt(2)
  v_bitop3_b32 v14, v14, v15, v1 bitop3:0x7e
  v_mfma_f32_16x16x32_bf16 v[36:39], v[156:159], v[76:79], v[36:39]
  v_cmp_ne_u32 vcc, 0, v14
  s_waitcnt lgkmcnt(2)
  v_mfma_f32_16x16x32_bf16 v[16:19], v[160:163], v[80:83], v[16:19]
  ds_read_b128 v[72:75], v2 offset:6144
  v_mfma_f32_16x16x32_bf16 v[28:31], v[160:163], v[84:87], v[28:31]
  ds_read_b128 v[76:79], v2 offset:26624
  v_mfma_f32_16x16x32_bf16 v[20:23], v[164:167], v[80:83], v[20:23]
  v_permlane16_swap_b32 v48, v60
  v_mfma_f32_16x16x32_bf16 v[32:35], v[164:167], v[84:87], v[32:35]
  v_permlane16_swap_b32 v49, v61
  v_mfma_f32_16x16x32_bf16 v[24:27], v[168:171], v[80:83], v[24:27]
  v_permlane16_swap_b32 v50, v62
  v_mfma_f32_16x16x32_bf16 v[36:39], v[168:171], v[84:87], v[36:39]
  s_waitcnt lgkmcnt(2)
  v_mfma_f32_16x16x32_bf16 v[16:19], v[172:175], v[64:67], v[16:19]
  ds_read_b128 v[80:83], v2 offset:7168
  v_mfma_f32_16x16x32_bf16 v[28:31], v[172:175], v[68:71], v[28:31]
  ds_read_b128 v[84:87], v2 offset:27648
  v_mfma_f32_16x16x32_bf16 v[20:23], v[176:179], v[64:67], v[20:23]
  v_permlane16_swap_b32 v51, v63
  v_mfma_f32_16x16x32_bf16 v[32:35], v[176:179], v[68:71], v[32:35]
  s_cbranch_vccz Lsckd_72
Lsck_71:
  s_add_u32 s55, s62, 1024
  buffer_load_dwordx4 v[12:15], v7, s[4:7], s55 offen sc1
  s_waitcnt vmcnt(0)
  v_bitop3_b32 v14, v14, v15, v1 bitop3:0x7e
  v_cmp_ne_u32 vcc, 0, v14
  s_nop 1
  s_nop 1
  s_cbranch_vccnz Lsck_71
Lsckd_72:
  buffer_inv sc1
  s_waitcnt vmcnt(0)
  v_fmac_f32 v40, v12, v88
  v_mfma_f32_16x16x32_bf16 v[24:27], v[180:183], v[64:67], v[24:27]
  v_fmac_f32 v41, v12, v89
  v_fmac_f32 v42, v12, v90
  v_mfma_f32_16x16x32_bf16 v[36:39], v[180:183], v[68:71], v[36:39]
  v_fmac_f32 v43, v12, v91
  s_waitcnt lgkmcnt(2)
  v_mfma_f32_16x16x32_bf16 v[16:19], v[184:187], v[72:75], v[16:19]
  ds_read_b128 v[64:67], v2 offset:8192
  s_add_u32 m0, s53, 40960
  v_mfma_f32_16x16x32_bf16 v[28:31], v[184:187], v[76:79], v[28:31]
  ds_read_b128 v[68:71], v2 offset:28672
  s_add_u32 s48, s51, 122880
  v_mfma_f32_16x16x32_bf16 v[20:23], v[188:191], v[72:75], v[20:23]
  buffer_load_dwordx4 v2, s[4:7], s48 offen offset:0 sc1 lds
  buffer_load_dwordx4 v2, s[4:7], s48 offen offset:2048 sc1 lds
  v_mfma_f32_16x16x32_bf16 v[32:35], v[188:191], v[76:79], v[32:35]
  v_fmac_f32 v44, v12, v92
  v_fmac_f32 v45, v12, v93
  v_mfma_f32_16x16x32_bf16 v[24:27], v[192:195], v[72:75], v[24:27]
  v_fmac_f32 v46, v12, v94
  v_fmac_f32 v47, v12, v95
  v_mfma_f32_16x16x32_bf16 v[36:39], v[192:195], v[76:79], v[36:39]
  v_fmac_f32 v48, v12, v96
  s_waitcnt lgkmcnt(2)
  v_mfma_f32_16x16x32_bf16 v[16:19], v[196:199], v[80:83], v[16:19]
  ds_read_b128 v[72:75], v2 offset:9216
  s_add_u32 m0, s53, 45056
  v_mfma_f32_16x16x32_bf16 v[28:31], v[196:199], v[84:87], v[28:31]
  ds_read_b128 v[76:79], v2 offset:29696
  s_add_u32 s48, s51, 126976
  v_mfma_f32_16x16x32_bf16 v[20:23], v[200:203], v[80:83], v[20:23]
  buffer_load_dwordx4 v2, s[4:7], s48 offen offset:0 sc1 lds
  v_fmac_f32 v49, v12, v97
  v_mfma_f32_16x16x32_bf16 v[32:35], v[200:203], v[84:87], v[32:35]
  v_fmac_f32 v50, v12, v98
  v_fmac_f32 v51, v12, v99
  v_mfma_f32_16x16x32_bf16 v[24:27], v[204:207], v[80:83], v[24:27]
  v_fmac_f32 v52, v12, v100
  v_fmac_f32 v53, v12, v101
  v_mfma_f32_16x16x32_bf16 v[36:39], v[204:207], v[84:87], v[36:39]
  v_fmac_f32 v54, v12, v102
  s_waitcnt lgkmcnt(2)
  v_mfma_f32_16x16x32_bf16 v[16:19], v[208:211], v[64:67], v[16:19]
  ds_read_b128 v[80:83], v2 offset:10240
  buffer_load_dwordx4 v2, s[4:7], s48 offen offset:2048 sc1 lds
  v_mfma_f32_16x16x32_bf16 v[28:31], v[208:211], v[68:71], v[28:31]
  ds_read_b128 v[84:87], v2 offset:30720
  v_fmac_f32 v55, v12, v103
  v_mfma_f32_16x16x32_bf16 v[20:23], v[212:215], v[64:67], v[20:23]
  v_fmac_f32 v56, v12, v104
  v_fmac_f32 v57, v12, v105
  v_mfma_f32_16x16x32_bf16 v[32:35], v[212:215], v[68:71], v[32:35]
  v_fmac_f32 v58, v12, v106
  v_fmac_f32 v59, v12, v107
  v_mfma_f32_16x16x32_bf16 v[24:27], v[216:219], v[64:67], v[24:27]
  v_fmac_f32 v60, v12, v108
  v_fmac_f32 v61, v12, v109
  v_mfma_f32_16x16x32_bf16 v[36:39], v[216:219], v[68:71], v[36:39]
  v_fmac_f32 v62, v12, v110
  s_waitcnt lgkmcnt(2)
  v_mfma_f32_16x16x32_bf16 v[16:19], v[220:223], v[72:75], v[16:19]
  ds_read_b128 v[64:67], v2 offset:11264
  s_add_u32 m0, s53, 49152
  v_mfma_f32_16x16x32_bf16 v[28:31], v[220:223], v[76:79], v[28:31]
  ds_read_b128 v[68:71], v2 offset:31744
  s_add_u32 s48, s61, 131072
  v_mfma_f32_16x16x32_bf16 v[20:23], v[224:227], v[72:75], v[20:23]
  buffer_load_dwordx4 v2, s[4:7], s48 offen offset:0 sc1 lds
  v_fmac_f32 v63, v12, v111
  v_mfma_f32_16x16x32_bf16 v[32:35], v[224:227], v[76:79], v[32:35]
  v_max_f32 v40, 0, v40
  v_mul_f32 v52, v13, v52
  v_mfma_f32_16x16x32_bf16 v[24:27], v[228:231], v[72:75], v[24:27]
  v_max_f32 v41, 0, v41
  v_mul_f32 v53, v13, v53
  v_mfma_f32_16x16x32_bf16 v[36:39], v[228:231], v[76:79], v[36:39]
  v_max_f32 v42, 0, v42
  s_waitcnt lgkmcnt(2)
  v_mfma_f32_16x16x32_bf16 v[16:19], v[232:235], v[80:83], v[16:19]
  ds_read_b128 v[72:75], v2 offset:12288
  buffer_load_dwordx4 v2, s[4:7], s48 offen offset:2048 sc1 lds
  v_mfma_f32_16x16x32_bf16 v[28:31], v[232:235], v[84:87], v[28:31]
  ds_read_b128 v[76:79], v2 offset:32768
  v_mul_f32 v54, v13, v54
  v_mfma_f32_16x16x32_bf16 v[20:23], v[236:239], v[80:83], v[20:23]
  v_max_f32 v43, 0, v43
  v_mul_f32 v55, v13, v55
  v_mfma_f32_16x16x32_bf16 v[32:35], v[236:239], v[84:87], v[32:35]
  v_max_f32 v44, 0, v44
  v_mul_f32 v56, v13, v56
  v_mfma_f32_16x16x32_bf16 v[24:27], v[240:243], v[80:83], v[24:27]
  v_max_f32 v45, 0, v45
  v_mul_f32 v57, v13, v57
  v_mfma_f32_16x16x32_bf16 v[36:39], v[240:243], v[84:87], v[36:39]
  v_max_f32 v46, 0, v46
  s_waitcnt lgkmcnt(2)
  v_mfma_f32_16x16x32_bf16 v[16:19], v[244:247], v[64:67], v[16:19]
  ds_read_b128 v[80:83], v2 offset:13312
  s_add_u32 m0, s53, 53248
  v_mfma_f32_16x16x32_bf16 v[28:31], v[244:247], v[68:71], v[28:31]
  ds_read_b128 v[84:87], v2 offset:33792
  s_add_u32 s48, s61, 135168
  v_mfma_f32_16x16x32_bf16 v[20:23], v[248:251], v[64:67], v[20:23]
  buffer_load_dwordx4 v2, s[4:7], s48 offen offset:0 sc1 lds
  v_mul_f32 v58, v13, v58
  v_mfma_f32_16x16x32_bf16 v[32:35], v[248:251], v[68:71], v[32:35]
  v_max_f32 v47, 0, v47
  v_mul_f32 v59, v13, v59
  v_mfma_f32_16x16x32_bf16 v[24:27], v[252:255], v[64:67], v[24:27]
  v_max_f32 v48, 0, v48
  v_mul_f32 v60, v13, v60
  v_mfma_f32_16x16x32_bf16 v[36:39], v[252:255], v[68:71], v[36:39]
  v_max_f32 v49, 0, v49
  s_waitcnt lgkmcnt(2)
  v_mfma_f32_16x16x32_bf16 v[16:19], a[0:3], v[72:75], v[16:19]
  ds_read_b128 v[64:67], v2 offset:14336
  buffer_load_dwordx4 v2, s[4:7], s48 offen offset:2048 sc1 lds
  v_mfma_f32_16x16x32_bf16 v[28:31], a[0:3], v[76:79], v[28:31]
  ds_read_b128 v[68:71], v2 offset:34816
  v_mul_f32 v61, v13, v61
  v_mfma_f32_16x16x32_bf16 v[20:23], a[4:7], v[72:75], v[20:23]
  v_max_f32 v50, 0, v50
  v_mul_f32 v62, v13, v62
  v_mfma_f32_16x16x32_bf16 v[32:35], a[4:7], v[76:79], v[32:35]
  v_max_f32 v51, 0, v51
  v_mul_f32 v63, v13, v63
  v_mfma_f32_16x16x32_bf16 v[24:27], a[8:11], v[72:75], v[24:27]
  v_mul_f32 v40, v40, v52
  v_mul_f32 v41, v41, v53
  v_mfma_f32_16x16x32_bf16 v[36:39], a[8:11], v[76:79], v[36:39]
  v_mul_f32 v42, v42, v54
  s_waitcnt lgkmcnt(2)
  v_mfma_f32_16x16x32_bf16 v[16:19], a[12:15], v[80:83], v[16:19]
  ds_read_b128 v[72:75], v2 offset:15360
  s_add_u32 m0, s53, 57344
  v_mfma_f32_16x16x32_bf16 v[28:31], a[12:15], v[84:87], v[28:31]
  ds_read_b128 v[76:79], v2 offset:35840
  s_add_u32 s48, s61, 139264
  v_mfma_f32_16x16x32_bf16 v[20:23], a[16:19], v[80:83], v[20:23]
  buffer_load_dwordx4 v2, s[4:7], s48 offen offset:0 sc1 lds
  v_mul_f32 v43, v43, v55
  v_mfma_f32_16x16x32_bf16 v[32:35], a[16:19], v[84:87], v[32:35]
  v_mul_f32 v44, v44, v56
  v_mul_f32 v45, v45, v57
  v_mfma_f32_16x16x32_bf16 v[24:27], a[20:23], v[80:83], v[24:27]
  v_mul_f32 v46, v46, v58
  v_mul_f32 v47, v47, v59
  v_mfma_f32_16x16x32_bf16 v[36:39], a[20:23], v[84:87], v[36:39]
  v_mul_f32 v48, v48, v60
  s_waitcnt lgkmcnt(2)
  v_mfma_f32_16x16x32_bf16 v[16:19], a[24:27], v[64:67], v[16:19]
  ds_read_b128 v[80:83], v2 offset:16384
  buffer_load_dwordx4 v2, s[4:7], s48 offen offset:2048 sc1 lds
  v_mfma_f32_16x16x32_bf16 v[28:31], a[24:27], v[68:71], v[28:31]
  ds_read_b128 v[84:87], v2 offset:36864
  v_mul_f32 v49, v49, v61
  v_mfma_f32_16x16x32_bf16 v[20:23], a[28:31], v[64:67], v[20:23]
  v_mul_f32 v50, v50, v62
  v_mul_f32 v51, v51, v63
  v_mfma_f32_16x16x32_bf16 v[32:35], a[28:31], v[68:71], v[32:35]
  v_cvt_pk_bf16_f32 v52, v40, v41
  v_cvt_pk_bf16_f32 v53, v42, v43
  v_mfma_f32_16x16x32_bf16 v[24:27], a[32:35], v[64:67], v[24:27]
  v_cvt_pk_bf16_f32 v54, v44, v45
  v_cvt_pk_bf16_f32 v55, v46, v47
  v_mfma_f32_16x16x32_bf16 v[36:39], a[32:35], v[68:71], v[36:39]
  v_cvt_pk_bf16_f32 v56, v48, v49
  s_waitcnt lgkmcnt(2)
  v_mfma_f32_16x16x32_bf16 v[16:19], a[36:39], v[72:75], v[16:19]
  ds_read_b128 v[64:67], v2 offset:17408
  s_add_u32 s55, s62, 512
  v_mfma_f32_16x16x32_bf16 v[28:31], a[36:39], v[76:79], v[28:31]
  ds_read_b128 v[68:71], v2 offset:37888
  buffer_load_dwordx4 v[8:11], v7, s[4:7], s55 offen sc1
  v_mfma_f32_16x16x32_bf16 v[20:23], a[40:43], v[72:75], v[20:23]
  v_cvt_pk_bf16_f32 v57, v50, v51
  s_add_u32 s49, s52, 196608
  v_mfma_f32_16x16x32_bf16 v[32:35], a[40:43], v[76:79], v[32:35]
  buffer_store_dwordx4 v[52:55], v3, s[4:7], s49 offen sc1
  buffer_store_dwordx2 v[56:57], v4, s[4:7], s49 offen sc1
  v_mfma_f32_16x16x32_bf16 v[24:27], a[44:47], v[72:75], v[24:27]
  v_mfma_f32_16x16x32_bf16 v[36:39], a[44:47], v[76:79], v[36:39]
  s_waitcnt lgkmcnt(2)
  v_mfma_f32_16x16x32_bf16 v[16:19], a[48:51], v[80:83], v[16:19]
  ds_read_b128 v[72:75], v2 offset:18432
  v_mfma_f32_16x16x32_bf16 v[28:31], a[48:51], v[84:87], v[28:31]
  ds_read_b128 v[76:79], v2 offset:38912
  v_mfma_f32_16x16x32_bf16 v[20:23], a[52:55], v[80:83], v[20:23]
  v_mfma_f32_16x16x32_bf16 v[32:35], a[52:55], v[84:87], v[32:35]
  v_mfma_f32_16x16x32_bf16 v[24:27], a[56:59], v[80:83], v[24:27]
  v_mfma_f32_16x16x32_bf16 v[36:39], a[56:59], v[84:87], v[36:39]
  s_waitcnt lgkmcnt(2)
  v_mfma_f32_16x16x32_bf16 v[16:19], a[60:63], v[64:67], v[16:19]
  ds_read_b128 v[80:83], v2 offset:19456
  v_mfma_f32_16x16x32_bf16 v[28:31], a[60:63], v[68:71], v[28:31]
  ds_read_b128 v[84:87], v2 offset:39936
  v_mfma_f32_16x16x32_bf16 v[20:23], a[64:67], v[64:67], v[20:23]
  v_mfma_f32_16x16x32_bf16 v[32:35], a[64:67], v[68:71], v[32:35]
  v_mfma_f32_16x16x32_bf16 v[24:27], a[68:71], v[64:67], v[24:27]
  v_mfma_f32_16x16x32_bf16 v[36:39], a[68:71], v[68:71], v[36:39]
  s_waitcnt lgkmcnt(2)
  v_mfma_f32_16x16x32_bf16 v[16:19], a[72:75], v[72:75], v[16:19]
  s_waitcnt vmcnt(3) lgkmcnt(0)
  s_barrier
  ds_read_b128 v[64:67], v5 offset:0
  v_mfma_f32_16x16x32_bf16 v[28:31], a[72:75], v[76:79], v[28:31]
  ds_read_b128 v[68:71], v5 offset:20480
  v_mfma_f32_16x16x32_bf16 v[20:23], a[76:79], v[72:75], v[20:23]
  v_mfma_f32_16x16x32_bf16 v[32:35], a[76:79], v[76:79], v[32:35]
  v_mfma_f32_16x16x32_bf16 v[24:27], a[80:83], v[72:75], v[24:27]
  v_mfma_f32_16x16x32_bf16 v[36:39], a[80:83], v[76:79], v[36:39]
  s_waitcnt lgkmcnt(2)
  v_mfma_f32_16x16x32_bf16 v[16:19], a[84:87], v[80:83], v[16:19]
  ds_read_b128 v[72:75], v5 offset:1024
  v_mfma_f32_16x16x32_bf16 v[28:31], a[84:87], v[84:87], v[28:31]
  ds_read_b128 v[76:79], v5 offset:21504
  v_mfma_f32_16x16x32_bf16 v[20:23], a[88:91], v[80:83], v[20:23]
  v_mfma_f32_16x16x32_bf16 v[32:35], a[88:91], v[84:87], v[32:35]
  v_mfma_f32_16x16x32_bf16 v[24:27], a[92:95], v[80:83], v[24:27]
  v_mfma_f32_16x16x32_bf16 v[36:39], a[92:95], v[84:87], v[36:39]
  s_waitcnt lgkmcnt(2)
  v_mfma_f32_16x16x32_bf16 v[40:43], v[112:115], v[64:67], 0
  ds_read_b128 v[80:83], v5 offset:2048
  v_mfma_f32_16x16x32_bf16 v[52:55], v[112:115], v[68:71], 0
  ds_read_b128 v[84:87], v5 offset:22528
  v_mfma_f32_16x16x32_bf16 v[44:47], v[116:119], v[64:67], 0
  v_mfma_f32_16x16x32_bf16 v[56:59], v[116:119], v[68:71], 0
  v_mfma_f32_16x16x32_bf16 v[48:51], v[120:123], v[64:67], 0
  v_mfma_f32_16x16x32_bf16 v[60:63], v[120:123], v[68:71], 0
  s_waitcnt lgkmcnt(2)
  v_mfma_f32_16x16x32_bf16 v[40:43], v[124:127], v[72:75], v[40:43]
  ds_read_b128 v[64:67], v5 offset:3072
  v_mfma_f32_16x16x32_bf16 v[52:55], v[124:127], v[76:79], v[52:55]
  ds_read_b128 v[68:71], v5 offset:23552
  v_mfma_f32_16x16x32_bf16 v[44:47], v[128:131], v[72:75], v[44:47]
  v_permlane16_swap_b32 v16, v28
  v_mfma_f32_16x16x32_bf16 v[56:59], v[128:131], v[76:79], v[56:59]
  v_permlane16_swap_b32 v17, v29
  v_mfma_f32_16x16x32_bf16 v[48:51], v[132:135], v[72:75], v[48:51]
  v_permlane16_swap_b32 v18, v30
  v_mfma_f32_16x16x32_bf16 v[60:63], v[132:135], v[76:79], v[60:63]
  s_waitcnt lgkmcnt(2)
  v_mfma_f32_16x16x32_bf16 v[40:43], v[136:139], v[80:83], v[40:43]
  ds_read_b128 v[72:75], v5 offset:4096
  v_mfma_f32_16x16x32_bf16 v[52:55], v[136:139], v[84:87], v[52:55]
  ds_read_b128 v[76:79], v5 offset:24576
  v_mfma_f32_16x16x32_bf16 v[44:47], v[140:143], v[80:83], v[44:47]
  s_waitcnt vmcnt(0)
  s_add_u32 s46, s64, 32768
  s_mov_b64 exec, 1
  buffer_store_dword v1, off, s[4:7], s46 sc1
  s_mov_b64 exec, -1
  v_mfma_f32_16x16x32_bf16 v[56:59], v[140:143], v[84:87], v[56:59]
  v_permlane16_swap_b32 v19, v31
  v_mfma_f32_16x16x32_bf16 v[48:51], v[144:147], v[80:83], v[48:51]
  v_permlane16_swap_b32 v20, v32
  v_mfma_f32_16x16x32_bf16 v[60:63], v[144:147], v[84:87], v[60:63]
  s_waitcnt lgkmcnt(2)
  v_mfma_f32_16x16x32_bf16 v[40:43], v[148:151], v[64:67], v[40:43]
  ds_read_b128 v[80:83], v5 offset:5120
  v_mfma_f32_16x16x32_bf16 v[52:55], v[148:151], v[68:71], v[52:55]
  ds_read_b128 v[84:87], v5 offset:25600
  v_mfma_f32_16x16x32_bf16 v[44:47], v[152:155], v[64:67], v[44:47]
  v_permlane16_swap_b32 v21, v33
  v_mfma_f32_16x16x32_bf16 v[56:59], v[152:155], v[68:71], v[56:59]
  v_permlane16_swap_b32 v22, v34
  v_mfma_f32_16x16x32_bf16 v[48:51], v[156:159], v[64:67], v[48:51]
  v_permlane16_swap_b32 v23, v35
  v_mfma_f32_16x16x32_bf16 v[60:63], v[156:159], v[68:71], v[60:63]
  s_waitcnt vmcnt(3)
  s_waitcnt lgkmcnt(2)
  v_mfma_f32_16x16x32_bf16 v[40:43], v[160:163], v[72:75], v[40:43]
  ds_read_b128 v[64:67], v5 offset:6144
  v_bitop3_b32 v10, v10, v11, v1 bitop3:0x7e
  v_mfma_f32_16x16x32_bf16 v[52:55], v[160:163], v[76:79], v[52:55]
  ds_read_b128 v[68:71], v5 offset:26624
  v_cmp_ne_u32 vcc, 0, v10
  v_mfma_f32_16x16x32_bf16 v[44:47], v[164:167], v[72:75], v[44:47]
  v_permlane16_swap_b32 v24, v36
  v_mfma_f32_16x16x32_bf16 v[56:59], v[164:167], v[76:79], v[56:59]
  v_permlane16_swap_b32 v25, v37
  v_mfma_f32_16x16x32_bf16 v[48:51], v[168:171], v[72:75], v[48:51]
  v_permlane16_swap_b32 v26, v38
  v_mfma_f32_16x16x32_bf16 v[60:63], v[168:171], v[76:79], v[60:63]
  s_waitcnt lgkmcnt(2)
  v_mfma_f32_16x16x32_bf16 v[40:43], v[172:175], v[80:83], v[40:43]
  ds_read_b128 v[72:75], v5 offset:7168
  s_add_u32 s55, s65, 32768
  v_mfma_f32_16x16x32_bf16 v[52:55], v[172:175], v[84:87], v[52:55]
  ds_read_b128 v[76:79], v5 offset:27648
  buffer_load_dwordx4 v[12:15], v6, s[4:7], s55 offen sc1
  v_mfma_f32_16x16x32_bf16 v[44:47], v[176:179], v[80:83], v[44:47]
  v_permlane16_swap_b32 v27, v39
  v_mfma_f32_16x16x32_bf16 v[56:59], v[176:179], v[84:87], v[56:59]
  s_cbranch_vccz Lsckd_74
Lsck_73:
  s_add_u32 s55, s62, 512
  buffer_load_dwordx4 v[8:11], v7, s[4:7], s55 offen sc1
  s_waitcnt vmcnt(0)
  v_bitop3_b32 v10, v10, v11, v1 bitop3:0x7e
  v_cmp_ne_u32 vcc, 0, v10
  s_nop 1
  s_nop 1
  s_cbranch_vccnz Lsck_73
Lsckd_74:
  buffer_inv sc1
  s_waitcnt vmcnt(0)
  v_fmac_f32 v16, v8, v88
  v_mfma_f32_16x16x32_bf16 v[48:51], v[180:183], v[80:83], v[48:51]
  v_fmac_f32 v17, v8, v89
  v_fmac_f32 v18, v8, v90
  v_mfma_f32_16x16x32_bf16 v[60:63], v[180:183], v[84:87], v[60:63]
  v_fmac_f32 v19, v8, v91
  s_waitcnt lgkmcnt(2)
  v_mfma_f32_16x16x32_bf16 v[40:43], v[184:187], v[64:67], v[40:43]
  ds_read_b128 v[80:83], v5 offset:8192
  v_fmac_f32 v20, v8, v92
  v_mfma_f32_16x16x32_bf16 v[52:55], v[184:187], v[68:71], v[52:55]
  ds_read_b128 v[84:87], v5 offset:28672
  v_fmac_f32 v21, v8, v93
  v_mfma_f32_16x16x32_bf16 v[44:47], v[188:191], v[64:67], v[44:47]
  v_fmac_f32 v22, v8, v94
  v_fmac_f32 v23, v8, v95
  v_mfma_f32_16x16x32_bf16 v[56:59], v[188:191], v[68:71], v[56:59]
  v_fmac_f32 v24, v8, v96
  v_fmac_f32 v25, v8, v97
  v_mfma_f32_16x16x32_bf16 v[48:51], v[192:195], v[64:67], v[48:51]
  v_fmac_f32 v26, v8, v98
  v_fmac_f32 v27, v8, v99
  v_mfma_f32_16x16x32_bf16 v[60:63], v[192:195], v[68:71], v[60:63]
  v_fmac_f32 v28, v8, v100
  s_waitcnt lgkmcnt(2)
  v_mfma_f32_16x16x32_bf16 v[40:43], v[196:199], v[72:75], v[40:43]
  ds_read_b128 v[64:67], v5 offset:9216
  v_fmac_f32 v29, v8, v101
  v_mfma_f32_16x16x32_bf16 v[52:55], v[196:199], v[76:79], v[52:55]
  ds_read_b128 v[68:71], v5 offset:29696
  v_fmac_f32 v30, v8, v102
  v_mfma_f32_16x16x32_bf16 v[44:47], v[200:203], v[72:75], v[44:47]
  v_fmac_f32 v31, v8, v103
  v_fmac_f32 v32, v8, v104
  v_mfma_f32_16x16x32_bf16 v[56:59], v[200:203], v[76:79], v[56:59]
  v_fmac_f32 v33, v8, v105
  v_fmac_f32 v34, v8, v106
  v_mfma_f32_16x16x32_bf16 v[48:51], v[204:207], v[72:75], v[48:51]
  v_fmac_f32 v35, v8, v107
  v_fmac_f32 v36, v8, v108
  v_mfma_f32_16x16x32_bf16 v[60:63], v[204:207], v[76:79], v[60:63]
  v_fmac_f32 v37, v8, v109
  s_waitcnt lgkmcnt(2)
  v_mfma_f32_16x16x32_bf16 v[40:43], v[208:211], v[80:83], v[40:43]
  ds_read_b128 v[72:75], v5 offset:10240
  v_fmac_f32 v38, v8, v110
  v_mfma_f32_16x16x32_bf16 v[52:55], v[208:211], v[84:87], v[52:55]
  ds_read_b128 v[76:79], v5 offset:30720
  v_fmac_f32 v39, v8, v111
  v_mfma_f32_16x16x32_bf16 v[44:47], v[212:215], v[80:83], v[44:47]
  s_waitcnt vmcnt(0)
  v_bitop3_b32 v12, v12, v13, v1 bitop3:0x7e
  v_mfma_f32_16x16x32_bf16 v[56:59], v[212:215], v[84:87], v[56:59]
  v_bitop3_b32 v14, v14, v15, v1 bitop3:0x7e
  v_or_b32 v12, v12, v14
  v_mfma_f32_16x16x32_bf16 v[48:51], v[216:219], v[80:83], v[48:51]
  v_cmp_ne_u32 vcc, 0, v12
  v_max_f32 v16, 0, v16
  v_mfma_f32_16x16x32_bf16 v[60:63], v[216:219], v[84:87], v[60:63]
  v_mul_f32 v28, v9, v28
  s_waitcnt lgkmcnt(2)
  v_mfma_f32_16x16x32_bf16 v[40:43], v[220:223], v[64:67], v[40:43]
  ds_read_b128 v[80:83], v5 offset:11264
  s_cbranch_vccz Lsckd_76
Lsck_75:
  s_add_u32 s55, s65, 32768
  buffer_load_dwordx4 v[12:15], v6, s[4:7], s55 offen sc1
  s_waitcnt vmcnt(0)
  v_bitop3_b32 v12, v12, v13, v1 bitop3:0x7e
  v_bitop3_b32 v14, v14, v15, v1 bitop3:0x7e
  v_or_b32 v12, v12, v14
  v_cmp_ne_u32 vcc, 0, v12
  s_nop 1
  s_nop 1
  s_cbranch_vccnz Lsck_75
Lsckd_76:
  buffer_inv sc1
  s_waitcnt vmcnt(0)
  v_mfma_f32_16x16x32_bf16 v[52:55], v[220:223], v[68:71], v[52:55]
  ds_read_b128 v[84:87], v5 offset:31744
  v_mfma_f32_16x16x32_bf16 v[44:47], v[224:227], v[64:67], v[44:47]
  v_max_f32 v17, 0, v17
  v_mul_f32 v29, v9, v29
  v_mfma_f32_16x16x32_bf16 v[56:59], v[224:227], v[68:71], v[56:59]
  v_max_f32 v18, 0, v18
  v_mul_f32 v30, v9, v30
  v_mfma_f32_16x16x32_bf16 v[48:51], v[228:231], v[64:67], v[48:51]
  v_max_f32 v19, 0, v19
  v_mul_f32 v31, v9, v31
  v_mfma_f32_16x16x32_bf16 v[60:63], v[228:231], v[68:71], v[60:63]
  v_max_f32 v20, 0, v20
  s_waitcnt lgkmcnt(2)
  v_mfma_f32_16x16x32_bf16 v[40:43], v[232:235], v[72:75], v[40:43]
  ds_read_b128 v[64:67], v5 offset:12288
  s_add_u32 s55, s62, 1536
  buffer_load_dwordx4 v[12:15], v7, s[4:7], s55 offen sc1
  v_mfma_f32_16x16x32_bf16 v[52:55], v[232:235], v[76:79], v[52:55]
  ds_read_b128 v[68:71], v5 offset:32768
  s_add_u32 m0, s60, 0
  v_mfma_f32_16x16x32_bf16 v[44:47], v[236:239], v[72:75], v[44:47]
  s_add_u32 s48, s59, 0
  buffer_load_dwordx4 v2, s[4:7], s48 offen offset:0 sc1 lds
  v_mfma_f32_16x16x32_bf16 v[56:59], v[236:239], v[76:79], v[56:59]
  buffer_load_dwordx4 v2, s[4:7], s48 offen offset:1024 sc1 lds
  v_mul_f32 v32, v9, v32
  v_mfma_f32_16x16x32_bf16 v[48:51], v[240:243], v[72:75], v[48:51]
  v_max_f32 v21, 0, v21
  v_mul_f32 v33, v9, v33
  v_mfma_f32_16x16x32_bf16 v[60:63], v[240:243], v[76:79], v[60:63]
  v_max_f32 v22, 0, v22
  s_waitcnt lgkmcnt(2)
  v_mfma_f32_16x16x32_bf16 v[40:43], v[244:247], v[80:83], v[40:43]
  ds_read_b128 v[72:75], v5 offset:13312
  buffer_load_dwordx4 v2, s[4:7], s48 offen offset:2048 sc1 lds
  buffer_load_dwordx4 v2, s[4:7], s48 offen offset:3072 sc1 lds
  v_mfma_f32_16x16x32_bf16 v[52:55], v[244:247], v[84:87], v[52:55]
  ds_read_b128 v[76:79], v5 offset:33792
  v_mul_f32 v34, v9, v34
  v_mfma_f32_16x16x32_bf16 v[44:47], v[248:251], v[80:83], v[44:47]
  v_max_f32 v23, 0, v23
  v_mul_f32 v35, v9, v35
  v_mfma_f32_16x16x32_bf16 v[56:59], v[248:251], v[84:87], v[56:59]
  v_max_f32 v24, 0, v24
  v_mul_f32 v36, v9, v36
  v_mfma_f32_16x16x32_bf16 v[48:51], v[252:255], v[80:83], v[48:51]
  v_max_f32 v25, 0, v25
  v_mul_f32 v37, v9, v37
  v_mfma_f32_16x16x32_bf16 v[60:63], v[252:255], v[84:87], v[60:63]
  v_max_f32 v26, 0, v26
  s_waitcnt lgkmcnt(2)
  v_mfma_f32_16x16x32_bf16 v[40:43], a[0:3], v[64:67], v[40:43]
  ds_read_b128 v[80:83], v5 offset:14336
  s_add_u32 m0, s60, 4096
  v_mfma_f32_16x16x32_bf16 v[52:55], a[0:3], v[68:71], v[52:55]
  ds_read_b128 v[84:87], v5 offset:34816
  s_add_u32 s48, s59, 8192
  v_mfma_f32_16x16x32_bf16 v[44:47], a[4:7], v[64:67], v[44:47]
  buffer_load_dwordx4 v2, s[4:7], s48 offen offset:0 sc1 lds
  v_mul_f32 v38, v9, v38
  v_mfma_f32_16x16x32_bf16 v[56:59], a[4:7], v[68:71], v[56:59]
  v_max_f32 v27, 0, v27
  v_mul_f32 v39, v9, v39
  v_mfma_f32_16x16x32_bf16 v[48:51], a[8:11], v[64:67], v[48:51]
  v_mul_f32 v16, v16, v28
  v_mul_f32 v17, v17, v29
  v_mfma_f32_16x16x32_bf16 v[60:63], a[8:11], v[68:71], v[60:63]
  v_mul_f32 v18, v18, v30
  s_waitcnt lgkmcnt(2)
  v_mfma_f32_16x16x32_bf16 v[40:43], a[12:15], v[72:75], v[40:43]
  ds_read_b128 v[64:67], v5 offset:15360
  buffer_load_dwordx4 v2, s[4:7], s48 offen offset:1024 sc1 lds
  v_mfma_f32_16x16x32_bf16 v[52:55], a[12:15], v[76:79], v[52:55]
  ds_read_b128 v[68:71], v5 offset:35840
  v_mul_f32 v19, v19, v31
  v_mfma_f32_16x16x32_bf16 v[44:47], a[16:19], v[72:75], v[44:47]
  v_mul_f32 v20, v20, v32
  v_mul_f32 v21, v21, v33
  v_mfma_f32_16x16x32_bf16 v[56:59], a[16:19], v[76:79], v[56:59]
  v_mul_f32 v22, v22, v34
  v_mul_f32 v23, v23, v35
  v_mfma_f32_16x16x32_bf16 v[48:51], a[20:23], v[72:75], v[48:51]
  v_mul_f32 v24, v24, v36
  v_mul_f32 v25, v25, v37
  v_mfma_f32_16x16x32_bf16 v[60:63], a[20:23], v[76:79], v[60:63]
  v_mul_f32 v26, v26, v38
  s_waitcnt lgkmcnt(2)
  v_mfma_f32_16x16x32_bf16 v[40:43], a[24:27], v[80:83], v[40:43]
  ds_read_b128 v[72:75], v5 offset:16384
  buffer_load_dwordx4 v2, s[4:7], s48 offen offset:2048 sc1 lds
  v_mfma_f32_16x16x32_bf16 v[52:55], a[24:27], v[84:87], v[52:55]
  ds_read_b128 v[76:79], v5 offset:36864
  v_mul_f32 v27, v27, v39
  v_mfma_f32_16x16x32_bf16 v[44:47], a[28:31], v[80:83], v[44:47]
  v_cvt_pk_bf16_f32 v28, v16, v17
  v_cvt_pk_bf16_f32 v29, v18, v19
  v_mfma_f32_16x16x32_bf16 v[56:59], a[28:31], v[84:87], v[56:59]
  v_cvt_pk_bf16_f32 v30, v20, v21
  v_cvt_pk_bf16_f32 v31, v22, v23
  v_mfma_f32_16x16x32_bf16 v[48:51], a[32:35], v[80:83], v[48:51]
  v_cvt_pk_bf16_f32 v32, v24, v25
  v_cvt_pk_bf16_f32 v33, v26, v27
  v_mfma_f32_16x16x32_bf16 v[60:63], a[32:35], v[84:87], v[60:63]
  s_add_u32 s49, s52, 98304
  s_waitcnt lgkmcnt(2)
  v_mfma_f32_16x16x32_bf16 v[40:43], a[36:39], v[64:67], v[40:43]
  ds_read_b128 v[80:83], v5 offset:17408
  s_add_u32 m0, s60, 7168
  v_mfma_f32_16x16x32_bf16 v[52:55], a[36:39], v[68:71], v[52:55]
  ds_read_b128 v[84:87], v5 offset:37888
  s_add_u32 s48, s59, 4096
  v_mfma_f32_16x16x32_bf16 v[44:47], a[40:43], v[64:67], v[44:47]
  buffer_load_dwordx4 v2, s[4:7], s48 offen offset:0 sc1 lds
  buffer_store_dwordx4 v[28:31], v3, s[4:7], s49 offen sc1
  v_mfma_f32_16x16x32_bf16 v[56:59], a[40:43], v[68:71], v[56:59]
  buffer_store_dwordx2 v[32:33], v4, s[4:7], s49 offen sc1
  v_mfma_f32_16x16x32_bf16 v[48:51], a[44:47], v[64:67], v[48:51]
  v_mfma_f32_16x16x32_bf16 v[60:63], a[44:47], v[68:71], v[60:63]
  s_waitcnt lgkmcnt(2)
  v_mfma_f32_16x16x32_bf16 v[40:43], a[48:51], v[72:75], v[40:43]
  ds_read_b128 v[64:67], v5 offset:18432
  buffer_load_dwordx4 v2, s[4:7], s48 offen offset:1024 sc1 lds
  v_mfma_f32_16x16x32_bf16 v[52:55], a[48:51], v[76:79], v[52:55]
  ds_read_b128 v[68:71], v5 offset:38912
  v_mfma_f32_16x16x32_bf16 v[44:47], a[52:55], v[72:75], v[44:47]
  v_mfma_f32_16x16x32_bf16 v[56:59], a[52:55], v[76:79], v[56:59]
  v_mfma_f32_16x16x32_bf16 v[48:51], a[56:59], v[72:75], v[48:51]
  v_mfma_f32_16x16x32_bf16 v[60:63], a[56:59], v[76:79], v[60:63]
  s_waitcnt lgkmcnt(2)
  v_mfma_f32_16x16x32_bf16 v[40:43], a[60:63], v[80:83], v[40:43]
  ds_read_b128 v[72:75], v5 offset:19456
  v_mfma_f32_16x16x32_bf16 v[52:55], a[60:63], v[84:87], v[52:55]
  ds_read_b128 v[76:79], v5 offset:39936
  v_mfma_f32_16x16x32_bf16 v[44:47], a[64:67], v[80:83], v[44:47]
  v_mfma_f32_16x16x32_bf16 v[56:59], a[64:67], v[84:87], v[56:59]
  v_mfma_f32_16x16x32_bf16 v[48:51], a[68:71], v[80:83], v[48:51]
  v_mfma_f32_16x16x32_bf16 v[60:63], a[68:71], v[84:87], v[60:63]
  s_waitcnt lgkmcnt(2)
  v_mfma_f32_16x16x32_bf16 v[40:43], a[72:75], v[64:67], v[40:43]
  s_waitcnt vmcnt(11)
  v_bitop3_b32 v14, v14, v15, v1 bitop3:0x7e
  v_mfma_f32_16x16x32_bf16 v[52:55], a[72:75], v[68:71], v[52:55]
  v_cmp_ne_u32 vcc, 0, v14
  v_add_u32 v8, s60, v2
  v_mfma_f32_16x16x32_bf16 v[44:47], a[76:79], v[64:67], v[44:47]
  s_nop 0
  s_nop 0
  s_cbranch_vccz Lsckd_78
Lsck_77:
  s_add_u32 s55, s62, 1536
  buffer_load_dwordx4 v[12:15], v7, s[4:7], s55 offen sc1
  s_waitcnt vmcnt(0)
  v_bitop3_b32 v14, v14, v15, v1 bitop3:0x7e
  v_cmp_ne_u32 vcc, 0, v14
  s_nop 1
  s_nop 1
  s_cbranch_vccnz Lsck_77
Lsckd_78:
  buffer_inv sc1
  s_waitcnt vmcnt(0)
  v_mfma_f32_16x16x32_bf16 v[56:59], a[76:79], v[68:71], v[56:59]
  v_add_u32 v7, s56, v2
  v_mfma_f32_16x16x32_bf16 v[48:51], a[80:83], v[64:67], v[48:51]
  v_mfma_f32_16x16x32_bf16 v[60:63], a[80:83], v[68:71], v[60:63]
  s_waitcnt lgkmcnt(0)
  v_mfma_f32_16x16x32_bf16 v[40:43], a[84:87], v[72:75], v[40:43]
  v_mfma_f32_16x16x32_bf16 v[52:55], a[84:87], v[76:79], v[52:55]
  v_mfma_f32_16x16x32_bf16 v[44:47], a[88:91], v[72:75], v[44:47]
  v_mfma_f32_16x16x32_bf16 v[56:59], a[88:91], v[76:79], v[56:59]
  v_mfma_f32_16x16x32_bf16 v[48:51], a[92:95], v[72:75], v[48:51]
  v_mfma_f32_16x16x32_bf16 v[60:63], a[92:95], v[76:79], v[60:63]
  s_waitcnt vmcnt(9)
  ds_read_b128 v[64:67], v8 offset:0
  ds_read_b128 v[68:71], v8 offset:1024
  s_nop 0
  v_permlane16_swap_b32 v40, v52
  v_permlane16_swap_b32 v41, v53
  v_permlane16_swap_b32 v42, v54
  v_permlane16_swap_b32 v43, v55
  v_permlane16_swap_b32 v44, v56
  v_permlane16_swap_b32 v45, v57
  v_permlane16_swap_b32 v46, v58
  v_permlane16_swap_b32 v47, v59
  v_permlane16_swap_b32 v48, v60
  v_permlane16_swap_b32 v49, v61
  v_permlane16_swap_b32 v50, v62
  v_permlane16_swap_b32 v51, v63
  v_pk_fma_f32 v[40:41], v[88:89], v[12:13], v[40:41] op_sel_hi:[1,0,1]
  v_pk_fma_f32 v[42:43], v[90:91], v[12:13], v[42:43] op_sel_hi:[1,0,1]
  v_pk_fma_f32 v[44:45], v[92:93], v[12:13], v[44:45] op_sel_hi:[1,0,1]
  v_pk_fma_f32 v[46:47], v[94:95], v[12:13], v[46:47] op_sel_hi:[1,0,1]
  v_pk_fma_f32 v[48:49], v[96:97], v[12:13], v[48:49] op_sel_hi:[1,0,1]
  v_pk_fma_f32 v[50:51], v[98:99], v[12:13], v[50:51] op_sel_hi:[1,0,1]
  v_pk_fma_f32 v[52:53], v[100:101], v[12:13], v[52:53] op_sel_hi:[1,0,1]
  v_pk_fma_f32 v[54:55], v[102:103], v[12:13], v[54:55] op_sel_hi:[1,0,1]
  v_pk_fma_f32 v[56:57], v[104:105], v[12:13], v[56:57] op_sel_hi:[1,0,1]
  v_pk_fma_f32 v[58:59], v[106:107], v[12:13], v[58:59] op_sel_hi:[1,0,1]
  v_pk_fma_f32 v[60:61], v[108:109], v[12:13], v[60:61] op_sel_hi:[1,0,1]
  v_pk_fma_f32 v[62:63], v[110:111], v[12:13], v[62:63] op_sel_hi:[1,0,1]
  v_max_f32 v40, 0, v40
  v_max_f32 v41, 0, v41
  v_max_f32 v42, 0, v42
  v_max_f32 v43, 0, v43
  v_max_f32 v44, 0, v44
  v_max_f32 v45, 0, v45
  v_max_f32 v46, 0, v46
  v_max_f32 v47, 0, v47
  v_max_f32 v48, 0, v48
  v_max_f32 v49, 0, v49
  v_max_f32 v50, 0, v50
  v_max_f32 v51, 0, v51
  v_pk_mul_f32 v[52:53], v[52:53], v[12:13] op_sel:[0,1] op_sel_hi:[1,1]
  v_pk_mul_f32 v[54:55], v[54:55], v[12:13] op_sel:[0,1] op_sel_hi:[1,1]
  v_pk_mul_f32 v[56:57], v[56:57], v[12:13] op_sel:[0,1] op_sel_hi:[1,1]
  v_pk_mul_f32 v[58:59], v[58:59], v[12:13] op_sel:[0,1] op_sel_hi:[1,1]
  v_pk_mul_f32 v[60:61], v[60:61], v[12:13] op_sel:[0,1] op_sel_hi:[1,1]
  v_pk_mul_f32 v[62:63], v[62:63], v[12:13] op_sel:[0,1] op_sel_hi:[1,1]
  v_pk_mul_f32 v[40:41], v[40:41], v[52:53]
  v_pk_mul_f32 v[42:43], v[42:43], v[54:55]
  v_pk_mul_f32 v[44:45], v[44:45], v[56:57]
  v_pk_mul_f32 v[46:47], v[46:47], v[58:59]
  v_pk_mul_f32 v[48:49], v[48:49], v[60:61]
  v_pk_mul_f32 v[50:51], v[50:51], v[62:63]
  v_cvt_pk_bf16_f32 v52, v40, v41
  v_cvt_pk_bf16_f32 v53, v42, v43
  v_cvt_pk_bf16_f32 v54, v44, v45
  v_cvt_pk_bf16_f32 v55, v46, v47
  v_cvt_pk_bf16_f32 v56, v48, v49
  v_cvt_pk_bf16_f32 v57, v50, v51
  s_add_u32 s49, s52, 294912
  buffer_store_dwordx4 v[52:55], v3, s[4:7], s49 offen sc1
  buffer_store_dwordx2 v[56:57], v4, s[4:7], s49 offen sc1
  s_add_u32 s62, s59, 4096
  buffer_load_dwordx4 v[76:79], v2, s[4:7], s62 offen offset:2048 sc1
  buffer_load_dwordx4 v[80:83], v2, s[4:7], s62 offen offset:3072 sc1
  s_add_u32 s54, s59, 8192
  buffer_load_dwordx4 v[84:87], v2, s[4:7], s54 offen offset:3072 sc1
  s_waitcnt lgkmcnt(1)
  v_mfma_f32_16x16x32_bf16 v[16:19], a[96:99], v[64:67], 0
  s_waitcnt vmcnt(11)
  ds_read_b128 v[72:75], v8 offset:4096
  s_add_u32 s60, s59, 49152
  v_mfma_f32_16x16x32_bf16 v[20:23], a[100:103], v[64:67], 0
  buffer_load_dwordx4 v[112:115], v2, s[4:7], s60 offen offset:0 sc1
  ds_read_b128 v[88:91], v7 offset:0
  ds_read_b128 v[92:95], v7 offset:1024
  v_mfma_f32_16x16x32_bf16 v[24:27], a[104:107], v[64:67], 0
  ds_read_b128 v[96:99], v7 offset:2048
  ds_read_b128 v[100:103], v7 offset:3072
  ds_read_b128 v[104:107], v7 offset:4096
  v_mfma_f32_16x16x32_bf16 v[28:31], a[108:111], v[64:67], 0
  s_lshl_b32 s48, s42, 12
  v_add_u32 v3, s48, v5
  s_lshl_b32 s48, s42, 10
  v_mfma_f32_16x16x32_bf16 v[32:35], a[112:115], v[64:67], 0
  v_add_u32 v13, s48, v5
  s_waitcnt lgkmcnt(6)
  v_mfma_f32_16x16x32_bf16 v[16:19], a[116:119], v[68:71], v[16:19]
  s_waitcnt vmcnt(14)
  ds_read_b128 v[64:67], v8 offset:2048
  buffer_load_dwordx4 v[116:119], v2, s[4:7], s60 offen offset:1024 sc1
  v_mfma_f32_16x16x32_bf16 v[20:23], a[120:123], v[68:71], v[20:23]
  v_and_b32 v4, 15, v0
  v_lshrrev_b32 v15, 4, v0
  v_mul_u32_u24 v14, 1280, v4
  v_mfma_f32_16x16x32_bf16 v[24:27], a[124:127], v[68:71], v[24:27]
  v_lshl_add_u32 v14, v15, 3, v14
  v_lshlrev_b32 v4, 4, v4
  v_and_b32 v15, 1, v15
  v_mfma_f32_16x16x32_bf16 v[28:31], a[128:131], v[68:71], v[28:31]
  v_lshl_add_u32 v4, v15, 3, v4
  v_lshrrev_b32 v15, 5, v0
  v_mfma_f32_16x16x32_bf16 v[32:35], a[132:135], v[68:71], v[32:35]
  s_waitcnt lgkmcnt(6)
  s_waitcnt lgkmcnt(1)
  v_mfma_f32_16x16x32_bf16 v[16:19], v[88:91], v[72:75], v[16:19]
  s_waitcnt vmcnt(14)
  ds_read_b128 v[68:71], v8 offset:3072
  s_add_u32 s54, s59, 57344
  v_mfma_f32_16x16x32_bf16 v[20:23], v[92:95], v[72:75], v[20:23]
  buffer_load_dwordx4 v[56:59], v2, s[4:7], s54 offen offset:0 sc1
  v_lshl_add_u32 v4, v15, 10, v4
  s_and_b32 s63, s41, 7
  v_mfma_f32_16x16x32_bf16 v[24:27], v[96:99], v[72:75], v[24:27]
  s_mul_i32 s48, s63, 10
  s_lshl_b32 s49, s42, 1
  v_mfma_f32_16x16x32_bf16 v[28:31], v[100:103], v[72:75], v[28:31]
  s_add_u32 s50, s48, s49
  s_add_u32 s51, s48, 8
  v_mfma_f32_16x16x32_bf16 v[32:35], v[104:107], v[72:75], v[32:35]
  ds_read_b128 v[88:91], v7 offset:5120
  s_waitcnt lgkmcnt(2)
  v_mfma_f32_16x16x32_bf16 v[16:19], a[136:139], v[64:67], v[16:19]
  s_waitcnt vmcnt(13)
  ds_read_b128 v[72:75], v8 offset:5120
  buffer_load_dwordx4 v[60:63], v2, s[4:7], s60 offen offset:2048 sc1
  v_mfma_f32_16x16x32_bf16 v[20:23], a[140:143], v[64:67], v[20:23]
  ds_read_b128 v[92:95], v7 offset:6144
  ds_read_b128 v[96:99], v7 offset:7168
  ds_read_b128 v[100:103], v7 offset:8192
  v_mfma_f32_16x16x32_bf16 v[24:27], a[144:147], v[64:67], v[24:27]
  ds_read_b128 v[104:107], v7 offset:9216
  s_mul_i32 s48, s50, 205
  s_lshr_b32 s48, s48, 12
  v_mfma_f32_16x16x32_bf16 v[28:31], a[148:151], v[64:67], v[28:31]
  s_mul_i32 s49, s48, 20
  s_sub_u32 s50, s50, s49
  v_mfma_f32_16x16x32_bf16 v[32:35], a[152:155], v[64:67], v[32:35]
  s_sub_u32 s50, s50, s67
  s_waitcnt lgkmcnt(6)
  v_mfma_f32_16x16x32_bf16 v[16:19], a[156:159], v[68:71], v[16:19]
  s_waitcnt vmcnt(12)
  ds_read_b128 v[64:67], v8 offset:7168
  v_mfma_f32_16x16x32_bf16 v[20:23], a[160:163], v[68:71], v[20:23]
  buffer_load_dwordx4 v[120:123], v2, s[4:7], s60 offen offset:3072 sc1
  s_add_u32 s49, s50, 20
  v_mfma_f32_16x16x32_bf16 v[24:27], a[164:167], v[68:71], v[24:27]
  s_min_u32 s50, s50, s49
  s_lshl_b32 s50, s50, 2
  v_mfma_f32_16x16x32_bf16 v[28:31], a[168:171], v[68:71], v[28:31]
  s_add_u32 s50, s50, s48
  s_mul_i32 s48, s51, 205
  v_mfma_f32_16x16x32_bf16 v[32:35], a[172:175], v[68:71], v[32:35]
  s_waitcnt lgkmcnt(5)
  s_waitcnt lgkmcnt(1)
  v_mfma_f32_16x16x32_bf16 v[16:19], v[88:91], v[72:75], v[16:19]
  s_waitcnt vmcnt(10)
  ds_read_b128 v[68:71], v8 offset:8192
  v_mfma_f32_16x16x32_bf16 v[20:23], v[92:95], v[72:75], v[20:23]
  buffer_load_dwordx4 v[124:127], v2, s[4:7], s54 offen offset:1024 sc1
  s_lshr_b32 s48, s48, 12
  v_mfma_f32_16x16x32_bf16 v[24:27], v[96:99], v[72:75], v[24:27]
  s_mul_i32 s49, s48, 20
  s_sub_u32 s51, s51, s49
  v_mfma_f32_16x16x32_bf16 v[28:31], v[100:103], v[72:75], v[28:31]
  s_sub_u32 s51, s51, s67
  s_add_u32 s49, s51, 20
  v_mfma_f32_16x16x32_bf16 v[32:35], v[104:107], v[72:75], v[32:35]
  ds_read_b128 v[88:91], v7 offset:10240
  s_waitcnt lgkmcnt(2)
  v_mfma_f32_16x16x32_bf16 v[16:19], a[176:179], v[64:67], v[16:19]
  s_waitcnt vmcnt(15)
  ds_read_b128 v[72:75], v8 offset:6144
  s_add_u32 s62, s59, 53248
  v_mfma_f32_16x16x32_bf16 v[20:23], a[180:183], v[64:67], v[20:23]
  buffer_load_dwordx4 v[128:131], v2, s[4:7], s62 offen offset:0 sc1
  ds_read_b128 v[92:95], v7 offset:11264
  ds_read_b128 v[96:99], v7 offset:12288
  v_mfma_f32_16x16x32_bf16 v[24:27], a[184:187], v[64:67], v[24:27]
  ds_read_b128 v[100:103], v7 offset:13312
  ds_read_b128 v[104:107], v7 offset:14336
  s_min_u32 s51, s51, s49
  v_mfma_f32_16x16x32_bf16 v[28:31], a[188:191], v[64:67], v[28:31]
  s_lshl_b32 s51, s51, 2
  s_add_u32 s51, s51, s48
  v_mfma_f32_16x16x32_bf16 v[32:35], a[192:195], v[64:67], v[32:35]
  s_lshl_b32 s50, s50, 8
  s_waitcnt lgkmcnt(6)
  v_mfma_f32_16x16x32_bf16 v[16:19], a[196:199], v[68:71], v[16:19]
  buffer_load_dwordx4 v[132:135], v2, s[4:7], s62 offen offset:1024 sc1
  s_lshl_b32 s51, s51, 8
  s_lshr_b32 s48, s41, 3
  v_mfma_f32_16x16x32_bf16 v[20:23], a[200:203], v[68:71], v[20:23]
  s_lshl_b32 s49, s40, 2
  s_add_u32 s48, s48, s49
  v_mfma_f32_16x16x32_bf16 v[24:27], a[204:207], v[68:71], v[24:27]
  s_mul_i32 s48, s48, 81920
  s_add_u32 s49, s48, 1048576
  v_mfma_f32_16x16x32_bf16 v[28:31], a[208:211], v[68:71], v[28:31]
  s_add_u32 s50, s50, s49
  s_add_u32 s51, s51, s49
  v_mfma_f32_16x16x32_bf16 v[32:35], a[212:215], v[68:71], v[32:35]
  s_waitcnt vmcnt(11)
  s_add_u32 s46, s64, 24576
  s_mov_b64 exec, 1
  buffer_store_dword v1, off, s[4:7], s46 sc1
  s_mov_b64 exec, -1
  s_waitcnt lgkmcnt(4)
  s_waitcnt lgkmcnt(0)
  v_mfma_f32_16x16x32_bf16 v[16:19], v[88:91], v[72:75], v[16:19]
  buffer_load_dwordx4 v[64:67], v2, s[4:7], s54 offen offset:2048 sc1
  s_mul_i32 s63, s63, 160
  v_mfma_f32_16x16x32_bf16 v[20:23], v[92:95], v[72:75], v[20:23]
  s_add_u32 s48, s48, s63
  s_lshl_b32 s49, s42, 5
  v_mfma_f32_16x16x32_bf16 v[24:27], v[96:99], v[72:75], v[24:27]
  s_add_u32 s52, s48, s49
  s_add_u32 s53, s48, 128
  v_mfma_f32_16x16x32_bf16 v[28:31], v[100:103], v[72:75], v[28:31]
  s_mul_i32 s48, s42, 20480
  s_add_u32 s51, s51, s48
  v_mfma_f32_16x16x32_bf16 v[32:35], v[104:107], v[72:75], v[32:35]
  ds_read_b128 v[88:91], v7 offset:15360
  s_waitcnt vmcnt(12)
  v_mfma_f32_16x16x32_bf16 v[16:19], a[216:219], v[76:79], v[16:19]
  buffer_load_dwordx4 v[68:71], v2, s[4:7], s62 offen offset:2048 sc1
  ds_read_b128 v[92:95], v7 offset:16384
  v_mfma_f32_16x16x32_bf16 v[20:23], a[220:223], v[76:79], v[20:23]
  ds_read_b128 v[96:99], v7 offset:17408
  ds_read_b128 v[100:103], v7 offset:18432
  v_mfma_f32_16x16x32_bf16 v[24:27], a[224:227], v[76:79], v[24:27]
  ds_read_b128 v[104:107], v7 offset:19456
  s_lshl_b32 s49, s42, 10
  v_mfma_f32_16x16x32_bf16 v[28:31], a[228:231], v[76:79], v[28:31]
  s_add_u32 s49, s49, 16384
  v_add_u32 v15, s49, v2
  v_mfma_f32_16x16x32_bf16 v[32:35], a[232:235], v[76:79], v[32:35]
  s_mul_i32 s49, s42, 3072
  s_waitcnt vmcnt(12)
  v_mfma_f32_16x16x32_bf16 v[16:19], a[236:239], v[80:83], v[16:19]
  s_add_u32 s55, s65, 24576
  buffer_load_dwordx4 v[8:11], v6, s[4:7], s55 offen sc1
  v_mfma_f32_16x16x32_bf16 v[20:23], a[240:243], v[80:83], v[20:23]
  s_add_u32 s55, s50, 0
  buffer_load_dwordx2 v[108:109], v4, s[4:7], s55 offen sc1
  v_mfma_f32_16x16x32_bf16 v[24:27], a[244:247], v[80:83], v[24:27]
  buffer_load_dwordx4 v[72:75], v2, s[4:7], s62 offen offset:3072 sc1
  v_add_u32 v5, s49, v15
  v_mfma_f32_16x16x32_bf16 v[28:31], a[248:251], v[80:83], v[28:31]
  s_add_u32 s53, s53, s48
  v_mfma_f32_16x16x32_bf16 v[32:35], a[252:255], v[80:83], v[32:35]
  s_barrier
  s_waitcnt vmcnt(14)
  s_waitcnt lgkmcnt(0)
  v_mfma_f32_16x16x32_bf16 v[16:19], v[88:91], v[84:87], v[16:19]
  buffer_load_dwordx4 v[76:79], v2, s[4:7], s54 offen offset:3072 sc1
  v_mfma_f32_16x16x32_bf16 v[20:23], v[92:95], v[84:87], v[20:23]
  v_mfma_f32_16x16x32_bf16 v[24:27], v[96:99], v[84:87], v[24:27]
  v_mfma_f32_16x16x32_bf16 v[28:31], v[100:103], v[84:87], v[28:31]
  v_mfma_f32_16x16x32_bf16 v[32:35], v[104:107], v[84:87], v[32:35]
  ds_read_b128 v[88:91], v7 offset:0
  ds_read_b128 v[92:95], v7 offset:1024
  s_waitcnt vmcnt(14)
  v_mfma_f32_16x16x32_bf16 v[36:39], a[96:99], v[112:115], 0
  ds_read_b128 v[96:99], v7 offset:2048
  ds_read_b128 v[100:103], v7 offset:3072
  v_mfma_f32_16x16x32_bf16 v[40:43], a[100:103], v[112:115], 0
  ds_read_b128 v[104:107], v7 offset:4096
  v_mfma_f32_16x16x32_bf16 v[44:47], a[104:107], v[112:115], 0
  ds_write_b128 v3, v[16:19] offset:0
  v_mfma_f32_16x16x32_bf16 v[48:51], a[108:111], v[112:115], 0
  ds_write_b128 v3, v[20:23] offset:1024
  v_mfma_f32_16x16x32_bf16 v[52:55], a[112:115], v[112:115], 0
  s_waitcnt vmcnt(13)
  v_mfma_f32_16x16x32_bf16 v[36:39], a[116:119], v[116:119], v[36:39]
  ds_write_b128 v3, v[24:27] offset:2048
  v_mfma_f32_16x16x32_bf16 v[40:43], a[120:123], v[116:119], v[40:43]
  ds_write_b128 v3, v[28:31] offset:3072
  v_mfma_f32_16x16x32_bf16 v[44:47], a[124:127], v[116:119], v[44:47]
  ds_write_b128 v15, v[32:35] offset:0
  v_mfma_f32_16x16x32_bf16 v[48:51], a[128:131], v[116:119], v[48:51]
  v_mfma_f32_16x16x32_bf16 v[52:55], a[132:135], v[116:119], v[52:55]
  s_waitcnt vmcnt(12)
  s_waitcnt lgkmcnt(5)
  v_mfma_f32_16x16x32_bf16 v[36:39], v[88:91], v[56:59], v[36:39]
  v_mfma_f32_16x16x32_bf16 v[40:43], v[92:95], v[56:59], v[40:43]
  v_mfma_f32_16x16x32_bf16 v[44:47], v[96:99], v[56:59], v[44:47]
  v_mfma_f32_16x16x32_bf16 v[48:51], v[100:103], v[56:59], v[48:51]
  v_mfma_f32_16x16x32_bf16 v[52:55], v[104:107], v[56:59], v[52:55]
  ds_read_b128 v[88:91], v7 offset:5120
  s_waitcnt vmcnt(11)
  v_mfma_f32_16x16x32_bf16 v[36:39], a[136:139], v[60:63], v[36:39]
  ds_read_b128 v[92:95], v7 offset:6144
  ds_read_b128 v[96:99], v7 offset:7168
  v_mfma_f32_16x16x32_bf16 v[40:43], a[140:143], v[60:63], v[40:43]
  ds_read_b128 v[100:103], v7 offset:8192
  ds_read_b128 v[104:107], v7 offset:9216
  v_mfma_f32_16x16x32_bf16 v[44:47], a[144:147], v[60:63], v[44:47]
  v_mfma_f32_16x16x32_bf16 v[48:51], a[148:151], v[60:63], v[48:51]
  v_mfma_f32_16x16x32_bf16 v[52:55], a[152:155], v[60:63], v[52:55]
  s_waitcnt lgkmcnt(5)
  s_barrier
  s_waitcnt vmcnt(10)
  v_mfma_f32_16x16x32_bf16 v[36:39], a[156:159], v[120:123], v[36:39]
  s_waitcnt vmcnt(3)
  v_bitop3_b32 v8, v8, v9, v1 bitop3:0x7e
  v_mfma_f32_16x16x32_bf16 v[40:43], a[160:163], v[120:123], v[40:43]
  v_bitop3_b32 v10, v10, v11, v1 bitop3:0x7e
  v_or_b32 v8, v8, v10
  v_mfma_f32_16x16x32_bf16 v[44:47], a[164:167], v[120:123], v[44:47]
  v_cmp_ne_u32 vcc, 0, v8
  s_nop 0
  v_mfma_f32_16x16x32_bf16 v[48:51], a[168:171], v[120:123], v[48:51]
  s_nop 1
  s_cbranch_vccz Lsckd_80
Lsck_79:
  s_add_u32 s55, s65, 24576
  buffer_load_dwordx4 v[8:11], v6, s[4:7], s55 offen sc1
  s_waitcnt vmcnt(0)
  v_bitop3_b32 v8, v8, v9, v1 bitop3:0x7e
  v_bitop3_b32 v10, v10, v11, v1 bitop3:0x7e
  v_or_b32 v8, v8, v10
  v_cmp_ne_u32 vcc, 0, v8
  s_nop 1
  s_nop 1
  s_cbranch_vccnz Lsck_79
Lsckd_80:
  buffer_inv sc1
  s_waitcnt vmcnt(0)
  v_mfma_f32_16x16x32_bf16 v[52:55], a[172:175], v[120:123], v[52:55]
  s_waitcnt vmcnt(9)
  s_waitcnt lgkmcnt(0)
  v_mfma_f32_16x16x32_bf16 v[36:39], v[88:91], v[124:127], v[36:39]
  s_add_u32 s60, s59, 98304
  buffer_load_dwordx4 v[80:83], v2, s[4:7], s60 offen offset:0 sc1
  v_mfma_f32_16x16x32_bf16 v[40:43], v[92:95], v[124:127], v[40:43]
  buffer_load_dwordx4 v[84:87], v2, s[4:7], s60 offen offset:1024 sc1
  ds_read_b128 v[16:19], v13 offset:0
  v_mfma_f32_16x16x32_bf16 v[44:47], v[96:99], v[124:127], v[44:47]
  ds_read_b128 v[20:23], v13 offset:4096
  ds_read_b128 v[24:27], v13 offset:8192
  v_mfma_f32_16x16x32_bf16 v[48:51], v[100:103], v[124:127], v[48:51]
  ds_read_b128 v[28:31], v13 offset:12288
  s_waitcnt vmcnt(4)
  v_mfma_f32_16x16x32_bf16 v[52:55], v[104:107], v[124:127], v[52:55]
  ds_read_b128 v[88:91], v7 offset:10240
  s_waitcnt vmcnt(10)
  v_mfma_f32_16x16x32_bf16 v[36:39], a[176:179], v[128:131], v[36:39]
  s_add_u32 s54, s59, 106496
  buffer_load_dwordx4 v[8:11], v2, s[4:7], s54 offen offset:0 sc1
  v_mfma_f32_16x16x32_bf16 v[40:43], a[180:183], v[128:131], v[40:43]
  buffer_load_dwordx4 v[112:115], v2, s[4:7], s60 offen offset:2048 sc1
  ds_read_b128 v[92:95], v7 offset:11264
  v_mfma_f32_16x16x32_bf16 v[44:47], a[184:187], v[128:131], v[44:47]
  ds_read_b128 v[96:99], v7 offset:12288
  ds_read_b128 v[100:103], v7 offset:13312
  v_mfma_f32_16x16x32_bf16 v[48:51], a[188:191], v[128:131], v[48:51]
  ds_read_b128 v[104:107], v7 offset:14336
  v_lshlrev_b32 v32, 16, v108
  v_mfma_f32_16x16x32_bf16 v[52:55], a[192:195], v[128:131], v[52:55]
  v_and_b32 v33, 0xffff0000, v108
  s_waitcnt vmcnt(11)
  v_mfma_f32_16x16x32_bf16 v[36:39], a[196:199], v[132:135], v[36:39]
  buffer_load_dwordx4 v[116:119], v2, s[4:7], s60 offen offset:3072 sc1
  buffer_load_dwordx4 v[56:59], v2, s[4:7], s54 offen offset:1024 sc1
  v_mfma_f32_16x16x32_bf16 v[40:43], a[200:203], v[132:135], v[40:43]
  v_lshlrev_b32 v34, 16, v109
  v_and_b32 v35, 0xffff0000, v109
  v_mfma_f32_16x16x32_bf16 v[44:47], a[204:207], v[132:135], v[44:47]
  s_waitcnt lgkmcnt(5)
  v_add_f32 v16, v16, v20
  v_mfma_f32_16x16x32_bf16 v[48:51], a[208:211], v[132:135], v[48:51]
  v_add_f32 v17, v17, v21
  v_add_f32 v18, v18, v22
  v_mfma_f32_16x16x32_bf16 v[52:55], a[212:215], v[132:135], v[52:55]
  s_waitcnt vmcnt(11)
  s_waitcnt lgkmcnt(0)
  v_mfma_f32_16x16x32_bf16 v[36:39], v[88:91], v[64:67], v[36:39]
  s_add_u32 s55, s50, 20480
  buffer_load_dwordx2 v[110:111], v4, s[4:7], s55 offen sc1
  v_mfma_f32_16x16x32_bf16 v[40:43], v[92:95], v[64:67], v[40:43]
  s_add_u32 s62, s59, 102400
  buffer_load_dwordx4 v[60:63], v2, s[4:7], s62 offen offset:0 sc1
  v_mfma_f32_16x16x32_bf16 v[44:47], v[96:99], v[64:67], v[44:47]
  buffer_load_dwordx4 v[120:123], v2, s[4:7], s62 offen offset:1024 sc1
  v_add_f32 v19, v19, v23
  v_mfma_f32_16x16x32_bf16 v[48:51], v[100:103], v[64:67], v[48:51]
  v_add_f32 v24, v24, v28
  v_add_f32 v25, v25, v29
  v_mfma_f32_16x16x32_bf16 v[52:55], v[104:107], v[64:67], v[52:55]
  ds_read_b128 v[88:91], v7 offset:15360
  s_waitcnt vmcnt(13)
  v_mfma_f32_16x16x32_bf16 v[36:39], a[216:219], v[68:71], v[36:39]
  buffer_load_dwordx4 v[124:127], v2, s[4:7], s54 offen offset:2048 sc1
  ds_read_b128 v[92:95], v7 offset:16384
  v_mfma_f32_16x16x32_bf16 v[40:43], a[220:223], v[68:71], v[40:43]
  ds_read_b128 v[96:99], v7 offset:17408
  ds_read_b128 v[100:103], v7 offset:18432
  v_mfma_f32_16x16x32_bf16 v[44:47], a[224:227], v[68:71], v[44:47]
  ds_read_b128 v[104:107], v7 offset:19456
  v_add_f32 v26, v26, v30
  v_mfma_f32_16x16x32_bf16 v[48:51], a[228:231], v[68:71], v[48:51]
  v_add_f32 v27, v27, v31
  v_add_f32 v16, v16, v32
  v_mfma_f32_16x16x32_bf16 v[52:55], a[232:235], v[68:71], v[52:55]
  v_add_f32 v17, v17, v33
  s_waitcnt vmcnt(11)
  v_mfma_f32_16x16x32_bf16 v[36:39], a[236:239], v[72:75], v[36:39]
  buffer_load_dwordx4 v[128:131], v2, s[4:7], s62 offen offset:2048 sc1
  v_add_f32 v18, v18, v34
  v_mfma_f32_16x16x32_bf16 v[40:43], a[240:243], v[72:75], v[40:43]
  v_add_f32 v19, v19, v35
  v_add_f32 v16, v16, v24
  v_mfma_f32_16x16x32_bf16 v[44:47], a[244:247], v[72:75], v[44:47]
  v_add_f32 v17, v17, v25
  v_add_f32 v18, v18, v26
  v_mfma_f32_16x16x32_bf16 v[48:51], a[248:251], v[72:75], v[48:51]
  v_add_f32 v19, v19, v27
  v_cvt_pk_bf16_f32 v20, v16, v17
  v_mfma_f32_16x16x32_bf16 v[52:55], a[252:255], v[72:75], v[52:55]
  s_waitcnt vmcnt(11)
  s_waitcnt lgkmcnt(0)
  v_mfma_f32_16x16x32_bf16 v[36:39], v[88:91], v[76:79], v[36:39]
  buffer_load_dwordx4 v[132:135], v2, s[4:7], s62 offen offset:3072 sc1
  v_cvt_pk_bf16_f32 v21, v18, v19
  v_mfma_f32_16x16x32_bf16 v[40:43], v[92:95], v[76:79], v[40:43]
  s_add_u32 s49, s52, 0
  buffer_store_dwordx2 v[20:21], v14, s[32:35], s49 offen
  v_mfma_f32_16x16x32_bf16 v[44:47], v[96:99], v[76:79], v[44:47]
  v_mfma_f32_16x16x32_bf16 v[48:51], v[100:103], v[76:79], v[48:51]
  v_mfma_f32_16x16x32_bf16 v[52:55], v[104:107], v[76:79], v[52:55]
  ds_read_b128 v[88:91], v7 offset:0
  s_waitcnt vmcnt(12)
  v_mfma_f32_16x16x32_bf16 v[16:19], a[96:99], v[80:83], 0
  buffer_load_dwordx4 v[64:67], v2, s[4:7], s54 offen offset:3072 sc1
  ds_read_b128 v[92:95], v7 offset:1024
  v_mfma_f32_16x16x32_bf16 v[20:23], a[100:103], v[80:83], 0
  ds_read_b128 v[96:99], v7 offset:2048
  ds_read_b128 v[100:103], v7 offset:3072
  v_mfma_f32_16x16x32_bf16 v[24:27], a[104:107], v[80:83], 0
  ds_read_b128 v[104:107], v7 offset:4096
  v_mfma_f32_16x16x32_bf16 v[28:31], a[108:111], v[80:83], 0
  ds_write_b128 v3, v[36:39] offset:16384
  v_mfma_f32_16x16x32_bf16 v[32:35], a[112:115], v[80:83], 0
  s_waitcnt vmcnt(12)
  v_mfma_f32_16x16x32_bf16 v[16:19], a[116:119], v[84:87], v[16:19]
  s_add_u32 s60, s59, 147456
  buffer_load_dwordx4 v[68:71], v2, s[4:7], s60 offen offset:0 sc1
  v_mfma_f32_16x16x32_bf16 v[20:23], a[120:123], v[84:87], v[20:23]
  ds_write_b128 v3, v[40:43] offset:17408
  v_mfma_f32_16x16x32_bf16 v[24:27], a[124:127], v[84:87], v[24:27]
  ds_write_b128 v3, v[44:47] offset:18432
  v_mfma_f32_16x16x32_bf16 v[28:31], a[128:131], v[84:87], v[28:31]
  ds_write_b128 v3, v[48:51] offset:19456
  v_mfma_f32_16x16x32_bf16 v[32:35], a[132:135], v[84:87], v[32:35]
  s_waitcnt vmcnt(12)
  s_waitcnt lgkmcnt(4)
  v_mfma_f32_16x16x32_bf16 v[16:19], v[88:91], v[8:11], v[16:19]
  buffer_load_dwordx4 v[72:75], v2, s[4:7], s60 offen offset:1024 sc1
  v_mfma_f32_16x16x32_bf16 v[20:23], v[92:95], v[8:11], v[20:23]
  ds_write_b128 v15, v[52:55] offset:4096
  v_mfma_f32_16x16x32_bf16 v[24:27], v[96:99], v[8:11], v[24:27]
  v_mfma_f32_16x16x32_bf16 v[28:31], v[100:103], v[8:11], v[28:31]
  v_mfma_f32_16x16x32_bf16 v[32:35], v[104:107], v[8:11], v[32:35]
  ds_read_b128 v[88:91], v7 offset:5120
  s_waitcnt vmcnt(12)
  v_mfma_f32_16x16x32_bf16 v[16:19], a[136:139], v[112:115], v[16:19]
  s_add_u32 s54, s59, 155648
  buffer_load_dwordx4 v[76:79], v2, s[4:7], s54 offen offset:0 sc1
  v_mfma_f32_16x16x32_bf16 v[20:23], a[140:143], v[112:115], v[20:23]
  ds_read_b128 v[92:95], v7 offset:6144
  ds_read_b128 v[96:99], v7 offset:7168
  v_mfma_f32_16x16x32_bf16 v[24:27], a[144:147], v[112:115], v[24:27]
  ds_read_b128 v[100:103], v7 offset:8192
  ds_read_b128 v[104:107], v7 offset:9216
  v_mfma_f32_16x16x32_bf16 v[28:31], a[148:151], v[112:115], v[28:31]
  v_mfma_f32_16x16x32_bf16 v[32:35], a[152:155], v[112:115], v[32:35]
  s_waitcnt lgkmcnt(5)
  s_barrier
  s_waitcnt vmcnt(12)
  v_mfma_f32_16x16x32_bf16 v[16:19], a[156:159], v[116:119], v[16:19]
  buffer_load_dwordx4 v[80:83], v2, s[4:7], s60 offen offset:2048 sc1
  ds_read_b128 v[36:39], v13 offset:16384
  v_mfma_f32_16x16x32_bf16 v[20:23], a[160:163], v[116:119], v[20:23]
  ds_read_b128 v[40:43], v13 offset:20480
  ds_read_b128 v[44:47], v13 offset:24576
  v_mfma_f32_16x16x32_bf16 v[24:27], a[164:167], v[116:119], v[24:27]
  ds_read_b128 v[48:51], v13 offset:28672
  s_waitcnt vmcnt(11)
  v_mfma_f32_16x16x32_bf16 v[28:31], a[168:171], v[116:119], v[28:31]
  v_lshlrev_b32 v52, 16, v110
  v_and_b32 v53, 0xffff0000, v110
  v_mfma_f32_16x16x32_bf16 v[32:35], a[172:175], v[116:119], v[32:35]
  s_waitcnt vmcnt(12)
  s_waitcnt lgkmcnt(4)
  v_mfma_f32_16x16x32_bf16 v[16:19], v[88:91], v[56:59], v[16:19]
  buffer_load_dwordx4 v[84:87], v2, s[4:7], s60 offen offset:3072 sc1
  v_lshlrev_b32 v54, 16, v111
  v_mfma_f32_16x16x32_bf16 v[20:23], v[92:95], v[56:59], v[20:23]
  v_and_b32 v55, 0xffff0000, v111
  v_mfma_f32_16x16x32_bf16 v[24:27], v[96:99], v[56:59], v[24:27]
  v_mfma_f32_16x16x32_bf16 v[28:31], v[100:103], v[56:59], v[28:31]
  v_mfma_f32_16x16x32_bf16 v[32:35], v[104:107], v[56:59], v[32:35]
  ds_read_b128 v[88:91], v7 offset:10240
  s_waitcnt vmcnt(11)
  v_mfma_f32_16x16x32_bf16 v[16:19], a[176:179], v[60:63], v[16:19]
  buffer_load_dwordx4 v[8:11], v2, s[4:7], s54 offen offset:1024 sc1
  ds_read_b128 v[92:95], v7 offset:11264
  v_mfma_f32_16x16x32_bf16 v[20:23], a[180:183], v[60:63], v[20:23]
  ds_read_b128 v[96:99], v7 offset:12288
  ds_read_b128 v[100:103], v7 offset:13312
  v_mfma_f32_16x16x32_bf16 v[24:27], a[184:187], v[60:63], v[24:27]
  ds_read_b128 v[104:107], v7 offset:14336
  s_waitcnt lgkmcnt(5)
  v_mfma_f32_16x16x32_bf16 v[28:31], a[188:191], v[60:63], v[28:31]
  v_add_f32 v36, v36, v40
  v_add_f32 v37, v37, v41
  v_mfma_f32_16x16x32_bf16 v[32:35], a[192:195], v[60:63], v[32:35]
  v_add_f32 v38, v38, v42
  s_waitcnt vmcnt(11)
  v_mfma_f32_16x16x32_bf16 v[16:19], a[196:199], v[120:123], v[16:19]
  s_add_u32 s62, s59, 151552
  buffer_load_dwordx4 v[112:115], v2, s[4:7], s62 offen offset:0 sc1
  v_mfma_f32_16x16x32_bf16 v[20:23], a[200:203], v[120:123], v[20:23]
  v_add_f32 v39, v39, v43
  v_add_f32 v44, v44, v48
  v_mfma_f32_16x16x32_bf16 v[24:27], a[204:207], v[120:123], v[24:27]
  v_add_f32 v45, v45, v49
  v_add_f32 v46, v46, v50
  v_mfma_f32_16x16x32_bf16 v[28:31], a[208:211], v[120:123], v[28:31]
  v_add_f32 v47, v47, v51
  v_add_f32 v36, v36, v52
  v_mfma_f32_16x16x32_bf16 v[32:35], a[212:215], v[120:123], v[32:35]
  s_waitcnt vmcnt(11)
  s_waitcnt lgkmcnt(0)
  v_mfma_f32_16x16x32_bf16 v[16:19], v[88:91], v[124:127], v[16:19]
  s_add_u32 s55, s50, 40960
  buffer_load_dwordx2 v[108:109], v4, s[4:7], s55 offen sc1
  v_mfma_f32_16x16x32_bf16 v[20:23], v[92:95], v[124:127], v[20:23]
  buffer_load_dwordx4 v[116:119], v2, s[4:7], s62 offen offset:1024 sc1
  v_add_f32 v37, v37, v53
  v_mfma_f32_16x16x32_bf16 v[24:27], v[96:99], v[124:127], v[24:27]
  v_add_f32 v38, v38, v54
  v_add_f32 v39, v39, v55
  v_mfma_f32_16x16x32_bf16 v[28:31], v[100:103], v[124:127], v[28:31]
  v_add_f32 v36, v36, v44
  v_add_f32 v37, v37, v45
  v_mfma_f32_16x16x32_bf16 v[32:35], v[104:107], v[124:127], v[32:35]
  ds_read_b128 v[88:91], v7 offset:15360
  s_waitcnt vmcnt(12)
  v_mfma_f32_16x16x32_bf16 v[16:19], a[216:219], v[128:131], v[16:19]
  buffer_load_dwordx4 v[56:59], v2, s[4:7], s54 offen offset:2048 sc1
  ds_read_b128 v[92:95], v7 offset:16384
  v_mfma_f32_16x16x32_bf16 v[20:23], a[220:223], v[128:131], v[20:23]
  ds_read_b128 v[96:99], v7 offset:17408
  ds_read_b128 v[100:103], v7 offset:18432
  v_mfma_f32_16x16x32_bf16 v[24:27], a[224:227], v[128:131], v[24:27]
  ds_read_b128 v[104:107], v7 offset:19456
  v_add_f32 v38, v38, v46
  v_mfma_f32_16x16x32_bf16 v[28:31], a[228:231], v[128:131], v[28:31]
  v_add_f32 v39, v39, v47
  v_cvt_pk_bf16_f32 v40, v36, v37
  v_mfma_f32_16x16x32_bf16 v[32:35], a[232:235], v[128:131], v[32:35]
  v_cvt_pk_bf16_f32 v41, v38, v39
  s_waitcnt vmcnt(12)
  v_mfma_f32_16x16x32_bf16 v[16:19], a[236:239], v[132:135], v[16:19]
  buffer_load_dwordx4 v[60:63], v2, s[4:7], s62 offen offset:2048 sc1
  s_add_u32 s49, s52, 20480
  v_mfma_f32_16x16x32_bf16 v[20:23], a[240:243], v[132:135], v[20:23]
  buffer_store_dwordx2 v[40:41], v14, s[32:35], s49 offen
  v_mfma_f32_16x16x32_bf16 v[24:27], a[244:247], v[132:135], v[24:27]
  v_mfma_f32_16x16x32_bf16 v[28:31], a[248:251], v[132:135], v[28:31]
  v_mfma_f32_16x16x32_bf16 v[32:35], a[252:255], v[132:135], v[32:35]
  s_waitcnt vmcnt(12)
  s_waitcnt lgkmcnt(0)
  v_mfma_f32_16x16x32_bf16 v[16:19], v[88:91], v[64:67], v[16:19]
  buffer_load_dwordx4 v[120:123], v2, s[4:7], s62 offen offset:3072 sc1
  v_mfma_f32_16x16x32_bf16 v[20:23], v[92:95], v[64:67], v[20:23]
  v_mfma_f32_16x16x32_bf16 v[24:27], v[96:99], v[64:67], v[24:27]
  v_mfma_f32_16x16x32_bf16 v[28:31], v[100:103], v[64:67], v[28:31]
  v_mfma_f32_16x16x32_bf16 v[32:35], v[104:107], v[64:67], v[32:35]
  ds_read_b128 v[88:91], v7 offset:0
  s_waitcnt vmcnt(12)
  v_mfma_f32_16x16x32_bf16 v[36:39], a[96:99], v[68:71], 0
  buffer_load_dwordx4 v[124:127], v2, s[4:7], s54 offen offset:3072 sc1
  ds_read_b128 v[92:95], v7 offset:1024
  v_mfma_f32_16x16x32_bf16 v[40:43], a[100:103], v[68:71], 0
  ds_read_b128 v[96:99], v7 offset:2048
  ds_read_b128 v[100:103], v7 offset:3072
  v_mfma_f32_16x16x32_bf16 v[44:47], a[104:107], v[68:71], 0
  ds_read_b128 v[104:107], v7 offset:4096
  v_mfma_f32_16x16x32_bf16 v[48:51], a[108:111], v[68:71], 0
  ds_write_b128 v3, v[16:19] offset:0
  v_mfma_f32_16x16x32_bf16 v[52:55], a[112:115], v[68:71], 0
  s_waitcnt vmcnt(12)
  v_mfma_f32_16x16x32_bf16 v[36:39], a[116:119], v[72:75], v[36:39]
  ds_write_b128 v3, v[20:23] offset:1024
  v_mfma_f32_16x16x32_bf16 v[40:43], a[120:123], v[72:75], v[40:43]
  ds_write_b128 v3, v[24:27] offset:2048
  v_mfma_f32_16x16x32_bf16 v[44:47], a[124:127], v[72:75], v[44:47]
  ds_write_b128 v3, v[28:31] offset:3072
  v_mfma_f32_16x16x32_bf16 v[48:51], a[128:131], v[72:75], v[48:51]
  ds_write_b128 v15, v[32:35] offset:8192
  v_mfma_f32_16x16x32_bf16 v[52:55], a[132:135], v[72:75], v[52:55]
  s_waitcnt vmcnt(11)
  s_waitcnt lgkmcnt(5)
  v_mfma_f32_16x16x32_bf16 v[36:39], v[88:91], v[76:79], v[36:39]
  v_mfma_f32_16x16x32_bf16 v[40:43], v[92:95], v[76:79], v[40:43]
  v_mfma_f32_16x16x32_bf16 v[44:47], v[96:99], v[76:79], v[44:47]
  v_mfma_f32_16x16x32_bf16 v[48:51], v[100:103], v[76:79], v[48:51]
  v_mfma_f32_16x16x32_bf16 v[52:55], v[104:107], v[76:79], v[52:55]
  ds_read_b128 v[88:91], v7 offset:5120
  s_waitcnt vmcnt(10)
  v_mfma_f32_16x16x32_bf16 v[36:39], a[136:139], v[80:83], v[36:39]
  ds_read_b128 v[92:95], v7 offset:6144
  ds_read_b128 v[96:99], v7 offset:7168
  v_mfma_f32_16x16x32_bf16 v[40:43], a[140:143], v[80:83], v[40:43]
  ds_read_b128 v[100:103], v7 offset:8192
  ds_read_b128 v[104:107], v7 offset:9216
  v_mfma_f32_16x16x32_bf16 v[44:47], a[144:147], v[80:83], v[44:47]
  v_mfma_f32_16x16x32_bf16 v[48:51], a[148:151], v[80:83], v[48:51]
  v_mfma_f32_16x16x32_bf16 v[52:55], a[152:155], v[80:83], v[52:55]
  s_waitcnt lgkmcnt(5)
  s_barrier
  s_waitcnt vmcnt(9)
  v_mfma_f32_16x16x32_bf16 v[36:39], a[156:159], v[84:87], v[36:39]
  ds_read_b128 v[16:19], v13 offset:0
  ds_read_b128 v[20:23], v13 offset:4096
  v_mfma_f32_16x16x32_bf16 v[40:43], a[160:163], v[84:87], v[40:43]
  ds_read_b128 v[24:27], v13 offset:8192
  ds_read_b128 v[28:31], v13 offset:12288
  v_mfma_f32_16x16x32_bf16 v[44:47], a[164:167], v[84:87], v[44:47]
  s_waitcnt vmcnt(6)
  v_lshlrev_b32 v32, 16, v108
  v_mfma_f32_16x16x32_bf16 v[48:51], a[168:171], v[84:87], v[48:51]
  v_and_b32 v33, 0xffff0000, v108
  v_lshlrev_b32 v34, 16, v109
  v_mfma_f32_16x16x32_bf16 v[52:55], a[172:175], v[84:87], v[52:55]
  s_waitcnt vmcnt(8)
  s_waitcnt lgkmcnt(4)
  v_mfma_f32_16x16x32_bf16 v[36:39], v[88:91], v[8:11], v[36:39]
  v_and_b32 v35, 0xffff0000, v109
  v_mfma_f32_16x16x32_bf16 v[40:43], v[92:95], v[8:11], v[40:43]
  v_mfma_f32_16x16x32_bf16 v[44:47], v[96:99], v[8:11], v[44:47]
  v_mfma_f32_16x16x32_bf16 v[48:51], v[100:103], v[8:11], v[48:51]
  s_waitcnt lgkmcnt(0)
  v_add_f32 v16, v16, v20
  v_mfma_f32_16x16x32_bf16 v[52:55], v[104:107], v[8:11], v[52:55]
  ds_read_b128 v[88:91], v7 offset:10240
  s_waitcnt vmcnt(7)
  v_mfma_f32_16x16x32_bf16 v[36:39], a[176:179], v[112:115], v[36:39]
  ds_read_b128 v[92:95], v7 offset:11264
  ds_read_b128 v[96:99], v7 offset:12288
  v_mfma_f32_16x16x32_bf16 v[40:43], a[180:183], v[112:115], v[40:43]
  ds_read_b128 v[100:103], v7 offset:13312
  ds_read_b128 v[104:107], v7 offset:14336
  v_mfma_f32_16x16x32_bf16 v[44:47], a[184:187], v[112:115], v[44:47]
  v_add_f32 v17, v17, v21
  v_add_f32 v18, v18, v22
  v_mfma_f32_16x16x32_bf16 v[48:51], a[188:191], v[112:115], v[48:51]
  v_add_f32 v19, v19, v23
  v_add_f32 v24, v24, v28
  v_mfma_f32_16x16x32_bf16 v[52:55], a[192:195], v[112:115], v[52:55]
  v_add_f32 v25, v25, v29
  s_waitcnt vmcnt(5)
  v_mfma_f32_16x16x32_bf16 v[36:39], a[196:199], v[116:119], v[36:39]
  v_add_f32 v26, v26, v30
  v_add_f32 v27, v27, v31
  v_mfma_f32_16x16x32_bf16 v[40:43], a[200:203], v[116:119], v[40:43]
  v_add_f32 v16, v16, v32
  v_add_f32 v17, v17, v33
  v_mfma_f32_16x16x32_bf16 v[44:47], a[204:207], v[116:119], v[44:47]
  v_add_f32 v18, v18, v34
  v_add_f32 v19, v19, v35
  v_mfma_f32_16x16x32_bf16 v[48:51], a[208:211], v[116:119], v[48:51]
  v_add_f32 v16, v16, v24
  v_add_f32 v17, v17, v25
  v_mfma_f32_16x16x32_bf16 v[52:55], a[212:215], v[116:119], v[52:55]
  s_waitcnt vmcnt(4)
  s_waitcnt lgkmcnt(0)
  v_mfma_f32_16x16x32_bf16 v[36:39], v[88:91], v[56:59], v[36:39]
  s_add_u32 s55, s50, 61440
  buffer_load_dwordx2 v[110:111], v4, s[4:7], s55 offen sc1
  v_mfma_f32_16x16x32_bf16 v[40:43], v[92:95], v[56:59], v[40:43]
  s_add_u32 s55, s51, 0
  buffer_load_dwordx2 v[128:129], v4, s[4:7], s55 offen sc1
  v_mfma_f32_16x16x32_bf16 v[44:47], v[96:99], v[56:59], v[44:47]
  v_add_f32 v18, v18, v26
  v_add_f32 v19, v19, v27
  v_mfma_f32_16x16x32_bf16 v[48:51], v[100:103], v[56:59], v[48:51]
  v_cvt_pk_bf16_f32 v20, v16, v17
  v_cvt_pk_bf16_f32 v21, v18, v19
  v_mfma_f32_16x16x32_bf16 v[52:55], v[104:107], v[56:59], v[52:55]
  ds_read_b128 v[88:91], v7 offset:15360
  s_waitcnt vmcnt(5)
  v_mfma_f32_16x16x32_bf16 v[36:39], a[216:219], v[60:63], v[36:39]
  ds_read_b128 v[92:95], v7 offset:16384
  ds_read_b128 v[96:99], v7 offset:17408
  v_mfma_f32_16x16x32_bf16 v[40:43], a[220:223], v[60:63], v[40:43]
  ds_read_b128 v[100:103], v7 offset:18432
  ds_read_b128 v[104:107], v7 offset:19456
  v_mfma_f32_16x16x32_bf16 v[44:47], a[224:227], v[60:63], v[44:47]
  s_add_u32 s49, s52, 40960
  buffer_store_dwordx2 v[20:21], v14, s[32:35], s49 offen
  v_mfma_f32_16x16x32_bf16 v[48:51], a[228:231], v[60:63], v[48:51]
  v_mfma_f32_16x16x32_bf16 v[52:55], a[232:235], v[60:63], v[52:55]
  s_waitcnt vmcnt(4)
  v_mfma_f32_16x16x32_bf16 v[36:39], a[236:239], v[120:123], v[36:39]
  v_mfma_f32_16x16x32_bf16 v[40:43], a[240:243], v[120:123], v[40:43]
  v_mfma_f32_16x16x32_bf16 v[44:47], a[244:247], v[120:123], v[44:47]
  v_mfma_f32_16x16x32_bf16 v[48:51], a[248:251], v[120:123], v[48:51]
  v_mfma_f32_16x16x32_bf16 v[52:55], a[252:255], v[120:123], v[52:55]
  s_waitcnt vmcnt(3)
  s_waitcnt lgkmcnt(0)
  v_mfma_f32_16x16x32_bf16 v[36:39], v[88:91], v[124:127], v[36:39]
  v_mfma_f32_16x16x32_bf16 v[40:43], v[92:95], v[124:127], v[40:43]
  v_mfma_f32_16x16x32_bf16 v[44:47], v[96:99], v[124:127], v[44:47]
  v_mfma_f32_16x16x32_bf16 v[48:51], v[100:103], v[124:127], v[48:51]
  v_mfma_f32_16x16x32_bf16 v[52:55], v[104:107], v[124:127], v[52:55]
  s_nop 3
  ds_write_b128 v3, v[36:39] offset:16384
  ds_write_b128 v3, v[40:43] offset:17408
  ds_write_b128 v3, v[44:47] offset:18432
  ds_write_b128 v3, v[48:51] offset:19456
  ds_write_b128 v15, v[52:55] offset:12288
  s_waitcnt vmcnt(1)
  v_lshlrev_b32 v104, 16, v128
  v_and_b32 v105, 0xffff0000, v128
  v_lshlrev_b32 v106, 16, v129
  v_and_b32 v107, 0xffff0000, v129
  v_lshlrev_b32 v32, 16, v110
  v_and_b32 v33, 0xffff0000, v110
  v_lshlrev_b32 v34, 16, v111
  v_and_b32 v35, 0xffff0000, v111
  s_waitcnt lgkmcnt(0)
  s_barrier
  ds_read_b128 v[16:19], v13 offset:16384
  ds_read_b128 v[20:23], v13 offset:20480
  ds_read_b128 v[24:27], v13 offset:24576
  ds_read_b128 v[28:31], v13 offset:28672
  ds_read_b128 v[88:91], v5 offset:0
  ds_read_b128 v[92:95], v5 offset:1024
  ds_read_b128 v[96:99], v5 offset:2048
  ds_read_b128 v[100:103], v5 offset:3072
  s_waitcnt lgkmcnt(4)
  v_pk_add_f32 v[16:17], v[16:17], v[20:21]
  v_pk_add_f32 v[24:25], v[24:25], v[28:29]
  v_pk_add_f32 v[18:19], v[18:19], v[22:23]
  v_pk_add_f32 v[26:27], v[26:27], v[30:31]
  v_pk_add_f32 v[16:17], v[16:17], v[32:33]
  v_pk_add_f32 v[18:19], v[18:19], v[34:35]
  v_pk_add_f32 v[16:17], v[16:17], v[24:25]
  v_pk_add_f32 v[18:19], v[18:19], v[26:27]
  v_cvt_pk_bf16_f32 v20, v16, v17
  v_cvt_pk_bf16_f32 v21, v18, v19
  s_add_u32 s49, s52, 61440
  buffer_store_dwordx2 v[20:21], v14, s[32:35], s49 offen
  s_waitcnt lgkmcnt(0)
  v_pk_add_f32 v[88:89], v[88:89], v[92:93]
  v_pk_add_f32 v[96:97], v[96:97], v[100:101]
  v_pk_add_f32 v[90:91], v[90:91], v[94:95]
  v_pk_add_f32 v[98:99], v[98:99], v[102:103]
  v_pk_add_f32 v[88:89], v[88:89], v[104:105]
  v_pk_add_f32 v[90:91], v[90:91], v[106:107]
  v_pk_add_f32 v[88:89], v[88:89], v[96:97]
  v_pk_add_f32 v[90:91], v[90:91], v[98:99]
  v_cvt_pk_bf16_f32 v92, v88, v89
  v_cvt_pk_bf16_f32 v93, v90, v91
  s_add_u32 s49, s53, 0
  buffer_store_dwordx2 v[92:93], v14, s[32:35], s49 offen
L_fin_s:
  s_endpgm
L_exit:
  s_endpgm
.fill 1024, 4, 0xbf800000
.section .rodata,"a"
.p2align 6
.amdhsa_kernel interleave_layers__ssm_conv_h3__glu_gated_reglu__prompt_kernel
  .amdhsa_next_free_vgpr 512
  .amdhsa_next_free_sgpr 102
  .amdhsa_accum_offset 256
  .amdhsa_group_segment_fixed_size 0
  .amdhsa_kernarg_size 104
  .amdhsa_user_sgpr_count 2
  .amdhsa_user_sgpr_kernarg_segment_ptr 1
  .amdhsa_system_sgpr_workgroup_id_x 1
  .amdhsa_float_denorm_mode_32 3
.end_amdhsa_kernel
```
